```python
import torch

def _softmax(x, axis=-1):
    return torch.softmax(x, dim=axis)
def _gelu(x):
    return torch.nn.functional.gelu(x, approximate="tanh")
def _silu(x):
    return torch.nn.functional.silu(x)
def _sigmoid(x):
    return torch.sigmoid(x)
def _layernorm(x, axis=-1, eps=1e-5):
    m = x.mean(dim=axis, keepdim=True)
    v = x.var(dim=axis, keepdim=True, unbiased=False)
    return (x - m) / torch.sqrt(v + eps)
def _scatter_add(tgt, idx, src, axis=0):
    return tgt.clone().index_add_(axis, idx, src)
def _segment_sum(src, seg, n):
    out = torch.zeros((n,) + src.shape[1:], dtype=src.dtype)
    return out.index_add_(0, seg, src)
def _pad(x, pw):
    flat = tuple(v for pair in reversed(pw) for v in pair)
    return torch.nn.functional.pad(x, flat)

kernel_name = 'recurrent_scan__gqa_block_cached__glu_gated_swiglu__prompt'

def setup_inputs():

    _w = (lambda a: (lambda t: t.to(torch.bfloat16) if t.is_floating_point() else t)(torch.as_tensor(a)))
    def _A_setup():
        B, Sq, D = 1, 2048, 640
        Hq, Hkv, Sk, Dh = 32, 32, 2048, 128
        assert Hq % Hkv == 0, (Hq, Hkv)
        return {
            "x": _w((lambda *s: torch.randn(*s, dtype=torch.bfloat16) * 0.05)(B, Sq, D)),
            "k_cache": _w((lambda *s: torch.randn(*s, dtype=torch.bfloat16) * 1.6)(B, Hkv, Sk, Dh)),
            "v_cache": _w((lambda *s: torch.randn(*s, dtype=torch.bfloat16) * 1.6)(B, Hkv, Sk, Dh)),
            "wq": _w((lambda *s: torch.randn(*s, dtype=torch.bfloat16) * 1.6)(D, Hq * Dh) * (D ** -0.5)),
            "wo": _w((lambda *s: torch.randn(*s, dtype=torch.bfloat16) * 1.6)(Hq * Dh, D) * ((Hq * Dh) ** -0.5)),
        }
    _A_in = _A_setup()

    def _B_setup():
        B, S, D, F = 1, 2048, 640, 1728
        return {
            "x": _w((lambda *s: torch.randn(*s, dtype=torch.bfloat16) * 0.05)(B, S, D)),
            "w1": _w((lambda *s: torch.randn(*s, dtype=torch.bfloat16) * 0.2)(D, F) * (2.0 / D) ** 0.5),
            "w3": _w((lambda *s: torch.randn(*s, dtype=torch.bfloat16) * 0.2)(D, F) * (2.0 / D) ** 0.5),
            "w2": _w((lambda *s: torch.randn(*s, dtype=torch.bfloat16) * 0.2)(F, D) * (2.0 / F) ** 0.5),
        }
    _B_in = _B_setup()

    return {
        "A_x": _A_in["x"],
        "A_k_cache": _A_in["k_cache"],
        "A_v_cache": _A_in["v_cache"],
        "A_wq": _A_in["wq"],
        "A_wo": _A_in["wo"],
        "B_x": _B_in["x"],
        "B_w1": _B_in["w1"],
        "B_w3": _B_in["w3"],
        "B_w2": _B_in["w2"],
    }

def reference(A_x, A_k_cache, A_v_cache, A_wq, A_wo, B_x, B_w1, B_w3, B_w2):
    def _A_ref(x, k_cache, v_cache, wq, wo):
        B, Sq, D = x.shape
        Hq, Dh = 32, 128
        Hkv = k_cache.shape[1]
        rep = Hq // Hkv
        q = (lambda x, *d: x.permute(*d))((x @ wq).reshape(B, Sq, Hq, Dh), 0, 2, 1, 3)
        k = (lambda x, n, axis: torch.repeat_interleave(x, n, dim=axis))(k_cache, rep, axis=1)
        v = (lambda x, n, axis: torch.repeat_interleave(x, n, dim=axis))(v_cache, rep, axis=1)
        scores = torch.einsum("bhqd,bhkd->bhqk", q, k) * (Dh ** -0.5)
        p = _softmax(scores, axis=-1)
        o = torch.einsum("bhqk,bhkd->bhqd", p, v)
        return (lambda x, *d: x.permute(*d))(o, 0, 2, 1, 3).reshape(B, Sq, Hq * Dh) @ wo

    def _B_ref(x, w1, w3, w2):
        gate = torch.einsum("bsd,df->bsf", x, w1)
        up = torch.einsum("bsd,df->bsf", x, w3)
        h = _silu(gate) * up
        out = torch.einsum("bsf,fd->bsd", h, w2)
        return out

    x = A_x
    xn = _layernorm(x, axis=-1)
    s = _A_ref(xn, A_k_cache, A_v_cache, A_wq, A_wo)
    g = _silu(_B_ref(xn, B_w1, B_w3, B_w2))
    return x + s * g
```

```asm
; @launch grid=(256,1,1) block=(256,1,1) lds=163840
.amdgcn_target "amdgcn-amd-amdhsa--gfx950"
.text
.globl recurrent_scan__gqa_block_cached__glu_gated_swiglu__prompt_kernel
.p2align 8
.type recurrent_scan__gqa_block_cached__glu_gated_swiglu__prompt_kernel,@function
recurrent_scan__gqa_block_cached__glu_gated_swiglu__prompt_kernel:
    s_cmp_ge_u32 s2, 256
    s_cbranch_scc1 L_end
    s_load_dwordx2 s[52:53], s[0:1], 0
    s_load_dwordx2 s[8:9], s[0:1], 88
    s_load_dwordx4 s[4:7], s[0:1], 48
    s_getpc_b64 s[12:13]
L_pc:
    s_mov_b32 s14, L_codeend-L_pc
    s_mov_b32 s15, 0x20000
    s_bfe_u32 s3, s2, 0x40003
    s_lshl_b32 s3, s3, 13
    v_lshrrev_b32 v52, 6, v0
    v_and_b32 v53, 15, v0
    v_lshl_or_b32 v48, v52, 4, v53
    v_lshlrev_b32 v48, 7, v48
    v_bfe_u32 v49, v0, 4, 1
    v_mad_u32_u24 v48, v49, s3, v48
    v_bfe_u32 v49, v0, 5, 1
    v_lshl_or_b32 v48, v49, 30, v48
    buffer_load_dword v44, v48, s[12:15], 0 offen
    v_readfirstlane_b32 s32, v52
    v_lshrrev_b32 v50, 4, v0
    v_mul_u32_u24 v50, 1280, v50
    v_lshl_add_u32 v50, v53, 4, v50
    s_mul_i32 s72, s2, 10240
    s_mov_b32 s54, 2621440
    s_mov_b32 s55, 0x20000
    s_cmp_lt_u32 s32, 2
    s_waitcnt lgkmcnt(0)
    s_cbranch_scc0 L_nox0
    buffer_load_dwordx4 v[128:131], v50, s[52:55], s72 offen offset:0
    buffer_load_dwordx4 v[132:135], v50, s[52:55], s72 offen offset:256
    buffer_load_dwordx4 v[136:139], v50, s[52:55], s72 offen offset:512
    buffer_load_dwordx4 v[140:143], v50, s[52:55], s72 offen offset:768
    buffer_load_dwordx4 v[144:147], v50, s[52:55], s72 offen offset:1024
L_nox0:
    s_cselect_b32 s20, s4, s6
    s_cselect_b32 s21, s5, s7
    s_lshr_b32 s34, s2, 5
    s_lshl_b32 s42, s34, 7
    s_add_u32 s42, s42, 72351744
    s_load_dwordx2 s[38:39], s[8:9], s42
    s_load_dwordx2 s[16:17], s[0:1], 24
    s_load_dwordx2 s[24:25], s[0:1], 8
    s_load_dwordx2 s[28:29], s[0:1], 16
    s_load_dwordx2 s[60:61], s[0:1], 32
    s_load_dwordx2 s[68:69], s[0:1], 64
    s_load_dwordx2 s[56:57], s[0:1], 72
    v_and_b32 v0, 63, v0
    v_lshrrev_b32 v52, 4, v0
    s_and_b32 s33, s2, 31
    s_lshl_b32 s50, s32, 13
    v_lshrrev_b32 v54, 3, v0
    v_and_b32 v55, 7, v0
    v_and_b32 v48, 1, v52
    v_lshlrev_b32 v48, 1, v48
    v_xor_b32 v48, v48, v55
    v_mul_u32_u24 v49, 3456, v54
    v_lshl_add_u32 v20, v48, 4, v49
    v_xor_b32 v48, 64, v20
    v_add_u32 v21, 26624, v48
    v_add_u32 v22, 53248, v20
    v_add_u32 v23, 79872, v48
    s_and_b32 s3, s32, 1
    s_mul_i32 s3, s3, 221184
    s_lshl_b32 s48, s33, 7
    s_add_u32 s48, s3, s48
    s_cmp_lt_u32 s33, 27
    s_cselect_b32 s22, 2211840, 0
    s_mov_b32 s23, 0x20000
    s_cmp_lt_u32 s32, 2
    s_cbranch_scc1 L_x
    s_mov_b32 s6, s22
    s_mov_b32 s7, 0x20000
    s_mov_b32 s3, s48
    s_add_u32 m0, s50, -16384
    s_nop 0
    buffer_load_dwordx4 v20, s[4:7], s3 offen offset:0 nt lds
    buffer_load_dwordx4 v21, s[4:7], s3 offen offset:1024 nt lds
    buffer_load_dwordx4 v22, s[4:7], s3 offen offset:2048 nt lds
    buffer_load_dwordx4 v23, s[4:7], s3 offen offset:3072 nt lds
    s_add_u32 s3, s3, 110592
    s_add_u32 m0, s50, -12288
    s_nop 0
    buffer_load_dwordx4 v20, s[4:7], s3 offen offset:0 nt lds
    buffer_load_dwordx4 v21, s[4:7], s3 offen offset:1024 nt lds
    buffer_load_dwordx4 v22, s[4:7], s3 offen offset:2048 nt lds
    buffer_load_dwordx4 v23, s[4:7], s3 offen offset:3072 nt lds
    s_add_u32 s3, s3, 331776
    s_add_u32 m0, s50, 0
    s_nop 0
    buffer_load_dwordx4 v20, s[20:23], s48 offen offset:0 nt lds
    buffer_load_dwordx4 v21, s[20:23], s48 offen offset:1024 nt lds
    buffer_load_dwordx4 v22, s[20:23], s48 offen offset:2048 nt lds
    buffer_load_dwordx4 v23, s[20:23], s48 offen offset:3072 nt lds
    s_add_u32 s48, s48, 110592
    s_add_u32 m0, s50, 4096
    s_nop 0
    buffer_load_dwordx4 v20, s[20:23], s48 offen offset:0 nt lds
    buffer_load_dwordx4 v21, s[20:23], s48 offen offset:1024 nt lds
    buffer_load_dwordx4 v22, s[20:23], s48 offen offset:2048 nt lds
    buffer_load_dwordx4 v23, s[20:23], s48 offen offset:3072 nt lds
    s_add_u32 s48, s48, 331776
L_x:
    v_lshlrev_b32 v48, 1, v52
    v_xor_b32 v48, v48, v53
    v_lshlrev_b32 v49, 13, v52
    v_lshl_add_u32 v24, v48, 4, v49
    v_xor_b32 v48, 128, v24
    v_add_u32 v25, 31744, v24
    v_add_u32 v26, 63488, v48
    v_add_u32 v27, 95232, v48
    s_lshl_b32 s3, s32, 18
    s_lshl_b32 s49, s33, 8
    s_add_u32 s49, s3, s49
    s_mov_b32 s18, 5242880
    s_mov_b32 s19, 0x20000
    s_mov_b32 s10, 75497472
    s_mov_b32 s11, 0x20000
    v_lshlrev_b32 v1, 4, v0
    s_lshl_b32 s3, s2, 2
    s_add_u32 s3, s3, s32
    s_lshl_b32 s3, s3, 7
    s_add_u32 s51, s3, 71303168
    v_min_u32 v48, 1, v52
    v_lshlrev_b32 v48, 30, v48
    v_bfe_u32 v54, v0, 2, 2
    v_lshl_add_u32 v57, v53, 3, v48
    v_and_b32 v55, 3, v0
    v_lshlrev_b32 v48, 8, v54
    v_lshl_add_u32 v48, v52, 6, v48
    v_lshl_add_u32 v112, v55, 4, v48
    s_lshl_b32 s7, s34, 2
    s_add_u32 s7, s7, s32
    s_mul_i32 s44, s7, 81920
    s_add_u32 s45, s44, 20480
    s_add_u32 s46, s44, 40960
    s_add_u32 s47, s44, 61440
    v_lshl_add_u32 v47, v52, 3, v54
    v_lshlrev_b32 v49, 7, v47
    v_lshl_add_u32 v49, v55, 3, v49
    v_bfe_u32 v48, v0, 3, 2
    v_lshl_add_u32 v28, v48, 5, v49
    v_xor_b32 v29, 32, v28
    v_xor_b32 v30, 64, v28
    v_xor_b32 v31, 96, v28
    v_bfe_u32 v48, v0, 2, 3
    v_lshlrev_b32 v48, 1, v48
    v_xor_b32 v48, v48, v55
    v_lshlrev_b32 v49, 8, v47
    v_lshl_add_u32 v49, v48, 4, v49
    v_add_u32 v32, 65536, v49
    v_xor_b32 v33, 64, v32
    v_xor_b32 v34, 128, v32
    v_xor_b32 v35, 192, v32
    v_and_b32 v48, 7, v0
    v_lshlrev_b32 v113, 9, v48
    s_lshl_b32 s3, s7, 12
    s_add_u32 s82, s3, 71303168
    s_cmp_lt_u32 s32, 2
    s_cbranch_scc0 L_noln
    v_lshlrev_b32 v51, 10, v54
    v_lshl_add_u32 v51, v55, 6, v51
    v_lshl_add_u32 v51, v52, 4, v51
    s_lshr_b32 s3, s2, 1
    s_mul_i32 s3, s3, 20480
    s_and_b32 s4, s2, 1
    s_lshl_b32 s4, s4, 1
    s_add_u32 s4, s4, s32
    s_lshl_b32 s4, s4, 8
    s_add_u32 s3, s3, s4
    s_waitcnt vmcnt(4)
    v_lshlrev_b32 v160, 16, v128
    v_and_b32 v161, 0xffff0000, v128
    v_lshlrev_b32 v162, 16, v129
    v_and_b32 v163, 0xffff0000, v129
    v_lshlrev_b32 v164, 16, v130
    v_and_b32 v165, 0xffff0000, v130
    v_lshlrev_b32 v166, 16, v131
    v_and_b32 v167, 0xffff0000, v131
    s_waitcnt vmcnt(3)
    v_lshlrev_b32 v168, 16, v132
    v_and_b32 v169, 0xffff0000, v132
    v_lshlrev_b32 v170, 16, v133
    v_and_b32 v171, 0xffff0000, v133
    v_lshlrev_b32 v172, 16, v134
    v_and_b32 v173, 0xffff0000, v134
    v_lshlrev_b32 v174, 16, v135
    v_and_b32 v175, 0xffff0000, v135
    s_waitcnt vmcnt(2)
    v_lshlrev_b32 v176, 16, v136
    v_and_b32 v177, 0xffff0000, v136
    v_lshlrev_b32 v178, 16, v137
    v_and_b32 v179, 0xffff0000, v137
    v_lshlrev_b32 v180, 16, v138
    v_and_b32 v181, 0xffff0000, v138
    v_lshlrev_b32 v182, 16, v139
    v_and_b32 v183, 0xffff0000, v139
    s_waitcnt vmcnt(1)
    v_lshlrev_b32 v184, 16, v140
    v_and_b32 v185, 0xffff0000, v140
    v_lshlrev_b32 v186, 16, v141
    v_and_b32 v187, 0xffff0000, v141
    v_lshlrev_b32 v188, 16, v142
    v_and_b32 v189, 0xffff0000, v142
    v_lshlrev_b32 v190, 16, v143
    v_and_b32 v191, 0xffff0000, v143
    s_waitcnt vmcnt(0)
    v_lshlrev_b32 v192, 16, v144
    v_and_b32 v193, 0xffff0000, v144
    v_lshlrev_b32 v194, 16, v145
    v_and_b32 v195, 0xffff0000, v145
    v_lshlrev_b32 v196, 16, v146
    v_and_b32 v197, 0xffff0000, v146
    v_lshlrev_b32 v198, 16, v147
    v_and_b32 v199, 0xffff0000, v147
    v_pk_add_f32 v[36:37], v[160:161], v[162:163]
    v_pk_add_f32 v[36:37], v[36:37], v[164:165]
    v_pk_add_f32 v[36:37], v[36:37], v[166:167]
    v_pk_add_f32 v[36:37], v[36:37], v[168:169]
    v_pk_add_f32 v[36:37], v[36:37], v[170:171]
    v_pk_add_f32 v[36:37], v[36:37], v[172:173]
    v_pk_add_f32 v[36:37], v[36:37], v[174:175]
    v_pk_add_f32 v[36:37], v[36:37], v[176:177]
    v_pk_add_f32 v[36:37], v[36:37], v[178:179]
    v_pk_add_f32 v[36:37], v[36:37], v[180:181]
    v_pk_add_f32 v[36:37], v[36:37], v[182:183]
    v_pk_add_f32 v[36:37], v[36:37], v[184:185]
    v_pk_add_f32 v[36:37], v[36:37], v[186:187]
    v_pk_add_f32 v[36:37], v[36:37], v[188:189]
    v_pk_add_f32 v[36:37], v[36:37], v[190:191]
    v_pk_add_f32 v[36:37], v[36:37], v[192:193]
    v_pk_add_f32 v[36:37], v[36:37], v[194:195]
    v_pk_add_f32 v[36:37], v[36:37], v[196:197]
    v_pk_add_f32 v[36:37], v[36:37], v[198:199]
    v_add_f32 v36, v36, v37
    s_nop 1
    v_add_f32_dpp v36, v36, v36 row_ror:8 row_mask:0xf bank_mask:0xf
    s_nop 1
    v_add_f32_dpp v36, v36, v36 row_ror:4 row_mask:0xf bank_mask:0xf
    s_nop 1
    v_add_f32_dpp v36, v36, v36 row_ror:2 row_mask:0xf bank_mask:0xf
    s_nop 1
    v_add_f32_dpp v36, v36, v36 row_ror:1 row_mask:0xf bank_mask:0xf
    v_mul_f32 v36, 0xbacccccd, v36
    v_pk_add_f32 v[160:161], v[160:161], v[36:37] op_sel_hi:[1,0]
    v_pk_add_f32 v[162:163], v[162:163], v[36:37] op_sel_hi:[1,0]
    v_pk_add_f32 v[164:165], v[164:165], v[36:37] op_sel_hi:[1,0]
    v_pk_add_f32 v[166:167], v[166:167], v[36:37] op_sel_hi:[1,0]
    v_pk_add_f32 v[168:169], v[168:169], v[36:37] op_sel_hi:[1,0]
    v_pk_add_f32 v[170:171], v[170:171], v[36:37] op_sel_hi:[1,0]
    v_pk_add_f32 v[172:173], v[172:173], v[36:37] op_sel_hi:[1,0]
    v_pk_add_f32 v[174:175], v[174:175], v[36:37] op_sel_hi:[1,0]
    v_pk_add_f32 v[176:177], v[176:177], v[36:37] op_sel_hi:[1,0]
    v_pk_add_f32 v[178:179], v[178:179], v[36:37] op_sel_hi:[1,0]
    v_pk_add_f32 v[180:181], v[180:181], v[36:37] op_sel_hi:[1,0]
    v_pk_add_f32 v[182:183], v[182:183], v[36:37] op_sel_hi:[1,0]
    v_pk_add_f32 v[184:185], v[184:185], v[36:37] op_sel_hi:[1,0]
    v_pk_add_f32 v[186:187], v[186:187], v[36:37] op_sel_hi:[1,0]
    v_pk_add_f32 v[188:189], v[188:189], v[36:37] op_sel_hi:[1,0]
    v_pk_add_f32 v[190:191], v[190:191], v[36:37] op_sel_hi:[1,0]
    v_pk_add_f32 v[192:193], v[192:193], v[36:37] op_sel_hi:[1,0]
    v_pk_add_f32 v[194:195], v[194:195], v[36:37] op_sel_hi:[1,0]
    v_pk_add_f32 v[196:197], v[196:197], v[36:37] op_sel_hi:[1,0]
    v_pk_add_f32 v[198:199], v[198:199], v[36:37] op_sel_hi:[1,0]
    v_pk_mul_f32 v[38:39], v[160:161], v[160:161]
    v_pk_fma_f32 v[38:39], v[162:163], v[162:163], v[38:39]
    v_pk_fma_f32 v[38:39], v[164:165], v[164:165], v[38:39]
    v_pk_fma_f32 v[38:39], v[166:167], v[166:167], v[38:39]
    v_pk_fma_f32 v[38:39], v[168:169], v[168:169], v[38:39]
    v_pk_fma_f32 v[38:39], v[170:171], v[170:171], v[38:39]
    v_pk_fma_f32 v[38:39], v[172:173], v[172:173], v[38:39]
    v_pk_fma_f32 v[38:39], v[174:175], v[174:175], v[38:39]
    v_pk_fma_f32 v[38:39], v[176:177], v[176:177], v[38:39]
    v_pk_fma_f32 v[38:39], v[178:179], v[178:179], v[38:39]
    v_pk_fma_f32 v[38:39], v[180:181], v[180:181], v[38:39]
    v_pk_fma_f32 v[38:39], v[182:183], v[182:183], v[38:39]
    v_pk_fma_f32 v[38:39], v[184:185], v[184:185], v[38:39]
    v_pk_fma_f32 v[38:39], v[186:187], v[186:187], v[38:39]
    v_pk_fma_f32 v[38:39], v[188:189], v[188:189], v[38:39]
    v_pk_fma_f32 v[38:39], v[190:191], v[190:191], v[38:39]
    v_pk_fma_f32 v[38:39], v[192:193], v[192:193], v[38:39]
    v_pk_fma_f32 v[38:39], v[194:195], v[194:195], v[38:39]
    v_pk_fma_f32 v[38:39], v[196:197], v[196:197], v[38:39]
    v_pk_fma_f32 v[38:39], v[198:199], v[198:199], v[38:39]
    v_add_f32 v38, v38, v39
    s_nop 1
    v_add_f32_dpp v38, v38, v38 row_ror:8 row_mask:0xf bank_mask:0xf
    s_nop 1
    v_add_f32_dpp v38, v38, v38 row_ror:4 row_mask:0xf bank_mask:0xf
    s_nop 1
    v_add_f32_dpp v38, v38, v38 row_ror:2 row_mask:0xf bank_mask:0xf
    s_nop 1
    v_add_f32_dpp v38, v38, v38 row_ror:1 row_mask:0xf bank_mask:0xf
    v_mul_f32 v38, 0x3acccccd, v38
    v_add_f32 v38, 0x3727c5ac, v38
    v_rsq_f32 v38, v38
    s_nop 0
    v_mul_f32 v38, 0x3e0293ee, v38
    v_pk_mul_f32 v[160:161], v[160:161], v[38:39] op_sel_hi:[1,0]
    v_pk_mul_f32 v[162:163], v[162:163], v[38:39] op_sel_hi:[1,0]
    v_pk_mul_f32 v[164:165], v[164:165], v[38:39] op_sel_hi:[1,0]
    v_pk_mul_f32 v[166:167], v[166:167], v[38:39] op_sel_hi:[1,0]
    v_cvt_pk_bf16_f32 v128, v160, v161
    v_cvt_pk_bf16_f32 v129, v162, v163
    v_cvt_pk_bf16_f32 v130, v164, v165
    v_cvt_pk_bf16_f32 v131, v166, v167
    buffer_store_dwordx4 v[128:131], v51, s[8:11], s3 offen sc1
    s_add_u32 s3, s3, 4096
    v_pk_mul_f32 v[168:169], v[168:169], v[38:39] op_sel_hi:[1,0]
    v_pk_mul_f32 v[170:171], v[170:171], v[38:39] op_sel_hi:[1,0]
    v_pk_mul_f32 v[172:173], v[172:173], v[38:39] op_sel_hi:[1,0]
    v_pk_mul_f32 v[174:175], v[174:175], v[38:39] op_sel_hi:[1,0]
    v_cvt_pk_bf16_f32 v132, v168, v169
    v_cvt_pk_bf16_f32 v133, v170, v171
    v_cvt_pk_bf16_f32 v134, v172, v173
    v_cvt_pk_bf16_f32 v135, v174, v175
    buffer_store_dwordx4 v[132:135], v51, s[8:11], s3 offen sc1
    s_add_u32 s3, s3, 4096
    v_pk_mul_f32 v[176:177], v[176:177], v[38:39] op_sel_hi:[1,0]
    v_pk_mul_f32 v[178:179], v[178:179], v[38:39] op_sel_hi:[1,0]
    v_pk_mul_f32 v[180:181], v[180:181], v[38:39] op_sel_hi:[1,0]
    v_pk_mul_f32 v[182:183], v[182:183], v[38:39] op_sel_hi:[1,0]
    v_cvt_pk_bf16_f32 v136, v176, v177
    v_cvt_pk_bf16_f32 v137, v178, v179
    v_cvt_pk_bf16_f32 v138, v180, v181
    v_cvt_pk_bf16_f32 v139, v182, v183
    buffer_store_dwordx4 v[136:139], v51, s[8:11], s3 offen sc1
    s_add_u32 s3, s3, 4096
    v_pk_mul_f32 v[184:185], v[184:185], v[38:39] op_sel_hi:[1,0]
    v_pk_mul_f32 v[186:187], v[186:187], v[38:39] op_sel_hi:[1,0]
    v_pk_mul_f32 v[188:189], v[188:189], v[38:39] op_sel_hi:[1,0]
    v_pk_mul_f32 v[190:191], v[190:191], v[38:39] op_sel_hi:[1,0]
    v_cvt_pk_bf16_f32 v140, v184, v185
    v_cvt_pk_bf16_f32 v141, v186, v187
    v_cvt_pk_bf16_f32 v142, v188, v189
    v_cvt_pk_bf16_f32 v143, v190, v191
    buffer_store_dwordx4 v[140:143], v51, s[8:11], s3 offen sc1
    s_add_u32 s3, s3, 4096
    v_pk_mul_f32 v[192:193], v[192:193], v[38:39] op_sel_hi:[1,0]
    v_pk_mul_f32 v[194:195], v[194:195], v[38:39] op_sel_hi:[1,0]
    v_pk_mul_f32 v[196:197], v[196:197], v[38:39] op_sel_hi:[1,0]
    v_pk_mul_f32 v[198:199], v[198:199], v[38:39] op_sel_hi:[1,0]
    v_cvt_pk_bf16_f32 v144, v192, v193
    v_cvt_pk_bf16_f32 v145, v194, v195
    v_cvt_pk_bf16_f32 v146, v196, v197
    v_cvt_pk_bf16_f32 v147, v198, v199
    buffer_store_dwordx4 v[144:147], v51, s[8:11], s3 offen sc1
    s_add_u32 s3, s3, 4096
    s_add_u32 s48, s48, 442368
L_noln:
    s_waitcnt lgkmcnt(0)
    s_add_u32 s38, s38, 1
    s_addc_u32 s39, s39, 0
    v_mov_b32 v58, s38
    v_mov_b32 v59, s39
    s_cmp_lg_u32 s32, 0
    s_waitcnt vmcnt(0)
    s_barrier
    s_cbranch_scc1 L_nofl
    s_add_u32 s72, s51, 0
    buffer_store_dwordx2 v[58:59], v57, s[8:11], s72 offen sc1
L_nofl:
    buffer_load_dwordx2 v[114:115], v113, s[8:11], s82 offen sc1
    ds_read_b64_tr_b16 v[64:65], v28 offset:0
    ds_read_b64_tr_b16 v[66:67], v28 offset:512
    ds_read_b64_tr_b16 v[68:69], v28 offset:4096
    ds_read_b64_tr_b16 v[70:71], v28 offset:4608
    ds_read_b64_tr_b16 v[72:73], v28 offset:8192
    ds_read_b64_tr_b16 v[74:75], v28 offset:8704
    ds_read_b64_tr_b16 v[76:77], v28 offset:12288
    ds_read_b64_tr_b16 v[78:79], v28 offset:12800
    s_waitcnt vmcnt(0)
    v_cmp_ne_u64 vcc, s[38:39], v[114:115]
    s_mov_b32 s42, 0
    s_cbranch_vccz Lpok0
Lspin0:
    buffer_load_dwordx2 v[114:115], v113, s[8:11], s82 offen sc1
    s_add_u32 s42, s42, 1
    s_waitcnt vmcnt(0)
    v_cmp_ne_u64 vcc, s[38:39], v[114:115]
    s_cmp_ge_u32 s42, 0x100000
    s_cbranch_scc1 Lpok0
    s_cbranch_vccnz Lspin0
Lpok0:
    buffer_load_dwordx4 a[128:131], v112, s[8:11], s44 offen offset:0 sc1
    buffer_load_dwordx4 a[132:135], v112, s[8:11], s44 offen offset:1024 sc1
    buffer_load_dwordx4 a[136:139], v112, s[8:11], s44 offen offset:2048 sc1
    buffer_load_dwordx4 a[140:143], v112, s[8:11], s44 offen offset:3072 sc1
    s_add_u32 s44, s44, 4096
    buffer_load_dwordx4 a[144:147], v112, s[8:11], s45 offen offset:0 sc1
    buffer_load_dwordx4 a[148:151], v112, s[8:11], s45 offen offset:1024 sc1
    buffer_load_dwordx4 a[152:155], v112, s[8:11], s45 offen offset:2048 sc1
    buffer_load_dwordx4 a[156:159], v112, s[8:11], s45 offen offset:3072 sc1
    s_add_u32 s45, s45, 4096
    buffer_load_dwordx4 a[160:163], v112, s[8:11], s46 offen offset:0 sc1
    buffer_load_dwordx4 a[164:167], v112, s[8:11], s46 offen offset:1024 sc1
    buffer_load_dwordx4 a[168:171], v112, s[8:11], s46 offen offset:2048 sc1
    buffer_load_dwordx4 a[172:175], v112, s[8:11], s46 offen offset:3072 sc1
    s_add_u32 s46, s46, 4096
    buffer_load_dwordx4 a[176:179], v112, s[8:11], s47 offen offset:0 sc1
    buffer_load_dwordx4 a[180:183], v112, s[8:11], s47 offen offset:1024 sc1
    buffer_load_dwordx4 a[184:187], v112, s[8:11], s47 offen offset:2048 sc1
    buffer_load_dwordx4 a[188:191], v112, s[8:11], s47 offen offset:3072 sc1
    s_add_u32 s47, s47, 4096
    s_waitcnt vmcnt(12) lgkmcnt(0)
    v_mfma_f32_16x16x32_bf16 v[128:131], v[64:67], a[128:131], 0
    ds_read_b64_tr_b16 v[80:81], v28 offset:16384
    v_mfma_f32_16x16x32_bf16 v[128:131], v[68:71], a[132:135], v[128:131]
    ds_read_b64_tr_b16 v[82:83], v28 offset:16896
    v_mfma_f32_16x16x32_bf16 v[128:131], v[72:75], a[136:139], v[128:131]
    ds_read_b64_tr_b16 v[84:85], v28 offset:20480
    v_mfma_f32_16x16x32_bf16 v[128:131], v[76:79], a[140:143], v[128:131]
    ds_read_b64_tr_b16 v[86:87], v28 offset:20992
    s_waitcnt vmcnt(8)
    v_mfma_f32_16x16x32_bf16 v[132:135], v[76:79], a[156:159], 0
    ds_read_b64_tr_b16 v[88:89], v28 offset:24576
    v_mfma_f32_16x16x32_bf16 v[132:135], v[72:75], a[152:155], v[132:135]
    ds_read_b64_tr_b16 v[90:91], v28 offset:25088
    v_mfma_f32_16x16x32_bf16 v[132:135], v[68:71], a[148:151], v[132:135]
    ds_read_b64_tr_b16 v[92:93], v28 offset:28672
    v_mfma_f32_16x16x32_bf16 v[132:135], v[64:67], a[144:147], v[132:135]
    ds_read_b64_tr_b16 v[94:95], v28 offset:29184
    s_waitcnt vmcnt(4)
    v_mfma_f32_16x16x32_bf16 v[136:139], v[64:67], a[160:163], 0
    v_mfma_f32_16x16x32_bf16 v[136:139], v[68:71], a[164:167], v[136:139]
    v_mfma_f32_16x16x32_bf16 v[136:139], v[72:75], a[168:171], v[136:139]
    v_mfma_f32_16x16x32_bf16 v[136:139], v[76:79], a[172:175], v[136:139]
    s_waitcnt vmcnt(0)
    v_mfma_f32_16x16x32_bf16 v[140:143], v[76:79], a[188:191], 0
    v_mfma_f32_16x16x32_bf16 v[140:143], v[72:75], a[184:187], v[140:143]
    v_mfma_f32_16x16x32_bf16 v[140:143], v[68:71], a[180:183], v[140:143]
    v_mfma_f32_16x16x32_bf16 v[140:143], v[64:67], a[176:179], v[140:143]
    s_waitcnt lgkmcnt(0)
    v_mfma_f32_16x16x32_bf16 v[204:207], v[80:83], a[176:179], 0
    ds_read_b64_tr_b16 v[64:65], v29 offset:0
    s_and_b32 s35, s2, 3
    v_mfma_f32_16x16x32_bf16 v[204:207], v[84:87], a[180:183], v[204:207]
    ds_read_b64_tr_b16 v[66:67], v29 offset:512
    s_add_u32 m0, s50, 98304
    v_mfma_f32_16x16x32_bf16 v[204:207], v[88:91], a[184:187], v[204:207]
    buffer_load_dwordx4 v24, s[16:19], s49 offen offset:0 nt lds
    ds_read_b64_tr_b16 v[68:69], v29 offset:4096
    v_mfma_f32_16x16x32_bf16 v[204:207], v[92:95], a[188:191], v[204:207]
    ds_read_b64_tr_b16 v[70:71], v29 offset:4608
    s_lshr_b32 s43, s33, 3
    v_mfma_f32_16x16x32_bf16 v[200:203], v[92:95], a[172:175], 0
    ds_read_b64_tr_b16 v[72:73], v29 offset:8192
    s_lshl_b32 s84, s33, 19
    v_mfma_f32_16x16x32_bf16 v[200:203], v[88:91], a[168:171], v[200:203]
    ds_read_b64_tr_b16 v[74:75], v29 offset:8704
    s_add_u32 s24, s24, s84
    s_addc_u32 s25, s25, 0
    v_mfma_f32_16x16x32_bf16 v[200:203], v[84:87], a[164:167], v[200:203]
    buffer_load_dwordx4 v25, s[16:19], s49 offen offset:1024 nt lds
    ds_read_b64_tr_b16 v[76:77], v29 offset:12288
    v_mfma_f32_16x16x32_bf16 v[200:203], v[80:83], a[160:163], v[200:203]
    ds_read_b64_tr_b16 v[78:79], v29 offset:12800
    s_mov_b32 s26, 524288
    v_mfma_f32_16x16x32_bf16 v[196:199], v[80:83], a[144:147], 0
    s_mov_b32 s27, 0x20000
    s_add_u32 s28, s28, s84
    s_addc_u32 s29, s29, 0
    v_mfma_f32_16x16x32_bf16 v[196:199], v[84:87], a[148:151], v[196:199]
    s_mov_b32 s30, 524288
    s_mov_b32 s31, 0x20000
    v_mfma_f32_16x16x32_bf16 v[196:199], v[88:91], a[152:155], v[196:199]
    buffer_load_dwordx4 v26, s[16:19], s49 offen offset:2048 nt lds
    s_mov_b32 s36, s50
    v_mfma_f32_16x16x32_bf16 v[196:199], v[92:95], a[156:159], v[196:199]
    s_mov_b32 s37, s50
    s_mov_b32 s41, 0
    v_mfma_f32_16x16x32_bf16 v[192:195], v[92:95], a[140:143], 0
    s_mov_b32 s12, s8
    s_mov_b32 s13, s9
    v_mfma_f32_16x16x32_bf16 v[192:195], v[88:91], a[136:139], v[192:195]
    s_cmp_lt_u32 s33, 27
    s_cselect_b32 s14, 75497472, 0
    v_mfma_f32_16x16x32_bf16 v[192:195], v[84:87], a[132:135], v[192:195]
    buffer_load_dwordx4 v27, s[16:19], s49 offen offset:3072 nt lds
    s_add_u32 s49, s49, 131072
    v_mfma_f32_16x16x32_bf16 v[192:195], v[80:83], a[128:131], v[192:195]
    s_waitcnt lgkmcnt(0)
    v_mfma_f32_16x16x32_bf16 v[144:147], v[64:67], a[128:131], 0
    ds_read_b64_tr_b16 v[80:81], v29 offset:16384
    s_mov_b32 s58, 2621440
    v_mfma_f32_16x16x32_bf16 v[144:147], v[68:71], a[132:135], v[144:147]
    ds_read_b64_tr_b16 v[82:83], v29 offset:16896
    s_add_u32 m0, s50, 102400
    v_mfma_f32_16x16x32_bf16 v[144:147], v[72:75], a[136:139], v[144:147]
    buffer_load_dwordx4 v24, s[16:19], s49 offen offset:0 nt lds
    ds_read_b64_tr_b16 v[84:85], v29 offset:20480
    v_mfma_f32_16x16x32_bf16 v[144:147], v[76:79], a[140:143], v[144:147]
    ds_read_b64_tr_b16 v[86:87], v29 offset:20992
    s_mov_b32 s59, 0x20000
    v_mfma_f32_16x16x32_bf16 v[148:151], v[76:79], a[156:159], 0
    ds_read_b64_tr_b16 v[88:89], v29 offset:24576
    s_lshl_b32 s84, s7, 11
    v_mfma_f32_16x16x32_bf16 v[148:151], v[72:75], a[152:155], v[148:151]
    ds_read_b64_tr_b16 v[90:91], v29 offset:25088
    v_min_u32 v48, 1, v52
    v_mfma_f32_16x16x32_bf16 v[148:151], v[68:71], a[148:151], v[148:151]
    buffer_load_dwordx4 v25, s[16:19], s49 offen offset:1024 nt lds
    ds_read_b64_tr_b16 v[92:93], v29 offset:28672
    v_mfma_f32_16x16x32_bf16 v[148:151], v[64:67], a[144:147], v[148:151]
    ds_read_b64_tr_b16 v[94:95], v29 offset:29184
    v_lshlrev_b32 v48, 30, v48
    v_mfma_f32_16x16x32_bf16 v[152:155], v[64:67], a[160:163], 0
    v_lshl_add_u32 v48, v53, 7, v48
    v_add_u32 v54, s84, v48
    v_mfma_f32_16x16x32_bf16 v[152:155], v[68:71], a[164:167], v[152:155]
    v_xor_b32 v48, v52, v53
    v_lshlrev_b32 v49, 8, v52
    v_mfma_f32_16x16x32_bf16 v[152:155], v[72:75], a[168:171], v[152:155]
    buffer_load_dwordx4 v26, s[16:19], s49 offen offset:2048 nt lds
    v_lshl_add_u32 v2, v48, 4, v49
    v_mfma_f32_16x16x32_bf16 v[152:155], v[76:79], a[172:175], v[152:155]
    v_xor_b32 v3, 64, v2
    v_xor_b32 v4, 128, v2
    v_mfma_f32_16x16x32_bf16 v[156:159], v[76:79], a[188:191], 0
    v_xor_b32 v5, 192, v2
    v_lshlrev_b32 v47, 1, v52
    v_mfma_f32_16x16x32_bf16 v[156:159], v[72:75], a[184:187], v[156:159]
    v_xor_b32 v47, v47, v53
    v_lshl_add_u32 v6, v47, 4, v49
    v_mfma_f32_16x16x32_bf16 v[156:159], v[68:71], a[180:183], v[156:159]
    buffer_load_dwordx4 v27, s[16:19], s49 offen offset:3072 nt lds
    s_add_u32 s49, s49, 917504
    v_mfma_f32_16x16x32_bf16 v[156:159], v[64:67], a[176:179], v[156:159]
    s_waitcnt lgkmcnt(0)
    v_mfma_f32_16x16x32_bf16 v[220:223], v[80:83], a[176:179], 0
    ds_read_b64_tr_b16 v[64:65], v30 offset:0
    v_xor_b32 v7, 128, v6
    v_mfma_f32_16x16x32_bf16 v[220:223], v[84:87], a[180:183], v[220:223]
    ds_read_b64_tr_b16 v[66:67], v30 offset:512
    s_add_u32 m0, s50, 32768
    v_mfma_f32_16x16x32_bf16 v[220:223], v[88:91], a[184:187], v[220:223]
    buffer_load_dwordx4 v20, s[20:23], s48 offen offset:0 nt lds
    ds_read_b64_tr_b16 v[68:69], v30 offset:4096
    v_mfma_f32_16x16x32_bf16 v[220:223], v[92:95], a[188:191], v[220:223]
    ds_read_b64_tr_b16 v[70:71], v30 offset:4608
    v_lshlrev_b32 v49, 8, v53
    v_mfma_f32_16x16x32_bf16 v[216:219], v[92:95], a[172:175], 0
    ds_read_b64_tr_b16 v[72:73], v30 offset:8192
    v_lshl_add_u32 v49, v48, 4, v49
    v_mfma_f32_16x16x32_bf16 v[216:219], v[88:91], a[168:171], v[216:219]
    ds_read_b64_tr_b16 v[74:75], v30 offset:8704
    v_add_u32 v8, 32768, v49
    v_mfma_f32_16x16x32_bf16 v[216:219], v[84:87], a[164:167], v[216:219]
    buffer_load_dwordx4 v21, s[20:23], s48 offen offset:1024 nt lds
    ds_read_b64_tr_b16 v[76:77], v30 offset:12288
    v_mfma_f32_16x16x32_bf16 v[216:219], v[80:83], a[160:163], v[216:219]
    ds_read_b64_tr_b16 v[78:79], v30 offset:12800
    v_xor_b32 v9, 64, v8
    v_mfma_f32_16x16x32_bf16 v[212:215], v[80:83], a[144:147], 0
    v_xor_b32 v10, 128, v8
    v_xor_b32 v11, 192, v8
    v_mfma_f32_16x16x32_bf16 v[212:215], v[84:87], a[148:151], v[212:215]
    v_lshrrev_b32 v46, 2, v0
    v_lshlrev_b32 v49, 8, v46
    v_mfma_f32_16x16x32_bf16 v[212:215], v[88:91], a[152:155], v[212:215]
    buffer_load_dwordx4 v22, s[20:23], s48 offen offset:2048 nt lds
    v_and_b32 v48, 7, v46
    v_mfma_f32_16x16x32_bf16 v[212:215], v[92:95], a[156:159], v[212:215]
    v_lshl_add_u32 v49, v48, 5, v49
    v_lshl_add_u32 v49, v55, 3, v49
    v_mfma_f32_16x16x32_bf16 v[208:211], v[92:95], a[140:143], 0
    v_add_u32 v12, 98304, v49
    v_xor_b32 v13, 32, v12
    v_mfma_f32_16x16x32_bf16 v[208:211], v[88:91], a[136:139], v[208:211]
    v_xor_b32 v14, 64, v12
    v_xor_b32 v15, 96, v12
    v_mfma_f32_16x16x32_bf16 v[208:211], v[84:87], a[132:135], v[208:211]
    buffer_load_dwordx4 v23, s[20:23], s48 offen offset:3072 nt lds
    s_add_u32 s48, s48, 110592
    v_mfma_f32_16x16x32_bf16 v[208:211], v[80:83], a[128:131], v[208:211]
    s_waitcnt lgkmcnt(0)
    v_mfma_f32_16x16x32_bf16 v[160:163], v[64:67], a[128:131], 0
    ds_read_b64_tr_b16 v[80:81], v30 offset:16384
    v_xor_b32 v16, 128, v12
    v_mfma_f32_16x16x32_bf16 v[160:163], v[68:71], a[132:135], v[160:163]
    ds_read_b64_tr_b16 v[82:83], v30 offset:16896
    v_xor_b32 v17, 160, v12
    v_mfma_f32_16x16x32_bf16 v[160:163], v[72:75], a[136:139], v[160:163]
    ds_read_b64_tr_b16 v[84:85], v30 offset:20480
    v_xor_b32 v18, 192, v12
    v_mfma_f32_16x16x32_bf16 v[160:163], v[76:79], a[140:143], v[160:163]
    ds_read_b64_tr_b16 v[86:87], v30 offset:20992
    s_add_u32 m0, s50, 36864
    v_mfma_f32_16x16x32_bf16 v[164:167], v[76:79], a[156:159], 0
    buffer_load_dwordx4 v20, s[20:23], s48 offen offset:0 nt lds
    ds_read_b64_tr_b16 v[88:89], v30 offset:24576
    v_mfma_f32_16x16x32_bf16 v[164:167], v[72:75], a[152:155], v[164:167]
    ds_read_b64_tr_b16 v[90:91], v30 offset:25088
    v_xor_b32 v19, 224, v12
    v_mfma_f32_16x16x32_bf16 v[164:167], v[68:71], a[148:151], v[164:167]
    ds_read_b64_tr_b16 v[92:93], v30 offset:28672
    v_mov_b32 v60, 0x3f803f80
    v_mfma_f32_16x16x32_bf16 v[164:167], v[64:67], a[144:147], v[164:167]
    ds_read_b64_tr_b16 v[94:95], v30 offset:29184
    v_mov_b32 v61, 0x3f803f80
    v_mfma_f32_16x16x32_bf16 v[168:171], v[64:67], a[160:163], 0
    v_mov_b32 v62, 0x3f803f80
    v_mov_b32 v63, 0x3f803f80
    v_mfma_f32_16x16x32_bf16 v[168:171], v[68:71], a[164:167], v[168:171]
    buffer_load_dwordx4 v21, s[20:23], s48 offen offset:1024 nt lds
    v_and_b32 v48, 1, v0
    v_mfma_f32_16x16x32_bf16 v[168:171], v[72:75], a[168:171], v[168:171]
    v_mul_u32_u24 v48, 0xaaaa, v48
    v_add_u32 v56, 0x4444, v48
    v_mfma_f32_16x16x32_bf16 v[168:171], v[76:79], a[172:175], v[168:171]
    v_lshl_or_b32 v56, v56, 16, v56
    v_add_u32 v48, 0, v0
    v_mfma_f32_16x16x32_bf16 v[172:175], v[76:79], a[188:191], 0
    v_mul_u32_u24 v49, 3277, v48
    v_lshrrev_b32 v49, 16, v49
    v_mfma_f32_16x16x32_bf16 v[172:175], v[72:75], a[184:187], v[172:175]
    v_mul_u32_u24 v47, 20, v49
    v_sub_u32 v48, v48, v47
    v_mfma_f32_16x16x32_bf16 v[172:175], v[68:71], a[180:183], v[172:175]
    buffer_load_dwordx4 v22, s[20:23], s48 offen offset:2048 nt lds
    v_bfe_u32 v47, v49, 2, 1
    v_mfma_f32_16x16x32_bf16 v[172:175], v[64:67], a[176:179], v[172:175]
    s_waitcnt lgkmcnt(0)
    v_mfma_f32_16x16x32_bf16 v[236:239], v[80:83], a[176:179], 0
    ds_read_b64_tr_b16 v[64:65], v31 offset:0
    v_lshlrev_b32 v47, 1, v47
    v_mfma_f32_16x16x32_bf16 v[236:239], v[84:87], a[180:183], v[236:239]
    ds_read_b64_tr_b16 v[66:67], v31 offset:512
    v_xor_b32 v48, v48, v47
    v_mfma_f32_16x16x32_bf16 v[236:239], v[88:91], a[184:187], v[236:239]
    ds_read_b64_tr_b16 v[68:69], v31 offset:4096
    v_mul_u32_u24 v49, 1280, v49
    v_mfma_f32_16x16x32_bf16 v[236:239], v[92:95], a[188:191], v[236:239]
    ds_read_b64_tr_b16 v[70:71], v31 offset:4608
    v_lshl_add_u32 v49, v48, 4, v49
    v_mfma_f32_16x16x32_bf16 v[232:235], v[92:95], a[172:175], 0
    buffer_load_dwordx4 v23, s[20:23], s48 offen offset:3072 nt lds
    ds_read_b64_tr_b16 v[72:73], v31 offset:8192
    s_add_u32 s48, s48, 331776
    v_mfma_f32_16x16x32_bf16 v[232:235], v[88:91], a[168:171], v[232:235]
    ds_read_b64_tr_b16 v[74:75], v31 offset:8704
    v_subrev_u32 v116, 0, v49
    v_mfma_f32_16x16x32_bf16 v[232:235], v[84:87], a[164:167], v[232:235]
    ds_read_b64_tr_b16 v[76:77], v31 offset:12288
    v_add_u32 v48, 64, v0
    v_mfma_f32_16x16x32_bf16 v[232:235], v[80:83], a[160:163], v[232:235]
    ds_read_b64_tr_b16 v[78:79], v31 offset:12800
    v_mul_u32_u24 v49, 3277, v48
    v_mfma_f32_16x16x32_bf16 v[228:231], v[80:83], a[144:147], 0
    v_lshrrev_b32 v49, 16, v49
    v_mul_u32_u24 v47, 20, v49
    v_mfma_f32_16x16x32_bf16 v[228:231], v[84:87], a[148:151], v[228:231]
    buffer_load_dwordx4 a[192:195], v112, s[8:11], s44 offen offset:0 sc1
    v_sub_u32 v48, v48, v47
    v_mfma_f32_16x16x32_bf16 v[228:231], v[88:91], a[152:155], v[228:231]
    v_bfe_u32 v47, v49, 2, 1
    v_lshlrev_b32 v47, 1, v47
    v_mfma_f32_16x16x32_bf16 v[228:231], v[92:95], a[156:159], v[228:231]
    v_xor_b32 v48, v48, v47
    v_mul_u32_u24 v49, 1280, v49
    v_mfma_f32_16x16x32_bf16 v[224:227], v[92:95], a[140:143], 0
    v_lshl_add_u32 v49, v48, 4, v49
    v_subrev_u32 v117, 1024, v49
    v_mfma_f32_16x16x32_bf16 v[224:227], v[88:91], a[136:139], v[224:227]
    v_add_u32 v48, 128, v0
    v_mul_u32_u24 v49, 3277, v48
    v_mfma_f32_16x16x32_bf16 v[224:227], v[84:87], a[132:135], v[224:227]
    buffer_load_dwordx4 a[196:199], v112, s[8:11], s44 offen offset:1024 sc1
    v_lshrrev_b32 v49, 16, v49
    v_mfma_f32_16x16x32_bf16 v[224:227], v[80:83], a[128:131], v[224:227]
    s_waitcnt lgkmcnt(0)
    v_mfma_f32_16x16x32_bf16 v[176:179], v[64:67], a[128:131], 0
    ds_read_b64_tr_b16 v[80:81], v31 offset:16384
    v_mul_u32_u24 v47, 20, v49
    v_mfma_f32_16x16x32_bf16 v[176:179], v[68:71], a[132:135], v[176:179]
    ds_read_b64_tr_b16 v[82:83], v31 offset:16896
    v_sub_u32 v48, v48, v47
    v_mfma_f32_16x16x32_bf16 v[176:179], v[72:75], a[136:139], v[176:179]
    ds_read_b64_tr_b16 v[84:85], v31 offset:20480
    v_bfe_u32 v47, v49, 2, 1
    v_mfma_f32_16x16x32_bf16 v[176:179], v[76:79], a[140:143], v[176:179]
    ds_read_b64_tr_b16 v[86:87], v31 offset:20992
    v_lshlrev_b32 v47, 1, v47
    v_mfma_f32_16x16x32_bf16 v[180:183], v[76:79], a[156:159], 0
    buffer_load_dwordx4 a[200:203], v112, s[8:11], s44 offen offset:2048 sc1
    ds_read_b64_tr_b16 v[88:89], v31 offset:24576
    v_mfma_f32_16x16x32_bf16 v[180:183], v[72:75], a[152:155], v[180:183]
    ds_read_b64_tr_b16 v[90:91], v31 offset:25088
    v_xor_b32 v48, v48, v47
    v_mfma_f32_16x16x32_bf16 v[180:183], v[68:71], a[148:151], v[180:183]
    ds_read_b64_tr_b16 v[92:93], v31 offset:28672
    v_mul_u32_u24 v49, 1280, v49
    v_mfma_f32_16x16x32_bf16 v[180:183], v[64:67], a[144:147], v[180:183]
    ds_read_b64_tr_b16 v[94:95], v31 offset:29184
    v_lshl_add_u32 v49, v48, 4, v49
    v_mfma_f32_16x16x32_bf16 v[184:187], v[64:67], a[160:163], 0
    v_subrev_u32 v118, 2048, v49
    v_add_u32 v48, 192, v0
    v_mfma_f32_16x16x32_bf16 v[184:187], v[68:71], a[164:167], v[184:187]
    buffer_load_dwordx4 a[204:207], v112, s[8:11], s44 offen offset:3072 sc1
    s_add_u32 s44, s44, 4096
    v_mfma_f32_16x16x32_bf16 v[184:187], v[72:75], a[168:171], v[184:187]
    v_mul_u32_u24 v49, 3277, v48
    v_lshrrev_b32 v49, 16, v49
    v_mfma_f32_16x16x32_bf16 v[184:187], v[76:79], a[172:175], v[184:187]
    v_mul_u32_u24 v47, 20, v49
    v_sub_u32 v48, v48, v47
    v_mfma_f32_16x16x32_bf16 v[188:191], v[76:79], a[188:191], 0
    v_bfe_u32 v47, v49, 2, 1
    v_lshlrev_b32 v47, 1, v47
    v_mfma_f32_16x16x32_bf16 v[188:191], v[72:75], a[184:187], v[188:191]
    v_xor_b32 v48, v48, v47
    v_mul_u32_u24 v49, 1280, v49
    v_mfma_f32_16x16x32_bf16 v[188:191], v[68:71], a[180:183], v[188:191]
    buffer_load_dwordx4 a[208:211], v112, s[8:11], s45 offen offset:0 sc1
    v_lshl_add_u32 v49, v48, 4, v49
    v_mfma_f32_16x16x32_bf16 v[188:191], v[64:67], a[176:179], v[188:191]
    s_waitcnt vmcnt(13) lgkmcnt(0)
    s_barrier
    v_mfma_f32_16x16x32_bf16 v[252:255], v[80:83], a[176:179], 0
    ds_read_b64_tr_b16 v[64:65], v32 offset:32768
    v_subrev_u32 v119, 3072, v49
    v_mfma_f32_16x16x32_bf16 v[252:255], v[84:87], a[180:183], v[252:255]
    ds_read_b64_tr_b16 v[66:67], v32 offset:33792
    v_add_u32 v48, 256, v0
    v_mfma_f32_16x16x32_bf16 v[252:255], v[88:91], a[184:187], v[252:255]
    ds_read_b64_tr_b16 v[68:69], v32 offset:40960
    v_mul_u32_u24 v49, 3277, v48
    v_mfma_f32_16x16x32_bf16 v[252:255], v[92:95], a[188:191], v[252:255]
    ds_read_b64_tr_b16 v[70:71], v32 offset:41984
    v_lshrrev_b32 v49, 16, v49
    v_mfma_f32_16x16x32_bf16 v[248:251], v[92:95], a[172:175], 0
    buffer_load_dwordx4 a[212:215], v112, s[8:11], s45 offen offset:1024 sc1
    ds_read_b64_tr_b16 v[72:73], v32 offset:49152
    v_mfma_f32_16x16x32_bf16 v[248:251], v[88:91], a[168:171], v[248:251]
    ds_read_b64_tr_b16 v[74:75], v32 offset:50176
    v_mul_u32_u24 v47, 20, v49
    v_mfma_f32_16x16x32_bf16 v[248:251], v[84:87], a[164:167], v[248:251]
    ds_read_b64_tr_b16 v[76:77], v32 offset:57344
    v_sub_u32 v48, v48, v47
    v_mfma_f32_16x16x32_bf16 v[248:251], v[80:83], a[160:163], v[248:251]
    ds_read_b64_tr_b16 v[78:79], v32 offset:58368
    v_bfe_u32 v47, v49, 2, 1
    v_mfma_f32_16x16x32_bf16 v[244:247], v[80:83], a[144:147], 0
    v_lshlrev_b32 v47, 1, v47
    v_xor_b32 v48, v48, v47
    v_mfma_f32_16x16x32_bf16 v[244:247], v[84:87], a[148:151], v[244:247]
    buffer_load_dwordx4 a[216:219], v112, s[8:11], s45 offen offset:2048 sc1
    v_mul_u32_u24 v49, 1280, v49
    v_mfma_f32_16x16x32_bf16 v[244:247], v[88:91], a[152:155], v[244:247]
    v_lshl_add_u32 v49, v48, 4, v49
    v_subrev_u32 v120, 0, v49
    v_mfma_f32_16x16x32_bf16 v[244:247], v[92:95], a[156:159], v[244:247]
    v_mul_u32_u24 v48, 320, v46
    v_lshl_add_u32 v48, v55, 3, v48
    v_mfma_f32_16x16x32_bf16 v[240:243], v[92:95], a[140:143], 0
    v_and_b32 v49, 1, v52
    v_lshl_add_u32 v121, v49, 5, v48
    v_mfma_f32_16x16x32_bf16 v[240:243], v[88:91], a[136:139], v[240:243]
    v_xor_b32 v122, 32, v121
    v_add_u32 v123, 61440, v121
    v_mfma_f32_16x16x32_bf16 v[240:243], v[84:87], a[132:135], v[240:243]
    buffer_load_dwordx4 a[220:223], v112, s[8:11], s45 offen offset:3072 sc1
    s_add_u32 s45, s45, 4096
    v_mfma_f32_16x16x32_bf16 v[240:243], v[80:83], a[128:131], v[240:243]
    s_waitcnt lgkmcnt(0)
    v_mfma_f32_16x16x32_bf16 a[0:3], v[64:67], a[128:131], 0
    ds_read_b64_tr_b16 v[80:81], v32 offset:32776
    v_add_u32 v124, 61440, v122
    v_mfma_f32_16x16x32_bf16 a[0:3], v[68:71], a[132:135], a[0:3]
    ds_read_b64_tr_b16 v[82:83], v32 offset:33800
    v_add_u32 v125, 122880, v121
    v_mfma_f32_16x16x32_bf16 a[0:3], v[72:75], a[136:139], a[0:3]
    ds_read_b64_tr_b16 v[84:85], v32 offset:40968
    v_add_u32 v126, 122880, v122
    v_mfma_f32_16x16x32_bf16 a[0:3], v[76:79], a[140:143], a[0:3]
    ds_read_b64_tr_b16 v[86:87], v32 offset:41992
    v_mul_u32_u24 v48, 1280, v53
    v_mfma_f32_16x16x32_bf16 a[4:7], v[76:79], a[156:159], 0
    buffer_load_dwordx4 a[224:227], v112, s[8:11], s46 offen offset:0 sc1
    ds_read_b64_tr_b16 v[88:89], v32 offset:49160
    v_mfma_f32_16x16x32_bf16 a[4:7], v[72:75], a[152:155], a[4:7]
    ds_read_b64_tr_b16 v[90:91], v32 offset:50184
    v_lshl_add_u32 v127, v52, 4, v48
    v_mfma_f32_16x16x32_bf16 a[4:7], v[68:71], a[148:151], a[4:7]
    ds_read_b64_tr_b16 v[92:93], v32 offset:57352
    s_mul_i32 s73, s32, 5120
    v_mfma_f32_16x16x32_bf16 a[4:7], v[64:67], a[144:147], a[4:7]
    ds_read_b64_tr_b16 v[94:95], v32 offset:58376
    s_mul_i32 s84, s43, 320
    v_mfma_f32_16x16x32_bf16 a[8:11], v[64:67], a[160:163], 0
    s_mul_i32 s85, s32, 20480
    s_add_u32 s74, s84, s85
    v_mfma_f32_16x16x32_bf16 a[8:11], v[68:71], a[164:167], a[8:11]
    buffer_load_dwordx4 a[228:231], v112, s[8:11], s46 offen offset:1024 sc1
    s_mov_b32 s75, s74
    v_mfma_f32_16x16x32_bf16 a[8:11], v[72:75], a[168:171], a[8:11]
    s_mul_i32 s84, s35, 1310720
    s_add_u32 s60, s60, s84
    s_addc_u32 s61, s61, 0
    v_mfma_f32_16x16x32_bf16 a[8:11], v[76:79], a[172:175], a[8:11]
    s_mov_b32 s62, 1310720
    s_mov_b32 s63, 0x20000
    v_mfma_f32_16x16x32_bf16 a[12:15], v[76:79], a[188:191], 0
    s_mul_i32 s76, s35, 14
    s_cmp_eq_u32 s35, 3
    s_subb_u32 s76, s76, 0
    v_mfma_f32_16x16x32_bf16 a[12:15], v[72:75], a[184:187], a[12:15]
    s_cmp_lt_u32 s35, 2
    s_cselect_b32 s77, 14, 13
    v_mfma_f32_16x16x32_bf16 a[12:15], v[68:71], a[180:183], a[12:15]
    buffer_load_dwordx4 a[232:235], v112, s[8:11], s46 offen offset:2048 sc1
    s_mul_i32 s84, s76, 40960
    v_mfma_f32_16x16x32_bf16 a[12:15], v[64:67], a[176:179], a[12:15]
    s_waitcnt lgkmcnt(0)
    v_mfma_f32_16x16x32_bf16 a[28:31], v[80:83], a[176:179], 0
    ds_read_b64_tr_b16 v[64:65], v33 offset:32768
    s_add_u32 s68, s68, s84
    s_addc_u32 s69, s69, 0
    v_mfma_f32_16x16x32_bf16 a[28:31], v[84:87], a[180:183], a[28:31]
    ds_read_b64_tr_b16 v[66:67], v33 offset:33792
    s_mul_i32 s70, s77, 40960
    v_mfma_f32_16x16x32_bf16 a[28:31], v[88:91], a[184:187], a[28:31]
    ds_read_b64_tr_b16 v[68:69], v33 offset:40960
    s_mov_b32 s71, 0x20000
    v_mfma_f32_16x16x32_bf16 a[28:31], v[92:95], a[188:191], a[28:31]
    ds_read_b64_tr_b16 v[70:71], v33 offset:41984
    s_lshl_b32 s66, s77, 12
    v_mfma_f32_16x16x32_bf16 a[24:27], v[92:95], a[172:175], 0
    buffer_load_dwordx4 a[236:239], v112, s[8:11], s46 offen offset:3072 sc1
    ds_read_b64_tr_b16 v[72:73], v33 offset:49152
    s_add_u32 s46, s46, 4096
    v_mfma_f32_16x16x32_bf16 a[24:27], v[88:91], a[168:171], a[24:27]
    ds_read_b64_tr_b16 v[74:75], v33 offset:50176
    s_mov_b32 s67, 0x20000
    v_mfma_f32_16x16x32_bf16 a[24:27], v[84:87], a[164:167], a[24:27]
    ds_read_b64_tr_b16 v[76:77], v33 offset:57344
    s_bfe_u32 s84, s2, 0x10002
    v_mfma_f32_16x16x32_bf16 a[24:27], v[80:83], a[160:163], a[24:27]
    ds_read_b64_tr_b16 v[78:79], v33 offset:58368
    s_lshl_b32 s84, s84, 1
    v_mfma_f32_16x16x32_bf16 a[20:23], v[80:83], a[144:147], 0
    s_lshr_b32 s85, s32, 1
    s_add_u32 s77, s84, s85
    v_mfma_f32_16x16x32_bf16 a[20:23], v[84:87], a[148:151], a[20:23]
    buffer_load_dwordx4 a[240:243], v112, s[8:11], s47 offen offset:0 sc1
    s_lshl_b32 s84, s34, 2
    v_mfma_f32_16x16x32_bf16 a[20:23], v[88:91], a[152:155], a[20:23]
    s_add_u32 s84, s84, s77
    s_mul_i32 s84, s84, 54
    v_mfma_f32_16x16x32_bf16 a[20:23], v[92:95], a[156:159], a[20:23]
    s_add_u32 s84, s84, s76
    s_lshl_b32 s84, s84, 12
    v_mfma_f32_16x16x32_bf16 a[16:19], v[92:95], a[140:143], 0
    s_add_u32 s84, s84, 20971520
    s_add_u32 s64, s8, s84
    s_addc_u32 s65, s9, 0
    v_mfma_f32_16x16x32_bf16 a[16:19], v[88:91], a[136:139], a[16:19]
    s_lshl_b32 s85, s34, 5
    s_lshr_b32 s84, s76, 1
    v_mfma_f32_16x16x32_bf16 a[16:19], v[84:87], a[132:135], a[16:19]
    buffer_load_dwordx4 a[244:247], v112, s[8:11], s47 offen offset:1024 sc1
    s_add_u32 s84, s84, s85
    v_mfma_f32_16x16x32_bf16 a[16:19], v[80:83], a[128:131], a[16:19]
    s_waitcnt lgkmcnt(0)
    v_mfma_f32_16x16x32_bf16 a[32:35], v[64:67], a[128:131], 0
    ds_read_b64_tr_b16 v[80:81], v33 offset:32776
    s_lshl_b32 s84, s84, 2
    v_mfma_f32_16x16x32_bf16 a[32:35], v[68:71], a[132:135], a[32:35]
    ds_read_b64_tr_b16 v[82:83], v33 offset:33800
    s_add_u32 s84, s84, s77
    v_mfma_f32_16x16x32_bf16 a[32:35], v[72:75], a[136:139], a[32:35]
    ds_read_b64_tr_b16 v[84:85], v33 offset:40968
    s_lshl_b32 s84, s84, 7
    v_mfma_f32_16x16x32_bf16 a[32:35], v[76:79], a[140:143], a[32:35]
    ds_read_b64_tr_b16 v[86:87], v33 offset:41992
    s_add_u32 s82, s84, 71434240
    v_mfma_f32_16x16x32_bf16 a[36:39], v[76:79], a[156:159], 0
    buffer_load_dwordx4 a[248:251], v112, s[8:11], s47 offen offset:2048 sc1
    ds_read_b64_tr_b16 v[88:89], v33 offset:49160
    v_mfma_f32_16x16x32_bf16 a[36:39], v[72:75], a[152:155], a[36:39]
    ds_read_b64_tr_b16 v[90:91], v33 offset:50184
    v_min_u32 v113, 6, v0
    v_mfma_f32_16x16x32_bf16 a[36:39], v[68:71], a[148:151], a[36:39]
    ds_read_b64_tr_b16 v[92:93], v33 offset:57352
    v_lshlrev_b32 v113, 9, v113
    v_mfma_f32_16x16x32_bf16 a[36:39], v[64:67], a[144:147], a[36:39]
    ds_read_b64_tr_b16 v[94:95], v33 offset:58376
    s_lshl_b32 s84, s35, 3
    v_mfma_f32_16x16x32_bf16 a[40:43], v[64:67], a[160:163], 0
    s_add_u32 s84, s84, s85
    s_lshl_b32 s84, s84, 2
    v_mfma_f32_16x16x32_bf16 a[40:43], v[68:71], a[164:167], a[40:43]
    buffer_load_dwordx4 a[252:255], v112, s[8:11], s47 offen offset:3072 sc1
    s_add_u32 s47, s47, 4096
    v_mfma_f32_16x16x32_bf16 a[40:43], v[72:75], a[168:171], a[40:43]
    s_add_u32 s84, s84, s77
    s_lshl_b32 s85, s84, 7
    v_mfma_f32_16x16x32_bf16 a[40:43], v[76:79], a[172:175], a[40:43]
    s_add_u32 s83, s85, 71565312
    s_and_b32 s76, s32, 1
    v_mfma_f32_16x16x32_bf16 a[44:47], v[76:79], a[188:191], 0
    s_lshl_b32 s76, s76, 11
    s_lshl_b32 s84, s84, 14
    v_mfma_f32_16x16x32_bf16 a[44:47], v[72:75], a[184:187], a[44:47]
    s_add_u32 m0, s50, 65536
    s_add_u32 s84, s84, s76
    v_mfma_f32_16x16x32_bf16 a[44:47], v[68:71], a[180:183], a[44:47]
    buffer_load_dwordx4 v24, s[16:19], s49 offen offset:0 nt lds
    s_add_u32 s77, s84, 4194304
    v_mfma_f32_16x16x32_bf16 a[44:47], v[64:67], a[176:179], a[44:47]
    s_waitcnt lgkmcnt(0)
    v_mfma_f32_16x16x32_bf16 a[60:63], v[80:83], a[176:179], 0
    ds_read_b64_tr_b16 v[64:65], v34 offset:32768
    s_lshl_b32 s84, s2, 2
    v_mfma_f32_16x16x32_bf16 a[60:63], v[84:87], a[180:183], a[60:63]
    ds_read_b64_tr_b16 v[66:67], v34 offset:33792
    s_add_u32 s84, s84, s32
    v_mfma_f32_16x16x32_bf16 a[60:63], v[88:91], a[184:187], a[60:63]
    ds_read_b64_tr_b16 v[68:69], v34 offset:40960
    s_lshl_b32 s84, s84, 14
    v_mfma_f32_16x16x32_bf16 a[60:63], v[92:95], a[188:191], a[60:63]
    ds_read_b64_tr_b16 v[70:71], v34 offset:41984
    s_add_u32 s78, s84, 4194304
    v_mfma_f32_16x16x32_bf16 a[56:59], v[92:95], a[172:175], 0
    buffer_load_dwordx4 v25, s[16:19], s49 offen offset:1024 nt lds
    ds_read_b64_tr_b16 v[72:73], v34 offset:49152
    v_mfma_f32_16x16x32_bf16 a[56:59], v[88:91], a[168:171], a[56:59]
    ds_read_b64_tr_b16 v[74:75], v34 offset:50176
    s_andn2_b32 s84, s2, 3
    v_mfma_f32_16x16x32_bf16 a[56:59], v[84:87], a[164:167], a[56:59]
    ds_read_b64_tr_b16 v[76:77], v34 offset:57344
    s_add_u32 s85, s84, s32
    v_mfma_f32_16x16x32_bf16 a[56:59], v[80:83], a[160:163], a[56:59]
    ds_read_b64_tr_b16 v[78:79], v34 offset:58368
    s_mul_i32 s85, s85, 40
    v_mfma_f32_16x16x32_bf16 a[52:55], v[80:83], a[144:147], 0
    s_sub_u32 s84, s35, s32
    s_and_b32 s84, s84, 3
    v_mfma_f32_16x16x32_bf16 a[52:55], v[84:87], a[148:151], a[52:55]
    buffer_load_dwordx4 v26, s[16:19], s49 offen offset:2048 nt lds
    s_add_u32 s85, s85, s84
    v_mfma_f32_16x16x32_bf16 a[52:55], v[88:91], a[152:155], a[52:55]
    s_lshl_b32 s79, s85, 10
    s_mul_i32 s85, s2, 10
    v_mfma_f32_16x16x32_bf16 a[52:55], v[92:95], a[156:159], a[52:55]
    s_add_u32 s85, s85, s32
    s_lshl_b32 s80, s85, 12
    v_mfma_f32_16x16x32_bf16 a[48:51], v[92:95], a[140:143], 0
    s_lshr_b32 s84, s2, 3
    s_lshl_b32 s84, s84, 2
    v_mfma_f32_16x16x32_bf16 a[48:51], v[88:91], a[136:139], a[48:51]
    s_add_u32 s84, s84, s32
    s_mul_i32 s81, s84, 2048
    v_mfma_f32_16x16x32_bf16 a[48:51], v[84:87], a[132:135], a[48:51]
    buffer_load_dwordx4 v27, s[16:19], s49 offen offset:3072 nt lds
    s_add_u32 s49, s49, 131072
    v_mfma_f32_16x16x32_bf16 a[48:51], v[80:83], a[128:131], a[48:51]
    s_waitcnt lgkmcnt(0)
    v_mfma_f32_16x16x32_bf16 a[64:67], v[64:67], a[128:131], 0
    ds_read_b64_tr_b16 v[80:81], v34 offset:32776
    s_mul_i32 s84, s7, 54
    v_mfma_f32_16x16x32_bf16 a[64:67], v[68:71], a[132:135], a[64:67]
    ds_read_b64_tr_b16 v[82:83], v34 offset:33800
    s_lshl_b32 s85, s33, 1
    v_mfma_f32_16x16x32_bf16 a[64:67], v[72:75], a[136:139], a[64:67]
    ds_read_b64_tr_b16 v[84:85], v34 offset:40968
    s_add_u32 s84, s84, s85
    v_mfma_f32_16x16x32_bf16 a[64:67], v[76:79], a[140:143], a[64:67]
    ds_read_b64_tr_b16 v[86:87], v34 offset:41992
    s_add_u32 m0, s50, 69632
    v_mfma_f32_16x16x32_bf16 a[68:71], v[76:79], a[156:159], 0
    buffer_load_dwordx4 v24, s[16:19], s49 offen offset:0 nt lds
    ds_read_b64_tr_b16 v[88:89], v34 offset:49160
    v_mfma_f32_16x16x32_bf16 a[68:71], v[72:75], a[152:155], a[68:71]
    ds_read_b64_tr_b16 v[90:91], v34 offset:50184
    s_lshl_b32 s84, s84, 12
    v_mfma_f32_16x16x32_bf16 a[68:71], v[68:71], a[148:151], a[68:71]
    ds_read_b64_tr_b16 v[92:93], v34 offset:57352
    s_add_u32 s6, s84, 20971520
    v_mfma_f32_16x16x32_bf16 a[68:71], v[64:67], a[144:147], a[68:71]
    ds_read_b64_tr_b16 v[94:95], v34 offset:58376
    s_add_u32 s7, s6, 4096
    v_mfma_f32_16x16x32_bf16 a[72:75], v[64:67], a[160:163], 0
    s_mov_b32 s4, 0xc13504f3
    s_mov_b32 s5, 0x3c853526
    v_mfma_f32_16x16x32_bf16 a[72:75], v[68:71], a[164:167], a[72:75]
    buffer_load_dwordx4 v25, s[16:19], s49 offen offset:1024 nt lds
    v_mfma_f32_16x16x32_bf16 a[72:75], v[72:75], a[168:171], a[72:75]
    v_mfma_f32_16x16x32_bf16 a[72:75], v[76:79], a[172:175], a[72:75]
    v_mfma_f32_16x16x32_bf16 a[76:79], v[76:79], a[188:191], 0
    v_mfma_f32_16x16x32_bf16 a[76:79], v[72:75], a[184:187], a[76:79]
    v_mfma_f32_16x16x32_bf16 a[76:79], v[68:71], a[180:183], a[76:79]
    buffer_load_dwordx4 v26, s[16:19], s49 offen offset:2048 nt lds
    v_mfma_f32_16x16x32_bf16 a[76:79], v[64:67], a[176:179], a[76:79]
    s_waitcnt lgkmcnt(0)
    v_mfma_f32_16x16x32_bf16 a[92:95], v[80:83], a[176:179], 0
    ds_read_b64_tr_b16 v[64:65], v35 offset:32768
    v_mfma_f32_16x16x32_bf16 a[92:95], v[84:87], a[180:183], a[92:95]
    ds_read_b64_tr_b16 v[66:67], v35 offset:33792
    v_mfma_f32_16x16x32_bf16 a[92:95], v[88:91], a[184:187], a[92:95]
    ds_read_b64_tr_b16 v[68:69], v35 offset:40960
    v_mfma_f32_16x16x32_bf16 a[92:95], v[92:95], a[188:191], a[92:95]
    ds_read_b64_tr_b16 v[70:71], v35 offset:41984
    v_mfma_f32_16x16x32_bf16 a[88:91], v[92:95], a[172:175], 0
    buffer_load_dwordx4 v27, s[16:19], s49 offen offset:3072 nt lds
    ds_read_b64_tr_b16 v[72:73], v35 offset:49152
    s_add_u32 s49, s49, 917504
    v_mfma_f32_16x16x32_bf16 a[88:91], v[88:91], a[168:171], a[88:91]
    ds_read_b64_tr_b16 v[74:75], v35 offset:50176
    v_mfma_f32_16x16x32_bf16 a[88:91], v[84:87], a[164:167], a[88:91]
    ds_read_b64_tr_b16 v[76:77], v35 offset:57344
    v_mfma_f32_16x16x32_bf16 a[88:91], v[80:83], a[160:163], a[88:91]
    ds_read_b64_tr_b16 v[78:79], v35 offset:58368
    v_mfma_f32_16x16x32_bf16 a[84:87], v[80:83], a[144:147], 0
    s_add_u32 m0, s50, 0
    v_mfma_f32_16x16x32_bf16 a[84:87], v[84:87], a[148:151], a[84:87]
    buffer_load_dwordx4 v20, s[20:23], s48 offen offset:0 nt lds
    v_mfma_f32_16x16x32_bf16 a[84:87], v[88:91], a[152:155], a[84:87]
    v_mfma_f32_16x16x32_bf16 a[84:87], v[92:95], a[156:159], a[84:87]
    v_mfma_f32_16x16x32_bf16 a[80:83], v[92:95], a[140:143], 0
    v_mfma_f32_16x16x32_bf16 a[80:83], v[88:91], a[136:139], a[80:83]
    v_mfma_f32_16x16x32_bf16 a[80:83], v[84:87], a[132:135], a[80:83]
    buffer_load_dwordx4 v21, s[20:23], s48 offen offset:1024 nt lds
    v_mfma_f32_16x16x32_bf16 a[80:83], v[80:83], a[128:131], a[80:83]
    s_waitcnt lgkmcnt(0)
    v_mfma_f32_16x16x32_bf16 a[96:99], v[64:67], a[128:131], 0
    ds_read_b64_tr_b16 v[80:81], v35 offset:32776
    v_mfma_f32_16x16x32_bf16 a[96:99], v[68:71], a[132:135], a[96:99]
    ds_read_b64_tr_b16 v[82:83], v35 offset:33800
    v_mfma_f32_16x16x32_bf16 a[96:99], v[72:75], a[136:139], a[96:99]
    ds_read_b64_tr_b16 v[84:85], v35 offset:40968
    v_mfma_f32_16x16x32_bf16 a[96:99], v[76:79], a[140:143], a[96:99]
    ds_read_b64_tr_b16 v[86:87], v35 offset:41992
    v_mfma_f32_16x16x32_bf16 a[100:103], v[76:79], a[156:159], 0
    buffer_load_dwordx4 v22, s[20:23], s48 offen offset:2048 nt lds
    ds_read_b64_tr_b16 v[88:89], v35 offset:49160
    v_mfma_f32_16x16x32_bf16 a[100:103], v[72:75], a[152:155], a[100:103]
    ds_read_b64_tr_b16 v[90:91], v35 offset:50184
    v_mfma_f32_16x16x32_bf16 a[100:103], v[68:71], a[148:151], a[100:103]
    ds_read_b64_tr_b16 v[92:93], v35 offset:57352
    v_mfma_f32_16x16x32_bf16 a[100:103], v[64:67], a[144:147], a[100:103]
    ds_read_b64_tr_b16 v[94:95], v35 offset:58376
    v_mfma_f32_16x16x32_bf16 a[104:107], v[64:67], a[160:163], 0
    v_mfma_f32_16x16x32_bf16 a[104:107], v[68:71], a[164:167], a[104:107]
    buffer_load_dwordx4 v23, s[20:23], s48 offen offset:3072 nt lds
    s_add_u32 s48, s48, 110592
    v_mfma_f32_16x16x32_bf16 a[104:107], v[72:75], a[168:171], a[104:107]
    v_mfma_f32_16x16x32_bf16 a[104:107], v[76:79], a[172:175], a[104:107]
    v_mfma_f32_16x16x32_bf16 a[108:111], v[76:79], a[188:191], 0
    v_mfma_f32_16x16x32_bf16 a[108:111], v[72:75], a[184:187], a[108:111]
    s_add_u32 m0, s50, 4096
    v_mfma_f32_16x16x32_bf16 a[108:111], v[68:71], a[180:183], a[108:111]
    buffer_load_dwordx4 v20, s[20:23], s48 offen offset:0 nt lds
    v_mfma_f32_16x16x32_bf16 a[108:111], v[64:67], a[176:179], a[108:111]
    s_waitcnt vmcnt(29) lgkmcnt(0)
    s_barrier
    v_mfma_f32_16x16x32_bf16 a[124:127], v[80:83], a[176:179], 0
    ds_read_b64_tr_b16 v[64:65], v28 offset:32768
    v_mfma_f32_16x16x32_bf16 a[124:127], v[84:87], a[180:183], a[124:127]
    ds_read_b64_tr_b16 v[66:67], v28 offset:33280
    v_mfma_f32_16x16x32_bf16 a[124:127], v[88:91], a[184:187], a[124:127]
    ds_read_b64_tr_b16 v[68:69], v28 offset:36864
    v_mfma_f32_16x16x32_bf16 a[124:127], v[92:95], a[188:191], a[124:127]
    ds_read_b64_tr_b16 v[70:71], v28 offset:37376
    v_mfma_f32_16x16x32_bf16 a[120:123], v[92:95], a[172:175], 0
    buffer_load_dwordx4 v21, s[20:23], s48 offen offset:1024 nt lds
    ds_read_b64_tr_b16 v[72:73], v28 offset:40960
    v_mfma_f32_16x16x32_bf16 a[120:123], v[88:91], a[168:171], a[120:123]
    ds_read_b64_tr_b16 v[74:75], v28 offset:41472
    v_mfma_f32_16x16x32_bf16 a[120:123], v[84:87], a[164:167], a[120:123]
    ds_read_b64_tr_b16 v[76:77], v28 offset:45056
    v_mfma_f32_16x16x32_bf16 a[120:123], v[80:83], a[160:163], a[120:123]
    ds_read_b64_tr_b16 v[78:79], v28 offset:45568
    v_mfma_f32_16x16x32_bf16 a[116:119], v[80:83], a[144:147], 0
    v_mfma_f32_16x16x32_bf16 a[116:119], v[84:87], a[148:151], a[116:119]
    buffer_load_dwordx4 v22, s[20:23], s48 offen offset:2048 nt lds
    v_mfma_f32_16x16x32_bf16 a[116:119], v[88:91], a[152:155], a[116:119]
    v_mfma_f32_16x16x32_bf16 a[116:119], v[92:95], a[156:159], a[116:119]
    v_mfma_f32_16x16x32_bf16 a[112:115], v[92:95], a[140:143], 0
    v_mfma_f32_16x16x32_bf16 a[112:115], v[88:91], a[136:139], a[112:115]
    v_mfma_f32_16x16x32_bf16 a[112:115], v[84:87], a[132:135], a[112:115]
    buffer_load_dwordx4 v23, s[20:23], s48 offen offset:3072 nt lds
    s_add_u32 s48, s48, 331776
    v_mfma_f32_16x16x32_bf16 a[112:115], v[80:83], a[128:131], a[112:115]
    s_waitcnt vmcnt(16) lgkmcnt(0)
    v_mfma_f32_16x16x32_bf16 v[128:131], v[64:67], a[192:195], v[128:131]
    ds_read_b64_tr_b16 v[80:81], v28 offset:49152
    v_mfma_f32_16x16x32_bf16 v[128:131], v[68:71], a[196:199], v[128:131]
    ds_read_b64_tr_b16 v[82:83], v28 offset:49664
    v_mfma_f32_16x16x32_bf16 v[128:131], v[72:75], a[200:203], v[128:131]
    ds_read_b64_tr_b16 v[84:85], v28 offset:53248
    v_mfma_f32_16x16x32_bf16 v[128:131], v[76:79], a[204:207], v[128:131]
    ds_read_b64_tr_b16 v[86:87], v28 offset:53760
    v_mfma_f32_16x16x32_bf16 v[132:135], v[76:79], a[220:223], v[132:135]
    ds_read_b64_tr_b16 v[88:89], v28 offset:57344
    v_mfma_f32_16x16x32_bf16 v[132:135], v[72:75], a[216:219], v[132:135]
    ds_read_b64_tr_b16 v[90:91], v28 offset:57856
    v_mfma_f32_16x16x32_bf16 v[132:135], v[68:71], a[212:215], v[132:135]
    ds_read_b64_tr_b16 v[92:93], v28 offset:61440
    v_mfma_f32_16x16x32_bf16 v[132:135], v[64:67], a[208:211], v[132:135]
    ds_read_b64_tr_b16 v[94:95], v28 offset:61952
    v_mfma_f32_16x16x32_bf16 v[136:139], v[64:67], a[224:227], v[136:139]
    s_add_u32 m0, s50, 98304
    v_mfma_f32_16x16x32_bf16 v[136:139], v[68:71], a[228:231], v[136:139]
    buffer_load_dwordx4 v24, s[16:19], s49 offen offset:0 nt lds
    v_mfma_f32_16x16x32_bf16 v[136:139], v[72:75], a[232:235], v[136:139]
    v_mfma_f32_16x16x32_bf16 v[136:139], v[76:79], a[236:239], v[136:139]
    v_mfma_f32_16x16x32_bf16 v[140:143], v[76:79], a[252:255], v[140:143]
    v_mfma_f32_16x16x32_bf16 v[140:143], v[72:75], a[248:251], v[140:143]
    v_mfma_f32_16x16x32_bf16 v[140:143], v[68:71], a[244:247], v[140:143]
    buffer_load_dwordx4 v25, s[16:19], s49 offen offset:1024 nt lds
    v_mfma_f32_16x16x32_bf16 v[140:143], v[64:67], a[240:243], v[140:143]
    s_waitcnt lgkmcnt(0)
    v_mfma_f32_16x16x32_bf16 v[204:207], v[80:83], a[240:243], v[204:207]
    ds_read_b64_tr_b16 v[64:65], v29 offset:32768
    v_mfma_f32_16x16x32_bf16 v[204:207], v[84:87], a[244:247], v[204:207]
    ds_read_b64_tr_b16 v[66:67], v29 offset:33280
    v_mfma_f32_16x16x32_bf16 v[204:207], v[88:91], a[248:251], v[204:207]
    ds_read_b64_tr_b16 v[68:69], v29 offset:36864
    v_mfma_f32_16x16x32_bf16 v[204:207], v[92:95], a[252:255], v[204:207]
    ds_read_b64_tr_b16 v[70:71], v29 offset:37376
    v_mfma_f32_16x16x32_bf16 v[200:203], v[92:95], a[236:239], v[200:203]
    ds_read_b64_tr_b16 v[72:73], v29 offset:40960
    v_mfma_f32_16x16x32_bf16 v[200:203], v[88:91], a[232:235], v[200:203]
    ds_read_b64_tr_b16 v[74:75], v29 offset:41472
    v_mfma_f32_16x16x32_bf16 v[200:203], v[84:87], a[228:231], v[200:203]
    ds_read_b64_tr_b16 v[76:77], v29 offset:45056
    v_mfma_f32_16x16x32_bf16 v[200:203], v[80:83], a[224:227], v[200:203]
    ds_read_b64_tr_b16 v[78:79], v29 offset:45568
    v_mfma_f32_16x16x32_bf16 v[196:199], v[80:83], a[208:211], v[196:199]
    v_mfma_f32_16x16x32_bf16 v[196:199], v[84:87], a[212:215], v[196:199]
    buffer_load_dwordx4 v26, s[16:19], s49 offen offset:2048 nt lds
    v_mfma_f32_16x16x32_bf16 v[196:199], v[88:91], a[216:219], v[196:199]
    v_mfma_f32_16x16x32_bf16 v[196:199], v[92:95], a[220:223], v[196:199]
    v_mfma_f32_16x16x32_bf16 v[192:195], v[92:95], a[204:207], v[192:195]
    v_mfma_f32_16x16x32_bf16 v[192:195], v[88:91], a[200:203], v[192:195]
    v_mfma_f32_16x16x32_bf16 v[192:195], v[84:87], a[196:199], v[192:195]
    buffer_load_dwordx4 v27, s[16:19], s49 offen offset:3072 nt lds
    s_add_u32 s49, s49, 131072
    v_mfma_f32_16x16x32_bf16 v[192:195], v[80:83], a[192:195], v[192:195]
    s_waitcnt lgkmcnt(0)
    v_mfma_f32_16x16x32_bf16 v[144:147], v[64:67], a[192:195], v[144:147]
    ds_read_b64_tr_b16 v[80:81], v29 offset:49152
    v_mfma_f32_16x16x32_bf16 v[144:147], v[68:71], a[196:199], v[144:147]
    ds_read_b64_tr_b16 v[82:83], v29 offset:49664
    v_mfma_f32_16x16x32_bf16 v[144:147], v[72:75], a[200:203], v[144:147]
    ds_read_b64_tr_b16 v[84:85], v29 offset:53248
    v_mfma_f32_16x16x32_bf16 v[144:147], v[76:79], a[204:207], v[144:147]
    ds_read_b64_tr_b16 v[86:87], v29 offset:53760
    v_mfma_f32_16x16x32_bf16 v[148:151], v[76:79], a[220:223], v[148:151]
    ds_read_b64_tr_b16 v[88:89], v29 offset:57344
    v_mfma_f32_16x16x32_bf16 v[148:151], v[72:75], a[216:219], v[148:151]
    ds_read_b64_tr_b16 v[90:91], v29 offset:57856
    v_mfma_f32_16x16x32_bf16 v[148:151], v[68:71], a[212:215], v[148:151]
    ds_read_b64_tr_b16 v[92:93], v29 offset:61440
    v_mfma_f32_16x16x32_bf16 v[148:151], v[64:67], a[208:211], v[148:151]
    ds_read_b64_tr_b16 v[94:95], v29 offset:61952
    v_mfma_f32_16x16x32_bf16 v[152:155], v[64:67], a[224:227], v[152:155]
    s_add_u32 m0, s50, 102400
    v_mfma_f32_16x16x32_bf16 v[152:155], v[68:71], a[228:231], v[152:155]
    buffer_load_dwordx4 v24, s[16:19], s49 offen offset:0 nt lds
    v_mfma_f32_16x16x32_bf16 v[152:155], v[72:75], a[232:235], v[152:155]
    v_mfma_f32_16x16x32_bf16 v[152:155], v[76:79], a[236:239], v[152:155]
    v_mfma_f32_16x16x32_bf16 v[156:159], v[76:79], a[252:255], v[156:159]
    v_mfma_f32_16x16x32_bf16 v[156:159], v[72:75], a[248:251], v[156:159]
    v_mfma_f32_16x16x32_bf16 v[156:159], v[68:71], a[244:247], v[156:159]
    buffer_load_dwordx4 v25, s[16:19], s49 offen offset:1024 nt lds
    v_mfma_f32_16x16x32_bf16 v[156:159], v[64:67], a[240:243], v[156:159]
    s_waitcnt lgkmcnt(0)
    v_mfma_f32_16x16x32_bf16 v[220:223], v[80:83], a[240:243], v[220:223]
    ds_read_b64_tr_b16 v[64:65], v30 offset:32768
    v_mfma_f32_16x16x32_bf16 v[220:223], v[84:87], a[244:247], v[220:223]
    ds_read_b64_tr_b16 v[66:67], v30 offset:33280
    v_mfma_f32_16x16x32_bf16 v[220:223], v[88:91], a[248:251], v[220:223]
    ds_read_b64_tr_b16 v[68:69], v30 offset:36864
    v_mfma_f32_16x16x32_bf16 v[220:223], v[92:95], a[252:255], v[220:223]
    ds_read_b64_tr_b16 v[70:71], v30 offset:37376
    v_mfma_f32_16x16x32_bf16 v[216:219], v[92:95], a[236:239], v[216:219]
    ds_read_b64_tr_b16 v[72:73], v30 offset:40960
    v_mfma_f32_16x16x32_bf16 v[216:219], v[88:91], a[232:235], v[216:219]
    ds_read_b64_tr_b16 v[74:75], v30 offset:41472
    v_mfma_f32_16x16x32_bf16 v[216:219], v[84:87], a[228:231], v[216:219]
    ds_read_b64_tr_b16 v[76:77], v30 offset:45056
    v_mfma_f32_16x16x32_bf16 v[216:219], v[80:83], a[224:227], v[216:219]
    ds_read_b64_tr_b16 v[78:79], v30 offset:45568
    v_mfma_f32_16x16x32_bf16 v[212:215], v[80:83], a[208:211], v[212:215]
    v_mfma_f32_16x16x32_bf16 v[212:215], v[84:87], a[212:215], v[212:215]
    buffer_load_dwordx4 v26, s[16:19], s49 offen offset:2048 nt lds
    v_mfma_f32_16x16x32_bf16 v[212:215], v[88:91], a[216:219], v[212:215]
    v_mfma_f32_16x16x32_bf16 v[212:215], v[92:95], a[220:223], v[212:215]
    v_mfma_f32_16x16x32_bf16 v[208:211], v[92:95], a[204:207], v[208:211]
    v_mfma_f32_16x16x32_bf16 v[208:211], v[88:91], a[200:203], v[208:211]
    v_mfma_f32_16x16x32_bf16 v[208:211], v[84:87], a[196:199], v[208:211]
    buffer_load_dwordx4 v27, s[16:19], s49 offen offset:3072 nt lds
    s_add_u32 s49, s49, 917504
    v_mfma_f32_16x16x32_bf16 v[208:211], v[80:83], a[192:195], v[208:211]
    s_waitcnt lgkmcnt(0)
    v_mfma_f32_16x16x32_bf16 v[160:163], v[64:67], a[192:195], v[160:163]
    ds_read_b64_tr_b16 v[80:81], v30 offset:49152
    v_mfma_f32_16x16x32_bf16 v[160:163], v[68:71], a[196:199], v[160:163]
    ds_read_b64_tr_b16 v[82:83], v30 offset:49664
    v_mfma_f32_16x16x32_bf16 v[160:163], v[72:75], a[200:203], v[160:163]
    ds_read_b64_tr_b16 v[84:85], v30 offset:53248
    v_mfma_f32_16x16x32_bf16 v[160:163], v[76:79], a[204:207], v[160:163]
    ds_read_b64_tr_b16 v[86:87], v30 offset:53760
    v_mfma_f32_16x16x32_bf16 v[164:167], v[76:79], a[220:223], v[164:167]
    ds_read_b64_tr_b16 v[88:89], v30 offset:57344
    v_mfma_f32_16x16x32_bf16 v[164:167], v[72:75], a[216:219], v[164:167]
    ds_read_b64_tr_b16 v[90:91], v30 offset:57856
    v_mfma_f32_16x16x32_bf16 v[164:167], v[68:71], a[212:215], v[164:167]
    ds_read_b64_tr_b16 v[92:93], v30 offset:61440
    v_mfma_f32_16x16x32_bf16 v[164:167], v[64:67], a[208:211], v[164:167]
    ds_read_b64_tr_b16 v[94:95], v30 offset:61952
    v_mfma_f32_16x16x32_bf16 v[168:171], v[64:67], a[224:227], v[168:171]
    v_mfma_f32_16x16x32_bf16 v[168:171], v[68:71], a[228:231], v[168:171]
    buffer_load_dwordx4 a[128:131], v112, s[8:11], s44 offen offset:0 sc1
    v_mfma_f32_16x16x32_bf16 v[168:171], v[72:75], a[232:235], v[168:171]
    v_mfma_f32_16x16x32_bf16 v[168:171], v[76:79], a[236:239], v[168:171]
    v_mfma_f32_16x16x32_bf16 v[172:175], v[76:79], a[252:255], v[172:175]
    v_mfma_f32_16x16x32_bf16 v[172:175], v[72:75], a[248:251], v[172:175]
    v_mfma_f32_16x16x32_bf16 v[172:175], v[68:71], a[244:247], v[172:175]
    buffer_load_dwordx4 a[132:135], v112, s[8:11], s44 offen offset:1024 sc1
    v_mfma_f32_16x16x32_bf16 v[172:175], v[64:67], a[240:243], v[172:175]
    s_waitcnt lgkmcnt(0)
    v_mfma_f32_16x16x32_bf16 v[236:239], v[80:83], a[240:243], v[236:239]
    ds_read_b64_tr_b16 v[64:65], v31 offset:32768
    v_mfma_f32_16x16x32_bf16 v[236:239], v[84:87], a[244:247], v[236:239]
    ds_read_b64_tr_b16 v[66:67], v31 offset:33280
    v_mfma_f32_16x16x32_bf16 v[236:239], v[88:91], a[248:251], v[236:239]
    ds_read_b64_tr_b16 v[68:69], v31 offset:36864
    v_mfma_f32_16x16x32_bf16 v[236:239], v[92:95], a[252:255], v[236:239]
    ds_read_b64_tr_b16 v[70:71], v31 offset:37376
    v_mfma_f32_16x16x32_bf16 v[232:235], v[92:95], a[236:239], v[232:235]
    ds_read_b64_tr_b16 v[72:73], v31 offset:40960
    v_mfma_f32_16x16x32_bf16 v[232:235], v[88:91], a[232:235], v[232:235]
    ds_read_b64_tr_b16 v[74:75], v31 offset:41472
    v_mfma_f32_16x16x32_bf16 v[232:235], v[84:87], a[228:231], v[232:235]
    ds_read_b64_tr_b16 v[76:77], v31 offset:45056
    v_mfma_f32_16x16x32_bf16 v[232:235], v[80:83], a[224:227], v[232:235]
    ds_read_b64_tr_b16 v[78:79], v31 offset:45568
    v_mfma_f32_16x16x32_bf16 v[228:231], v[80:83], a[208:211], v[228:231]
    v_mfma_f32_16x16x32_bf16 v[228:231], v[84:87], a[212:215], v[228:231]
    buffer_load_dwordx4 a[136:139], v112, s[8:11], s44 offen offset:2048 sc1
    v_mfma_f32_16x16x32_bf16 v[228:231], v[88:91], a[216:219], v[228:231]
    v_mfma_f32_16x16x32_bf16 v[228:231], v[92:95], a[220:223], v[228:231]
    v_mfma_f32_16x16x32_bf16 v[224:227], v[92:95], a[204:207], v[224:227]
    v_mfma_f32_16x16x32_bf16 v[224:227], v[88:91], a[200:203], v[224:227]
    v_mfma_f32_16x16x32_bf16 v[224:227], v[84:87], a[196:199], v[224:227]
    buffer_load_dwordx4 a[140:143], v112, s[8:11], s44 offen offset:3072 sc1
    s_add_u32 s44, s44, 4096
    v_mfma_f32_16x16x32_bf16 v[224:227], v[80:83], a[192:195], v[224:227]
    s_waitcnt lgkmcnt(0)
    v_mfma_f32_16x16x32_bf16 v[176:179], v[64:67], a[192:195], v[176:179]
    ds_read_b64_tr_b16 v[80:81], v31 offset:49152
    v_mfma_f32_16x16x32_bf16 v[176:179], v[68:71], a[196:199], v[176:179]
    ds_read_b64_tr_b16 v[82:83], v31 offset:49664
    v_mfma_f32_16x16x32_bf16 v[176:179], v[72:75], a[200:203], v[176:179]
    ds_read_b64_tr_b16 v[84:85], v31 offset:53248
    v_mfma_f32_16x16x32_bf16 v[176:179], v[76:79], a[204:207], v[176:179]
    ds_read_b64_tr_b16 v[86:87], v31 offset:53760
    v_mfma_f32_16x16x32_bf16 v[180:183], v[76:79], a[220:223], v[180:183]
    ds_read_b64_tr_b16 v[88:89], v31 offset:57344
    v_mfma_f32_16x16x32_bf16 v[180:183], v[72:75], a[216:219], v[180:183]
    ds_read_b64_tr_b16 v[90:91], v31 offset:57856
    v_mfma_f32_16x16x32_bf16 v[180:183], v[68:71], a[212:215], v[180:183]
    ds_read_b64_tr_b16 v[92:93], v31 offset:61440
    v_mfma_f32_16x16x32_bf16 v[180:183], v[64:67], a[208:211], v[180:183]
    ds_read_b64_tr_b16 v[94:95], v31 offset:61952
    v_mfma_f32_16x16x32_bf16 v[184:187], v[64:67], a[224:227], v[184:187]
    v_mfma_f32_16x16x32_bf16 v[184:187], v[68:71], a[228:231], v[184:187]
    buffer_load_dwordx4 a[144:147], v112, s[8:11], s45 offen offset:0 sc1
    v_mfma_f32_16x16x32_bf16 v[184:187], v[72:75], a[232:235], v[184:187]
    v_mfma_f32_16x16x32_bf16 v[184:187], v[76:79], a[236:239], v[184:187]
    v_mfma_f32_16x16x32_bf16 v[188:191], v[76:79], a[252:255], v[188:191]
    v_mfma_f32_16x16x32_bf16 v[188:191], v[72:75], a[248:251], v[188:191]
    v_mfma_f32_16x16x32_bf16 v[188:191], v[68:71], a[244:247], v[188:191]
    buffer_load_dwordx4 a[148:151], v112, s[8:11], s45 offen offset:1024 sc1
    v_mfma_f32_16x16x32_bf16 v[188:191], v[64:67], a[240:243], v[188:191]
    s_waitcnt vmcnt(22) lgkmcnt(0)
    s_barrier
    v_mfma_f32_16x16x32_bf16 v[252:255], v[80:83], a[240:243], v[252:255]
    ds_read_b64_tr_b16 v[64:65], v32 offset:0
    v_mfma_f32_16x16x32_bf16 v[252:255], v[84:87], a[244:247], v[252:255]
    ds_read_b64_tr_b16 v[66:67], v32 offset:1024
    v_mfma_f32_16x16x32_bf16 v[252:255], v[88:91], a[248:251], v[252:255]
    ds_read_b64_tr_b16 v[68:69], v32 offset:8192
    v_mfma_f32_16x16x32_bf16 v[252:255], v[92:95], a[252:255], v[252:255]
    ds_read_b64_tr_b16 v[70:71], v32 offset:9216
    v_mfma_f32_16x16x32_bf16 v[248:251], v[92:95], a[236:239], v[248:251]
    ds_read_b64_tr_b16 v[72:73], v32 offset:16384
    v_mfma_f32_16x16x32_bf16 v[248:251], v[88:91], a[232:235], v[248:251]
    ds_read_b64_tr_b16 v[74:75], v32 offset:17408
    v_mfma_f32_16x16x32_bf16 v[248:251], v[84:87], a[228:231], v[248:251]
    ds_read_b64_tr_b16 v[76:77], v32 offset:24576
    v_mfma_f32_16x16x32_bf16 v[248:251], v[80:83], a[224:227], v[248:251]
    ds_read_b64_tr_b16 v[78:79], v32 offset:25600
    v_mfma_f32_16x16x32_bf16 v[244:247], v[80:83], a[208:211], v[244:247]
    v_mfma_f32_16x16x32_bf16 v[244:247], v[84:87], a[212:215], v[244:247]
    buffer_load_dwordx4 a[152:155], v112, s[8:11], s45 offen offset:2048 sc1
    v_mfma_f32_16x16x32_bf16 v[244:247], v[88:91], a[216:219], v[244:247]
    v_mfma_f32_16x16x32_bf16 v[244:247], v[92:95], a[220:223], v[244:247]
    v_mfma_f32_16x16x32_bf16 v[240:243], v[92:95], a[204:207], v[240:243]
    v_mfma_f32_16x16x32_bf16 v[240:243], v[88:91], a[200:203], v[240:243]
    v_mfma_f32_16x16x32_bf16 v[240:243], v[84:87], a[196:199], v[240:243]
    buffer_load_dwordx4 a[156:159], v112, s[8:11], s45 offen offset:3072 sc1
    s_add_u32 s45, s45, 4096
    v_mfma_f32_16x16x32_bf16 v[240:243], v[80:83], a[192:195], v[240:243]
    s_waitcnt lgkmcnt(0)
    v_mfma_f32_16x16x32_bf16 a[0:3], v[64:67], a[192:195], a[0:3]
    ds_read_b64_tr_b16 v[80:81], v32 offset:8
    v_mfma_f32_16x16x32_bf16 a[0:3], v[68:71], a[196:199], a[0:3]
    ds_read_b64_tr_b16 v[82:83], v32 offset:1032
    v_mfma_f32_16x16x32_bf16 a[0:3], v[72:75], a[200:203], a[0:3]
    ds_read_b64_tr_b16 v[84:85], v32 offset:8200
    v_mfma_f32_16x16x32_bf16 a[0:3], v[76:79], a[204:207], a[0:3]
    ds_read_b64_tr_b16 v[86:87], v32 offset:9224
    v_mfma_f32_16x16x32_bf16 a[4:7], v[76:79], a[220:223], a[4:7]
    ds_read_b64_tr_b16 v[88:89], v32 offset:16392
    v_mfma_f32_16x16x32_bf16 a[4:7], v[72:75], a[216:219], a[4:7]
    ds_read_b64_tr_b16 v[90:91], v32 offset:17416
    v_mfma_f32_16x16x32_bf16 a[4:7], v[68:71], a[212:215], a[4:7]
    ds_read_b64_tr_b16 v[92:93], v32 offset:24584
    v_mfma_f32_16x16x32_bf16 a[4:7], v[64:67], a[208:211], a[4:7]
    ds_read_b64_tr_b16 v[94:95], v32 offset:25608
    v_mfma_f32_16x16x32_bf16 a[8:11], v[64:67], a[224:227], a[8:11]
    v_mfma_f32_16x16x32_bf16 a[8:11], v[68:71], a[228:231], a[8:11]
    buffer_load_dwordx4 a[160:163], v112, s[8:11], s46 offen offset:0 sc1
    v_mfma_f32_16x16x32_bf16 a[8:11], v[72:75], a[232:235], a[8:11]
    v_mfma_f32_16x16x32_bf16 a[8:11], v[76:79], a[236:239], a[8:11]
    v_mfma_f32_16x16x32_bf16 a[12:15], v[76:79], a[252:255], a[12:15]
    v_mfma_f32_16x16x32_bf16 a[12:15], v[72:75], a[248:251], a[12:15]
    v_mfma_f32_16x16x32_bf16 a[12:15], v[68:71], a[244:247], a[12:15]
    buffer_load_dwordx4 a[164:167], v112, s[8:11], s46 offen offset:1024 sc1
    v_mfma_f32_16x16x32_bf16 a[12:15], v[64:67], a[240:243], a[12:15]
    s_waitcnt lgkmcnt(0)
    v_mfma_f32_16x16x32_bf16 a[28:31], v[80:83], a[240:243], a[28:31]
    ds_read_b64_tr_b16 v[64:65], v33 offset:0
    v_mfma_f32_16x16x32_bf16 a[28:31], v[84:87], a[244:247], a[28:31]
    ds_read_b64_tr_b16 v[66:67], v33 offset:1024
    v_mfma_f32_16x16x32_bf16 a[28:31], v[88:91], a[248:251], a[28:31]
    ds_read_b64_tr_b16 v[68:69], v33 offset:8192
    v_mfma_f32_16x16x32_bf16 a[28:31], v[92:95], a[252:255], a[28:31]
    ds_read_b64_tr_b16 v[70:71], v33 offset:9216
    v_mfma_f32_16x16x32_bf16 a[24:27], v[92:95], a[236:239], a[24:27]
    ds_read_b64_tr_b16 v[72:73], v33 offset:16384
    v_mfma_f32_16x16x32_bf16 a[24:27], v[88:91], a[232:235], a[24:27]
    ds_read_b64_tr_b16 v[74:75], v33 offset:17408
    v_mfma_f32_16x16x32_bf16 a[24:27], v[84:87], a[228:231], a[24:27]
    ds_read_b64_tr_b16 v[76:77], v33 offset:24576
    v_mfma_f32_16x16x32_bf16 a[24:27], v[80:83], a[224:227], a[24:27]
    ds_read_b64_tr_b16 v[78:79], v33 offset:25600
    v_mfma_f32_16x16x32_bf16 a[20:23], v[80:83], a[208:211], a[20:23]
    v_mfma_f32_16x16x32_bf16 a[20:23], v[84:87], a[212:215], a[20:23]
    buffer_load_dwordx4 a[168:171], v112, s[8:11], s46 offen offset:2048 sc1
    v_mfma_f32_16x16x32_bf16 a[20:23], v[88:91], a[216:219], a[20:23]
    v_mfma_f32_16x16x32_bf16 a[20:23], v[92:95], a[220:223], a[20:23]
    v_mfma_f32_16x16x32_bf16 a[16:19], v[92:95], a[204:207], a[16:19]
    v_mfma_f32_16x16x32_bf16 a[16:19], v[88:91], a[200:203], a[16:19]
    v_mfma_f32_16x16x32_bf16 a[16:19], v[84:87], a[196:199], a[16:19]
    buffer_load_dwordx4 a[172:175], v112, s[8:11], s46 offen offset:3072 sc1
    s_add_u32 s46, s46, 4096
    v_mfma_f32_16x16x32_bf16 a[16:19], v[80:83], a[192:195], a[16:19]
    s_waitcnt lgkmcnt(0)
    v_mfma_f32_16x16x32_bf16 a[32:35], v[64:67], a[192:195], a[32:35]
    ds_read_b64_tr_b16 v[80:81], v33 offset:8
    v_mfma_f32_16x16x32_bf16 a[32:35], v[68:71], a[196:199], a[32:35]
    ds_read_b64_tr_b16 v[82:83], v33 offset:1032
    v_mfma_f32_16x16x32_bf16 a[32:35], v[72:75], a[200:203], a[32:35]
    ds_read_b64_tr_b16 v[84:85], v33 offset:8200
    v_mfma_f32_16x16x32_bf16 a[32:35], v[76:79], a[204:207], a[32:35]
    ds_read_b64_tr_b16 v[86:87], v33 offset:9224
    v_mfma_f32_16x16x32_bf16 a[36:39], v[76:79], a[220:223], a[36:39]
    ds_read_b64_tr_b16 v[88:89], v33 offset:16392
    v_mfma_f32_16x16x32_bf16 a[36:39], v[72:75], a[216:219], a[36:39]
    ds_read_b64_tr_b16 v[90:91], v33 offset:17416
    v_mfma_f32_16x16x32_bf16 a[36:39], v[68:71], a[212:215], a[36:39]
    ds_read_b64_tr_b16 v[92:93], v33 offset:24584
    v_mfma_f32_16x16x32_bf16 a[36:39], v[64:67], a[208:211], a[36:39]
    ds_read_b64_tr_b16 v[94:95], v33 offset:25608
    v_mfma_f32_16x16x32_bf16 a[40:43], v[64:67], a[224:227], a[40:43]
    v_mfma_f32_16x16x32_bf16 a[40:43], v[68:71], a[228:231], a[40:43]
    buffer_load_dwordx4 a[176:179], v112, s[8:11], s47 offen offset:0 sc1
    v_mfma_f32_16x16x32_bf16 a[40:43], v[72:75], a[232:235], a[40:43]
    v_mfma_f32_16x16x32_bf16 a[40:43], v[76:79], a[236:239], a[40:43]
    v_mfma_f32_16x16x32_bf16 a[44:47], v[76:79], a[252:255], a[44:47]
    v_mfma_f32_16x16x32_bf16 a[44:47], v[72:75], a[248:251], a[44:47]
    v_mfma_f32_16x16x32_bf16 a[44:47], v[68:71], a[244:247], a[44:47]
    buffer_load_dwordx4 a[180:183], v112, s[8:11], s47 offen offset:1024 sc1
    v_mfma_f32_16x16x32_bf16 a[44:47], v[64:67], a[240:243], a[44:47]
    s_waitcnt lgkmcnt(0)
    v_mfma_f32_16x16x32_bf16 a[60:63], v[80:83], a[240:243], a[60:63]
    ds_read_b64_tr_b16 v[64:65], v34 offset:0
    v_mfma_f32_16x16x32_bf16 a[60:63], v[84:87], a[244:247], a[60:63]
    ds_read_b64_tr_b16 v[66:67], v34 offset:1024
    v_mfma_f32_16x16x32_bf16 a[60:63], v[88:91], a[248:251], a[60:63]
    ds_read_b64_tr_b16 v[68:69], v34 offset:8192
    v_mfma_f32_16x16x32_bf16 a[60:63], v[92:95], a[252:255], a[60:63]
    ds_read_b64_tr_b16 v[70:71], v34 offset:9216
    v_mfma_f32_16x16x32_bf16 a[56:59], v[92:95], a[236:239], a[56:59]
    ds_read_b64_tr_b16 v[72:73], v34 offset:16384
    v_mfma_f32_16x16x32_bf16 a[56:59], v[88:91], a[232:235], a[56:59]
    ds_read_b64_tr_b16 v[74:75], v34 offset:17408
    v_mfma_f32_16x16x32_bf16 a[56:59], v[84:87], a[228:231], a[56:59]
    ds_read_b64_tr_b16 v[76:77], v34 offset:24576
    v_mfma_f32_16x16x32_bf16 a[56:59], v[80:83], a[224:227], a[56:59]
    ds_read_b64_tr_b16 v[78:79], v34 offset:25600
    v_mfma_f32_16x16x32_bf16 a[52:55], v[80:83], a[208:211], a[52:55]
    v_mfma_f32_16x16x32_bf16 a[52:55], v[84:87], a[212:215], a[52:55]
    buffer_load_dwordx4 a[184:187], v112, s[8:11], s47 offen offset:2048 sc1
    v_mfma_f32_16x16x32_bf16 a[52:55], v[88:91], a[216:219], a[52:55]
    v_mfma_f32_16x16x32_bf16 a[52:55], v[92:95], a[220:223], a[52:55]
    v_mfma_f32_16x16x32_bf16 a[48:51], v[92:95], a[204:207], a[48:51]
    v_mfma_f32_16x16x32_bf16 a[48:51], v[88:91], a[200:203], a[48:51]
    v_mfma_f32_16x16x32_bf16 a[48:51], v[84:87], a[196:199], a[48:51]
    buffer_load_dwordx4 a[188:191], v112, s[8:11], s47 offen offset:3072 sc1
    s_add_u32 s47, s47, 4096
    v_mfma_f32_16x16x32_bf16 a[48:51], v[80:83], a[192:195], a[48:51]
    s_waitcnt lgkmcnt(0)
    v_mfma_f32_16x16x32_bf16 a[64:67], v[64:67], a[192:195], a[64:67]
    ds_read_b64_tr_b16 v[80:81], v34 offset:8
    v_mfma_f32_16x16x32_bf16 a[64:67], v[68:71], a[196:199], a[64:67]
    ds_read_b64_tr_b16 v[82:83], v34 offset:1032
    v_mfma_f32_16x16x32_bf16 a[64:67], v[72:75], a[200:203], a[64:67]
    ds_read_b64_tr_b16 v[84:85], v34 offset:8200
    v_mfma_f32_16x16x32_bf16 a[64:67], v[76:79], a[204:207], a[64:67]
    ds_read_b64_tr_b16 v[86:87], v34 offset:9224
    v_mfma_f32_16x16x32_bf16 a[68:71], v[76:79], a[220:223], a[68:71]
    ds_read_b64_tr_b16 v[88:89], v34 offset:16392
    v_mfma_f32_16x16x32_bf16 a[68:71], v[72:75], a[216:219], a[68:71]
    ds_read_b64_tr_b16 v[90:91], v34 offset:17416
    v_mfma_f32_16x16x32_bf16 a[68:71], v[68:71], a[212:215], a[68:71]
    ds_read_b64_tr_b16 v[92:93], v34 offset:24584
    v_mfma_f32_16x16x32_bf16 a[68:71], v[64:67], a[208:211], a[68:71]
    ds_read_b64_tr_b16 v[94:95], v34 offset:25608
    v_mfma_f32_16x16x32_bf16 a[72:75], v[64:67], a[224:227], a[72:75]
    s_add_u32 m0, s50, 32768
    v_mfma_f32_16x16x32_bf16 a[72:75], v[68:71], a[228:231], a[72:75]
    buffer_load_dwordx4 v20, s[20:23], s48 offen offset:0 nt lds
    v_mfma_f32_16x16x32_bf16 a[72:75], v[72:75], a[232:235], a[72:75]
    v_mfma_f32_16x16x32_bf16 a[72:75], v[76:79], a[236:239], a[72:75]
    v_mfma_f32_16x16x32_bf16 a[76:79], v[76:79], a[252:255], a[76:79]
    v_mfma_f32_16x16x32_bf16 a[76:79], v[72:75], a[248:251], a[76:79]
    v_mfma_f32_16x16x32_bf16 a[76:79], v[68:71], a[244:247], a[76:79]
    buffer_load_dwordx4 v21, s[20:23], s48 offen offset:1024 nt lds
    v_mfma_f32_16x16x32_bf16 a[76:79], v[64:67], a[240:243], a[76:79]
    s_waitcnt lgkmcnt(0)
    v_mfma_f32_16x16x32_bf16 a[92:95], v[80:83], a[240:243], a[92:95]
    ds_read_b64_tr_b16 v[64:65], v35 offset:0
    v_mfma_f32_16x16x32_bf16 a[92:95], v[84:87], a[244:247], a[92:95]
    ds_read_b64_tr_b16 v[66:67], v35 offset:1024
    v_mfma_f32_16x16x32_bf16 a[92:95], v[88:91], a[248:251], a[92:95]
    ds_read_b64_tr_b16 v[68:69], v35 offset:8192
    v_mfma_f32_16x16x32_bf16 a[92:95], v[92:95], a[252:255], a[92:95]
    ds_read_b64_tr_b16 v[70:71], v35 offset:9216
    v_mfma_f32_16x16x32_bf16 a[88:91], v[92:95], a[236:239], a[88:91]
    ds_read_b64_tr_b16 v[72:73], v35 offset:16384
    v_mfma_f32_16x16x32_bf16 a[88:91], v[88:91], a[232:235], a[88:91]
    ds_read_b64_tr_b16 v[74:75], v35 offset:17408
    v_mfma_f32_16x16x32_bf16 a[88:91], v[84:87], a[228:231], a[88:91]
    ds_read_b64_tr_b16 v[76:77], v35 offset:24576
    v_mfma_f32_16x16x32_bf16 a[88:91], v[80:83], a[224:227], a[88:91]
    ds_read_b64_tr_b16 v[78:79], v35 offset:25600
    v_mfma_f32_16x16x32_bf16 a[84:87], v[80:83], a[208:211], a[84:87]
    v_mfma_f32_16x16x32_bf16 a[84:87], v[84:87], a[212:215], a[84:87]
    buffer_load_dwordx4 v22, s[20:23], s48 offen offset:2048 nt lds
    v_mfma_f32_16x16x32_bf16 a[84:87], v[88:91], a[216:219], a[84:87]
    v_mfma_f32_16x16x32_bf16 a[84:87], v[92:95], a[220:223], a[84:87]
    v_mfma_f32_16x16x32_bf16 a[80:83], v[92:95], a[204:207], a[80:83]
    v_mfma_f32_16x16x32_bf16 a[80:83], v[88:91], a[200:203], a[80:83]
    v_mfma_f32_16x16x32_bf16 a[80:83], v[84:87], a[196:199], a[80:83]
    buffer_load_dwordx4 v23, s[20:23], s48 offen offset:3072 nt lds
    s_add_u32 s48, s48, 110592
    v_mfma_f32_16x16x32_bf16 a[80:83], v[80:83], a[192:195], a[80:83]
    s_waitcnt lgkmcnt(0)
    v_mfma_f32_16x16x32_bf16 a[96:99], v[64:67], a[192:195], a[96:99]
    ds_read_b64_tr_b16 v[80:81], v35 offset:8
    v_mfma_f32_16x16x32_bf16 a[96:99], v[68:71], a[196:199], a[96:99]
    ds_read_b64_tr_b16 v[82:83], v35 offset:1032
    v_mfma_f32_16x16x32_bf16 a[96:99], v[72:75], a[200:203], a[96:99]
    ds_read_b64_tr_b16 v[84:85], v35 offset:8200
    v_mfma_f32_16x16x32_bf16 a[96:99], v[76:79], a[204:207], a[96:99]
    ds_read_b64_tr_b16 v[86:87], v35 offset:9224
    v_mfma_f32_16x16x32_bf16 a[100:103], v[76:79], a[220:223], a[100:103]
    ds_read_b64_tr_b16 v[88:89], v35 offset:16392
    v_mfma_f32_16x16x32_bf16 a[100:103], v[72:75], a[216:219], a[100:103]
    ds_read_b64_tr_b16 v[90:91], v35 offset:17416
    v_mfma_f32_16x16x32_bf16 a[100:103], v[68:71], a[212:215], a[100:103]
    ds_read_b64_tr_b16 v[92:93], v35 offset:24584
    v_mfma_f32_16x16x32_bf16 a[100:103], v[64:67], a[208:211], a[100:103]
    ds_read_b64_tr_b16 v[94:95], v35 offset:25608
    v_mfma_f32_16x16x32_bf16 a[104:107], v[64:67], a[224:227], a[104:107]
    s_add_u32 m0, s50, 36864
    v_mfma_f32_16x16x32_bf16 a[104:107], v[68:71], a[228:231], a[104:107]
    buffer_load_dwordx4 v20, s[20:23], s48 offen offset:0 nt lds
    v_mfma_f32_16x16x32_bf16 a[104:107], v[72:75], a[232:235], a[104:107]
    v_mfma_f32_16x16x32_bf16 a[104:107], v[76:79], a[236:239], a[104:107]
    v_mfma_f32_16x16x32_bf16 a[108:111], v[76:79], a[252:255], a[108:111]
    v_mfma_f32_16x16x32_bf16 a[108:111], v[72:75], a[248:251], a[108:111]
    v_mfma_f32_16x16x32_bf16 a[108:111], v[68:71], a[244:247], a[108:111]
    buffer_load_dwordx4 v21, s[20:23], s48 offen offset:1024 nt lds
    v_mfma_f32_16x16x32_bf16 a[108:111], v[64:67], a[240:243], a[108:111]
    s_waitcnt vmcnt(30) lgkmcnt(0)
    s_barrier
    v_mfma_f32_16x16x32_bf16 a[124:127], v[80:83], a[240:243], a[124:127]
    ds_read_b64_tr_b16 v[64:65], v28 offset:0
    v_mfma_f32_16x16x32_bf16 a[124:127], v[84:87], a[244:247], a[124:127]
    ds_read_b64_tr_b16 v[66:67], v28 offset:512
    v_mfma_f32_16x16x32_bf16 a[124:127], v[88:91], a[248:251], a[124:127]
    ds_read_b64_tr_b16 v[68:69], v28 offset:4096
    v_mfma_f32_16x16x32_bf16 a[124:127], v[92:95], a[252:255], a[124:127]
    ds_read_b64_tr_b16 v[70:71], v28 offset:4608
    v_mfma_f32_16x16x32_bf16 a[120:123], v[92:95], a[236:239], a[120:123]
    ds_read_b64_tr_b16 v[72:73], v28 offset:8192
    v_mfma_f32_16x16x32_bf16 a[120:123], v[88:91], a[232:235], a[120:123]
    ds_read_b64_tr_b16 v[74:75], v28 offset:8704
    v_mfma_f32_16x16x32_bf16 a[120:123], v[84:87], a[228:231], a[120:123]
    ds_read_b64_tr_b16 v[76:77], v28 offset:12288
    v_mfma_f32_16x16x32_bf16 a[120:123], v[80:83], a[224:227], a[120:123]
    ds_read_b64_tr_b16 v[78:79], v28 offset:12800
    v_mfma_f32_16x16x32_bf16 a[116:119], v[80:83], a[208:211], a[116:119]
    v_mfma_f32_16x16x32_bf16 a[116:119], v[84:87], a[212:215], a[116:119]
    buffer_load_dwordx4 v22, s[20:23], s48 offen offset:2048 nt lds
    v_mfma_f32_16x16x32_bf16 a[116:119], v[88:91], a[216:219], a[116:119]
    v_mfma_f32_16x16x32_bf16 a[116:119], v[92:95], a[220:223], a[116:119]
    v_mfma_f32_16x16x32_bf16 a[112:115], v[92:95], a[204:207], a[112:115]
    v_mfma_f32_16x16x32_bf16 a[112:115], v[88:91], a[200:203], a[112:115]
    v_mfma_f32_16x16x32_bf16 a[112:115], v[84:87], a[196:199], a[112:115]
    buffer_load_dwordx4 v23, s[20:23], s48 offen offset:3072 nt lds
    s_add_u32 s48, s48, 331776
    v_mfma_f32_16x16x32_bf16 a[112:115], v[80:83], a[192:195], a[112:115]
    s_waitcnt vmcnt(8) lgkmcnt(0)
    v_mfma_f32_16x16x32_bf16 v[128:131], v[64:67], a[128:131], v[128:131]
    ds_read_b64_tr_b16 v[80:81], v28 offset:16384
    v_mfma_f32_16x16x32_bf16 v[128:131], v[68:71], a[132:135], v[128:131]
    ds_read_b64_tr_b16 v[82:83], v28 offset:16896
    v_mfma_f32_16x16x32_bf16 v[128:131], v[72:75], a[136:139], v[128:131]
    ds_read_b64_tr_b16 v[84:85], v28 offset:20480
    v_mfma_f32_16x16x32_bf16 v[128:131], v[76:79], a[140:143], v[128:131]
    ds_read_b64_tr_b16 v[86:87], v28 offset:20992
    s_add_u32 m0, s50, 131072
    v_mfma_f32_16x16x32_bf16 v[132:135], v[76:79], a[156:159], v[132:135]
    buffer_load_dwordx4 v20, s[20:23], s48 offen offset:0 nt lds
    ds_read_b64_tr_b16 v[88:89], v28 offset:24576
    v_mfma_f32_16x16x32_bf16 v[132:135], v[72:75], a[152:155], v[132:135]
    ds_read_b64_tr_b16 v[90:91], v28 offset:25088
    v_mfma_f32_16x16x32_bf16 v[132:135], v[68:71], a[148:151], v[132:135]
    ds_read_b64_tr_b16 v[92:93], v28 offset:28672
    v_mfma_f32_16x16x32_bf16 v[132:135], v[64:67], a[144:147], v[132:135]
    ds_read_b64_tr_b16 v[94:95], v28 offset:29184
    v_mfma_f32_16x16x32_bf16 v[136:139], v[64:67], a[160:163], v[136:139]
    v_mfma_f32_16x16x32_bf16 v[136:139], v[68:71], a[164:167], v[136:139]
    buffer_load_dwordx4 v21, s[20:23], s48 offen offset:1024 nt lds
    v_mfma_f32_16x16x32_bf16 v[136:139], v[72:75], a[168:171], v[136:139]
    v_mfma_f32_16x16x32_bf16 v[136:139], v[76:79], a[172:175], v[136:139]
    v_mfma_f32_16x16x32_bf16 v[140:143], v[76:79], a[188:191], v[140:143]
    v_mfma_f32_16x16x32_bf16 v[140:143], v[72:75], a[184:187], v[140:143]
    v_mfma_f32_16x16x32_bf16 v[140:143], v[68:71], a[180:183], v[140:143]
    buffer_load_dwordx4 v22, s[20:23], s48 offen offset:2048 nt lds
    v_mfma_f32_16x16x32_bf16 v[140:143], v[64:67], a[176:179], v[140:143]
    s_waitcnt lgkmcnt(0)
    v_mfma_f32_16x16x32_bf16 v[204:207], v[80:83], a[176:179], v[204:207]
    ds_read_b64_tr_b16 v[64:65], v29 offset:0
    v_mfma_f32_16x16x32_bf16 v[204:207], v[84:87], a[180:183], v[204:207]
    ds_read_b64_tr_b16 v[66:67], v29 offset:512
    v_mfma_f32_16x16x32_bf16 v[204:207], v[88:91], a[184:187], v[204:207]
    ds_read_b64_tr_b16 v[68:69], v29 offset:4096
    v_mfma_f32_16x16x32_bf16 v[204:207], v[92:95], a[188:191], v[204:207]
    ds_read_b64_tr_b16 v[70:71], v29 offset:4608
    v_mfma_f32_16x16x32_bf16 v[200:203], v[92:95], a[172:175], v[200:203]
    buffer_load_dwordx4 v23, s[20:23], s48 offen offset:3072 nt lds
    ds_read_b64_tr_b16 v[72:73], v29 offset:8192
    s_add_u32 s48, s48, 110592
    v_mfma_f32_16x16x32_bf16 v[200:203], v[88:91], a[168:171], v[200:203]
    ds_read_b64_tr_b16 v[74:75], v29 offset:8704
    v_mfma_f32_16x16x32_bf16 v[200:203], v[84:87], a[164:167], v[200:203]
    ds_read_b64_tr_b16 v[76:77], v29 offset:12288
    v_mfma_f32_16x16x32_bf16 v[200:203], v[80:83], a[160:163], v[200:203]
    ds_read_b64_tr_b16 v[78:79], v29 offset:12800
    v_mfma_f32_16x16x32_bf16 v[196:199], v[80:83], a[144:147], v[196:199]
    s_add_u32 m0, s50, 135168
    v_mfma_f32_16x16x32_bf16 v[196:199], v[84:87], a[148:151], v[196:199]
    buffer_load_dwordx4 v20, s[20:23], s48 offen offset:0 nt lds
    v_mfma_f32_16x16x32_bf16 v[196:199], v[88:91], a[152:155], v[196:199]
    v_mfma_f32_16x16x32_bf16 v[196:199], v[92:95], a[156:159], v[196:199]
    v_mfma_f32_16x16x32_bf16 v[192:195], v[92:95], a[140:143], v[192:195]
    v_mfma_f32_16x16x32_bf16 v[192:195], v[88:91], a[136:139], v[192:195]
    v_mfma_f32_16x16x32_bf16 v[192:195], v[84:87], a[132:135], v[192:195]
    buffer_load_dwordx4 v21, s[20:23], s48 offen offset:1024 nt lds
    v_mfma_f32_16x16x32_bf16 v[192:195], v[80:83], a[128:131], v[192:195]
    s_waitcnt lgkmcnt(0)
    v_mfma_f32_16x16x32_bf16 v[144:147], v[64:67], a[128:131], v[144:147]
    ds_read_b64_tr_b16 v[80:81], v29 offset:16384
    v_mfma_f32_16x16x32_bf16 v[144:147], v[68:71], a[132:135], v[144:147]
    ds_read_b64_tr_b16 v[82:83], v29 offset:16896
    v_mfma_f32_16x16x32_bf16 v[144:147], v[72:75], a[136:139], v[144:147]
    ds_read_b64_tr_b16 v[84:85], v29 offset:20480
    v_mfma_f32_16x16x32_bf16 v[144:147], v[76:79], a[140:143], v[144:147]
    ds_read_b64_tr_b16 v[86:87], v29 offset:20992
    v_mfma_f32_16x16x32_bf16 v[148:151], v[76:79], a[156:159], v[148:151]
    buffer_load_dwordx4 v22, s[20:23], s48 offen offset:2048 nt lds
    ds_read_b64_tr_b16 v[88:89], v29 offset:24576
    v_mfma_f32_16x16x32_bf16 v[148:151], v[72:75], a[152:155], v[148:151]
    ds_read_b64_tr_b16 v[90:91], v29 offset:25088
    v_mfma_f32_16x16x32_bf16 v[148:151], v[68:71], a[148:151], v[148:151]
    ds_read_b64_tr_b16 v[92:93], v29 offset:28672
    v_mfma_f32_16x16x32_bf16 v[148:151], v[64:67], a[144:147], v[148:151]
    ds_read_b64_tr_b16 v[94:95], v29 offset:29184
    v_mfma_f32_16x16x32_bf16 v[152:155], v[64:67], a[160:163], v[152:155]
    v_mfma_f32_16x16x32_bf16 v[152:155], v[68:71], a[164:167], v[152:155]
    buffer_load_dwordx4 v23, s[20:23], s48 offen offset:3072 nt lds
    s_add_u32 s48, s48, 331776
    v_mfma_f32_16x16x32_bf16 v[152:155], v[72:75], a[168:171], v[152:155]
    v_mfma_f32_16x16x32_bf16 v[152:155], v[76:79], a[172:175], v[152:155]
    v_mfma_f32_16x16x32_bf16 v[156:159], v[76:79], a[188:191], v[156:159]
    v_mfma_f32_16x16x32_bf16 v[156:159], v[72:75], a[184:187], v[156:159]
    s_add_u32 m0, s50, 65536
    v_mfma_f32_16x16x32_bf16 v[156:159], v[68:71], a[180:183], v[156:159]
    buffer_load_dwordx4 v24, s[16:19], s49 offen offset:0 nt lds
    v_mfma_f32_16x16x32_bf16 v[156:159], v[64:67], a[176:179], v[156:159]
    s_waitcnt lgkmcnt(0)
    v_mfma_f32_16x16x32_bf16 v[220:223], v[80:83], a[176:179], v[220:223]
    ds_read_b64_tr_b16 v[64:65], v30 offset:0
    v_mfma_f32_16x16x32_bf16 v[220:223], v[84:87], a[180:183], v[220:223]
    ds_read_b64_tr_b16 v[66:67], v30 offset:512
    v_mfma_f32_16x16x32_bf16 v[220:223], v[88:91], a[184:187], v[220:223]
    ds_read_b64_tr_b16 v[68:69], v30 offset:4096
    v_mfma_f32_16x16x32_bf16 v[220:223], v[92:95], a[188:191], v[220:223]
    ds_read_b64_tr_b16 v[70:71], v30 offset:4608
    v_mfma_f32_16x16x32_bf16 v[216:219], v[92:95], a[172:175], v[216:219]
    buffer_load_dwordx4 v25, s[16:19], s49 offen offset:1024 nt lds
    ds_read_b64_tr_b16 v[72:73], v30 offset:8192
    v_mfma_f32_16x16x32_bf16 v[216:219], v[88:91], a[168:171], v[216:219]
    ds_read_b64_tr_b16 v[74:75], v30 offset:8704
    v_mfma_f32_16x16x32_bf16 v[216:219], v[84:87], a[164:167], v[216:219]
    ds_read_b64_tr_b16 v[76:77], v30 offset:12288
    v_mfma_f32_16x16x32_bf16 v[216:219], v[80:83], a[160:163], v[216:219]
    ds_read_b64_tr_b16 v[78:79], v30 offset:12800
    v_mfma_f32_16x16x32_bf16 v[212:215], v[80:83], a[144:147], v[212:215]
    v_mfma_f32_16x16x32_bf16 v[212:215], v[84:87], a[148:151], v[212:215]
    buffer_load_dwordx4 v26, s[16:19], s49 offen offset:2048 nt lds
    v_mfma_f32_16x16x32_bf16 v[212:215], v[88:91], a[152:155], v[212:215]
    v_mfma_f32_16x16x32_bf16 v[212:215], v[92:95], a[156:159], v[212:215]
    v_mfma_f32_16x16x32_bf16 v[208:211], v[92:95], a[140:143], v[208:211]
    v_mfma_f32_16x16x32_bf16 v[208:211], v[88:91], a[136:139], v[208:211]
    v_mfma_f32_16x16x32_bf16 v[208:211], v[84:87], a[132:135], v[208:211]
    buffer_load_dwordx4 v27, s[16:19], s49 offen offset:3072 nt lds
    s_add_u32 s49, s49, 131072
    v_mfma_f32_16x16x32_bf16 v[208:211], v[80:83], a[128:131], v[208:211]
    s_waitcnt lgkmcnt(0)
    v_mfma_f32_16x16x32_bf16 v[160:163], v[64:67], a[128:131], v[160:163]
    ds_read_b64_tr_b16 v[80:81], v30 offset:16384
    v_mfma_f32_16x16x32_bf16 v[160:163], v[68:71], a[132:135], v[160:163]
    ds_read_b64_tr_b16 v[82:83], v30 offset:16896
    v_mfma_f32_16x16x32_bf16 v[160:163], v[72:75], a[136:139], v[160:163]
    ds_read_b64_tr_b16 v[84:85], v30 offset:20480
    v_mfma_f32_16x16x32_bf16 v[160:163], v[76:79], a[140:143], v[160:163]
    ds_read_b64_tr_b16 v[86:87], v30 offset:20992
    s_add_u32 m0, s50, 69632
    v_mfma_f32_16x16x32_bf16 v[164:167], v[76:79], a[156:159], v[164:167]
    buffer_load_dwordx4 v24, s[16:19], s49 offen offset:0 nt lds
    ds_read_b64_tr_b16 v[88:89], v30 offset:24576
    v_mfma_f32_16x16x32_bf16 v[164:167], v[72:75], a[152:155], v[164:167]
    ds_read_b64_tr_b16 v[90:91], v30 offset:25088
    v_mfma_f32_16x16x32_bf16 v[164:167], v[68:71], a[148:151], v[164:167]
    ds_read_b64_tr_b16 v[92:93], v30 offset:28672
    v_mfma_f32_16x16x32_bf16 v[164:167], v[64:67], a[144:147], v[164:167]
    ds_read_b64_tr_b16 v[94:95], v30 offset:29184
    v_mfma_f32_16x16x32_bf16 v[168:171], v[64:67], a[160:163], v[168:171]
    v_mfma_f32_16x16x32_bf16 v[168:171], v[68:71], a[164:167], v[168:171]
    buffer_load_dwordx4 v25, s[16:19], s49 offen offset:1024 nt lds
    v_mfma_f32_16x16x32_bf16 v[168:171], v[72:75], a[168:171], v[168:171]
    v_mfma_f32_16x16x32_bf16 v[168:171], v[76:79], a[172:175], v[168:171]
    v_mfma_f32_16x16x32_bf16 v[172:175], v[76:79], a[188:191], v[172:175]
    v_mfma_f32_16x16x32_bf16 v[172:175], v[72:75], a[184:187], v[172:175]
    v_mfma_f32_16x16x32_bf16 v[172:175], v[68:71], a[180:183], v[172:175]
    buffer_load_dwordx4 v26, s[16:19], s49 offen offset:2048 nt lds
    v_mfma_f32_16x16x32_bf16 v[172:175], v[64:67], a[176:179], v[172:175]
    s_waitcnt lgkmcnt(0)
    v_mfma_f32_16x16x32_bf16 v[236:239], v[80:83], a[176:179], v[236:239]
    ds_read_b64_tr_b16 v[64:65], v31 offset:0
    v_mfma_f32_16x16x32_bf16 v[236:239], v[84:87], a[180:183], v[236:239]
    ds_read_b64_tr_b16 v[66:67], v31 offset:512
    v_mfma_f32_16x16x32_bf16 v[236:239], v[88:91], a[184:187], v[236:239]
    ds_read_b64_tr_b16 v[68:69], v31 offset:4096
    v_mfma_f32_16x16x32_bf16 v[236:239], v[92:95], a[188:191], v[236:239]
    ds_read_b64_tr_b16 v[70:71], v31 offset:4608
    v_mfma_f32_16x16x32_bf16 v[232:235], v[92:95], a[172:175], v[232:235]
    buffer_load_dwordx4 v27, s[16:19], s49 offen offset:3072 nt lds
    ds_read_b64_tr_b16 v[72:73], v31 offset:8192
    s_add_u32 s49, s49, 917504
    v_mfma_f32_16x16x32_bf16 v[232:235], v[88:91], a[168:171], v[232:235]
    ds_read_b64_tr_b16 v[74:75], v31 offset:8704
    v_mfma_f32_16x16x32_bf16 v[232:235], v[84:87], a[164:167], v[232:235]
    ds_read_b64_tr_b16 v[76:77], v31 offset:12288
    v_mfma_f32_16x16x32_bf16 v[232:235], v[80:83], a[160:163], v[232:235]
    ds_read_b64_tr_b16 v[78:79], v31 offset:12800
    v_mfma_f32_16x16x32_bf16 v[228:231], v[80:83], a[144:147], v[228:231]
    v_mfma_f32_16x16x32_bf16 v[228:231], v[84:87], a[148:151], v[228:231]
    buffer_load_dwordx4 a[192:195], v112, s[8:11], s44 offen offset:0 sc1
    v_mfma_f32_16x16x32_bf16 v[228:231], v[88:91], a[152:155], v[228:231]
    v_mfma_f32_16x16x32_bf16 v[228:231], v[92:95], a[156:159], v[228:231]
    v_mfma_f32_16x16x32_bf16 v[224:227], v[92:95], a[140:143], v[224:227]
    v_mfma_f32_16x16x32_bf16 v[224:227], v[88:91], a[136:139], v[224:227]
    v_mfma_f32_16x16x32_bf16 v[224:227], v[84:87], a[132:135], v[224:227]
    buffer_load_dwordx4 a[196:199], v112, s[8:11], s44 offen offset:1024 sc1
    v_mfma_f32_16x16x32_bf16 v[224:227], v[80:83], a[128:131], v[224:227]
    s_waitcnt lgkmcnt(0)
    v_mfma_f32_16x16x32_bf16 v[176:179], v[64:67], a[128:131], v[176:179]
    ds_read_b64_tr_b16 v[80:81], v31 offset:16384
    v_mfma_f32_16x16x32_bf16 v[176:179], v[68:71], a[132:135], v[176:179]
    ds_read_b64_tr_b16 v[82:83], v31 offset:16896
    v_mfma_f32_16x16x32_bf16 v[176:179], v[72:75], a[136:139], v[176:179]
    ds_read_b64_tr_b16 v[84:85], v31 offset:20480
    v_mfma_f32_16x16x32_bf16 v[176:179], v[76:79], a[140:143], v[176:179]
    ds_read_b64_tr_b16 v[86:87], v31 offset:20992
    v_mfma_f32_16x16x32_bf16 v[180:183], v[76:79], a[156:159], v[180:183]
    buffer_load_dwordx4 a[200:203], v112, s[8:11], s44 offen offset:2048 sc1
    ds_read_b64_tr_b16 v[88:89], v31 offset:24576
    v_mfma_f32_16x16x32_bf16 v[180:183], v[72:75], a[152:155], v[180:183]
    ds_read_b64_tr_b16 v[90:91], v31 offset:25088
    v_mfma_f32_16x16x32_bf16 v[180:183], v[68:71], a[148:151], v[180:183]
    ds_read_b64_tr_b16 v[92:93], v31 offset:28672
    v_mfma_f32_16x16x32_bf16 v[180:183], v[64:67], a[144:147], v[180:183]
    ds_read_b64_tr_b16 v[94:95], v31 offset:29184
    v_mfma_f32_16x16x32_bf16 v[184:187], v[64:67], a[160:163], v[184:187]
    v_mfma_f32_16x16x32_bf16 v[184:187], v[68:71], a[164:167], v[184:187]
    buffer_load_dwordx4 a[204:207], v112, s[8:11], s44 offen offset:3072 sc1
    s_add_u32 s44, s44, 4096
    v_mfma_f32_16x16x32_bf16 v[184:187], v[72:75], a[168:171], v[184:187]
    v_mfma_f32_16x16x32_bf16 v[184:187], v[76:79], a[172:175], v[184:187]
    v_mfma_f32_16x16x32_bf16 v[188:191], v[76:79], a[188:191], v[188:191]
    v_mfma_f32_16x16x32_bf16 v[188:191], v[72:75], a[184:187], v[188:191]
    v_mfma_f32_16x16x32_bf16 v[188:191], v[68:71], a[180:183], v[188:191]
    buffer_load_dwordx4 a[208:211], v112, s[8:11], s45 offen offset:0 sc1
    v_mfma_f32_16x16x32_bf16 v[188:191], v[64:67], a[176:179], v[188:191]
    s_waitcnt lgkmcnt(0)
    s_barrier
    v_mfma_f32_16x16x32_bf16 v[252:255], v[80:83], a[176:179], v[252:255]
    ds_read_b64_tr_b16 v[64:65], v32 offset:32768
    v_mfma_f32_16x16x32_bf16 v[252:255], v[84:87], a[180:183], v[252:255]
    ds_read_b64_tr_b16 v[66:67], v32 offset:33792
    v_mfma_f32_16x16x32_bf16 v[252:255], v[88:91], a[184:187], v[252:255]
    ds_read_b64_tr_b16 v[68:69], v32 offset:40960
    v_mfma_f32_16x16x32_bf16 v[252:255], v[92:95], a[188:191], v[252:255]
    ds_read_b64_tr_b16 v[70:71], v32 offset:41984
    v_mfma_f32_16x16x32_bf16 v[248:251], v[92:95], a[172:175], v[248:251]
    buffer_load_dwordx4 a[212:215], v112, s[8:11], s45 offen offset:1024 sc1
    ds_read_b64_tr_b16 v[72:73], v32 offset:49152
    v_mfma_f32_16x16x32_bf16 v[248:251], v[88:91], a[168:171], v[248:251]
    ds_read_b64_tr_b16 v[74:75], v32 offset:50176
    v_mfma_f32_16x16x32_bf16 v[248:251], v[84:87], a[164:167], v[248:251]
    ds_read_b64_tr_b16 v[76:77], v32 offset:57344
    v_mfma_f32_16x16x32_bf16 v[248:251], v[80:83], a[160:163], v[248:251]
    ds_read_b64_tr_b16 v[78:79], v32 offset:58368
    v_mfma_f32_16x16x32_bf16 v[244:247], v[80:83], a[144:147], v[244:247]
    v_mfma_f32_16x16x32_bf16 v[244:247], v[84:87], a[148:151], v[244:247]
    buffer_load_dwordx4 a[216:219], v112, s[8:11], s45 offen offset:2048 sc1
    v_mfma_f32_16x16x32_bf16 v[244:247], v[88:91], a[152:155], v[244:247]
    v_mfma_f32_16x16x32_bf16 v[244:247], v[92:95], a[156:159], v[244:247]
    v_mfma_f32_16x16x32_bf16 v[240:243], v[92:95], a[140:143], v[240:243]
    v_mfma_f32_16x16x32_bf16 v[240:243], v[88:91], a[136:139], v[240:243]
    v_mfma_f32_16x16x32_bf16 v[240:243], v[84:87], a[132:135], v[240:243]
    buffer_load_dwordx4 a[220:223], v112, s[8:11], s45 offen offset:3072 sc1
    s_add_u32 s45, s45, 4096
    v_mfma_f32_16x16x32_bf16 v[240:243], v[80:83], a[128:131], v[240:243]
    s_waitcnt lgkmcnt(0)
    v_mfma_f32_16x16x32_bf16 a[0:3], v[64:67], a[128:131], a[0:3]
    ds_read_b64_tr_b16 v[80:81], v32 offset:32776
    v_mfma_f32_16x16x32_bf16 a[0:3], v[68:71], a[132:135], a[0:3]
    ds_read_b64_tr_b16 v[82:83], v32 offset:33800
    v_mfma_f32_16x16x32_bf16 a[0:3], v[72:75], a[136:139], a[0:3]
    ds_read_b64_tr_b16 v[84:85], v32 offset:40968
    v_mfma_f32_16x16x32_bf16 a[0:3], v[76:79], a[140:143], a[0:3]
    ds_read_b64_tr_b16 v[86:87], v32 offset:41992
    v_mfma_f32_16x16x32_bf16 a[4:7], v[76:79], a[156:159], a[4:7]
    ds_read_b64_tr_b16 v[88:89], v32 offset:49160
    v_mfma_f32_16x16x32_bf16 a[4:7], v[72:75], a[152:155], a[4:7]
    ds_read_b64_tr_b16 v[90:91], v32 offset:50184
    v_mfma_f32_16x16x32_bf16 a[4:7], v[68:71], a[148:151], a[4:7]
    ds_read_b64_tr_b16 v[92:93], v32 offset:57352
    v_mfma_f32_16x16x32_bf16 a[4:7], v[64:67], a[144:147], a[4:7]
    ds_read_b64_tr_b16 v[94:95], v32 offset:58376
    v_mfma_f32_16x16x32_bf16 a[8:11], v[64:67], a[160:163], a[8:11]
    v_mfma_f32_16x16x32_bf16 a[8:11], v[68:71], a[164:167], a[8:11]
    buffer_load_dwordx4 a[224:227], v112, s[8:11], s46 offen offset:0 sc1
    v_mfma_f32_16x16x32_bf16 a[8:11], v[72:75], a[168:171], a[8:11]
    v_mfma_f32_16x16x32_bf16 a[8:11], v[76:79], a[172:175], a[8:11]
    v_mfma_f32_16x16x32_bf16 a[12:15], v[76:79], a[188:191], a[12:15]
    v_mfma_f32_16x16x32_bf16 a[12:15], v[72:75], a[184:187], a[12:15]
    v_mfma_f32_16x16x32_bf16 a[12:15], v[68:71], a[180:183], a[12:15]
    buffer_load_dwordx4 a[228:231], v112, s[8:11], s46 offen offset:1024 sc1
    v_mfma_f32_16x16x32_bf16 a[12:15], v[64:67], a[176:179], a[12:15]
    s_waitcnt lgkmcnt(0)
    v_mfma_f32_16x16x32_bf16 a[28:31], v[80:83], a[176:179], a[28:31]
    ds_read_b64_tr_b16 v[64:65], v33 offset:32768
    v_mfma_f32_16x16x32_bf16 a[28:31], v[84:87], a[180:183], a[28:31]
    ds_read_b64_tr_b16 v[66:67], v33 offset:33792
    v_mfma_f32_16x16x32_bf16 a[28:31], v[88:91], a[184:187], a[28:31]
    ds_read_b64_tr_b16 v[68:69], v33 offset:40960
    v_mfma_f32_16x16x32_bf16 a[28:31], v[92:95], a[188:191], a[28:31]
    ds_read_b64_tr_b16 v[70:71], v33 offset:41984
    v_mfma_f32_16x16x32_bf16 a[24:27], v[92:95], a[172:175], a[24:27]
    ds_read_b64_tr_b16 v[72:73], v33 offset:49152
    v_mfma_f32_16x16x32_bf16 a[24:27], v[88:91], a[168:171], a[24:27]
    ds_read_b64_tr_b16 v[74:75], v33 offset:50176
    v_mfma_f32_16x16x32_bf16 a[24:27], v[84:87], a[164:167], a[24:27]
    ds_read_b64_tr_b16 v[76:77], v33 offset:57344
    v_mfma_f32_16x16x32_bf16 a[24:27], v[80:83], a[160:163], a[24:27]
    ds_read_b64_tr_b16 v[78:79], v33 offset:58368
    v_mfma_f32_16x16x32_bf16 a[20:23], v[80:83], a[144:147], a[20:23]
    v_mfma_f32_16x16x32_bf16 a[20:23], v[84:87], a[148:151], a[20:23]
    buffer_load_dwordx4 a[232:235], v112, s[8:11], s46 offen offset:2048 sc1
    v_mfma_f32_16x16x32_bf16 a[20:23], v[88:91], a[152:155], a[20:23]
    v_mfma_f32_16x16x32_bf16 a[20:23], v[92:95], a[156:159], a[20:23]
    v_mfma_f32_16x16x32_bf16 a[16:19], v[92:95], a[140:143], a[16:19]
    v_mfma_f32_16x16x32_bf16 a[16:19], v[88:91], a[136:139], a[16:19]
    v_mfma_f32_16x16x32_bf16 a[16:19], v[84:87], a[132:135], a[16:19]
    buffer_load_dwordx4 a[236:239], v112, s[8:11], s46 offen offset:3072 sc1
    s_add_u32 s46, s46, 4096
    v_mfma_f32_16x16x32_bf16 a[16:19], v[80:83], a[128:131], a[16:19]
    s_waitcnt lgkmcnt(0)
    v_mfma_f32_16x16x32_bf16 a[32:35], v[64:67], a[128:131], a[32:35]
    ds_read_b64_tr_b16 v[80:81], v33 offset:32776
    v_mfma_f32_16x16x32_bf16 a[32:35], v[68:71], a[132:135], a[32:35]
    ds_read_b64_tr_b16 v[82:83], v33 offset:33800
    v_mfma_f32_16x16x32_bf16 a[32:35], v[72:75], a[136:139], a[32:35]
    ds_read_b64_tr_b16 v[84:85], v33 offset:40968
    v_mfma_f32_16x16x32_bf16 a[32:35], v[76:79], a[140:143], a[32:35]
    ds_read_b64_tr_b16 v[86:87], v33 offset:41992
    v_mfma_f32_16x16x32_bf16 a[36:39], v[76:79], a[156:159], a[36:39]
    ds_read_b64_tr_b16 v[88:89], v33 offset:49160
    v_mfma_f32_16x16x32_bf16 a[36:39], v[72:75], a[152:155], a[36:39]
    ds_read_b64_tr_b16 v[90:91], v33 offset:50184
    v_mfma_f32_16x16x32_bf16 a[36:39], v[68:71], a[148:151], a[36:39]
    ds_read_b64_tr_b16 v[92:93], v33 offset:57352
    v_mfma_f32_16x16x32_bf16 a[36:39], v[64:67], a[144:147], a[36:39]
    ds_read_b64_tr_b16 v[94:95], v33 offset:58376
    v_mfma_f32_16x16x32_bf16 a[40:43], v[64:67], a[160:163], a[40:43]
    v_mfma_f32_16x16x32_bf16 a[40:43], v[68:71], a[164:167], a[40:43]
    buffer_load_dwordx4 a[240:243], v112, s[8:11], s47 offen offset:0 sc1
    v_mfma_f32_16x16x32_bf16 a[40:43], v[72:75], a[168:171], a[40:43]
    v_mfma_f32_16x16x32_bf16 a[40:43], v[76:79], a[172:175], a[40:43]
    v_mfma_f32_16x16x32_bf16 a[44:47], v[76:79], a[188:191], a[44:47]
    v_mfma_f32_16x16x32_bf16 a[44:47], v[72:75], a[184:187], a[44:47]
    v_mfma_f32_16x16x32_bf16 a[44:47], v[68:71], a[180:183], a[44:47]
    buffer_load_dwordx4 a[244:247], v112, s[8:11], s47 offen offset:1024 sc1
    v_mfma_f32_16x16x32_bf16 a[44:47], v[64:67], a[176:179], a[44:47]
    s_waitcnt lgkmcnt(0)
    v_mfma_f32_16x16x32_bf16 a[60:63], v[80:83], a[176:179], a[60:63]
    ds_read_b64_tr_b16 v[64:65], v34 offset:32768
    v_mfma_f32_16x16x32_bf16 a[60:63], v[84:87], a[180:183], a[60:63]
    ds_read_b64_tr_b16 v[66:67], v34 offset:33792
    v_mfma_f32_16x16x32_bf16 a[60:63], v[88:91], a[184:187], a[60:63]
    ds_read_b64_tr_b16 v[68:69], v34 offset:40960
    v_mfma_f32_16x16x32_bf16 a[60:63], v[92:95], a[188:191], a[60:63]
    ds_read_b64_tr_b16 v[70:71], v34 offset:41984
    v_mfma_f32_16x16x32_bf16 a[56:59], v[92:95], a[172:175], a[56:59]
    ds_read_b64_tr_b16 v[72:73], v34 offset:49152
    v_mfma_f32_16x16x32_bf16 a[56:59], v[88:91], a[168:171], a[56:59]
    ds_read_b64_tr_b16 v[74:75], v34 offset:50176
    v_mfma_f32_16x16x32_bf16 a[56:59], v[84:87], a[164:167], a[56:59]
    ds_read_b64_tr_b16 v[76:77], v34 offset:57344
    v_mfma_f32_16x16x32_bf16 a[56:59], v[80:83], a[160:163], a[56:59]
    ds_read_b64_tr_b16 v[78:79], v34 offset:58368
    v_mfma_f32_16x16x32_bf16 a[52:55], v[80:83], a[144:147], a[52:55]
    v_mfma_f32_16x16x32_bf16 a[52:55], v[84:87], a[148:151], a[52:55]
    buffer_load_dwordx4 a[248:251], v112, s[8:11], s47 offen offset:2048 sc1
    v_mfma_f32_16x16x32_bf16 a[52:55], v[88:91], a[152:155], a[52:55]
    v_mfma_f32_16x16x32_bf16 a[52:55], v[92:95], a[156:159], a[52:55]
    v_mfma_f32_16x16x32_bf16 a[48:51], v[92:95], a[140:143], a[48:51]
    v_mfma_f32_16x16x32_bf16 a[48:51], v[88:91], a[136:139], a[48:51]
    v_mfma_f32_16x16x32_bf16 a[48:51], v[84:87], a[132:135], a[48:51]
    buffer_load_dwordx4 a[252:255], v112, s[8:11], s47 offen offset:3072 sc1
    s_add_u32 s47, s47, 4096
    v_mfma_f32_16x16x32_bf16 a[48:51], v[80:83], a[128:131], a[48:51]
    s_waitcnt lgkmcnt(0)
    v_mfma_f32_16x16x32_bf16 a[64:67], v[64:67], a[128:131], a[64:67]
    ds_read_b64_tr_b16 v[80:81], v34 offset:32776
    v_mfma_f32_16x16x32_bf16 a[64:67], v[68:71], a[132:135], a[64:67]
    ds_read_b64_tr_b16 v[82:83], v34 offset:33800
    v_mfma_f32_16x16x32_bf16 a[64:67], v[72:75], a[136:139], a[64:67]
    ds_read_b64_tr_b16 v[84:85], v34 offset:40968
    v_mfma_f32_16x16x32_bf16 a[64:67], v[76:79], a[140:143], a[64:67]
    ds_read_b64_tr_b16 v[86:87], v34 offset:41992
    v_mfma_f32_16x16x32_bf16 a[68:71], v[76:79], a[156:159], a[68:71]
    ds_read_b64_tr_b16 v[88:89], v34 offset:49160
    v_mfma_f32_16x16x32_bf16 a[68:71], v[72:75], a[152:155], a[68:71]
    ds_read_b64_tr_b16 v[90:91], v34 offset:50184
    v_mfma_f32_16x16x32_bf16 a[68:71], v[68:71], a[148:151], a[68:71]
    ds_read_b64_tr_b16 v[92:93], v34 offset:57352
    v_mfma_f32_16x16x32_bf16 a[68:71], v[64:67], a[144:147], a[68:71]
    ds_read_b64_tr_b16 v[94:95], v34 offset:58376
    v_mfma_f32_16x16x32_bf16 a[72:75], v[64:67], a[160:163], a[72:75]
    v_mfma_f32_16x16x32_bf16 a[72:75], v[68:71], a[164:167], a[72:75]
    v_mfma_f32_16x16x32_bf16 a[72:75], v[72:75], a[168:171], a[72:75]
    v_mfma_f32_16x16x32_bf16 a[72:75], v[76:79], a[172:175], a[72:75]
    v_mfma_f32_16x16x32_bf16 a[76:79], v[76:79], a[188:191], a[76:79]
    v_mfma_f32_16x16x32_bf16 a[76:79], v[72:75], a[184:187], a[76:79]
    v_mfma_f32_16x16x32_bf16 a[76:79], v[68:71], a[180:183], a[76:79]
    v_mfma_f32_16x16x32_bf16 a[76:79], v[64:67], a[176:179], a[76:79]
    s_waitcnt lgkmcnt(0)
    v_mfma_f32_16x16x32_bf16 a[92:95], v[80:83], a[176:179], a[92:95]
    ds_read_b64_tr_b16 v[64:65], v35 offset:32768
    v_mfma_f32_16x16x32_bf16 a[92:95], v[84:87], a[180:183], a[92:95]
    ds_read_b64_tr_b16 v[66:67], v35 offset:33792
    v_mfma_f32_16x16x32_bf16 a[92:95], v[88:91], a[184:187], a[92:95]
    ds_read_b64_tr_b16 v[68:69], v35 offset:40960
    v_mfma_f32_16x16x32_bf16 a[92:95], v[92:95], a[188:191], a[92:95]
    ds_read_b64_tr_b16 v[70:71], v35 offset:41984
    v_mfma_f32_16x16x32_bf16 a[88:91], v[92:95], a[172:175], a[88:91]
    ds_read_b64_tr_b16 v[72:73], v35 offset:49152
    v_mfma_f32_16x16x32_bf16 a[88:91], v[88:91], a[168:171], a[88:91]
    ds_read_b64_tr_b16 v[74:75], v35 offset:50176
    v_mfma_f32_16x16x32_bf16 a[88:91], v[84:87], a[164:167], a[88:91]
    ds_read_b64_tr_b16 v[76:77], v35 offset:57344
    v_mfma_f32_16x16x32_bf16 a[88:91], v[80:83], a[160:163], a[88:91]
    ds_read_b64_tr_b16 v[78:79], v35 offset:58368
    v_mfma_f32_16x16x32_bf16 a[84:87], v[80:83], a[144:147], a[84:87]
    v_mfma_f32_16x16x32_bf16 a[84:87], v[84:87], a[148:151], a[84:87]
    v_mfma_f32_16x16x32_bf16 a[84:87], v[88:91], a[152:155], a[84:87]
    v_mfma_f32_16x16x32_bf16 a[84:87], v[92:95], a[156:159], a[84:87]
    v_mfma_f32_16x16x32_bf16 a[80:83], v[92:95], a[140:143], a[80:83]
    v_mfma_f32_16x16x32_bf16 a[80:83], v[88:91], a[136:139], a[80:83]
    v_mfma_f32_16x16x32_bf16 a[80:83], v[84:87], a[132:135], a[80:83]
    v_mfma_f32_16x16x32_bf16 a[80:83], v[80:83], a[128:131], a[80:83]
    s_waitcnt lgkmcnt(0)
    v_mfma_f32_16x16x32_bf16 a[96:99], v[64:67], a[128:131], a[96:99]
    ds_read_b64_tr_b16 v[80:81], v35 offset:32776
    v_mfma_f32_16x16x32_bf16 a[96:99], v[68:71], a[132:135], a[96:99]
    ds_read_b64_tr_b16 v[82:83], v35 offset:33800
    v_mfma_f32_16x16x32_bf16 a[96:99], v[72:75], a[136:139], a[96:99]
    ds_read_b64_tr_b16 v[84:85], v35 offset:40968
    v_mfma_f32_16x16x32_bf16 a[96:99], v[76:79], a[140:143], a[96:99]
    ds_read_b64_tr_b16 v[86:87], v35 offset:41992
    v_mfma_f32_16x16x32_bf16 a[100:103], v[76:79], a[156:159], a[100:103]
    ds_read_b64_tr_b16 v[88:89], v35 offset:49160
    v_mfma_f32_16x16x32_bf16 a[100:103], v[72:75], a[152:155], a[100:103]
    ds_read_b64_tr_b16 v[90:91], v35 offset:50184
    v_mfma_f32_16x16x32_bf16 a[100:103], v[68:71], a[148:151], a[100:103]
    ds_read_b64_tr_b16 v[92:93], v35 offset:57352
    v_mfma_f32_16x16x32_bf16 a[100:103], v[64:67], a[144:147], a[100:103]
    ds_read_b64_tr_b16 v[94:95], v35 offset:58376
    v_mfma_f32_16x16x32_bf16 a[104:107], v[64:67], a[160:163], a[104:107]
    v_mfma_f32_16x16x32_bf16 a[104:107], v[68:71], a[164:167], a[104:107]
    v_mfma_f32_16x16x32_bf16 a[104:107], v[72:75], a[168:171], a[104:107]
    v_mfma_f32_16x16x32_bf16 a[104:107], v[76:79], a[172:175], a[104:107]
    v_mfma_f32_16x16x32_bf16 a[108:111], v[76:79], a[188:191], a[108:111]
    v_mfma_f32_16x16x32_bf16 a[108:111], v[72:75], a[184:187], a[108:111]
    v_mfma_f32_16x16x32_bf16 a[108:111], v[68:71], a[180:183], a[108:111]
    v_mfma_f32_16x16x32_bf16 a[108:111], v[64:67], a[176:179], a[108:111]
    s_waitcnt vmcnt(32) lgkmcnt(0)
    s_barrier
    v_mfma_f32_16x16x32_bf16 a[124:127], v[80:83], a[176:179], a[124:127]
    ds_read_b64_tr_b16 v[64:65], v28 offset:32768
    v_mfma_f32_16x16x32_bf16 a[124:127], v[84:87], a[180:183], a[124:127]
    ds_read_b64_tr_b16 v[66:67], v28 offset:33280
    v_mfma_f32_16x16x32_bf16 a[124:127], v[88:91], a[184:187], a[124:127]
    ds_read_b64_tr_b16 v[68:69], v28 offset:36864
    v_mfma_f32_16x16x32_bf16 a[124:127], v[92:95], a[188:191], a[124:127]
    ds_read_b64_tr_b16 v[70:71], v28 offset:37376
    v_mfma_f32_16x16x32_bf16 a[120:123], v[92:95], a[172:175], a[120:123]
    ds_read_b64_tr_b16 v[72:73], v28 offset:40960
    v_mfma_f32_16x16x32_bf16 a[120:123], v[88:91], a[168:171], a[120:123]
    ds_read_b64_tr_b16 v[74:75], v28 offset:41472
    v_mfma_f32_16x16x32_bf16 a[120:123], v[84:87], a[164:167], a[120:123]
    ds_read_b64_tr_b16 v[76:77], v28 offset:45056
    v_mfma_f32_16x16x32_bf16 a[120:123], v[80:83], a[160:163], a[120:123]
    ds_read_b64_tr_b16 v[78:79], v28 offset:45568
    v_mfma_f32_16x16x32_bf16 a[116:119], v[80:83], a[144:147], a[116:119]
    v_mfma_f32_16x16x32_bf16 a[116:119], v[84:87], a[148:151], a[116:119]
    v_mfma_f32_16x16x32_bf16 a[116:119], v[88:91], a[152:155], a[116:119]
    v_mfma_f32_16x16x32_bf16 a[116:119], v[92:95], a[156:159], a[116:119]
    v_mfma_f32_16x16x32_bf16 a[112:115], v[92:95], a[140:143], a[112:115]
    v_mfma_f32_16x16x32_bf16 a[112:115], v[88:91], a[136:139], a[112:115]
    v_mfma_f32_16x16x32_bf16 a[112:115], v[84:87], a[132:135], a[112:115]
    v_mfma_f32_16x16x32_bf16 a[112:115], v[80:83], a[128:131], a[112:115]
    s_waitcnt vmcnt(0) lgkmcnt(0)
    v_mfma_f32_16x16x32_bf16 v[128:131], v[64:67], a[192:195], v[128:131]
    ds_read_b64_tr_b16 v[80:81], v28 offset:49152
    v_mfma_f32_16x16x32_bf16 v[128:131], v[68:71], a[196:199], v[128:131]
    ds_read_b64_tr_b16 v[82:83], v28 offset:49664
    v_mfma_f32_16x16x32_bf16 v[128:131], v[72:75], a[200:203], v[128:131]
    buffer_load_dwordx4 a[128:131], v112, s[8:11], s44 offen offset:0 sc1
    ds_read_b64_tr_b16 v[84:85], v28 offset:53248
    v_mfma_f32_16x16x32_bf16 v[128:131], v[76:79], a[204:207], v[128:131]
    ds_read_b64_tr_b16 v[86:87], v28 offset:53760
    v_mfma_f32_16x16x32_bf16 v[132:135], v[76:79], a[220:223], v[132:135]
    ds_read_b64_tr_b16 v[88:89], v28 offset:57344
    v_mfma_f32_16x16x32_bf16 v[132:135], v[72:75], a[216:219], v[132:135]
    ds_read_b64_tr_b16 v[90:91], v28 offset:57856
    v_mfma_f32_16x16x32_bf16 v[132:135], v[68:71], a[212:215], v[132:135]
    buffer_load_dwordx4 a[132:135], v112, s[8:11], s44 offen offset:1024 sc1
    ds_read_b64_tr_b16 v[92:93], v28 offset:61440
    v_mfma_f32_16x16x32_bf16 v[132:135], v[64:67], a[208:211], v[132:135]
    ds_read_b64_tr_b16 v[94:95], v28 offset:61952
    v_mfma_f32_16x16x32_bf16 v[136:139], v[64:67], a[224:227], v[136:139]
    v_mfma_f32_16x16x32_bf16 v[136:139], v[68:71], a[228:231], v[136:139]
    v_mfma_f32_16x16x32_bf16 v[136:139], v[72:75], a[232:235], v[136:139]
    buffer_load_dwordx4 a[136:139], v112, s[8:11], s44 offen offset:2048 sc1
    v_mfma_f32_16x16x32_bf16 v[136:139], v[76:79], a[236:239], v[136:139]
    v_mfma_f32_16x16x32_bf16 v[140:143], v[76:79], a[252:255], v[140:143]
    v_mfma_f32_16x16x32_bf16 v[140:143], v[72:75], a[248:251], v[140:143]
    v_mfma_f32_16x16x32_bf16 v[140:143], v[68:71], a[244:247], v[140:143]
    buffer_load_dwordx4 a[140:143], v112, s[8:11], s44 offen offset:3072 sc1
    s_add_u32 s44, s44, 4096
    v_mfma_f32_16x16x32_bf16 v[140:143], v[64:67], a[240:243], v[140:143]
    s_waitcnt lgkmcnt(0)
    v_mfma_f32_16x16x32_bf16 v[204:207], v[80:83], a[240:243], v[204:207]
    ds_read_b64_tr_b16 v[64:65], v29 offset:32768
    v_mfma_f32_16x16x32_bf16 v[204:207], v[84:87], a[244:247], v[204:207]
    ds_read_b64_tr_b16 v[66:67], v29 offset:33280
    v_mfma_f32_16x16x32_bf16 v[204:207], v[88:91], a[248:251], v[204:207]
    buffer_load_dwordx4 a[144:147], v112, s[8:11], s45 offen offset:0 sc1
    ds_read_b64_tr_b16 v[68:69], v29 offset:36864
    v_mfma_f32_16x16x32_bf16 v[204:207], v[92:95], a[252:255], v[204:207]
    ds_read_b64_tr_b16 v[70:71], v29 offset:37376
    v_mfma_f32_16x16x32_bf16 v[200:203], v[92:95], a[236:239], v[200:203]
    ds_read_b64_tr_b16 v[72:73], v29 offset:40960
    v_mfma_f32_16x16x32_bf16 v[200:203], v[88:91], a[232:235], v[200:203]
    ds_read_b64_tr_b16 v[74:75], v29 offset:41472
    v_mfma_f32_16x16x32_bf16 v[200:203], v[84:87], a[228:231], v[200:203]
    buffer_load_dwordx4 a[148:151], v112, s[8:11], s45 offen offset:1024 sc1
    ds_read_b64_tr_b16 v[76:77], v29 offset:45056
    v_mfma_f32_16x16x32_bf16 v[200:203], v[80:83], a[224:227], v[200:203]
    ds_read_b64_tr_b16 v[78:79], v29 offset:45568
    v_mfma_f32_16x16x32_bf16 v[196:199], v[80:83], a[208:211], v[196:199]
    v_mfma_f32_16x16x32_bf16 v[196:199], v[84:87], a[212:215], v[196:199]
    v_mfma_f32_16x16x32_bf16 v[196:199], v[88:91], a[216:219], v[196:199]
    buffer_load_dwordx4 a[152:155], v112, s[8:11], s45 offen offset:2048 sc1
    v_mfma_f32_16x16x32_bf16 v[196:199], v[92:95], a[220:223], v[196:199]
    v_mfma_f32_16x16x32_bf16 v[192:195], v[92:95], a[204:207], v[192:195]
    v_add_u32 v28, 131072, v28
    v_mfma_f32_16x16x32_bf16 v[192:195], v[88:91], a[200:203], v[192:195]
    v_mfma_f32_16x16x32_bf16 v[192:195], v[84:87], a[196:199], v[192:195]
    buffer_load_dwordx4 a[156:159], v112, s[8:11], s45 offen offset:3072 sc1
    s_add_u32 s45, s45, 4096
    v_mfma_f32_16x16x32_bf16 v[192:195], v[80:83], a[192:195], v[192:195]
    s_waitcnt lgkmcnt(0)
    v_mfma_f32_16x16x32_bf16 v[144:147], v[64:67], a[192:195], v[144:147]
    ds_read_b64_tr_b16 v[80:81], v29 offset:49152
    v_mfma_f32_16x16x32_bf16 v[144:147], v[68:71], a[196:199], v[144:147]
    ds_read_b64_tr_b16 v[82:83], v29 offset:49664
    v_mfma_f32_16x16x32_bf16 v[144:147], v[72:75], a[200:203], v[144:147]
    buffer_load_dwordx4 a[160:163], v112, s[8:11], s46 offen offset:0 sc1
    ds_read_b64_tr_b16 v[84:85], v29 offset:53248
    v_mfma_f32_16x16x32_bf16 v[144:147], v[76:79], a[204:207], v[144:147]
    ds_read_b64_tr_b16 v[86:87], v29 offset:53760
    v_mfma_f32_16x16x32_bf16 v[148:151], v[76:79], a[220:223], v[148:151]
    ds_read_b64_tr_b16 v[88:89], v29 offset:57344
    v_mfma_f32_16x16x32_bf16 v[148:151], v[72:75], a[216:219], v[148:151]
    ds_read_b64_tr_b16 v[90:91], v29 offset:57856
    v_mfma_f32_16x16x32_bf16 v[148:151], v[68:71], a[212:215], v[148:151]
    buffer_load_dwordx4 a[164:167], v112, s[8:11], s46 offen offset:1024 sc1
    ds_read_b64_tr_b16 v[92:93], v29 offset:61440
    v_mfma_f32_16x16x32_bf16 v[148:151], v[64:67], a[208:211], v[148:151]
    ds_read_b64_tr_b16 v[94:95], v29 offset:61952
    v_mfma_f32_16x16x32_bf16 v[152:155], v[64:67], a[224:227], v[152:155]
    v_mfma_f32_16x16x32_bf16 v[152:155], v[68:71], a[228:231], v[152:155]
    v_mfma_f32_16x16x32_bf16 v[152:155], v[72:75], a[232:235], v[152:155]
    buffer_load_dwordx4 a[168:171], v112, s[8:11], s46 offen offset:2048 sc1
    v_mfma_f32_16x16x32_bf16 v[152:155], v[76:79], a[236:239], v[152:155]
    v_mfma_f32_16x16x32_bf16 v[156:159], v[76:79], a[252:255], v[156:159]
    v_mfma_f32_16x16x32_bf16 v[156:159], v[72:75], a[248:251], v[156:159]
    v_mfma_f32_16x16x32_bf16 v[156:159], v[68:71], a[244:247], v[156:159]
    buffer_load_dwordx4 a[172:175], v112, s[8:11], s46 offen offset:3072 sc1
    s_add_u32 s46, s46, 4096
    v_mfma_f32_16x16x32_bf16 v[156:159], v[64:67], a[240:243], v[156:159]
    s_waitcnt lgkmcnt(0)
    v_mfma_f32_16x16x32_bf16 v[220:223], v[80:83], a[240:243], v[220:223]
    ds_read_b64_tr_b16 v[64:65], v30 offset:32768
    v_mfma_f32_16x16x32_bf16 v[220:223], v[84:87], a[244:247], v[220:223]
    ds_read_b64_tr_b16 v[66:67], v30 offset:33280
    v_mfma_f32_16x16x32_bf16 v[220:223], v[88:91], a[248:251], v[220:223]
    buffer_load_dwordx4 a[176:179], v112, s[8:11], s47 offen offset:0 sc1
    ds_read_b64_tr_b16 v[68:69], v30 offset:36864
    v_mfma_f32_16x16x32_bf16 v[220:223], v[92:95], a[252:255], v[220:223]
    ds_read_b64_tr_b16 v[70:71], v30 offset:37376
    v_mfma_f32_16x16x32_bf16 v[216:219], v[92:95], a[236:239], v[216:219]
    ds_read_b64_tr_b16 v[72:73], v30 offset:40960
    v_mfma_f32_16x16x32_bf16 v[216:219], v[88:91], a[232:235], v[216:219]
    ds_read_b64_tr_b16 v[74:75], v30 offset:41472
    v_mfma_f32_16x16x32_bf16 v[216:219], v[84:87], a[228:231], v[216:219]
    buffer_load_dwordx4 a[180:183], v112, s[8:11], s47 offen offset:1024 sc1
    ds_read_b64_tr_b16 v[76:77], v30 offset:45056
    v_mfma_f32_16x16x32_bf16 v[216:219], v[80:83], a[224:227], v[216:219]
    ds_read_b64_tr_b16 v[78:79], v30 offset:45568
    v_mfma_f32_16x16x32_bf16 v[212:215], v[80:83], a[208:211], v[212:215]
    v_mfma_f32_16x16x32_bf16 v[212:215], v[84:87], a[212:215], v[212:215]
    v_mfma_f32_16x16x32_bf16 v[212:215], v[88:91], a[216:219], v[212:215]
    buffer_load_dwordx4 a[184:187], v112, s[8:11], s47 offen offset:2048 sc1
    v_mfma_f32_16x16x32_bf16 v[212:215], v[92:95], a[220:223], v[212:215]
    v_mfma_f32_16x16x32_bf16 v[208:211], v[92:95], a[204:207], v[208:211]
    v_add_u32 v29, 131072, v29
    v_mfma_f32_16x16x32_bf16 v[208:211], v[88:91], a[200:203], v[208:211]
    v_mfma_f32_16x16x32_bf16 v[208:211], v[84:87], a[196:199], v[208:211]
    buffer_load_dwordx4 a[188:191], v112, s[8:11], s47 offen offset:3072 sc1
    s_add_u32 s47, s47, 4096
    v_mfma_f32_16x16x32_bf16 v[208:211], v[80:83], a[192:195], v[208:211]
    s_waitcnt lgkmcnt(0)
    v_mfma_f32_16x16x32_bf16 v[160:163], v[64:67], a[192:195], v[160:163]
    ds_read_b64_tr_b16 v[80:81], v30 offset:49152
    v_mfma_f32_16x16x32_bf16 v[160:163], v[68:71], a[196:199], v[160:163]
    ds_read_b64_tr_b16 v[82:83], v30 offset:49664
    v_mfma_f32_16x16x32_bf16 v[160:163], v[72:75], a[200:203], v[160:163]
    ds_read_b64_tr_b16 v[84:85], v30 offset:53248
    v_mfma_f32_16x16x32_bf16 v[160:163], v[76:79], a[204:207], v[160:163]
    ds_read_b64_tr_b16 v[86:87], v30 offset:53760
    v_mfma_f32_16x16x32_bf16 v[164:167], v[76:79], a[220:223], v[164:167]
    ds_read_b64_tr_b16 v[88:89], v30 offset:57344
    v_mfma_f32_16x16x32_bf16 v[164:167], v[72:75], a[216:219], v[164:167]
    ds_read_b64_tr_b16 v[90:91], v30 offset:57856
    v_mfma_f32_16x16x32_bf16 v[164:167], v[68:71], a[212:215], v[164:167]
    ds_read_b64_tr_b16 v[92:93], v30 offset:61440
    v_mfma_f32_16x16x32_bf16 v[164:167], v[64:67], a[208:211], v[164:167]
    ds_read_b64_tr_b16 v[94:95], v30 offset:61952
    v_mfma_f32_16x16x32_bf16 v[168:171], v[64:67], a[224:227], v[168:171]
    s_add_u32 m0, s50, 98304
    v_mfma_f32_16x16x32_bf16 v[168:171], v[68:71], a[228:231], v[168:171]
    buffer_load_dwordx4 v24, s[16:19], s49 offen offset:0 nt lds
    v_mfma_f32_16x16x32_bf16 v[168:171], v[72:75], a[232:235], v[168:171]
    v_mfma_f32_16x16x32_bf16 v[168:171], v[76:79], a[236:239], v[168:171]
    v_mfma_f32_16x16x32_bf16 v[172:175], v[76:79], a[252:255], v[172:175]
    v_mfma_f32_16x16x32_bf16 v[172:175], v[72:75], a[248:251], v[172:175]
    v_mfma_f32_16x16x32_bf16 v[172:175], v[68:71], a[244:247], v[172:175]
    buffer_load_dwordx4 v25, s[16:19], s49 offen offset:1024 nt lds
    v_mfma_f32_16x16x32_bf16 v[172:175], v[64:67], a[240:243], v[172:175]
    s_waitcnt lgkmcnt(0)
    v_mfma_f32_16x16x32_bf16 v[236:239], v[80:83], a[240:243], v[236:239]
    ds_read_b64_tr_b16 v[64:65], v31 offset:32768
    v_mfma_f32_16x16x32_bf16 v[236:239], v[84:87], a[244:247], v[236:239]
    ds_read_b64_tr_b16 v[66:67], v31 offset:33280
    v_mfma_f32_16x16x32_bf16 v[236:239], v[88:91], a[248:251], v[236:239]
    ds_read_b64_tr_b16 v[68:69], v31 offset:36864
    v_mfma_f32_16x16x32_bf16 v[236:239], v[92:95], a[252:255], v[236:239]
    ds_read_b64_tr_b16 v[70:71], v31 offset:37376
    v_mfma_f32_16x16x32_bf16 v[232:235], v[92:95], a[236:239], v[232:235]
    ds_read_b64_tr_b16 v[72:73], v31 offset:40960
    v_mfma_f32_16x16x32_bf16 v[232:235], v[88:91], a[232:235], v[232:235]
    ds_read_b64_tr_b16 v[74:75], v31 offset:41472
    v_mfma_f32_16x16x32_bf16 v[232:235], v[84:87], a[228:231], v[232:235]
    ds_read_b64_tr_b16 v[76:77], v31 offset:45056
    v_mfma_f32_16x16x32_bf16 v[232:235], v[80:83], a[224:227], v[232:235]
    ds_read_b64_tr_b16 v[78:79], v31 offset:45568
    v_mfma_f32_16x16x32_bf16 v[228:231], v[80:83], a[208:211], v[228:231]
    v_mfma_f32_16x16x32_bf16 v[228:231], v[84:87], a[212:215], v[228:231]
    buffer_load_dwordx4 v26, s[16:19], s49 offen offset:2048 nt lds
    v_mfma_f32_16x16x32_bf16 v[228:231], v[88:91], a[216:219], v[228:231]
    v_mfma_f32_16x16x32_bf16 v[228:231], v[92:95], a[220:223], v[228:231]
    v_mfma_f32_16x16x32_bf16 v[224:227], v[92:95], a[204:207], v[224:227]
    v_add_u32 v30, 131072, v30
    v_mfma_f32_16x16x32_bf16 v[224:227], v[88:91], a[200:203], v[224:227]
    v_mfma_f32_16x16x32_bf16 v[224:227], v[84:87], a[196:199], v[224:227]
    buffer_load_dwordx4 v27, s[16:19], s49 offen offset:3072 nt lds
    s_add_u32 s49, s49, 131072
    v_mfma_f32_16x16x32_bf16 v[224:227], v[80:83], a[192:195], v[224:227]
    s_waitcnt lgkmcnt(0)
    v_mfma_f32_16x16x32_bf16 v[176:179], v[64:67], a[192:195], v[176:179]
    ds_read_b64_tr_b16 v[80:81], v31 offset:49152
    v_mfma_f32_16x16x32_bf16 v[176:179], v[68:71], a[196:199], v[176:179]
    ds_read_b64_tr_b16 v[82:83], v31 offset:49664
    v_mfma_f32_16x16x32_bf16 v[176:179], v[72:75], a[200:203], v[176:179]
    ds_read_b64_tr_b16 v[84:85], v31 offset:53248
    v_mfma_f32_16x16x32_bf16 v[176:179], v[76:79], a[204:207], v[176:179]
    ds_read_b64_tr_b16 v[86:87], v31 offset:53760
    v_mfma_f32_16x16x32_bf16 v[180:183], v[76:79], a[220:223], v[180:183]
    ds_read_b64_tr_b16 v[88:89], v31 offset:57344
    v_mfma_f32_16x16x32_bf16 v[180:183], v[72:75], a[216:219], v[180:183]
    ds_read_b64_tr_b16 v[90:91], v31 offset:57856
    v_mfma_f32_16x16x32_bf16 v[180:183], v[68:71], a[212:215], v[180:183]
    ds_read_b64_tr_b16 v[92:93], v31 offset:61440
    v_mfma_f32_16x16x32_bf16 v[180:183], v[64:67], a[208:211], v[180:183]
    ds_read_b64_tr_b16 v[94:95], v31 offset:61952
    v_mfma_f32_16x16x32_bf16 v[184:187], v[64:67], a[224:227], v[184:187]
    s_add_u32 m0, s50, 102400
    v_mfma_f32_16x16x32_bf16 v[184:187], v[68:71], a[228:231], v[184:187]
    buffer_load_dwordx4 v24, s[16:19], s49 offen offset:0 nt lds
    v_mfma_f32_16x16x32_bf16 v[184:187], v[72:75], a[232:235], v[184:187]
    v_mfma_f32_16x16x32_bf16 v[184:187], v[76:79], a[236:239], v[184:187]
    v_mfma_f32_16x16x32_bf16 v[188:191], v[76:79], a[252:255], v[188:191]
    v_mfma_f32_16x16x32_bf16 v[188:191], v[72:75], a[248:251], v[188:191]
    v_mfma_f32_16x16x32_bf16 v[188:191], v[68:71], a[244:247], v[188:191]
    buffer_load_dwordx4 v25, s[16:19], s49 offen offset:1024 nt lds
    v_mfma_f32_16x16x32_bf16 v[188:191], v[64:67], a[240:243], v[188:191]
    s_waitcnt lgkmcnt(0)
    s_barrier
    v_mfma_f32_16x16x32_bf16 v[252:255], v[80:83], a[240:243], v[252:255]
    ds_read_b64_tr_b16 v[64:65], v28 offset:0
    v_mfma_f32_16x16x32_bf16 v[252:255], v[84:87], a[244:247], v[252:255]
    ds_read_b64_tr_b16 v[66:67], v28 offset:512
    v_mfma_f32_16x16x32_bf16 v[252:255], v[88:91], a[248:251], v[252:255]
    ds_read_b64_tr_b16 v[68:69], v28 offset:4096
    v_mfma_f32_16x16x32_bf16 v[252:255], v[92:95], a[252:255], v[252:255]
    ds_read_b64_tr_b16 v[70:71], v28 offset:4608
    v_mfma_f32_16x16x32_bf16 v[248:251], v[92:95], a[236:239], v[248:251]
    ds_read_b64_tr_b16 v[72:73], v28 offset:8192
    v_mfma_f32_16x16x32_bf16 v[248:251], v[88:91], a[232:235], v[248:251]
    ds_read_b64_tr_b16 v[74:75], v28 offset:8704
    v_mfma_f32_16x16x32_bf16 v[248:251], v[84:87], a[228:231], v[248:251]
    ds_read_b64_tr_b16 v[76:77], v28 offset:12288
    v_mfma_f32_16x16x32_bf16 v[248:251], v[80:83], a[224:227], v[248:251]
    ds_read_b64_tr_b16 v[78:79], v28 offset:12800
    v_mfma_f32_16x16x32_bf16 v[244:247], v[80:83], a[208:211], v[244:247]
    v_mfma_f32_16x16x32_bf16 v[244:247], v[84:87], a[212:215], v[244:247]
    buffer_load_dwordx4 v26, s[16:19], s49 offen offset:2048 nt lds
    v_mfma_f32_16x16x32_bf16 v[244:247], v[88:91], a[216:219], v[244:247]
    v_mfma_f32_16x16x32_bf16 v[244:247], v[92:95], a[220:223], v[244:247]
    v_mfma_f32_16x16x32_bf16 v[240:243], v[92:95], a[204:207], v[240:243]
    v_add_u32 v31, 131072, v31
    v_mfma_f32_16x16x32_bf16 v[240:243], v[88:91], a[200:203], v[240:243]
    v_mfma_f32_16x16x32_bf16 v[240:243], v[84:87], a[196:199], v[240:243]
    buffer_load_dwordx4 v27, s[16:19], s49 offen offset:3072 nt lds
    s_add_u32 s49, s49, 917504
    v_mfma_f32_16x16x32_bf16 v[240:243], v[80:83], a[192:195], v[240:243]
    s_waitcnt vmcnt(8) lgkmcnt(0)
    v_mfma_f32_16x16x32_bf16 v[128:131], v[64:67], a[128:131], v[128:131]
    ds_read_b64_tr_b16 v[80:81], v28 offset:16384
    v_add_u32 v20, 0, v1
    v_mfma_f32_16x16x32_bf16 v[128:131], v[68:71], a[132:135], v[128:131]
    ds_read_b64_tr_b16 v[82:83], v28 offset:16896
    v_add_u32 v21, 4096, v1
    v_mfma_f32_16x16x32_bf16 v[128:131], v[72:75], a[136:139], v[128:131]
    ds_read_b64_tr_b16 v[84:85], v28 offset:20480
    v_add_u32 v22, 8192, v1
    v_mfma_f32_16x16x32_bf16 v[128:131], v[76:79], a[140:143], v[128:131]
    ds_read_b64_tr_b16 v[86:87], v28 offset:20992
    v_add_u32 v23, 12288, v1
    v_mfma_f32_16x16x32_bf16 v[132:135], v[76:79], a[156:159], v[132:135]
    ds_read_b64_tr_b16 v[88:89], v28 offset:24576
    v_lshlrev_b32 v24, 7, v0
    v_mfma_f32_16x16x32_bf16 v[132:135], v[72:75], a[152:155], v[132:135]
    ds_read_b64_tr_b16 v[90:91], v28 offset:25088
    v_lshrrev_b32 v48, 4, v0
    v_mfma_f32_16x16x32_bf16 v[132:135], v[68:71], a[148:151], v[132:135]
    ds_read_b64_tr_b16 v[92:93], v28 offset:28672
    v_min_u32 v48, 1, v48
    v_mfma_f32_16x16x32_bf16 v[132:135], v[64:67], a[144:147], v[132:135]
    ds_read_b64_tr_b16 v[94:95], v28 offset:29184
    v_lshl_or_b32 v24, v48, 30, v24
    v_mfma_f32_16x16x32_bf16 v[136:139], v[64:67], a[160:163], v[136:139]
    s_add_u32 m0, s50, 32768
    s_mov_b32 s48, s81
    v_mfma_f32_16x16x32_bf16 v[136:139], v[68:71], a[164:167], v[136:139]
    buffer_load_dwordx4 v2, s[24:27], s36 offen offset:0 lds
    s_lshl_b32 s84, s34, 3
    v_mfma_f32_16x16x32_bf16 v[136:139], v[72:75], a[168:171], v[136:139]
    s_and_b32 s85, s2, 7
    s_add_u32 s84, s84, s85
    v_mfma_f32_16x16x32_bf16 v[136:139], v[76:79], a[172:175], v[136:139]
    s_mul_i32 s84, s84, 40960
    s_mul_i32 s85, s43, 320
    v_mfma_f32_16x16x32_bf16 v[140:143], v[76:79], a[188:191], v[140:143]
    s_add_u32 s84, s84, s85
    s_lshl_b32 s85, s32, 6
    v_mfma_f32_16x16x32_bf16 v[140:143], v[72:75], a[184:187], v[140:143]
    s_add_u32 s44, s84, s85
    s_add_u32 s46, s44, 20672
    v_mfma_f32_16x16x32_bf16 v[140:143], v[68:71], a[180:183], v[140:143]
    buffer_load_dwordx4 v3, s[24:27], s36 offen offset:1024 lds
    s_mov_b32 s85, 20416
    v_mfma_f32_16x16x32_bf16 v[140:143], v[64:67], a[176:179], v[140:143]
    s_waitcnt lgkmcnt(0)
    v_mfma_f32_16x16x32_bf16 v[192:195], v[80:83], a[128:131], v[192:195]
    ds_read_b64_tr_b16 v[64:65], v29 offset:0
    s_cmp_ge_u32 s32, 1
    s_cselect_b32 s85, s85, 256
    v_mfma_f32_16x16x32_bf16 v[192:195], v[84:87], a[132:135], v[192:195]
    ds_read_b64_tr_b16 v[66:67], v29 offset:512
    s_add_u32 s45, s44, s85
    v_mfma_f32_16x16x32_bf16 v[192:195], v[88:91], a[136:139], v[192:195]
    ds_read_b64_tr_b16 v[68:69], v29 offset:4096
    s_andn2_b32 s84, s2, 3
    v_mfma_f32_16x16x32_bf16 v[192:195], v[92:95], a[140:143], v[192:195]
    ds_read_b64_tr_b16 v[70:71], v29 offset:4608
    s_lshl_b32 s84, s84, 2
    v_mfma_f32_16x16x32_bf16 v[196:199], v[92:95], a[156:159], v[196:199]
    ds_read_b64_tr_b16 v[72:73], v29 offset:8192
    s_add_u32 s84, s84, s35
    v_mfma_f32_16x16x32_bf16 v[196:199], v[88:91], a[152:155], v[196:199]
    ds_read_b64_tr_b16 v[74:75], v29 offset:8704
    s_lshl_b32 s84, s84, 7
    v_mfma_f32_16x16x32_bf16 v[196:199], v[84:87], a[148:151], v[196:199]
    ds_read_b64_tr_b16 v[76:77], v29 offset:12288
    s_add_u32 s47, s84, 71696384
    v_mfma_f32_16x16x32_bf16 v[196:199], v[80:83], a[144:147], v[196:199]
    ds_read_b64_tr_b16 v[78:79], v29 offset:12800
    s_mov_b32 s20, s8
    v_mfma_f32_16x16x32_bf16 v[200:203], v[80:83], a[160:163], v[200:203]
    s_mov_b32 s21, s9
    s_cmp_eq_u32 s32, s35
    s_cselect_b32 s22, 0, 75497472
    v_mfma_f32_16x16x32_bf16 v[200:203], v[84:87], a[164:167], v[200:203]
    buffer_load_dwordx4 v4, s[24:27], s36 offen offset:2048 lds
    s_getpc_b64 s[16:17]
L_pc2:
    v_mfma_f32_16x16x32_bf16 v[200:203], v[88:91], a[168:171], v[200:203]
    s_mov_b32 s18, L_fallback-L_pc2
    s_and_b32 s85, s81, 30720
    v_mfma_f32_16x16x32_bf16 v[200:203], v[92:95], a[172:175], v[200:203]
    s_add_u32 s85, s85, Lpok1-L_pc2
    v_mfma_f32_16x16x32_bf16 v[204:207], v[92:95], a[188:191], v[204:207]
    v_mfma_f32_16x16x32_bf16 v[204:207], v[88:91], a[184:187], v[204:207]
    v_mfma_f32_16x16x32_bf16 v[204:207], v[84:87], a[180:183], v[204:207]
    buffer_load_dwordx4 v5, s[24:27], s36 offen offset:3072 lds
    s_add_u32 s36, s36, 4096
    v_mfma_f32_16x16x32_bf16 v[204:207], v[80:83], a[176:179], v[204:207]
    s_waitcnt lgkmcnt(0)
    v_mfma_f32_16x16x32_bf16 v[144:147], v[64:67], a[128:131], v[144:147]
    ds_read_b64_tr_b16 v[80:81], v29 offset:16384
    v_mfma_f32_16x16x32_bf16 v[144:147], v[68:71], a[132:135], v[144:147]
    ds_read_b64_tr_b16 v[82:83], v29 offset:16896
    v_mfma_f32_16x16x32_bf16 v[144:147], v[72:75], a[136:139], v[144:147]
    ds_read_b64_tr_b16 v[84:85], v29 offset:20480
    v_mfma_f32_16x16x32_bf16 v[144:147], v[76:79], a[140:143], v[144:147]
    ds_read_b64_tr_b16 v[86:87], v29 offset:20992
    v_mfma_f32_16x16x32_bf16 v[148:151], v[76:79], a[156:159], v[148:151]
    ds_read_b64_tr_b16 v[88:89], v29 offset:24576
    v_mfma_f32_16x16x32_bf16 v[148:151], v[72:75], a[152:155], v[148:151]
    ds_read_b64_tr_b16 v[90:91], v29 offset:25088
    v_mfma_f32_16x16x32_bf16 v[148:151], v[68:71], a[148:151], v[148:151]
    ds_read_b64_tr_b16 v[92:93], v29 offset:28672
    v_mfma_f32_16x16x32_bf16 v[148:151], v[64:67], a[144:147], v[148:151]
    ds_read_b64_tr_b16 v[94:95], v29 offset:29184
    v_mfma_f32_16x16x32_bf16 v[152:155], v[64:67], a[160:163], v[152:155]
    s_add_u32 m0, s50, 36864
    v_mfma_f32_16x16x32_bf16 v[152:155], v[68:71], a[164:167], v[152:155]
    buffer_load_dwordx4 v2, s[24:27], s36 offen offset:0 lds
    v_mfma_f32_16x16x32_bf16 v[152:155], v[72:75], a[168:171], v[152:155]
    v_mfma_f32_16x16x32_bf16 v[152:155], v[76:79], a[172:175], v[152:155]
    v_mfma_f32_16x16x32_bf16 v[156:159], v[76:79], a[188:191], v[156:159]
    v_mfma_f32_16x16x32_bf16 v[156:159], v[72:75], a[184:187], v[156:159]
    v_mfma_f32_16x16x32_bf16 v[156:159], v[68:71], a[180:183], v[156:159]
    buffer_load_dwordx4 v3, s[24:27], s36 offen offset:1024 lds
    v_mfma_f32_16x16x32_bf16 v[156:159], v[64:67], a[176:179], v[156:159]
    s_waitcnt lgkmcnt(0)
    v_mfma_f32_16x16x32_bf16 v[208:211], v[80:83], a[128:131], v[208:211]
    ds_read_b64_tr_b16 v[64:65], v30 offset:0
    v_mfma_f32_16x16x32_bf16 v[208:211], v[84:87], a[132:135], v[208:211]
    ds_read_b64_tr_b16 v[66:67], v30 offset:512
    v_mfma_f32_16x16x32_bf16 v[208:211], v[88:91], a[136:139], v[208:211]
    ds_read_b64_tr_b16 v[68:69], v30 offset:4096
    v_mfma_f32_16x16x32_bf16 v[208:211], v[92:95], a[140:143], v[208:211]
    ds_read_b64_tr_b16 v[70:71], v30 offset:4608
    v_mfma_f32_16x16x32_bf16 v[212:215], v[92:95], a[156:159], v[212:215]
    ds_read_b64_tr_b16 v[72:73], v30 offset:8192
    v_mfma_f32_16x16x32_bf16 v[212:215], v[88:91], a[152:155], v[212:215]
    ds_read_b64_tr_b16 v[74:75], v30 offset:8704
    v_mfma_f32_16x16x32_bf16 v[212:215], v[84:87], a[148:151], v[212:215]
    ds_read_b64_tr_b16 v[76:77], v30 offset:12288
    v_mfma_f32_16x16x32_bf16 v[212:215], v[80:83], a[144:147], v[212:215]
    ds_read_b64_tr_b16 v[78:79], v30 offset:12800
    v_mfma_f32_16x16x32_bf16 v[216:219], v[80:83], a[160:163], v[216:219]
    v_mfma_f32_16x16x32_bf16 v[216:219], v[84:87], a[164:167], v[216:219]
    buffer_load_dwordx4 v4, s[24:27], s36 offen offset:2048 lds
    v_mfma_f32_16x16x32_bf16 v[216:219], v[88:91], a[168:171], v[216:219]
    v_mfma_f32_16x16x32_bf16 v[216:219], v[92:95], a[172:175], v[216:219]
    v_mfma_f32_16x16x32_bf16 v[220:223], v[92:95], a[188:191], v[220:223]
    v_mfma_f32_16x16x32_bf16 v[220:223], v[88:91], a[184:187], v[220:223]
    v_mfma_f32_16x16x32_bf16 v[220:223], v[84:87], a[180:183], v[220:223]
    buffer_load_dwordx4 v5, s[24:27], s36 offen offset:3072 lds
    s_add_u32 s36, s36, 28672
    v_mfma_f32_16x16x32_bf16 v[220:223], v[80:83], a[176:179], v[220:223]
    s_waitcnt lgkmcnt(0)
    v_mfma_f32_16x16x32_bf16 v[160:163], v[64:67], a[128:131], v[160:163]
    ds_read_b64_tr_b16 v[80:81], v30 offset:16384
    v_mul_f32 v36, s4, v128
    v_mul_f32 v37, s4, v129
    v_mfma_f32_16x16x32_bf16 v[160:163], v[68:71], a[132:135], v[160:163]
    ds_read_b64_tr_b16 v[82:83], v30 offset:16896
    v_mul_f32 v38, s4, v130
    v_mul_f32 v39, s4, v131
    v_mfma_f32_16x16x32_bf16 v[160:163], v[72:75], a[136:139], v[160:163]
    ds_read_b64_tr_b16 v[84:85], v30 offset:20480
    v_mul_f32 v40, s4, v144
    v_mul_f32 v41, s4, v145
    v_mfma_f32_16x16x32_bf16 v[160:163], v[76:79], a[140:143], v[160:163]
    ds_read_b64_tr_b16 v[86:87], v30 offset:20992
    v_mul_f32 v42, s4, v146
    v_mul_f32 v43, s4, v147
    v_mfma_f32_16x16x32_bf16 v[164:167], v[76:79], a[156:159], v[164:167]
    ds_read_b64_tr_b16 v[88:89], v30 offset:24576
    v_exp_f32 v36, v36
    v_mfma_f32_16x16x32_bf16 v[164:167], v[72:75], a[152:155], v[164:167]
    ds_read_b64_tr_b16 v[90:91], v30 offset:25088
    v_mul_f32 v128, v128, v192
    v_mfma_f32_16x16x32_bf16 v[164:167], v[68:71], a[148:151], v[164:167]
    ds_read_b64_tr_b16 v[92:93], v30 offset:28672
    v_exp_f32 v37, v37
    v_mfma_f32_16x16x32_bf16 v[164:167], v[64:67], a[144:147], v[164:167]
    ds_read_b64_tr_b16 v[94:95], v30 offset:29184
    v_mul_f32 v129, v129, v193
    v_mfma_f32_16x16x32_bf16 v[168:171], v[64:67], a[160:163], v[168:171]
    v_exp_f32 v38, v38
    v_mul_f32 v130, v130, v194
    v_mfma_f32_16x16x32_bf16 v[168:171], v[68:71], a[164:167], v[168:171]
    v_exp_f32 v39, v39
    v_mul_f32 v131, v131, v195
    v_mfma_f32_16x16x32_bf16 v[168:171], v[72:75], a[168:171], v[168:171]
    v_exp_f32 v40, v40
    v_mul_f32 v144, v144, v208
    v_mfma_f32_16x16x32_bf16 v[168:171], v[76:79], a[172:175], v[168:171]
    v_exp_f32 v41, v41
    v_mul_f32 v145, v145, v209
    v_mfma_f32_16x16x32_bf16 v[172:175], v[76:79], a[188:191], v[172:175]
    v_exp_f32 v42, v42
    v_mul_f32 v146, v146, v210
    v_mfma_f32_16x16x32_bf16 v[172:175], v[72:75], a[184:187], v[172:175]
    v_exp_f32 v43, v43
    v_mul_f32 v147, v147, v211
    v_mfma_f32_16x16x32_bf16 v[172:175], v[68:71], a[180:183], v[172:175]
    v_fma_f32 v36, v36, s5, s5
    v_fma_f32 v37, v37, s5, s5
    v_fma_f32 v38, v38, s5, s5
    v_mfma_f32_16x16x32_bf16 v[172:175], v[64:67], a[176:179], v[172:175]
    s_waitcnt lgkmcnt(0)
    v_mfma_f32_16x16x32_bf16 v[224:227], v[80:83], a[128:131], v[224:227]
    ds_read_b64_tr_b16 v[64:65], v31 offset:0
    v_fma_f32 v39, v39, s5, s5
    v_fma_f32 v40, v40, s5, s5
    v_mfma_f32_16x16x32_bf16 v[224:227], v[84:87], a[132:135], v[224:227]
    ds_read_b64_tr_b16 v[66:67], v31 offset:512
    v_fma_f32 v41, v41, s5, s5
    v_fma_f32 v42, v42, s5, s5
    v_mfma_f32_16x16x32_bf16 v[224:227], v[88:91], a[136:139], v[224:227]
    ds_read_b64_tr_b16 v[68:69], v31 offset:4096
    v_fma_f32 v43, v43, s5, s5
    v_mfma_f32_16x16x32_bf16 v[224:227], v[92:95], a[140:143], v[224:227]
    ds_read_b64_tr_b16 v[70:71], v31 offset:4608
    v_rcp_f32 v36, v36
    v_mfma_f32_16x16x32_bf16 v[228:231], v[92:95], a[156:159], v[228:231]
    ds_read_b64_tr_b16 v[72:73], v31 offset:8192
    v_rcp_f32 v37, v37
    v_mfma_f32_16x16x32_bf16 v[228:231], v[88:91], a[152:155], v[228:231]
    ds_read_b64_tr_b16 v[74:75], v31 offset:8704
    v_rcp_f32 v38, v38
    v_mfma_f32_16x16x32_bf16 v[228:231], v[84:87], a[148:151], v[228:231]
    ds_read_b64_tr_b16 v[76:77], v31 offset:12288
    v_rcp_f32 v39, v39
    v_mfma_f32_16x16x32_bf16 v[228:231], v[80:83], a[144:147], v[228:231]
    ds_read_b64_tr_b16 v[78:79], v31 offset:12800
    v_rcp_f32 v40, v40
    v_mfma_f32_16x16x32_bf16 v[232:235], v[80:83], a[160:163], v[232:235]
    v_rcp_f32 v41, v41
    v_mfma_f32_16x16x32_bf16 v[232:235], v[84:87], a[164:167], v[232:235]
    v_rcp_f32 v42, v42
    v_mfma_f32_16x16x32_bf16 v[232:235], v[88:91], a[168:171], v[232:235]
    v_rcp_f32 v43, v43
    v_mul_f32 v36, v36, v128
    v_mfma_f32_16x16x32_bf16 v[232:235], v[92:95], a[172:175], v[232:235]
    v_mul_f32 v37, v37, v129
    v_mul_f32 v38, v38, v130
    v_mul_f32 v39, v39, v131
    v_mfma_f32_16x16x32_bf16 v[236:239], v[92:95], a[188:191], v[236:239]
    v_mul_f32 v40, v40, v144
    v_mul_f32 v41, v41, v145
    v_mul_f32 v42, v42, v146
    v_mfma_f32_16x16x32_bf16 v[236:239], v[88:91], a[184:187], v[236:239]
    v_mul_f32 v43, v43, v147
    v_cvt_pk_bf16_f32 v192, v36, v37
    v_cvt_pk_bf16_f32 v193, v38, v39
    v_mfma_f32_16x16x32_bf16 v[236:239], v[84:87], a[180:183], v[236:239]
    v_cvt_pk_bf16_f32 v194, v40, v41
    v_cvt_pk_bf16_f32 v195, v42, v43
    buffer_store_dwordx4 v[192:195], v1, s[12:15], s6 offen offset:0 sc1
    v_mfma_f32_16x16x32_bf16 v[236:239], v[80:83], a[176:179], v[236:239]
    s_waitcnt lgkmcnt(0)
    v_mfma_f32_16x16x32_bf16 v[176:179], v[64:67], a[128:131], v[176:179]
    ds_read_b64_tr_b16 v[80:81], v31 offset:16384
    v_mul_f32 v44, s4, v132
    v_mul_f32 v45, s4, v133
    v_mfma_f32_16x16x32_bf16 v[176:179], v[68:71], a[132:135], v[176:179]
    ds_read_b64_tr_b16 v[82:83], v31 offset:16896
    v_mul_f32 v46, s4, v134
    v_mul_f32 v47, s4, v135
    v_mfma_f32_16x16x32_bf16 v[176:179], v[72:75], a[136:139], v[176:179]
    ds_read_b64_tr_b16 v[84:85], v31 offset:20480
    v_mul_f32 v48, s4, v148
    v_mul_f32 v49, s4, v149
    v_mfma_f32_16x16x32_bf16 v[176:179], v[76:79], a[140:143], v[176:179]
    ds_read_b64_tr_b16 v[86:87], v31 offset:20992
    v_mul_f32 v50, s4, v150
    v_mul_f32 v51, s4, v151
    v_mfma_f32_16x16x32_bf16 v[180:183], v[76:79], a[156:159], v[180:183]
    ds_read_b64_tr_b16 v[88:89], v31 offset:24576
    v_exp_f32 v44, v44
    v_mfma_f32_16x16x32_bf16 v[180:183], v[72:75], a[152:155], v[180:183]
    ds_read_b64_tr_b16 v[90:91], v31 offset:25088
    v_mul_f32 v132, v132, v196
    v_mfma_f32_16x16x32_bf16 v[180:183], v[68:71], a[148:151], v[180:183]
    ds_read_b64_tr_b16 v[92:93], v31 offset:28672
    v_exp_f32 v45, v45
    v_mfma_f32_16x16x32_bf16 v[180:183], v[64:67], a[144:147], v[180:183]
    ds_read_b64_tr_b16 v[94:95], v31 offset:29184
    v_mul_f32 v133, v133, v197
    v_mfma_f32_16x16x32_bf16 v[184:187], v[64:67], a[160:163], v[184:187]
    v_exp_f32 v46, v46
    v_mul_f32 v134, v134, v198
    v_mfma_f32_16x16x32_bf16 v[184:187], v[68:71], a[164:167], v[184:187]
    v_exp_f32 v47, v47
    v_mul_f32 v135, v135, v199
    v_mfma_f32_16x16x32_bf16 v[184:187], v[72:75], a[168:171], v[184:187]
    v_exp_f32 v48, v48
    v_mul_f32 v148, v148, v212
    v_mfma_f32_16x16x32_bf16 v[184:187], v[76:79], a[172:175], v[184:187]
    v_exp_f32 v49, v49
    v_mul_f32 v149, v149, v213
    v_mfma_f32_16x16x32_bf16 v[188:191], v[76:79], a[188:191], v[188:191]
    v_exp_f32 v50, v50
    v_mul_f32 v150, v150, v214
    v_mfma_f32_16x16x32_bf16 v[188:191], v[72:75], a[184:187], v[188:191]
    v_exp_f32 v51, v51
    v_mul_f32 v151, v151, v215
    v_mfma_f32_16x16x32_bf16 v[188:191], v[68:71], a[180:183], v[188:191]
    v_fma_f32 v44, v44, s5, s5
    v_fma_f32 v45, v45, s5, s5
    v_fma_f32 v46, v46, s5, s5
    v_mfma_f32_16x16x32_bf16 v[188:191], v[64:67], a[176:179], v[188:191]
    s_waitcnt lgkmcnt(0)
    s_barrier
    v_mfma_f32_16x16x32_bf16 v[240:243], v[80:83], a[128:131], v[240:243]
    ds_read_b64_tr_b16 v[64:65], v32 offset:0
    v_fma_f32 v47, v47, s5, s5
    v_fma_f32 v48, v48, s5, s5
    v_mfma_f32_16x16x32_bf16 v[240:243], v[84:87], a[132:135], v[240:243]
    ds_read_b64_tr_b16 v[66:67], v32 offset:1024
    v_fma_f32 v49, v49, s5, s5
    v_fma_f32 v50, v50, s5, s5
    v_mfma_f32_16x16x32_bf16 v[240:243], v[88:91], a[136:139], v[240:243]
    ds_read_b64_tr_b16 v[68:69], v32 offset:8192
    v_fma_f32 v51, v51, s5, s5
    v_mfma_f32_16x16x32_bf16 v[240:243], v[92:95], a[140:143], v[240:243]
    ds_read_b64_tr_b16 v[70:71], v32 offset:9216
    v_rcp_f32 v44, v44
    v_mfma_f32_16x16x32_bf16 v[244:247], v[92:95], a[156:159], v[244:247]
    ds_read_b64_tr_b16 v[72:73], v32 offset:16384
    v_rcp_f32 v45, v45
    v_mfma_f32_16x16x32_bf16 v[244:247], v[88:91], a[152:155], v[244:247]
    ds_read_b64_tr_b16 v[74:75], v32 offset:17408
    v_rcp_f32 v46, v46
    v_mfma_f32_16x16x32_bf16 v[244:247], v[84:87], a[148:151], v[244:247]
    ds_read_b64_tr_b16 v[76:77], v32 offset:24576
    v_rcp_f32 v47, v47
    v_mfma_f32_16x16x32_bf16 v[244:247], v[80:83], a[144:147], v[244:247]
    ds_read_b64_tr_b16 v[78:79], v32 offset:25600
    v_rcp_f32 v48, v48
    v_mfma_f32_16x16x32_bf16 v[248:251], v[80:83], a[160:163], v[248:251]
    v_rcp_f32 v49, v49
    v_mfma_f32_16x16x32_bf16 v[248:251], v[84:87], a[164:167], v[248:251]
    v_rcp_f32 v50, v50
    v_mfma_f32_16x16x32_bf16 v[248:251], v[88:91], a[168:171], v[248:251]
    v_rcp_f32 v51, v51
    v_mul_f32 v44, v44, v132
    v_mfma_f32_16x16x32_bf16 v[248:251], v[92:95], a[172:175], v[248:251]
    v_mul_f32 v45, v45, v133
    v_mul_f32 v46, v46, v134
    v_mul_f32 v47, v47, v135
    v_mfma_f32_16x16x32_bf16 v[252:255], v[92:95], a[188:191], v[252:255]
    v_mul_f32 v48, v48, v148
    v_mul_f32 v49, v49, v149
    v_mul_f32 v50, v50, v150
    v_mfma_f32_16x16x32_bf16 v[252:255], v[88:91], a[184:187], v[252:255]
    v_mul_f32 v51, v51, v151
    v_cvt_pk_bf16_f32 v196, v44, v45
    v_cvt_pk_bf16_f32 v197, v46, v47
    v_mfma_f32_16x16x32_bf16 v[252:255], v[84:87], a[180:183], v[252:255]
    v_cvt_pk_bf16_f32 v198, v48, v49
    v_cvt_pk_bf16_f32 v199, v50, v51
    buffer_store_dwordx4 v[196:199], v1, s[12:15], s6 offen offset:1024 sc1
    v_mfma_f32_16x16x32_bf16 v[252:255], v[80:83], a[176:179], v[252:255]
    s_waitcnt lgkmcnt(0)
    v_mfma_f32_16x16x32_bf16 a[0:3], v[64:67], a[192:195], a[0:3]
    ds_read_b64_tr_b16 v[80:81], v32 offset:8
    v_mul_f32 v36, s4, v136
    v_mul_f32 v37, s4, v137
    v_mfma_f32_16x16x32_bf16 a[0:3], v[68:71], a[196:199], a[0:3]
    ds_read_b64_tr_b16 v[82:83], v32 offset:1032
    v_mul_f32 v38, s4, v138
    v_mul_f32 v39, s4, v139
    v_mfma_f32_16x16x32_bf16 a[0:3], v[72:75], a[200:203], a[0:3]
    ds_read_b64_tr_b16 v[84:85], v32 offset:8200
    v_mul_f32 v40, s4, v152
    v_mul_f32 v41, s4, v153
    v_mfma_f32_16x16x32_bf16 a[0:3], v[76:79], a[204:207], a[0:3]
    ds_read_b64_tr_b16 v[86:87], v32 offset:9224
    v_mul_f32 v42, s4, v154
    v_mul_f32 v43, s4, v155
    v_mfma_f32_16x16x32_bf16 a[4:7], v[76:79], a[220:223], a[4:7]
    ds_read_b64_tr_b16 v[88:89], v32 offset:16392
    v_exp_f32 v36, v36
    v_mfma_f32_16x16x32_bf16 a[4:7], v[72:75], a[216:219], a[4:7]
    ds_read_b64_tr_b16 v[90:91], v32 offset:17416
    v_mul_f32 v136, v136, v200
    v_mfma_f32_16x16x32_bf16 a[4:7], v[68:71], a[212:215], a[4:7]
    ds_read_b64_tr_b16 v[92:93], v32 offset:24584
    v_exp_f32 v37, v37
    v_mfma_f32_16x16x32_bf16 a[4:7], v[64:67], a[208:211], a[4:7]
    ds_read_b64_tr_b16 v[94:95], v32 offset:25608
    v_mul_f32 v137, v137, v201
    v_mfma_f32_16x16x32_bf16 a[8:11], v[64:67], a[224:227], a[8:11]
    v_exp_f32 v38, v38
    v_mul_f32 v138, v138, v202
    v_mfma_f32_16x16x32_bf16 a[8:11], v[68:71], a[228:231], a[8:11]
    v_exp_f32 v39, v39
    v_mul_f32 v139, v139, v203
    v_mfma_f32_16x16x32_bf16 a[8:11], v[72:75], a[232:235], a[8:11]
    v_exp_f32 v40, v40
    v_mul_f32 v152, v152, v216
    v_mfma_f32_16x16x32_bf16 a[8:11], v[76:79], a[236:239], a[8:11]
    v_exp_f32 v41, v41
    v_mul_f32 v153, v153, v217
    v_mfma_f32_16x16x32_bf16 a[12:15], v[76:79], a[252:255], a[12:15]
    v_exp_f32 v42, v42
    v_mul_f32 v154, v154, v218
    v_mfma_f32_16x16x32_bf16 a[12:15], v[72:75], a[248:251], a[12:15]
    v_exp_f32 v43, v43
    v_mul_f32 v155, v155, v219
    v_mfma_f32_16x16x32_bf16 a[12:15], v[68:71], a[244:247], a[12:15]
    v_fma_f32 v36, v36, s5, s5
    v_fma_f32 v37, v37, s5, s5
    v_fma_f32 v38, v38, s5, s5
    v_mfma_f32_16x16x32_bf16 a[12:15], v[64:67], a[240:243], a[12:15]
    s_waitcnt lgkmcnt(0)
    v_mfma_f32_16x16x32_bf16 a[16:19], v[80:83], a[192:195], a[16:19]
    ds_read_b64_tr_b16 v[64:65], v33 offset:0
    v_fma_f32 v39, v39, s5, s5
    v_fma_f32 v40, v40, s5, s5
    v_mfma_f32_16x16x32_bf16 a[16:19], v[84:87], a[196:199], a[16:19]
    ds_read_b64_tr_b16 v[66:67], v33 offset:1024
    v_fma_f32 v41, v41, s5, s5
    v_fma_f32 v42, v42, s5, s5
    v_mfma_f32_16x16x32_bf16 a[16:19], v[88:91], a[200:203], a[16:19]
    ds_read_b64_tr_b16 v[68:69], v33 offset:8192
    v_fma_f32 v43, v43, s5, s5
    v_mfma_f32_16x16x32_bf16 a[16:19], v[92:95], a[204:207], a[16:19]
    ds_read_b64_tr_b16 v[70:71], v33 offset:9216
    v_rcp_f32 v36, v36
    v_mfma_f32_16x16x32_bf16 a[20:23], v[92:95], a[220:223], a[20:23]
    ds_read_b64_tr_b16 v[72:73], v33 offset:16384
    v_rcp_f32 v37, v37
    v_mfma_f32_16x16x32_bf16 a[20:23], v[88:91], a[216:219], a[20:23]
    ds_read_b64_tr_b16 v[74:75], v33 offset:17408
    v_rcp_f32 v38, v38
    v_mfma_f32_16x16x32_bf16 a[20:23], v[84:87], a[212:215], a[20:23]
    ds_read_b64_tr_b16 v[76:77], v33 offset:24576
    v_rcp_f32 v39, v39
    v_mfma_f32_16x16x32_bf16 a[20:23], v[80:83], a[208:211], a[20:23]
    ds_read_b64_tr_b16 v[78:79], v33 offset:25600
    v_rcp_f32 v40, v40
    v_mfma_f32_16x16x32_bf16 a[24:27], v[80:83], a[224:227], a[24:27]
    v_rcp_f32 v41, v41
    v_mfma_f32_16x16x32_bf16 a[24:27], v[84:87], a[228:231], a[24:27]
    v_rcp_f32 v42, v42
    v_mfma_f32_16x16x32_bf16 a[24:27], v[88:91], a[232:235], a[24:27]
    v_rcp_f32 v43, v43
    v_mul_f32 v36, v36, v136
    v_mfma_f32_16x16x32_bf16 a[24:27], v[92:95], a[236:239], a[24:27]
    v_mul_f32 v37, v37, v137
    v_mul_f32 v38, v38, v138
    v_mul_f32 v39, v39, v139
    v_mfma_f32_16x16x32_bf16 a[28:31], v[92:95], a[252:255], a[28:31]
    v_mul_f32 v40, v40, v152
    v_mul_f32 v41, v41, v153
    v_mul_f32 v42, v42, v154
    v_mfma_f32_16x16x32_bf16 a[28:31], v[88:91], a[248:251], a[28:31]
    v_mul_f32 v43, v43, v155
    v_cvt_pk_bf16_f32 v200, v36, v37
    v_cvt_pk_bf16_f32 v201, v38, v39
    v_mfma_f32_16x16x32_bf16 a[28:31], v[84:87], a[244:247], a[28:31]
    v_cvt_pk_bf16_f32 v202, v40, v41
    v_cvt_pk_bf16_f32 v203, v42, v43
    buffer_store_dwordx4 v[200:203], v1, s[12:15], s6 offen offset:2048 sc1
    v_mfma_f32_16x16x32_bf16 a[28:31], v[80:83], a[240:243], a[28:31]
    s_waitcnt lgkmcnt(0)
    v_mfma_f32_16x16x32_bf16 a[32:35], v[64:67], a[192:195], a[32:35]
    ds_read_b64_tr_b16 v[80:81], v33 offset:8
    v_mul_f32 v44, s4, v140
    v_mul_f32 v45, s4, v141
    v_mfma_f32_16x16x32_bf16 a[32:35], v[68:71], a[196:199], a[32:35]
    ds_read_b64_tr_b16 v[82:83], v33 offset:1032
    v_mul_f32 v46, s4, v142
    v_mul_f32 v47, s4, v143
    v_mfma_f32_16x16x32_bf16 a[32:35], v[72:75], a[200:203], a[32:35]
    ds_read_b64_tr_b16 v[84:85], v33 offset:8200
    v_mul_f32 v48, s4, v156
    v_mul_f32 v49, s4, v157
    v_mfma_f32_16x16x32_bf16 a[32:35], v[76:79], a[204:207], a[32:35]
    ds_read_b64_tr_b16 v[86:87], v33 offset:9224
    v_mul_f32 v50, s4, v158
    v_mul_f32 v51, s4, v159
    v_mfma_f32_16x16x32_bf16 a[36:39], v[76:79], a[220:223], a[36:39]
    ds_read_b64_tr_b16 v[88:89], v33 offset:16392
    v_exp_f32 v44, v44
    v_mfma_f32_16x16x32_bf16 a[36:39], v[72:75], a[216:219], a[36:39]
    ds_read_b64_tr_b16 v[90:91], v33 offset:17416
    v_mul_f32 v140, v140, v204
    v_mfma_f32_16x16x32_bf16 a[36:39], v[68:71], a[212:215], a[36:39]
    ds_read_b64_tr_b16 v[92:93], v33 offset:24584
    v_exp_f32 v45, v45
    v_mfma_f32_16x16x32_bf16 a[36:39], v[64:67], a[208:211], a[36:39]
    ds_read_b64_tr_b16 v[94:95], v33 offset:25608
    v_mul_f32 v141, v141, v205
    v_mfma_f32_16x16x32_bf16 a[40:43], v[64:67], a[224:227], a[40:43]
    v_exp_f32 v46, v46
    v_mul_f32 v142, v142, v206
    v_mfma_f32_16x16x32_bf16 a[40:43], v[68:71], a[228:231], a[40:43]
    v_exp_f32 v47, v47
    v_mul_f32 v143, v143, v207
    v_mfma_f32_16x16x32_bf16 a[40:43], v[72:75], a[232:235], a[40:43]
    v_exp_f32 v48, v48
    v_mul_f32 v156, v156, v220
    v_mfma_f32_16x16x32_bf16 a[40:43], v[76:79], a[236:239], a[40:43]
    v_exp_f32 v49, v49
    v_mul_f32 v157, v157, v221
    v_mfma_f32_16x16x32_bf16 a[44:47], v[76:79], a[252:255], a[44:47]
    v_exp_f32 v50, v50
    v_mul_f32 v158, v158, v222
    v_mfma_f32_16x16x32_bf16 a[44:47], v[72:75], a[248:251], a[44:47]
    v_exp_f32 v51, v51
    v_mul_f32 v159, v159, v223
    v_mfma_f32_16x16x32_bf16 a[44:47], v[68:71], a[244:247], a[44:47]
    v_fma_f32 v44, v44, s5, s5
    v_fma_f32 v45, v45, s5, s5
    v_fma_f32 v46, v46, s5, s5
    v_mfma_f32_16x16x32_bf16 a[44:47], v[64:67], a[240:243], a[44:47]
    s_waitcnt lgkmcnt(0)
    v_mfma_f32_16x16x32_bf16 a[48:51], v[80:83], a[192:195], a[48:51]
    ds_read_b64_tr_b16 v[64:65], v34 offset:0
    v_fma_f32 v47, v47, s5, s5
    v_fma_f32 v48, v48, s5, s5
    v_mfma_f32_16x16x32_bf16 a[48:51], v[84:87], a[196:199], a[48:51]
    ds_read_b64_tr_b16 v[66:67], v34 offset:1024
    v_fma_f32 v49, v49, s5, s5
    v_fma_f32 v50, v50, s5, s5
    v_mfma_f32_16x16x32_bf16 a[48:51], v[88:91], a[200:203], a[48:51]
    ds_read_b64_tr_b16 v[68:69], v34 offset:8192
    v_fma_f32 v51, v51, s5, s5
    v_mfma_f32_16x16x32_bf16 a[48:51], v[92:95], a[204:207], a[48:51]
    ds_read_b64_tr_b16 v[70:71], v34 offset:9216
    v_rcp_f32 v44, v44
    v_mfma_f32_16x16x32_bf16 a[52:55], v[92:95], a[220:223], a[52:55]
    ds_read_b64_tr_b16 v[72:73], v34 offset:16384
    v_rcp_f32 v45, v45
    v_mfma_f32_16x16x32_bf16 a[52:55], v[88:91], a[216:219], a[52:55]
    ds_read_b64_tr_b16 v[74:75], v34 offset:17408
    v_rcp_f32 v46, v46
    v_mfma_f32_16x16x32_bf16 a[52:55], v[84:87], a[212:215], a[52:55]
    ds_read_b64_tr_b16 v[76:77], v34 offset:24576
    v_rcp_f32 v47, v47
    v_mfma_f32_16x16x32_bf16 a[52:55], v[80:83], a[208:211], a[52:55]
    ds_read_b64_tr_b16 v[78:79], v34 offset:25600
    v_rcp_f32 v48, v48
    v_mfma_f32_16x16x32_bf16 a[56:59], v[80:83], a[224:227], a[56:59]
    v_rcp_f32 v49, v49
    v_mfma_f32_16x16x32_bf16 a[56:59], v[84:87], a[228:231], a[56:59]
    v_rcp_f32 v50, v50
    v_mfma_f32_16x16x32_bf16 a[56:59], v[88:91], a[232:235], a[56:59]
    v_rcp_f32 v51, v51
    v_mul_f32 v44, v44, v140
    v_mfma_f32_16x16x32_bf16 a[56:59], v[92:95], a[236:239], a[56:59]
    v_mul_f32 v45, v45, v141
    v_mul_f32 v46, v46, v142
    v_mul_f32 v47, v47, v143
    v_mfma_f32_16x16x32_bf16 a[60:63], v[92:95], a[252:255], a[60:63]
    v_mul_f32 v48, v48, v156
    v_mul_f32 v49, v49, v157
    v_mul_f32 v50, v50, v158
    v_mfma_f32_16x16x32_bf16 a[60:63], v[88:91], a[248:251], a[60:63]
    v_mul_f32 v51, v51, v159
    v_cvt_pk_bf16_f32 v204, v44, v45
    v_cvt_pk_bf16_f32 v205, v46, v47
    v_mfma_f32_16x16x32_bf16 a[60:63], v[84:87], a[244:247], a[60:63]
    v_cvt_pk_bf16_f32 v206, v48, v49
    v_cvt_pk_bf16_f32 v207, v50, v51
    buffer_store_dwordx4 v[204:207], v1, s[12:15], s6 offen offset:3072 sc1
    v_mfma_f32_16x16x32_bf16 a[60:63], v[80:83], a[240:243], a[60:63]
    s_waitcnt lgkmcnt(0)
    v_mfma_f32_16x16x32_bf16 a[64:67], v[64:67], a[192:195], a[64:67]
    ds_read_b64_tr_b16 v[80:81], v34 offset:8
    v_mul_f32 v36, s4, v160
    v_mul_f32 v37, s4, v161
    v_mfma_f32_16x16x32_bf16 a[64:67], v[68:71], a[196:199], a[64:67]
    ds_read_b64_tr_b16 v[82:83], v34 offset:1032
    v_mul_f32 v38, s4, v162
    v_mul_f32 v39, s4, v163
    v_mfma_f32_16x16x32_bf16 a[64:67], v[72:75], a[200:203], a[64:67]
    ds_read_b64_tr_b16 v[84:85], v34 offset:8200
    v_mul_f32 v40, s4, v176
    v_mul_f32 v41, s4, v177
    v_mfma_f32_16x16x32_bf16 a[64:67], v[76:79], a[204:207], a[64:67]
    ds_read_b64_tr_b16 v[86:87], v34 offset:9224
    v_mul_f32 v42, s4, v178
    v_mul_f32 v43, s4, v179
    v_mfma_f32_16x16x32_bf16 a[68:71], v[76:79], a[220:223], a[68:71]
    ds_read_b64_tr_b16 v[88:89], v34 offset:16392
    v_exp_f32 v36, v36
    v_mfma_f32_16x16x32_bf16 a[68:71], v[72:75], a[216:219], a[68:71]
    ds_read_b64_tr_b16 v[90:91], v34 offset:17416
    v_mul_f32 v160, v160, v224
    v_mfma_f32_16x16x32_bf16 a[68:71], v[68:71], a[212:215], a[68:71]
    ds_read_b64_tr_b16 v[92:93], v34 offset:24584
    v_exp_f32 v37, v37
    v_mfma_f32_16x16x32_bf16 a[68:71], v[64:67], a[208:211], a[68:71]
    ds_read_b64_tr_b16 v[94:95], v34 offset:25608
    v_mul_f32 v161, v161, v225
    v_mfma_f32_16x16x32_bf16 a[72:75], v[64:67], a[224:227], a[72:75]
    v_exp_f32 v38, v38
    v_mul_f32 v162, v162, v226
    v_mfma_f32_16x16x32_bf16 a[72:75], v[68:71], a[228:231], a[72:75]
    v_exp_f32 v39, v39
    v_mul_f32 v163, v163, v227
    v_mfma_f32_16x16x32_bf16 a[72:75], v[72:75], a[232:235], a[72:75]
    v_exp_f32 v40, v40
    v_mul_f32 v176, v176, v240
    v_mfma_f32_16x16x32_bf16 a[72:75], v[76:79], a[236:239], a[72:75]
    v_exp_f32 v41, v41
    v_mul_f32 v177, v177, v241
    v_mfma_f32_16x16x32_bf16 a[76:79], v[76:79], a[252:255], a[76:79]
    v_exp_f32 v42, v42
    v_mul_f32 v178, v178, v242
    v_mfma_f32_16x16x32_bf16 a[76:79], v[72:75], a[248:251], a[76:79]
    v_exp_f32 v43, v43
    v_mul_f32 v179, v179, v243
    v_mfma_f32_16x16x32_bf16 a[76:79], v[68:71], a[244:247], a[76:79]
    v_fma_f32 v36, v36, s5, s5
    v_fma_f32 v37, v37, s5, s5
    v_fma_f32 v38, v38, s5, s5
    v_mfma_f32_16x16x32_bf16 a[76:79], v[64:67], a[240:243], a[76:79]
    s_waitcnt lgkmcnt(0)
    v_mfma_f32_16x16x32_bf16 a[80:83], v[80:83], a[192:195], a[80:83]
    ds_read_b64_tr_b16 v[64:65], v35 offset:0
    v_fma_f32 v39, v39, s5, s5
    v_fma_f32 v40, v40, s5, s5
    v_mfma_f32_16x16x32_bf16 a[80:83], v[84:87], a[196:199], a[80:83]
    ds_read_b64_tr_b16 v[66:67], v35 offset:1024
    v_fma_f32 v41, v41, s5, s5
    v_fma_f32 v42, v42, s5, s5
    v_mfma_f32_16x16x32_bf16 a[80:83], v[88:91], a[200:203], a[80:83]
    ds_read_b64_tr_b16 v[68:69], v35 offset:8192
    v_fma_f32 v43, v43, s5, s5
    v_mfma_f32_16x16x32_bf16 a[80:83], v[92:95], a[204:207], a[80:83]
    ds_read_b64_tr_b16 v[70:71], v35 offset:9216
    v_rcp_f32 v36, v36
    v_mfma_f32_16x16x32_bf16 a[84:87], v[92:95], a[220:223], a[84:87]
    ds_read_b64_tr_b16 v[72:73], v35 offset:16384
    v_rcp_f32 v37, v37
    v_mfma_f32_16x16x32_bf16 a[84:87], v[88:91], a[216:219], a[84:87]
    ds_read_b64_tr_b16 v[74:75], v35 offset:17408
    v_rcp_f32 v38, v38
    v_mfma_f32_16x16x32_bf16 a[84:87], v[84:87], a[212:215], a[84:87]
    ds_read_b64_tr_b16 v[76:77], v35 offset:24576
    v_rcp_f32 v39, v39
    v_mfma_f32_16x16x32_bf16 a[84:87], v[80:83], a[208:211], a[84:87]
    ds_read_b64_tr_b16 v[78:79], v35 offset:25600
    v_rcp_f32 v40, v40
    v_mfma_f32_16x16x32_bf16 a[88:91], v[80:83], a[224:227], a[88:91]
    v_rcp_f32 v41, v41
    v_mfma_f32_16x16x32_bf16 a[88:91], v[84:87], a[228:231], a[88:91]
    v_rcp_f32 v42, v42
    v_mfma_f32_16x16x32_bf16 a[88:91], v[88:91], a[232:235], a[88:91]
    v_rcp_f32 v43, v43
    v_mul_f32 v36, v36, v160
    v_mfma_f32_16x16x32_bf16 a[88:91], v[92:95], a[236:239], a[88:91]
    v_mul_f32 v37, v37, v161
    v_mul_f32 v38, v38, v162
    v_mul_f32 v39, v39, v163
    v_mfma_f32_16x16x32_bf16 a[92:95], v[92:95], a[252:255], a[92:95]
    v_mul_f32 v40, v40, v176
    v_mul_f32 v41, v41, v177
    v_mul_f32 v42, v42, v178
    v_mfma_f32_16x16x32_bf16 a[92:95], v[88:91], a[248:251], a[92:95]
    v_mul_f32 v43, v43, v179
    v_cvt_pk_bf16_f32 v224, v36, v37
    v_cvt_pk_bf16_f32 v225, v38, v39
    v_mfma_f32_16x16x32_bf16 a[92:95], v[84:87], a[244:247], a[92:95]
    v_cvt_pk_bf16_f32 v226, v40, v41
    v_cvt_pk_bf16_f32 v227, v42, v43
    buffer_store_dwordx4 v[224:227], v1, s[12:15], s7 offen offset:0 sc1
    v_mfma_f32_16x16x32_bf16 a[92:95], v[80:83], a[240:243], a[92:95]
    s_waitcnt lgkmcnt(0)
    v_mfma_f32_16x16x32_bf16 a[96:99], v[64:67], a[192:195], a[96:99]
    ds_read_b64_tr_b16 v[80:81], v35 offset:8
    v_mul_f32 v44, s4, v164
    v_mul_f32 v45, s4, v165
    v_mfma_f32_16x16x32_bf16 a[96:99], v[68:71], a[196:199], a[96:99]
    ds_read_b64_tr_b16 v[82:83], v35 offset:1032
    v_mul_f32 v46, s4, v166
    v_mul_f32 v47, s4, v167
    v_mfma_f32_16x16x32_bf16 a[96:99], v[72:75], a[200:203], a[96:99]
    ds_read_b64_tr_b16 v[84:85], v35 offset:8200
    v_mul_f32 v48, s4, v180
    v_mul_f32 v49, s4, v181
    v_mfma_f32_16x16x32_bf16 a[96:99], v[76:79], a[204:207], a[96:99]
    ds_read_b64_tr_b16 v[86:87], v35 offset:9224
    v_mul_f32 v50, s4, v182
    v_mul_f32 v51, s4, v183
    v_mfma_f32_16x16x32_bf16 a[100:103], v[76:79], a[220:223], a[100:103]
    ds_read_b64_tr_b16 v[88:89], v35 offset:16392
    v_exp_f32 v44, v44
    v_mfma_f32_16x16x32_bf16 a[100:103], v[72:75], a[216:219], a[100:103]
    ds_read_b64_tr_b16 v[90:91], v35 offset:17416
    v_mul_f32 v164, v164, v228
    v_mfma_f32_16x16x32_bf16 a[100:103], v[68:71], a[212:215], a[100:103]
    ds_read_b64_tr_b16 v[92:93], v35 offset:24584
    v_exp_f32 v45, v45
    v_mfma_f32_16x16x32_bf16 a[100:103], v[64:67], a[208:211], a[100:103]
    ds_read_b64_tr_b16 v[94:95], v35 offset:25608
    v_mul_f32 v165, v165, v229
    v_mfma_f32_16x16x32_bf16 a[104:107], v[64:67], a[224:227], a[104:107]
    v_exp_f32 v46, v46
    v_mul_f32 v166, v166, v230
    v_mfma_f32_16x16x32_bf16 a[104:107], v[68:71], a[228:231], a[104:107]
    v_exp_f32 v47, v47
    v_mul_f32 v167, v167, v231
    v_mfma_f32_16x16x32_bf16 a[104:107], v[72:75], a[232:235], a[104:107]
    v_exp_f32 v48, v48
    v_mul_f32 v180, v180, v244
    v_mfma_f32_16x16x32_bf16 a[104:107], v[76:79], a[236:239], a[104:107]
    v_exp_f32 v49, v49
    v_mul_f32 v181, v181, v245
    v_mfma_f32_16x16x32_bf16 a[108:111], v[76:79], a[252:255], a[108:111]
    v_exp_f32 v50, v50
    v_mul_f32 v182, v182, v246
    v_mfma_f32_16x16x32_bf16 a[108:111], v[72:75], a[248:251], a[108:111]
    v_exp_f32 v51, v51
    v_mul_f32 v183, v183, v247
    v_mfma_f32_16x16x32_bf16 a[108:111], v[68:71], a[244:247], a[108:111]
    v_fma_f32 v44, v44, s5, s5
    v_fma_f32 v45, v45, s5, s5
    v_fma_f32 v46, v46, s5, s5
    v_mfma_f32_16x16x32_bf16 a[108:111], v[64:67], a[240:243], a[108:111]
    s_waitcnt vmcnt(13) lgkmcnt(0)
    s_barrier
    v_mfma_f32_16x16x32_bf16 a[112:115], v[80:83], a[192:195], a[112:115]
    ds_read_b64_tr_b16 v[64:65], v32 offset:32768
    v_fma_f32 v47, v47, s5, s5
    v_fma_f32 v48, v48, s5, s5
    v_mfma_f32_16x16x32_bf16 a[112:115], v[84:87], a[196:199], a[112:115]
    ds_read_b64_tr_b16 v[66:67], v32 offset:33792
    v_fma_f32 v49, v49, s5, s5
    v_fma_f32 v50, v50, s5, s5
    v_mfma_f32_16x16x32_bf16 a[112:115], v[88:91], a[200:203], a[112:115]
    ds_read_b64_tr_b16 v[68:69], v32 offset:40960
    v_fma_f32 v51, v51, s5, s5
    v_mfma_f32_16x16x32_bf16 a[112:115], v[92:95], a[204:207], a[112:115]
    ds_read_b64_tr_b16 v[70:71], v32 offset:41984
    v_rcp_f32 v44, v44
    v_mfma_f32_16x16x32_bf16 a[116:119], v[92:95], a[220:223], a[116:119]
    ds_read_b64_tr_b16 v[72:73], v32 offset:49152
    v_rcp_f32 v45, v45
    v_mfma_f32_16x16x32_bf16 a[116:119], v[88:91], a[216:219], a[116:119]
    ds_read_b64_tr_b16 v[74:75], v32 offset:50176
    v_rcp_f32 v46, v46
    v_mfma_f32_16x16x32_bf16 a[116:119], v[84:87], a[212:215], a[116:119]
    ds_read_b64_tr_b16 v[76:77], v32 offset:57344
    v_rcp_f32 v47, v47
    v_mfma_f32_16x16x32_bf16 a[116:119], v[80:83], a[208:211], a[116:119]
    ds_read_b64_tr_b16 v[78:79], v32 offset:58368
    v_rcp_f32 v48, v48
    v_mfma_f32_16x16x32_bf16 a[120:123], v[80:83], a[224:227], a[120:123]
    v_rcp_f32 v49, v49
    v_mfma_f32_16x16x32_bf16 a[120:123], v[84:87], a[228:231], a[120:123]
    v_rcp_f32 v50, v50
    v_mfma_f32_16x16x32_bf16 a[120:123], v[88:91], a[232:235], a[120:123]
    v_rcp_f32 v51, v51
    v_mul_f32 v44, v44, v164
    v_mfma_f32_16x16x32_bf16 a[120:123], v[92:95], a[236:239], a[120:123]
    v_mul_f32 v45, v45, v165
    v_mul_f32 v46, v46, v166
    v_mul_f32 v47, v47, v167
    v_mfma_f32_16x16x32_bf16 a[124:127], v[92:95], a[252:255], a[124:127]
    v_mul_f32 v48, v48, v180
    v_mul_f32 v49, v49, v181
    v_mul_f32 v50, v50, v182
    v_mfma_f32_16x16x32_bf16 a[124:127], v[88:91], a[248:251], a[124:127]
    v_mul_f32 v51, v51, v183
    v_cvt_pk_bf16_f32 v228, v44, v45
    v_cvt_pk_bf16_f32 v229, v46, v47
    v_mfma_f32_16x16x32_bf16 a[124:127], v[84:87], a[244:247], a[124:127]
    v_cvt_pk_bf16_f32 v230, v48, v49
    v_cvt_pk_bf16_f32 v231, v50, v51
    buffer_store_dwordx4 v[228:231], v1, s[12:15], s7 offen offset:1024 sc1
    v_mfma_f32_16x16x32_bf16 a[124:127], v[80:83], a[240:243], a[124:127]
    s_waitcnt lgkmcnt(0)
    v_mfma_f32_16x16x32_bf16 a[0:3], v[64:67], a[128:131], a[0:3]
    ds_read_b64_tr_b16 v[80:81], v32 offset:32776
    v_mul_f32 v36, s4, v168
    v_mul_f32 v37, s4, v169
    v_mfma_f32_16x16x32_bf16 a[0:3], v[68:71], a[132:135], a[0:3]
    ds_read_b64_tr_b16 v[82:83], v32 offset:33800
    v_mul_f32 v38, s4, v170
    v_mul_f32 v39, s4, v171
    v_mfma_f32_16x16x32_bf16 a[0:3], v[72:75], a[136:139], a[0:3]
    ds_read_b64_tr_b16 v[84:85], v32 offset:40968
    v_mul_f32 v40, s4, v184
    v_mul_f32 v41, s4, v185
    v_mfma_f32_16x16x32_bf16 a[0:3], v[76:79], a[140:143], a[0:3]
    ds_read_b64_tr_b16 v[86:87], v32 offset:41992
    v_mul_f32 v42, s4, v186
    v_mul_f32 v43, s4, v187
    v_mfma_f32_16x16x32_bf16 a[4:7], v[76:79], a[156:159], a[4:7]
    ds_read_b64_tr_b16 v[88:89], v32 offset:49160
    v_exp_f32 v36, v36
    v_mfma_f32_16x16x32_bf16 a[4:7], v[72:75], a[152:155], a[4:7]
    ds_read_b64_tr_b16 v[90:91], v32 offset:50184
    v_mul_f32 v168, v168, v232
    v_mfma_f32_16x16x32_bf16 a[4:7], v[68:71], a[148:151], a[4:7]
    ds_read_b64_tr_b16 v[92:93], v32 offset:57352
    v_exp_f32 v37, v37
    v_mfma_f32_16x16x32_bf16 a[4:7], v[64:67], a[144:147], a[4:7]
    ds_read_b64_tr_b16 v[94:95], v32 offset:58376
    v_mul_f32 v169, v169, v233
    v_mfma_f32_16x16x32_bf16 a[8:11], v[64:67], a[160:163], a[8:11]
    s_add_u32 m0, s50, 65536
    v_exp_f32 v38, v38
    v_mfma_f32_16x16x32_bf16 a[8:11], v[68:71], a[164:167], a[8:11]
    buffer_load_dwordx4 v2, s[24:27], s36 offen offset:0 lds
    v_mul_f32 v170, v170, v234
    v_mfma_f32_16x16x32_bf16 a[8:11], v[72:75], a[168:171], a[8:11]
    v_exp_f32 v39, v39
    v_mul_f32 v171, v171, v235
    v_mfma_f32_16x16x32_bf16 a[8:11], v[76:79], a[172:175], a[8:11]
    v_exp_f32 v40, v40
    v_mul_f32 v184, v184, v248
    v_mfma_f32_16x16x32_bf16 a[12:15], v[76:79], a[188:191], a[12:15]
    v_exp_f32 v41, v41
    v_mul_f32 v185, v185, v249
    v_mfma_f32_16x16x32_bf16 a[12:15], v[72:75], a[184:187], a[12:15]
    v_exp_f32 v42, v42
    v_mul_f32 v186, v186, v250
    v_mfma_f32_16x16x32_bf16 a[12:15], v[68:71], a[180:183], a[12:15]
    buffer_load_dwordx4 v3, s[24:27], s36 offen offset:1024 lds
    v_exp_f32 v43, v43
    v_mfma_f32_16x16x32_bf16 a[12:15], v[64:67], a[176:179], a[12:15]
    s_waitcnt lgkmcnt(0)
    v_mfma_f32_16x16x32_bf16 a[16:19], v[80:83], a[128:131], a[16:19]
    ds_read_b64_tr_b16 v[64:65], v33 offset:32768
    v_mul_f32 v187, v187, v251
    v_fma_f32 v36, v36, s5, s5
    v_mfma_f32_16x16x32_bf16 a[16:19], v[84:87], a[132:135], a[16:19]
    ds_read_b64_tr_b16 v[66:67], v33 offset:33792
    v_fma_f32 v37, v37, s5, s5
    v_fma_f32 v38, v38, s5, s5
    v_mfma_f32_16x16x32_bf16 a[16:19], v[88:91], a[136:139], a[16:19]
    ds_read_b64_tr_b16 v[68:69], v33 offset:40960
    v_fma_f32 v39, v39, s5, s5
    v_fma_f32 v40, v40, s5, s5
    v_mfma_f32_16x16x32_bf16 a[16:19], v[92:95], a[140:143], a[16:19]
    ds_read_b64_tr_b16 v[70:71], v33 offset:41984
    v_fma_f32 v41, v41, s5, s5
    v_fma_f32 v42, v42, s5, s5
    v_mfma_f32_16x16x32_bf16 a[20:23], v[92:95], a[156:159], a[20:23]
    ds_read_b64_tr_b16 v[72:73], v33 offset:49152
    v_fma_f32 v43, v43, s5, s5
    v_mfma_f32_16x16x32_bf16 a[20:23], v[88:91], a[152:155], a[20:23]
    ds_read_b64_tr_b16 v[74:75], v33 offset:50176
    v_rcp_f32 v36, v36
    v_mfma_f32_16x16x32_bf16 a[20:23], v[84:87], a[148:151], a[20:23]
    ds_read_b64_tr_b16 v[76:77], v33 offset:57344
    v_rcp_f32 v37, v37
    v_mfma_f32_16x16x32_bf16 a[20:23], v[80:83], a[144:147], a[20:23]
    ds_read_b64_tr_b16 v[78:79], v33 offset:58368
    v_rcp_f32 v38, v38
    v_mfma_f32_16x16x32_bf16 a[24:27], v[80:83], a[160:163], a[24:27]
    v_rcp_f32 v39, v39
    v_mfma_f32_16x16x32_bf16 a[24:27], v[84:87], a[164:167], a[24:27]
    buffer_load_dwordx4 v4, s[24:27], s36 offen offset:2048 lds
    v_rcp_f32 v40, v40
    v_mfma_f32_16x16x32_bf16 a[24:27], v[88:91], a[168:171], a[24:27]
    v_rcp_f32 v41, v41
    v_mfma_f32_16x16x32_bf16 a[24:27], v[92:95], a[172:175], a[24:27]
    v_rcp_f32 v42, v42
    v_mfma_f32_16x16x32_bf16 a[28:31], v[92:95], a[188:191], a[28:31]
    v_rcp_f32 v43, v43
    v_mul_f32 v36, v36, v168
    v_mfma_f32_16x16x32_bf16 a[28:31], v[88:91], a[184:187], a[28:31]
    v_mul_f32 v37, v37, v169
    v_mul_f32 v38, v38, v170
    v_mul_f32 v39, v39, v171
    v_mfma_f32_16x16x32_bf16 a[28:31], v[84:87], a[180:183], a[28:31]
    buffer_load_dwordx4 v5, s[24:27], s36 offen offset:3072 lds
    s_add_u32 s36, s36, 4096
    v_mul_f32 v40, v40, v184
    v_mfma_f32_16x16x32_bf16 a[28:31], v[80:83], a[176:179], a[28:31]
    s_waitcnt lgkmcnt(0)
    v_mfma_f32_16x16x32_bf16 a[32:35], v[64:67], a[128:131], a[32:35]
    ds_read_b64_tr_b16 v[80:81], v33 offset:32776
    v_mul_f32 v41, v41, v185
    v_mul_f32 v42, v42, v186
    v_mfma_f32_16x16x32_bf16 a[32:35], v[68:71], a[132:135], a[32:35]
    ds_read_b64_tr_b16 v[82:83], v33 offset:33800
    v_mul_f32 v43, v43, v187
    v_cvt_pk_bf16_f32 v232, v36, v37
    v_mfma_f32_16x16x32_bf16 a[32:35], v[72:75], a[136:139], a[32:35]
    ds_read_b64_tr_b16 v[84:85], v33 offset:40968
    v_cvt_pk_bf16_f32 v233, v38, v39
    v_cvt_pk_bf16_f32 v234, v40, v41
    v_mfma_f32_16x16x32_bf16 a[32:35], v[76:79], a[140:143], a[32:35]
    ds_read_b64_tr_b16 v[86:87], v33 offset:41992
    v_cvt_pk_bf16_f32 v235, v42, v43
    buffer_store_dwordx4 v[232:235], v1, s[12:15], s7 offen offset:2048 sc1
    v_mfma_f32_16x16x32_bf16 a[36:39], v[76:79], a[156:159], a[36:39]
    ds_read_b64_tr_b16 v[88:89], v33 offset:49160
    v_mul_f32 v44, s4, v172
    v_mul_f32 v45, s4, v173
    v_mfma_f32_16x16x32_bf16 a[36:39], v[72:75], a[152:155], a[36:39]
    ds_read_b64_tr_b16 v[90:91], v33 offset:50184
    v_mul_f32 v46, s4, v174
    v_mul_f32 v47, s4, v175
    v_mfma_f32_16x16x32_bf16 a[36:39], v[68:71], a[148:151], a[36:39]
    ds_read_b64_tr_b16 v[92:93], v33 offset:57352
    v_mul_f32 v48, s4, v188
    v_mul_f32 v49, s4, v189
    v_mfma_f32_16x16x32_bf16 a[36:39], v[64:67], a[144:147], a[36:39]
    ds_read_b64_tr_b16 v[94:95], v33 offset:58376
    v_mul_f32 v50, s4, v190
    v_mul_f32 v51, s4, v191
    v_mfma_f32_16x16x32_bf16 a[40:43], v[64:67], a[160:163], a[40:43]
    s_add_u32 m0, s50, 69632
    v_exp_f32 v44, v44
    v_mfma_f32_16x16x32_bf16 a[40:43], v[68:71], a[164:167], a[40:43]
    buffer_load_dwordx4 v2, s[24:27], s36 offen offset:0 lds
    v_mul_f32 v172, v172, v236
    v_mfma_f32_16x16x32_bf16 a[40:43], v[72:75], a[168:171], a[40:43]
    v_exp_f32 v45, v45
    v_mul_f32 v173, v173, v237
    v_mfma_f32_16x16x32_bf16 a[40:43], v[76:79], a[172:175], a[40:43]
    v_exp_f32 v46, v46
    v_mul_f32 v174, v174, v238
    v_mfma_f32_16x16x32_bf16 a[44:47], v[76:79], a[188:191], a[44:47]
    v_exp_f32 v47, v47
    v_mul_f32 v175, v175, v239
    v_mfma_f32_16x16x32_bf16 a[44:47], v[72:75], a[184:187], a[44:47]
    v_exp_f32 v48, v48
    v_mul_f32 v188, v188, v252
    v_mfma_f32_16x16x32_bf16 a[44:47], v[68:71], a[180:183], a[44:47]
    buffer_load_dwordx4 v3, s[24:27], s36 offen offset:1024 lds
    v_exp_f32 v49, v49
    v_mfma_f32_16x16x32_bf16 a[44:47], v[64:67], a[176:179], a[44:47]
    s_waitcnt lgkmcnt(0)
    v_mfma_f32_16x16x32_bf16 a[48:51], v[80:83], a[128:131], a[48:51]
    ds_read_b64_tr_b16 v[64:65], v34 offset:32768
    v_mul_f32 v189, v189, v253
    v_mfma_f32_16x16x32_bf16 a[48:51], v[84:87], a[132:135], a[48:51]
    ds_read_b64_tr_b16 v[66:67], v34 offset:33792
    v_exp_f32 v50, v50
    v_mfma_f32_16x16x32_bf16 a[48:51], v[88:91], a[136:139], a[48:51]
    ds_read_b64_tr_b16 v[68:69], v34 offset:40960
    v_mul_f32 v190, v190, v254
    v_mfma_f32_16x16x32_bf16 a[48:51], v[92:95], a[140:143], a[48:51]
    ds_read_b64_tr_b16 v[70:71], v34 offset:41984
    v_exp_f32 v51, v51
    v_mfma_f32_16x16x32_bf16 a[52:55], v[92:95], a[156:159], a[52:55]
    ds_read_b64_tr_b16 v[72:73], v34 offset:49152
    v_mul_f32 v191, v191, v255
    v_fma_f32 v44, v44, s5, s5
    v_mfma_f32_16x16x32_bf16 a[52:55], v[88:91], a[152:155], a[52:55]
    ds_read_b64_tr_b16 v[74:75], v34 offset:50176
    v_fma_f32 v45, v45, s5, s5
    v_fma_f32 v46, v46, s5, s5
    v_mfma_f32_16x16x32_bf16 a[52:55], v[84:87], a[148:151], a[52:55]
    ds_read_b64_tr_b16 v[76:77], v34 offset:57344
    v_fma_f32 v47, v47, s5, s5
    v_fma_f32 v48, v48, s5, s5
    v_mfma_f32_16x16x32_bf16 a[52:55], v[80:83], a[144:147], a[52:55]
    ds_read_b64_tr_b16 v[78:79], v34 offset:58368
    v_fma_f32 v49, v49, s5, s5
    v_fma_f32 v50, v50, s5, s5
    v_mfma_f32_16x16x32_bf16 a[56:59], v[80:83], a[160:163], a[56:59]
    v_fma_f32 v51, v51, s5, s5
    v_rcp_f32 v44, v44
    v_mfma_f32_16x16x32_bf16 a[56:59], v[84:87], a[164:167], a[56:59]
    buffer_load_dwordx4 v4, s[24:27], s36 offen offset:2048 lds
    v_rcp_f32 v45, v45
    v_mfma_f32_16x16x32_bf16 a[56:59], v[88:91], a[168:171], a[56:59]
    v_rcp_f32 v46, v46
    v_mfma_f32_16x16x32_bf16 a[56:59], v[92:95], a[172:175], a[56:59]
    v_rcp_f32 v47, v47
    v_mfma_f32_16x16x32_bf16 a[60:63], v[92:95], a[188:191], a[60:63]
    v_rcp_f32 v48, v48
    v_mfma_f32_16x16x32_bf16 a[60:63], v[88:91], a[184:187], a[60:63]
    v_rcp_f32 v49, v49
    v_mfma_f32_16x16x32_bf16 a[60:63], v[84:87], a[180:183], a[60:63]
    buffer_load_dwordx4 v5, s[24:27], s36 offen offset:3072 lds
    s_add_u32 s36, s36, 28672
    v_mfma_f32_16x16x32_bf16 a[60:63], v[80:83], a[176:179], a[60:63]
    s_waitcnt lgkmcnt(0)
    v_mfma_f32_16x16x32_bf16 a[64:67], v[64:67], a[128:131], a[64:67]
    ds_read_b64_tr_b16 v[80:81], v34 offset:32776
    v_rcp_f32 v50, v50
    v_mfma_f32_16x16x32_bf16 a[64:67], v[68:71], a[132:135], a[64:67]
    ds_read_b64_tr_b16 v[82:83], v34 offset:33800
    v_rcp_f32 v51, v51
    v_mfma_f32_16x16x32_bf16 a[64:67], v[72:75], a[136:139], a[64:67]
    ds_read_b64_tr_b16 v[84:85], v34 offset:40968
    v_mul_f32 v44, v44, v172
    v_mul_f32 v45, v45, v173
    v_mfma_f32_16x16x32_bf16 a[64:67], v[76:79], a[140:143], a[64:67]
    ds_read_b64_tr_b16 v[86:87], v34 offset:41992
    v_mul_f32 v46, v46, v174
    v_mul_f32 v47, v47, v175
    v_mfma_f32_16x16x32_bf16 a[68:71], v[76:79], a[156:159], a[68:71]
    ds_read_b64_tr_b16 v[88:89], v34 offset:49160
    v_mul_f32 v48, v48, v188
    v_mul_f32 v49, v49, v189
    v_mfma_f32_16x16x32_bf16 a[68:71], v[72:75], a[152:155], a[68:71]
    ds_read_b64_tr_b16 v[90:91], v34 offset:50184
    v_mul_f32 v50, v50, v190
    v_mul_f32 v51, v51, v191
    v_mfma_f32_16x16x32_bf16 a[68:71], v[68:71], a[148:151], a[68:71]
    ds_read_b64_tr_b16 v[92:93], v34 offset:57352
    v_cvt_pk_bf16_f32 v236, v44, v45
    v_cvt_pk_bf16_f32 v237, v46, v47
    v_mfma_f32_16x16x32_bf16 a[68:71], v[64:67], a[144:147], a[68:71]
    ds_read_b64_tr_b16 v[94:95], v34 offset:58376
    v_cvt_pk_bf16_f32 v238, v48, v49
    v_cvt_pk_bf16_f32 v239, v50, v51
    v_mfma_f32_16x16x32_bf16 a[72:75], v[64:67], a[160:163], a[72:75]
    buffer_store_dwordx4 v[236:239], v1, s[12:15], s7 offen offset:3072 sc1
    v_accvgpr_read_b32 v96, a0
    v_accvgpr_read_b32 v97, a1
    v_mfma_f32_16x16x32_bf16 a[72:75], v[68:71], a[164:167], a[72:75]
    v_accvgpr_read_b32 v98, a2
    v_accvgpr_read_b32 v99, a3
    v_accvgpr_read_b32 v100, a16
    v_mfma_f32_16x16x32_bf16 a[72:75], v[72:75], a[168:171], a[72:75]
    v_accvgpr_read_b32 v101, a17
    v_accvgpr_read_b32 v102, a18
    v_accvgpr_read_b32 v103, a19
    v_mfma_f32_16x16x32_bf16 a[72:75], v[76:79], a[172:175], a[72:75]
    v_cvt_pk_bf16_f32 v96, v96, v97
    v_cvt_pk_bf16_f32 v97, v98, v99
    v_cvt_pk_bf16_f32 v98, v100, v101
    v_mfma_f32_16x16x32_bf16 a[76:79], v[76:79], a[188:191], a[76:79]
    v_cvt_pk_bf16_f32 v99, v102, v103
    v_accvgpr_write_b32 a192, v96
    v_accvgpr_write_b32 a193, v97
    v_mfma_f32_16x16x32_bf16 a[76:79], v[72:75], a[184:187], a[76:79]
    v_accvgpr_write_b32 a194, v98
    v_accvgpr_write_b32 a195, v99
    v_accvgpr_read_b32 v104, a4
    v_mfma_f32_16x16x32_bf16 a[76:79], v[68:71], a[180:183], a[76:79]
    v_accvgpr_read_b32 v105, a5
    v_accvgpr_read_b32 v106, a6
    v_accvgpr_read_b32 v107, a7
    v_mfma_f32_16x16x32_bf16 a[76:79], v[64:67], a[176:179], a[76:79]
    s_waitcnt lgkmcnt(0)
    v_mfma_f32_16x16x32_bf16 a[80:83], v[80:83], a[128:131], a[80:83]
    ds_read_b64_tr_b16 v[64:65], v35 offset:32768
    v_accvgpr_read_b32 v108, a20
    v_accvgpr_read_b32 v109, a21
    v_mfma_f32_16x16x32_bf16 a[80:83], v[84:87], a[132:135], a[80:83]
    ds_read_b64_tr_b16 v[66:67], v35 offset:33792
    v_accvgpr_read_b32 v110, a22
    v_accvgpr_read_b32 v111, a23
    v_mfma_f32_16x16x32_bf16 a[80:83], v[88:91], a[136:139], a[80:83]
    ds_read_b64_tr_b16 v[68:69], v35 offset:40960
    v_cvt_pk_bf16_f32 v104, v104, v105
    v_cvt_pk_bf16_f32 v105, v106, v107
    v_mfma_f32_16x16x32_bf16 a[80:83], v[92:95], a[140:143], a[80:83]
    ds_read_b64_tr_b16 v[70:71], v35 offset:41984
    v_cvt_pk_bf16_f32 v106, v108, v109
    v_cvt_pk_bf16_f32 v107, v110, v111
    v_mfma_f32_16x16x32_bf16 a[84:87], v[92:95], a[156:159], a[84:87]
    ds_read_b64_tr_b16 v[72:73], v35 offset:49152
    v_accvgpr_write_b32 a208, v104
    v_accvgpr_write_b32 a209, v105
    v_mfma_f32_16x16x32_bf16 a[84:87], v[88:91], a[152:155], a[84:87]
    ds_read_b64_tr_b16 v[74:75], v35 offset:50176
    v_accvgpr_write_b32 a210, v106
    v_accvgpr_write_b32 a211, v107
    v_mfma_f32_16x16x32_bf16 a[84:87], v[84:87], a[148:151], a[84:87]
    ds_read_b64_tr_b16 v[76:77], v35 offset:57344
    v_accvgpr_read_b32 v96, a8
    v_accvgpr_read_b32 v97, a9
    v_mfma_f32_16x16x32_bf16 a[84:87], v[80:83], a[144:147], a[84:87]
    ds_read_b64_tr_b16 v[78:79], v35 offset:58368
    v_accvgpr_read_b32 v98, a10
    v_accvgpr_read_b32 v99, a11
    v_mfma_f32_16x16x32_bf16 a[88:91], v[80:83], a[160:163], a[88:91]
    v_accvgpr_read_b32 v100, a24
    v_accvgpr_read_b32 v101, a25
    v_accvgpr_read_b32 v102, a26
    v_mfma_f32_16x16x32_bf16 a[88:91], v[84:87], a[164:167], a[88:91]
    v_accvgpr_read_b32 v103, a27
    v_cvt_pk_bf16_f32 v96, v96, v97
    v_cvt_pk_bf16_f32 v97, v98, v99
    v_mfma_f32_16x16x32_bf16 a[88:91], v[88:91], a[168:171], a[88:91]
    v_cvt_pk_bf16_f32 v98, v100, v101
    v_cvt_pk_bf16_f32 v99, v102, v103
    v_accvgpr_write_b32 a224, v96
    v_mfma_f32_16x16x32_bf16 a[88:91], v[92:95], a[172:175], a[88:91]
    v_accvgpr_write_b32 a225, v97
    v_accvgpr_write_b32 a226, v98
    v_accvgpr_write_b32 a227, v99
    v_mfma_f32_16x16x32_bf16 a[92:95], v[92:95], a[188:191], a[92:95]
    v_accvgpr_read_b32 v104, a12
    v_accvgpr_read_b32 v105, a13
    v_accvgpr_read_b32 v106, a14
    v_mfma_f32_16x16x32_bf16 a[92:95], v[88:91], a[184:187], a[92:95]
    v_accvgpr_read_b32 v107, a15
    v_accvgpr_read_b32 v108, a28
    v_accvgpr_read_b32 v109, a29
    v_mfma_f32_16x16x32_bf16 a[92:95], v[84:87], a[180:183], a[92:95]
    v_accvgpr_read_b32 v110, a30
    v_accvgpr_read_b32 v111, a31
    v_cvt_pk_bf16_f32 v104, v104, v105
    v_mfma_f32_16x16x32_bf16 a[92:95], v[80:83], a[176:179], a[92:95]
    s_waitcnt lgkmcnt(0)
    v_mfma_f32_16x16x32_bf16 a[96:99], v[64:67], a[128:131], a[96:99]
    ds_read_b64_tr_b16 v[80:81], v35 offset:32776
    v_cvt_pk_bf16_f32 v105, v106, v107
    v_cvt_pk_bf16_f32 v106, v108, v109
    v_mfma_f32_16x16x32_bf16 a[96:99], v[68:71], a[132:135], a[96:99]
    ds_read_b64_tr_b16 v[82:83], v35 offset:33800
    v_cvt_pk_bf16_f32 v107, v110, v111
    v_accvgpr_write_b32 a240, v104
    v_mfma_f32_16x16x32_bf16 a[96:99], v[72:75], a[136:139], a[96:99]
    ds_read_b64_tr_b16 v[84:85], v35 offset:40968
    v_accvgpr_write_b32 a241, v105
    v_accvgpr_write_b32 a242, v106
    v_mfma_f32_16x16x32_bf16 a[96:99], v[76:79], a[140:143], a[96:99]
    ds_read_b64_tr_b16 v[86:87], v35 offset:41992
    v_accvgpr_write_b32 a243, v107
    v_accvgpr_read_b32 v96, a32
    v_mfma_f32_16x16x32_bf16 a[100:103], v[76:79], a[156:159], a[100:103]
    ds_read_b64_tr_b16 v[88:89], v35 offset:49160
    v_accvgpr_read_b32 v97, a33
    v_accvgpr_read_b32 v98, a34
    v_mfma_f32_16x16x32_bf16 a[100:103], v[72:75], a[152:155], a[100:103]
    ds_read_b64_tr_b16 v[90:91], v35 offset:50184
    v_accvgpr_read_b32 v99, a35
    v_accvgpr_read_b32 v100, a48
    v_mfma_f32_16x16x32_bf16 a[100:103], v[68:71], a[148:151], a[100:103]
    ds_read_b64_tr_b16 v[92:93], v35 offset:57352
    v_accvgpr_read_b32 v101, a49
    v_accvgpr_read_b32 v102, a50
    v_mfma_f32_16x16x32_bf16 a[100:103], v[64:67], a[144:147], a[100:103]
    ds_read_b64_tr_b16 v[94:95], v35 offset:58376
    v_accvgpr_read_b32 v103, a51
    v_cvt_pk_bf16_f32 v96, v96, v97
    v_mfma_f32_16x16x32_bf16 a[104:107], v[64:67], a[160:163], a[104:107]
    v_cvt_pk_bf16_f32 v97, v98, v99
    v_cvt_pk_bf16_f32 v98, v100, v101
    v_cvt_pk_bf16_f32 v99, v102, v103
    v_mfma_f32_16x16x32_bf16 a[104:107], v[68:71], a[164:167], a[104:107]
    v_accvgpr_write_b32 a196, v96
    v_accvgpr_write_b32 a197, v97
    v_accvgpr_write_b32 a198, v98
    v_mfma_f32_16x16x32_bf16 a[104:107], v[72:75], a[168:171], a[104:107]
    v_accvgpr_write_b32 a199, v99
    v_accvgpr_read_b32 v104, a36
    v_accvgpr_read_b32 v105, a37
    v_mfma_f32_16x16x32_bf16 a[104:107], v[76:79], a[172:175], a[104:107]
    v_accvgpr_read_b32 v106, a38
    v_accvgpr_read_b32 v107, a39
    v_accvgpr_read_b32 v108, a52
    v_mfma_f32_16x16x32_bf16 a[108:111], v[76:79], a[188:191], a[108:111]
    v_accvgpr_read_b32 v109, a53
    v_accvgpr_read_b32 v110, a54
    v_accvgpr_read_b32 v111, a55
    v_mfma_f32_16x16x32_bf16 a[108:111], v[72:75], a[184:187], a[108:111]
    v_cvt_pk_bf16_f32 v104, v104, v105
    v_cvt_pk_bf16_f32 v105, v106, v107
    v_cvt_pk_bf16_f32 v106, v108, v109
    v_mfma_f32_16x16x32_bf16 a[108:111], v[68:71], a[180:183], a[108:111]
    v_cvt_pk_bf16_f32 v107, v110, v111
    v_accvgpr_write_b32 a212, v104
    v_accvgpr_write_b32 a213, v105
    v_mfma_f32_16x16x32_bf16 a[108:111], v[64:67], a[176:179], a[108:111]
    s_waitcnt vmcnt(16) lgkmcnt(0)
    s_barrier
    v_mfma_f32_16x16x32_bf16 a[112:115], v[80:83], a[128:131], a[112:115]
    s_add_u32 m0, s50, 98304
    v_accvgpr_write_b32 a214, v106
    v_accvgpr_write_b32 a215, v107
    v_mfma_f32_16x16x32_bf16 a[112:115], v[84:87], a[132:135], a[112:115]
    buffer_load_dwordx4 v6, s[28:31], s37 offen offset:0 lds
    v_accvgpr_read_b32 v96, a40
    v_accvgpr_read_b32 v97, a41
    v_mfma_f32_16x16x32_bf16 a[112:115], v[88:91], a[136:139], a[112:115]
    v_accvgpr_read_b32 v98, a42
    v_accvgpr_read_b32 v99, a43
    v_accvgpr_read_b32 v100, a56
    v_mfma_f32_16x16x32_bf16 a[112:115], v[92:95], a[140:143], a[112:115]
    buffer_load_dwordx4 v7, s[28:31], s37 offen offset:1024 lds
    v_accvgpr_read_b32 v101, a57
    v_accvgpr_read_b32 v102, a58
    v_mfma_f32_16x16x32_bf16 a[116:119], v[92:95], a[156:159], a[116:119]
    v_accvgpr_read_b32 v103, a59
    v_cvt_pk_bf16_f32 v96, v96, v97
    v_cvt_pk_bf16_f32 v97, v98, v99
    v_mfma_f32_16x16x32_bf16 a[116:119], v[88:91], a[152:155], a[116:119]
    buffer_load_dwordx4 v6, s[28:31], s37 offen offset:2048 lds
    v_cvt_pk_bf16_f32 v98, v100, v101
    v_cvt_pk_bf16_f32 v99, v102, v103
    v_mfma_f32_16x16x32_bf16 a[116:119], v[84:87], a[148:151], a[116:119]
    v_accvgpr_write_b32 a228, v96
    v_accvgpr_write_b32 a229, v97
    v_accvgpr_write_b32 a230, v98
    v_mfma_f32_16x16x32_bf16 a[116:119], v[80:83], a[144:147], a[116:119]
    buffer_load_dwordx4 v7, s[28:31], s37 offen offset:3072 lds
    s_add_u32 s37, s37, 4096
    v_accvgpr_write_b32 a231, v99
    v_mfma_f32_16x16x32_bf16 a[120:123], v[80:83], a[160:163], a[120:123]
    ds_read_b128 a[128:131], v8 offset:0
    v_accvgpr_read_b32 v104, a44
    v_accvgpr_read_b32 v105, a45
    v_mfma_f32_16x16x32_bf16 a[120:123], v[84:87], a[164:167], a[120:123]
    ds_read_b128 a[132:135], v9 offset:0
    v_accvgpr_read_b32 v106, a46
    v_accvgpr_read_b32 v107, a47
    v_mfma_f32_16x16x32_bf16 a[120:123], v[88:91], a[168:171], a[120:123]
    ds_read_b128 a[136:139], v10 offset:0
    v_accvgpr_read_b32 v108, a60
    v_accvgpr_read_b32 v109, a61
    v_mfma_f32_16x16x32_bf16 a[120:123], v[92:95], a[172:175], a[120:123]
    ds_read_b128 a[140:143], v11 offset:0
    v_accvgpr_read_b32 v110, a62
    v_accvgpr_read_b32 v111, a63
    v_mfma_f32_16x16x32_bf16 a[124:127], v[92:95], a[188:191], a[124:127]
    ds_read_b128 a[144:147], v8 offset:4096
    v_cvt_pk_bf16_f32 v104, v104, v105
    v_cvt_pk_bf16_f32 v105, v106, v107
    v_mfma_f32_16x16x32_bf16 a[124:127], v[88:91], a[184:187], a[124:127]
    ds_read_b128 a[148:151], v9 offset:4096
    v_cvt_pk_bf16_f32 v106, v108, v109
    v_cvt_pk_bf16_f32 v107, v110, v111
    v_mfma_f32_16x16x32_bf16 a[124:127], v[84:87], a[180:183], a[124:127]
    ds_read_b128 a[152:155], v10 offset:4096
    v_accvgpr_write_b32 a244, v104
    v_accvgpr_write_b32 a245, v105
    v_mfma_f32_16x16x32_bf16 a[124:127], v[80:83], a[176:179], a[124:127]
    ds_read_b128 a[156:159], v11 offset:4096
    s_waitcnt lgkmcnt(0)
    v_accvgpr_write_b32 a246, v106
    v_accvgpr_write_b32 a247, v107
    v_accvgpr_read_b32 v96, a64
    v_accvgpr_read_b32 v97, a65
    v_accvgpr_read_b32 v98, a66
    v_accvgpr_read_b32 v99, a67
    v_accvgpr_read_b32 v100, a80
    v_accvgpr_read_b32 v101, a81
    v_accvgpr_read_b32 v102, a82
    v_accvgpr_read_b32 v103, a83
    v_cvt_pk_bf16_f32 v96, v96, v97
    v_cvt_pk_bf16_f32 v97, v98, v99
    v_cvt_pk_bf16_f32 v98, v100, v101
    v_cvt_pk_bf16_f32 v99, v102, v103
    v_accvgpr_write_b32 a200, v96
    v_accvgpr_write_b32 a201, v97
    v_accvgpr_write_b32 a202, v98
    v_accvgpr_write_b32 a203, v99
    v_accvgpr_read_b32 v104, a68
    v_accvgpr_read_b32 v105, a69
    v_accvgpr_read_b32 v106, a70
    v_accvgpr_read_b32 v107, a71
    v_accvgpr_read_b32 v108, a84
    v_accvgpr_read_b32 v109, a85
    v_accvgpr_read_b32 v110, a86
    v_accvgpr_read_b32 v111, a87
    v_cvt_pk_bf16_f32 v104, v104, v105
    v_cvt_pk_bf16_f32 v105, v106, v107
    v_cvt_pk_bf16_f32 v106, v108, v109
    v_cvt_pk_bf16_f32 v107, v110, v111
    v_accvgpr_write_b32 a216, v104
    v_accvgpr_write_b32 a217, v105
    v_accvgpr_write_b32 a218, v106
    v_accvgpr_write_b32 a219, v107
    v_accvgpr_read_b32 v96, a72
    v_accvgpr_read_b32 v97, a73
    v_accvgpr_read_b32 v98, a74
    v_accvgpr_read_b32 v99, a75
    v_accvgpr_read_b32 v100, a88
    v_accvgpr_read_b32 v101, a89
    v_accvgpr_read_b32 v102, a90
    v_accvgpr_read_b32 v103, a91
    v_cvt_pk_bf16_f32 v96, v96, v97
    v_cvt_pk_bf16_f32 v97, v98, v99
    v_cvt_pk_bf16_f32 v98, v100, v101
    v_cvt_pk_bf16_f32 v99, v102, v103
    v_accvgpr_write_b32 a232, v96
    v_accvgpr_write_b32 a233, v97
    v_accvgpr_write_b32 a234, v98
    v_accvgpr_write_b32 a235, v99
    v_accvgpr_read_b32 v104, a76
    v_accvgpr_read_b32 v105, a77
    v_accvgpr_read_b32 v106, a78
    v_accvgpr_read_b32 v107, a79
    v_accvgpr_read_b32 v108, a92
    v_accvgpr_read_b32 v109, a93
    v_accvgpr_read_b32 v110, a94
    v_accvgpr_read_b32 v111, a95
    v_cvt_pk_bf16_f32 v104, v104, v105
    v_cvt_pk_bf16_f32 v105, v106, v107
    v_cvt_pk_bf16_f32 v106, v108, v109
    v_cvt_pk_bf16_f32 v107, v110, v111
    v_accvgpr_write_b32 a248, v104
    v_accvgpr_write_b32 a249, v105
    v_accvgpr_write_b32 a250, v106
    v_accvgpr_write_b32 a251, v107
    s_nop 1
    v_mfma_f32_16x16x32_bf16 v[96:99], a[128:131], a[192:195], 0
    v_accvgpr_read_b32 v36, a96
    v_accvgpr_read_b32 v37, a97
    v_accvgpr_read_b32 v38, a98
    v_accvgpr_read_b32 v39, a99
    v_accvgpr_read_b32 v40, a112
    v_accvgpr_read_b32 v41, a113
    v_mfma_f32_16x16x32_bf16 v[96:99], a[132:135], a[196:199], v[96:99]
    s_add_u32 m0, s50, 102400
    v_accvgpr_read_b32 v42, a114
    v_accvgpr_read_b32 v43, a115
    v_cvt_pk_bf16_f32 v36, v36, v37
    v_cvt_pk_bf16_f32 v37, v38, v39
    v_cvt_pk_bf16_f32 v38, v40, v41
    v_mfma_f32_16x16x32_bf16 v[96:99], a[136:139], a[200:203], v[96:99]
    buffer_load_dwordx4 v6, s[28:31], s37 offen offset:0 lds
    v_cvt_pk_bf16_f32 v39, v42, v43
    v_accvgpr_write_b32 a204, v36
    v_accvgpr_write_b32 a205, v37
    v_accvgpr_write_b32 a206, v38
    v_accvgpr_write_b32 a207, v39
    v_mfma_f32_16x16x32_bf16 v[100:103], a[128:131], a[208:211], 0
    v_accvgpr_read_b32 v44, a100
    v_accvgpr_read_b32 v45, a101
    v_accvgpr_read_b32 v46, a102
    v_accvgpr_read_b32 v47, a103
    v_accvgpr_read_b32 v48, a116
    v_accvgpr_read_b32 v49, a117
    v_mfma_f32_16x16x32_bf16 v[100:103], a[132:135], a[212:215], v[100:103]
    v_accvgpr_read_b32 v50, a118
    v_accvgpr_read_b32 v51, a119
    v_cvt_pk_bf16_f32 v44, v44, v45
    v_cvt_pk_bf16_f32 v45, v46, v47
    v_cvt_pk_bf16_f32 v46, v48, v49
    v_cvt_pk_bf16_f32 v47, v50, v51
    v_mfma_f32_16x16x32_bf16 v[100:103], a[136:139], a[216:219], v[100:103]
    buffer_load_dwordx4 v7, s[28:31], s37 offen offset:1024 lds
    v_accvgpr_write_b32 a220, v44
    v_accvgpr_write_b32 a221, v45
    v_accvgpr_write_b32 a222, v46
    v_accvgpr_write_b32 a223, v47
    v_accvgpr_read_b32 v36, a104
    v_mfma_f32_16x16x32_bf16 v[104:107], a[128:131], a[224:227], 0
    v_accvgpr_read_b32 v37, a105
    v_accvgpr_read_b32 v38, a106
    v_accvgpr_read_b32 v39, a107
    v_accvgpr_read_b32 v40, a120
    v_accvgpr_read_b32 v41, a121
    v_accvgpr_read_b32 v42, a122
    v_mfma_f32_16x16x32_bf16 v[104:107], a[132:135], a[228:231], v[104:107]
    v_accvgpr_read_b32 v43, a123
    v_cvt_pk_bf16_f32 v36, v36, v37
    v_cvt_pk_bf16_f32 v37, v38, v39
    v_cvt_pk_bf16_f32 v38, v40, v41
    v_cvt_pk_bf16_f32 v39, v42, v43
    v_accvgpr_write_b32 a236, v36
    v_mfma_f32_16x16x32_bf16 v[104:107], a[136:139], a[232:235], v[104:107]
    buffer_load_dwordx4 v6, s[28:31], s37 offen offset:2048 lds
    v_accvgpr_write_b32 a237, v37
    v_accvgpr_write_b32 a238, v38
    v_accvgpr_write_b32 a239, v39
    v_accvgpr_read_b32 v44, a108
    v_accvgpr_read_b32 v45, a109
    v_mfma_f32_16x16x32_bf16 v[108:111], a[128:131], a[240:243], 0
    v_accvgpr_read_b32 v46, a110
    v_accvgpr_read_b32 v47, a111
    v_accvgpr_read_b32 v48, a124
    v_accvgpr_read_b32 v49, a125
    v_accvgpr_read_b32 v50, a126
    v_accvgpr_read_b32 v51, a127
    v_mfma_f32_16x16x32_bf16 v[108:111], a[132:135], a[244:247], v[108:111]
    v_cvt_pk_bf16_f32 v44, v44, v45
    v_cvt_pk_bf16_f32 v45, v46, v47
    v_cvt_pk_bf16_f32 v46, v48, v49
    v_cvt_pk_bf16_f32 v47, v50, v51
    v_accvgpr_write_b32 a252, v44
    v_accvgpr_write_b32 a253, v45
    v_mfma_f32_16x16x32_bf16 v[108:111], a[136:139], a[248:251], v[108:111]
    buffer_load_dwordx4 v7, s[28:31], s37 offen offset:3072 lds
    s_add_u32 s37, s37, 28672
    v_accvgpr_write_b32 a254, v46
    v_accvgpr_write_b32 a255, v47
    v_mfma_f32_16x16x32_bf16 v[96:99], a[140:143], a[204:207], v[96:99]
    v_mov_b32 v64, 0
    v_mov_b32 v65, 0
    v_mfma_f32_16x16x32_bf16 v[100:103], a[140:143], a[220:223], v[100:103]
    v_mov_b32 v66, 0
    v_mov_b32 v67, 0
    v_mfma_f32_16x16x32_bf16 v[104:107], a[140:143], a[236:239], v[104:107]
    v_mov_b32 v68, 0
    v_mov_b32 v69, 0
    v_mfma_f32_16x16x32_bf16 v[108:111], a[140:143], a[252:255], v[108:111]
    v_mov_b32 v70, 0
    v_mov_b32 v71, 0
    v_mov_b32 v72, 0
    v_mov_b32 v73, 0
    v_mov_b32 v74, 0
    v_mov_b32 v75, 0
    v_mov_b32 v76, 0
    v_mov_b32 v77, 0
    v_mov_b32 v78, 0
    v_mov_b32 v79, 0
    s_mov_b32 s40, 7
    s_mov_b32 s49, 131072
    s_mov_b32 s75, s74
    s_and_b32 s76, s32, 1
    s_lshl_b32 s76, s76, 11
    v_max3_f32 v36, v96, v97, v98
    v_max_f32 v36, v36, v99
    v_max3_f32 v37, v100, v101, v102
    v_max_f32 v37, v37, v103
    v_max3_f32 v38, v104, v105, v106
    v_max_f32 v38, v38, v107
    v_max3_f32 v39, v108, v109, v110
    v_max_f32 v39, v39, v111
L_setm:
    v_mov_b32 v40, v36
    v_mov_b32 v41, v37
    v_mov_b32 v42, v38
    v_mov_b32 v43, v39
    v_permlane32_swap_b32 v36, v40
    v_permlane32_swap_b32 v37, v41
    v_permlane32_swap_b32 v38, v42
    v_permlane32_swap_b32 v39, v43
    v_max_f32 v36, v36, v40
    v_max_f32 v37, v37, v41
    v_max_f32 v38, v38, v42
    v_max_f32 v39, v39, v43
    v_mov_b32 v40, v36
    v_mov_b32 v41, v37
    v_mov_b32 v42, v38
    v_mov_b32 v43, v39
    v_permlane16_swap_b32 v36, v40
    v_permlane16_swap_b32 v37, v41
    v_permlane16_swap_b32 v38, v42
    v_permlane16_swap_b32 v39, v43
    v_max_f32 v36, v36, v40
    v_max_f32 v37, v37, v41
    v_max_f32 v38, v38, v42
    v_max_f32 v39, v39, v43
    v_sub_f32 v96, v96, v36
    v_sub_f32 v80, 0, v36
    v_sub_f32 v97, v97, v36
    v_sub_f32 v81, 0, v36
    v_sub_f32 v98, v98, v36
    v_sub_f32 v82, 0, v36
    v_sub_f32 v99, v99, v36
    v_sub_f32 v83, 0, v36
    v_sub_f32 v100, v100, v37
    v_sub_f32 v84, 0, v37
    v_sub_f32 v101, v101, v37
    v_sub_f32 v85, 0, v37
    v_sub_f32 v102, v102, v37
    v_sub_f32 v86, 0, v37
    v_sub_f32 v103, v103, v37
    v_sub_f32 v87, 0, v37
    v_sub_f32 v104, v104, v38
    v_sub_f32 v88, 0, v38
    v_sub_f32 v105, v105, v38
    v_sub_f32 v89, 0, v38
    v_sub_f32 v106, v106, v38
    v_sub_f32 v90, 0, v38
    v_sub_f32 v107, v107, v38
    v_sub_f32 v91, 0, v38
    v_sub_f32 v108, v108, v39
    v_sub_f32 v92, 0, v39
    v_sub_f32 v109, v109, v39
    v_sub_f32 v93, 0, v39
    v_sub_f32 v110, v110, v39
    v_sub_f32 v94, 0, v39
    v_sub_f32 v111, v111, v39
    v_sub_f32 v95, 0, v39
    v_mfma_f32_32x32x16_bf16 a[0:15], v[64:67], v[64:67], 0
    v_exp_f32 v96, v96
    v_exp_f32 v97, v97
    v_exp_f32 v98, v98
    v_exp_f32 v99, v99
    v_exp_f32 v100, v100
    v_exp_f32 v101, v101
    v_exp_f32 v102, v102
    v_exp_f32 v103, v103
    v_cvt_pk_bf16_f32 v128, v96, v97
    v_cvt_pk_bf16_f32 v129, v98, v99
    v_cvt_pk_bf16_f32 v144, v100, v101
    v_cvt_pk_bf16_f32 v145, v102, v103
    s_waitcnt lgkmcnt(0)
    v_mfma_f32_16x16x32_bf16 v[96:99], a[144:147], a[192:195], v[80:83]
    ds_read_b128 a[128:131], v8 offset:8192
    v_exp_f32 v104, v104
    v_mfma_f32_16x16x32_bf16 v[96:99], a[148:151], a[196:199], v[96:99]
    ds_read_b128 a[132:135], v9 offset:8192
    v_exp_f32 v105, v105
    v_mfma_f32_16x16x32_bf16 v[96:99], a[152:155], a[200:203], v[96:99]
    ds_read_b128 a[136:139], v10 offset:8192
    v_exp_f32 v106, v106
    v_cvt_pk_bf16_f32 v160, v104, v105
    v_mfma_f32_16x16x32_bf16 v[96:99], a[156:159], a[204:207], v[96:99]
    ds_read_b128 a[140:143], v11 offset:8192
    v_exp_f32 v107, v107
    v_mfma_f32_16x16x32_bf16 v[100:103], a[156:159], a[220:223], v[84:87]
    v_cvt_pk_bf16_f32 v161, v106, v107
    v_exp_f32 v108, v108
    v_mfma_f32_16x16x32_bf16 v[100:103], a[152:155], a[216:219], v[100:103]
    v_exp_f32 v109, v109
    v_mfma_f32_16x16x32_bf16 v[100:103], a[148:151], a[212:215], v[100:103]
    v_exp_f32 v110, v110
    v_cvt_pk_bf16_f32 v176, v108, v109
    v_mfma_f32_16x16x32_bf16 v[100:103], a[144:147], a[208:211], v[100:103]
    v_exp_f32 v111, v111
    v_mfma_f32_16x16x32_bf16 v[104:107], a[144:147], a[224:227], v[88:91]
    v_cvt_pk_bf16_f32 v177, v110, v111
    v_exp_f32 v96, v96
    v_mfma_f32_16x16x32_bf16 v[104:107], a[148:151], a[228:231], v[104:107]
    v_exp_f32 v97, v97
    v_mfma_f32_16x16x32_bf16 v[104:107], a[152:155], a[232:235], v[104:107]
    v_exp_f32 v98, v98
    v_cvt_pk_bf16_f32 v130, v96, v97
    v_mfma_f32_16x16x32_bf16 v[104:107], a[156:159], a[236:239], v[104:107]
    v_exp_f32 v99, v99
    v_mfma_f32_16x16x32_bf16 v[108:111], a[156:159], a[252:255], v[92:95]
    v_cvt_pk_bf16_f32 v131, v98, v99
    v_exp_f32 v100, v100
    v_mfma_f32_16x16x32_bf16 v[108:111], a[152:155], a[248:251], v[108:111]
    v_exp_f32 v101, v101
    v_mfma_f32_16x16x32_bf16 v[108:111], a[148:151], a[244:247], v[108:111]
    v_exp_f32 v102, v102
    v_cvt_pk_bf16_f32 v146, v100, v101
    v_mfma_f32_16x16x32_bf16 v[108:111], a[144:147], a[240:243], v[108:111]
    v_exp_f32 v103, v103
    v_mfma_f32_32x32x16_bf16 a[16:31], v[64:67], v[64:67], 0
    v_cvt_pk_bf16_f32 v147, v102, v103
    s_waitcnt lgkmcnt(0)
    v_mfma_f32_16x16x32_bf16 v[96:99], a[128:131], a[192:195], v[80:83]
    ds_read_b128 a[144:147], v8 offset:12288
    v_exp_f32 v104, v104
    v_mfma_f32_16x16x32_bf16 v[96:99], a[132:135], a[196:199], v[96:99]
    ds_read_b128 a[148:151], v9 offset:12288
    v_exp_f32 v105, v105
    v_mfma_f32_16x16x32_bf16 v[96:99], a[136:139], a[200:203], v[96:99]
    ds_read_b128 a[152:155], v10 offset:12288
    v_exp_f32 v106, v106
    v_cvt_pk_bf16_f32 v162, v104, v105
    v_mfma_f32_16x16x32_bf16 v[96:99], a[140:143], a[204:207], v[96:99]
    ds_read_b128 a[156:159], v11 offset:12288
    v_exp_f32 v107, v107
    v_mfma_f32_16x16x32_bf16 v[100:103], a[140:143], a[220:223], v[84:87]
    v_cvt_pk_bf16_f32 v163, v106, v107
    v_exp_f32 v108, v108
    v_mfma_f32_16x16x32_bf16 v[100:103], a[136:139], a[216:219], v[100:103]
    v_exp_f32 v109, v109
    v_mfma_f32_16x16x32_bf16 v[100:103], a[132:135], a[212:215], v[100:103]
    v_exp_f32 v110, v110
    v_cvt_pk_bf16_f32 v178, v108, v109
    v_mfma_f32_16x16x32_bf16 v[100:103], a[128:131], a[208:211], v[100:103]
    v_exp_f32 v111, v111
    v_mfma_f32_16x16x32_bf16 v[104:107], a[128:131], a[224:227], v[88:91]
    v_cvt_pk_bf16_f32 v179, v110, v111
    v_exp_f32 v96, v96
    v_mfma_f32_16x16x32_bf16 v[104:107], a[132:135], a[228:231], v[104:107]
    v_exp_f32 v97, v97
    v_mfma_f32_16x16x32_bf16 v[104:107], a[136:139], a[232:235], v[104:107]
    v_exp_f32 v98, v98
    v_cvt_pk_bf16_f32 v132, v96, v97
    v_mfma_f32_16x16x32_bf16 v[104:107], a[140:143], a[236:239], v[104:107]
    v_exp_f32 v99, v99
    v_mfma_f32_16x16x32_bf16 v[108:111], a[140:143], a[252:255], v[92:95]
    v_cvt_pk_bf16_f32 v133, v98, v99
    v_exp_f32 v100, v100
    v_mfma_f32_16x16x32_bf16 v[108:111], a[136:139], a[248:251], v[108:111]
    v_exp_f32 v101, v101
    v_mfma_f32_16x16x32_bf16 v[108:111], a[132:135], a[244:247], v[108:111]
    v_exp_f32 v102, v102
    v_cvt_pk_bf16_f32 v148, v100, v101
    v_mfma_f32_16x16x32_bf16 v[108:111], a[128:131], a[240:243], v[108:111]
    v_exp_f32 v103, v103
    v_mfma_f32_32x32x16_bf16 a[32:47], v[64:67], v[64:67], 0
    v_cvt_pk_bf16_f32 v149, v102, v103
    s_waitcnt lgkmcnt(0)
    v_mfma_f32_16x16x32_bf16 v[96:99], a[144:147], a[192:195], v[80:83]
    ds_read_b128 a[128:131], v8 offset:16384
    v_exp_f32 v104, v104
    v_mfma_f32_16x16x32_bf16 v[96:99], a[148:151], a[196:199], v[96:99]
    ds_read_b128 a[132:135], v9 offset:16384
    v_exp_f32 v105, v105
    v_mfma_f32_16x16x32_bf16 v[96:99], a[152:155], a[200:203], v[96:99]
    ds_read_b128 a[136:139], v10 offset:16384
    v_exp_f32 v106, v106
    v_cvt_pk_bf16_f32 v164, v104, v105
    v_mfma_f32_16x16x32_bf16 v[96:99], a[156:159], a[204:207], v[96:99]
    ds_read_b128 a[140:143], v11 offset:16384
    v_exp_f32 v107, v107
    v_mfma_f32_16x16x32_bf16 v[100:103], a[156:159], a[220:223], v[84:87]
    v_cvt_pk_bf16_f32 v165, v106, v107
    v_exp_f32 v108, v108
    v_mfma_f32_16x16x32_bf16 v[100:103], a[152:155], a[216:219], v[100:103]
    v_exp_f32 v109, v109
    v_mfma_f32_16x16x32_bf16 v[100:103], a[148:151], a[212:215], v[100:103]
    v_exp_f32 v110, v110
    v_cvt_pk_bf16_f32 v180, v108, v109
    v_mfma_f32_16x16x32_bf16 v[100:103], a[144:147], a[208:211], v[100:103]
    v_exp_f32 v111, v111
    v_mfma_f32_16x16x32_bf16 v[104:107], a[144:147], a[224:227], v[88:91]
    v_cvt_pk_bf16_f32 v181, v110, v111
    v_exp_f32 v96, v96
    v_mfma_f32_16x16x32_bf16 v[104:107], a[148:151], a[228:231], v[104:107]
    v_exp_f32 v97, v97
    v_mfma_f32_16x16x32_bf16 v[104:107], a[152:155], a[232:235], v[104:107]
    v_exp_f32 v98, v98
    v_cvt_pk_bf16_f32 v134, v96, v97
    v_mfma_f32_16x16x32_bf16 v[104:107], a[156:159], a[236:239], v[104:107]
    v_exp_f32 v99, v99
    v_mfma_f32_16x16x32_bf16 v[108:111], a[156:159], a[252:255], v[92:95]
    v_cvt_pk_bf16_f32 v135, v98, v99
    v_exp_f32 v100, v100
    v_mfma_f32_16x16x32_bf16 v[108:111], a[152:155], a[248:251], v[108:111]
    v_exp_f32 v101, v101
    v_mfma_f32_16x16x32_bf16 v[108:111], a[148:151], a[244:247], v[108:111]
    v_exp_f32 v102, v102
    v_cvt_pk_bf16_f32 v150, v100, v101
    v_mfma_f32_16x16x32_bf16 v[108:111], a[144:147], a[240:243], v[108:111]
    v_exp_f32 v103, v103
    v_mfma_f32_32x32x16_bf16 a[48:63], v[64:67], v[64:67], 0
    v_cvt_pk_bf16_f32 v151, v102, v103
    s_waitcnt lgkmcnt(0)
    v_mfma_f32_16x16x32_bf16 v[96:99], a[128:131], a[192:195], v[80:83]
    ds_read_b128 a[144:147], v8 offset:20480
    v_exp_f32 v104, v104
    v_mfma_f32_16x16x32_bf16 v[96:99], a[132:135], a[196:199], v[96:99]
    ds_read_b128 a[148:151], v9 offset:20480
    v_exp_f32 v105, v105
    v_mfma_f32_16x16x32_bf16 v[96:99], a[136:139], a[200:203], v[96:99]
    ds_read_b128 a[152:155], v10 offset:20480
    v_exp_f32 v106, v106
    v_cvt_pk_bf16_f32 v166, v104, v105
    v_mfma_f32_16x16x32_bf16 v[96:99], a[140:143], a[204:207], v[96:99]
    ds_read_b128 a[156:159], v11 offset:20480
    v_exp_f32 v107, v107
    v_mfma_f32_16x16x32_bf16 v[100:103], a[140:143], a[220:223], v[84:87]
    v_cvt_pk_bf16_f32 v167, v106, v107
    v_exp_f32 v108, v108
    v_mfma_f32_16x16x32_bf16 v[100:103], a[136:139], a[216:219], v[100:103]
    v_exp_f32 v109, v109
    v_mfma_f32_16x16x32_bf16 v[100:103], a[132:135], a[212:215], v[100:103]
    v_exp_f32 v110, v110
    v_cvt_pk_bf16_f32 v182, v108, v109
    v_mfma_f32_16x16x32_bf16 v[100:103], a[128:131], a[208:211], v[100:103]
    v_exp_f32 v111, v111
    v_mfma_f32_16x16x32_bf16 v[104:107], a[128:131], a[224:227], v[88:91]
    v_cvt_pk_bf16_f32 v183, v110, v111
    v_exp_f32 v96, v96
    v_mfma_f32_16x16x32_bf16 v[104:107], a[132:135], a[228:231], v[104:107]
    v_exp_f32 v97, v97
    v_mfma_f32_16x16x32_bf16 v[104:107], a[136:139], a[232:235], v[104:107]
    v_exp_f32 v98, v98
    v_cvt_pk_bf16_f32 v136, v96, v97
    v_mfma_f32_16x16x32_bf16 v[104:107], a[140:143], a[236:239], v[104:107]
    v_exp_f32 v99, v99
    v_mfma_f32_16x16x32_bf16 v[108:111], a[140:143], a[252:255], v[92:95]
    v_cvt_pk_bf16_f32 v137, v98, v99
    v_exp_f32 v100, v100
    v_mfma_f32_16x16x32_bf16 v[108:111], a[136:139], a[248:251], v[108:111]
    v_exp_f32 v101, v101
    v_mfma_f32_16x16x32_bf16 v[108:111], a[132:135], a[244:247], v[108:111]
    v_exp_f32 v102, v102
    v_cvt_pk_bf16_f32 v152, v100, v101
    v_mfma_f32_16x16x32_bf16 v[108:111], a[128:131], a[240:243], v[108:111]
    v_exp_f32 v103, v103
    v_mfma_f32_32x32x16_bf16 a[64:79], v[64:67], v[64:67], 0
    v_cvt_pk_bf16_f32 v153, v102, v103
    s_waitcnt lgkmcnt(0)
    v_mfma_f32_16x16x32_bf16 v[96:99], a[144:147], a[192:195], v[80:83]
    ds_read_b128 a[128:131], v8 offset:24576
    v_exp_f32 v104, v104
    v_mfma_f32_16x16x32_bf16 v[96:99], a[148:151], a[196:199], v[96:99]
    ds_read_b128 a[132:135], v9 offset:24576
    v_exp_f32 v105, v105
    v_mfma_f32_16x16x32_bf16 v[96:99], a[152:155], a[200:203], v[96:99]
    ds_read_b128 a[136:139], v10 offset:24576
    v_exp_f32 v106, v106
    v_cvt_pk_bf16_f32 v168, v104, v105
    v_mfma_f32_16x16x32_bf16 v[96:99], a[156:159], a[204:207], v[96:99]
    ds_read_b128 a[140:143], v11 offset:24576
    v_exp_f32 v107, v107
    v_mfma_f32_16x16x32_bf16 v[100:103], a[156:159], a[220:223], v[84:87]
    v_cvt_pk_bf16_f32 v169, v106, v107
    v_exp_f32 v108, v108
    v_mfma_f32_16x16x32_bf16 v[100:103], a[152:155], a[216:219], v[100:103]
    v_exp_f32 v109, v109
    v_mfma_f32_16x16x32_bf16 v[100:103], a[148:151], a[212:215], v[100:103]
    v_exp_f32 v110, v110
    v_cvt_pk_bf16_f32 v184, v108, v109
    v_mfma_f32_16x16x32_bf16 v[100:103], a[144:147], a[208:211], v[100:103]
    v_exp_f32 v111, v111
    v_mfma_f32_16x16x32_bf16 v[104:107], a[144:147], a[224:227], v[88:91]
    v_cvt_pk_bf16_f32 v185, v110, v111
    v_exp_f32 v96, v96
    v_mfma_f32_16x16x32_bf16 v[104:107], a[148:151], a[228:231], v[104:107]
    v_exp_f32 v97, v97
    v_mfma_f32_16x16x32_bf16 v[104:107], a[152:155], a[232:235], v[104:107]
    v_exp_f32 v98, v98
    v_cvt_pk_bf16_f32 v138, v96, v97
    v_mfma_f32_16x16x32_bf16 v[104:107], a[156:159], a[236:239], v[104:107]
    v_exp_f32 v99, v99
    v_mfma_f32_16x16x32_bf16 v[108:111], a[156:159], a[252:255], v[92:95]
    v_cvt_pk_bf16_f32 v139, v98, v99
    v_exp_f32 v100, v100
    v_mfma_f32_16x16x32_bf16 v[108:111], a[152:155], a[248:251], v[108:111]
    v_exp_f32 v101, v101
    v_mfma_f32_16x16x32_bf16 v[108:111], a[148:151], a[244:247], v[108:111]
    v_exp_f32 v102, v102
    v_cvt_pk_bf16_f32 v154, v100, v101
    v_mfma_f32_16x16x32_bf16 v[108:111], a[144:147], a[240:243], v[108:111]
    v_exp_f32 v103, v103
    v_mfma_f32_32x32x16_bf16 a[80:95], v[64:67], v[64:67], 0
    v_cvt_pk_bf16_f32 v155, v102, v103
    s_waitcnt lgkmcnt(0)
    v_mfma_f32_16x16x32_bf16 v[96:99], a[128:131], a[192:195], v[80:83]
    ds_read_b128 a[144:147], v8 offset:28672
    v_exp_f32 v104, v104
    v_mfma_f32_16x16x32_bf16 v[96:99], a[132:135], a[196:199], v[96:99]
    ds_read_b128 a[148:151], v9 offset:28672
    v_exp_f32 v105, v105
    v_mfma_f32_16x16x32_bf16 v[96:99], a[136:139], a[200:203], v[96:99]
    ds_read_b128 a[152:155], v10 offset:28672
    v_exp_f32 v106, v106
    v_cvt_pk_bf16_f32 v170, v104, v105
    v_mfma_f32_16x16x32_bf16 v[96:99], a[140:143], a[204:207], v[96:99]
    ds_read_b128 a[156:159], v11 offset:28672
    v_exp_f32 v107, v107
    v_mfma_f32_16x16x32_bf16 v[100:103], a[140:143], a[220:223], v[84:87]
    v_cvt_pk_bf16_f32 v171, v106, v107
    v_exp_f32 v108, v108
    v_mfma_f32_16x16x32_bf16 v[100:103], a[136:139], a[216:219], v[100:103]
    v_exp_f32 v109, v109
    v_mfma_f32_16x16x32_bf16 v[100:103], a[132:135], a[212:215], v[100:103]
    v_exp_f32 v110, v110
    v_cvt_pk_bf16_f32 v186, v108, v109
    v_mfma_f32_16x16x32_bf16 v[100:103], a[128:131], a[208:211], v[100:103]
    v_exp_f32 v111, v111
    v_mfma_f32_16x16x32_bf16 v[104:107], a[128:131], a[224:227], v[88:91]
    v_cvt_pk_bf16_f32 v187, v110, v111
    v_exp_f32 v96, v96
    v_mfma_f32_16x16x32_bf16 v[104:107], a[132:135], a[228:231], v[104:107]
    v_exp_f32 v97, v97
    v_mfma_f32_16x16x32_bf16 v[104:107], a[136:139], a[232:235], v[104:107]
    v_exp_f32 v98, v98
    v_cvt_pk_bf16_f32 v140, v96, v97
    v_mfma_f32_16x16x32_bf16 v[104:107], a[140:143], a[236:239], v[104:107]
    v_exp_f32 v99, v99
    v_mfma_f32_16x16x32_bf16 v[108:111], a[140:143], a[252:255], v[92:95]
    v_cvt_pk_bf16_f32 v141, v98, v99
    v_exp_f32 v100, v100
    v_mfma_f32_16x16x32_bf16 v[108:111], a[136:139], a[248:251], v[108:111]
    v_exp_f32 v101, v101
    v_mfma_f32_16x16x32_bf16 v[108:111], a[132:135], a[244:247], v[108:111]
    v_exp_f32 v102, v102
    v_cvt_pk_bf16_f32 v156, v100, v101
    v_mfma_f32_16x16x32_bf16 v[108:111], a[128:131], a[240:243], v[108:111]
    v_exp_f32 v103, v103
    v_mfma_f32_32x32x16_bf16 a[96:111], v[64:67], v[64:67], 0
    v_cvt_pk_bf16_f32 v157, v102, v103
    s_waitcnt vmcnt(0) lgkmcnt(0)
    s_barrier
    v_mfma_f32_16x16x32_bf16 v[96:99], a[144:147], a[192:195], v[80:83]
    ds_read_b128 a[128:131], v8 offset:32768
    v_exp_f32 v104, v104
    v_mfma_f32_16x16x32_bf16 v[96:99], a[148:151], a[196:199], v[96:99]
    ds_read_b128 a[132:135], v9 offset:32768
    v_exp_f32 v105, v105
    v_mfma_f32_16x16x32_bf16 v[96:99], a[152:155], a[200:203], v[96:99]
    ds_read_b128 a[136:139], v10 offset:32768
    s_add_u32 m0, s50, 131072
    v_exp_f32 v106, v106
    v_cvt_pk_bf16_f32 v172, v104, v105
    v_mfma_f32_16x16x32_bf16 v[96:99], a[156:159], a[204:207], v[96:99]
    ds_read_b128 a[140:143], v11 offset:32768
    v_exp_f32 v107, v107
    v_mfma_f32_16x16x32_bf16 v[100:103], a[156:159], a[220:223], v[84:87]
    v_cvt_pk_bf16_f32 v173, v106, v107
    buffer_load_dwordx4 v6, s[28:31], s37 offen offset:0 lds
    ds_read_b64_tr_b16 a[160:161], v12 offset:0
    v_exp_f32 v108, v108
    v_mfma_f32_16x16x32_bf16 v[100:103], a[152:155], a[216:219], v[100:103]
    ds_read_b64_tr_b16 a[162:163], v12 offset:4096
    v_exp_f32 v109, v109
    v_mfma_f32_16x16x32_bf16 v[100:103], a[148:151], a[212:215], v[100:103]
    ds_read_b64_tr_b16 a[164:165], v12 offset:8192
    v_exp_f32 v110, v110
    v_cvt_pk_bf16_f32 v188, v108, v109
    v_mfma_f32_16x16x32_bf16 v[100:103], a[144:147], a[208:211], v[100:103]
    ds_read_b64_tr_b16 a[166:167], v12 offset:12288
    v_exp_f32 v111, v111
    v_mfma_f32_16x16x32_bf16 v[104:107], a[144:147], a[224:227], v[88:91]
    v_cvt_pk_bf16_f32 v189, v110, v111
    buffer_load_dwordx4 v7, s[28:31], s37 offen offset:1024 lds
    ds_read_b64_tr_b16 a[168:169], v12 offset:16384
    s_add_u32 s72, s51, 131072
    buffer_store_dwordx2 v[58:59], v57, s[8:11], s72 offen sc1
    v_exp_f32 v96, v96
    v_mfma_f32_16x16x32_bf16 v[104:107], a[148:151], a[228:231], v[104:107]
    ds_read_b64_tr_b16 a[170:171], v12 offset:20480
    v_exp_f32 v97, v97
    v_mfma_f32_16x16x32_bf16 v[104:107], a[152:155], a[232:235], v[104:107]
    ds_read_b64_tr_b16 a[172:173], v12 offset:24576
    v_exp_f32 v98, v98
    v_cvt_pk_bf16_f32 v142, v96, v97
    v_mfma_f32_16x16x32_bf16 v[104:107], a[156:159], a[236:239], v[104:107]
    ds_read_b64_tr_b16 a[174:175], v12 offset:28672
    v_exp_f32 v99, v99
    v_mfma_f32_16x16x32_bf16 v[108:111], a[156:159], a[252:255], v[92:95]
    v_cvt_pk_bf16_f32 v143, v98, v99
    buffer_load_dwordx4 v6, s[28:31], s37 offen offset:2048 lds
    v_exp_f32 v100, v100
    v_mfma_f32_16x16x32_bf16 v[108:111], a[152:155], a[248:251], v[108:111]
    v_exp_f32 v101, v101
    v_mfma_f32_16x16x32_bf16 v[108:111], a[148:151], a[244:247], v[108:111]
    v_exp_f32 v102, v102
    v_cvt_pk_bf16_f32 v158, v100, v101
    v_mfma_f32_16x16x32_bf16 v[108:111], a[144:147], a[240:243], v[108:111]
    v_exp_f32 v103, v103
    v_mfma_f32_32x32x16_bf16 a[112:127], v[64:67], v[64:67], 0
    v_cvt_pk_bf16_f32 v159, v102, v103
    v_exp_f32 v104, v104
    v_exp_f32 v105, v105
    v_exp_f32 v106, v106
    v_exp_f32 v107, v107
    s_nop 0
    v_cvt_pk_bf16_f32 v174, v104, v105
    v_cvt_pk_bf16_f32 v175, v106, v107
    s_waitcnt lgkmcnt(0)
.p2align 6
L_loop:
    v_mfma_f32_16x16x32_bf16 v[96:99], a[128:131], a[192:195], v[80:83]
    v_exp_f32 v108, v108
    v_mfma_f32_16x16x32_bf16 v[96:99], a[132:135], a[196:199], v[96:99]
    ds_read_b128 a[144:147], v8 offset:36864
    v_mfma_f32_16x16x32_bf16 v[96:99], a[136:139], a[200:203], v[96:99]
    v_exp_f32 v109, v109
    v_mfma_f32_16x16x32_bf16 v[96:99], a[140:143], a[204:207], v[96:99]
    ds_read_b128 a[148:151], v9 offset:36864
    v_cvt_pk_bf16_f32 v190, v108, v109
    v_mfma_f32_16x16x32_bf16 v[100:103], a[140:143], a[220:223], v[84:87]
    v_exp_f32 v110, v110
    v_mfma_f32_16x16x32_bf16 v[100:103], a[136:139], a[216:219], v[100:103]
    buffer_load_dwordx4 v7, s[28:31], s37 offen offset:3072 lds
    s_add_u32 s37, s37, 4096
    v_mfma_f32_16x16x32_bf16 v[100:103], a[132:135], a[212:215], v[100:103]
    v_exp_f32 v111, v111
    v_mfma_f32_16x16x32_bf16 v[100:103], a[128:131], a[208:211], v[100:103]
    ds_read_b128 a[152:155], v10 offset:36864
    v_cvt_pk_bf16_f32 v191, v110, v111
    v_mfma_f32_16x16x32_bf16 v[104:107], a[128:131], a[224:227], v[88:91]
    v_exp_f32 v96, v96
    v_mfma_f32_16x16x32_bf16 v[104:107], a[132:135], a[228:231], v[104:107]
    ds_read_b128 a[156:159], v11 offset:36864
    s_waitcnt lgkmcnt(4)
    v_mfma_f32_16x16x32_bf16 v[104:107], a[136:139], a[232:235], v[104:107]
    v_exp_f32 v97, v97
    v_mfma_f32_16x16x32_bf16 v[104:107], a[140:143], a[236:239], v[104:107]
    ds_read_b64_tr_b16 a[176:177], v13 offset:0
    v_cvt_pk_bf16_f32 v192, v96, v97
    v_mfma_f32_16x16x32_bf16 v[108:111], a[140:143], a[252:255], v[92:95]
    v_exp_f32 v98, v98
    v_mfma_f32_16x16x32_bf16 v[108:111], a[136:139], a[248:251], v[108:111]
    v_mfma_f32_16x16x32_bf16 v[108:111], a[132:135], a[244:247], v[108:111]
    v_exp_f32 v99, v99
    v_mfma_f32_16x16x32_bf16 v[108:111], a[128:131], a[240:243], v[108:111]
    ds_read_b64_tr_b16 a[178:179], v13 offset:4096
    v_cvt_pk_bf16_f32 v193, v98, v99
    v_mfma_f32_16x16x32_bf16 a[0:3], a[160:163], v[128:131], a[0:3]
    v_exp_f32 v100, v100
    v_mfma_f32_16x16x32_bf16 a[0:3], a[164:167], v[132:135], a[0:3]
    ds_read_b64_tr_b16 a[180:181], v13 offset:8192
    s_add_u32 m0, s50, 135168
    v_mfma_f32_16x16x32_bf16 a[0:3], a[168:171], v[136:139], a[0:3]
    v_exp_f32 v101, v101
    v_mfma_f32_16x16x32_bf16 a[0:3], a[172:175], v[140:143], a[0:3]
    ds_read_b64_tr_b16 a[182:183], v13 offset:12288
    v_cvt_pk_bf16_f32 v208, v100, v101
    v_mfma_f32_16x16x32_bf16 a[4:7], a[172:175], v[156:159], a[4:7]
    v_exp_f32 v102, v102
    v_mfma_f32_16x16x32_bf16 a[4:7], a[168:171], v[152:155], a[4:7]
    buffer_load_dwordx4 v6, s[28:31], s37 offen offset:0 lds
    v_mfma_f32_16x16x32_bf16 a[4:7], a[164:167], v[148:151], a[4:7]
    v_exp_f32 v103, v103
    v_mfma_f32_16x16x32_bf16 a[4:7], a[160:163], v[144:147], a[4:7]
    ds_read_b64_tr_b16 a[184:185], v13 offset:16384
    v_cvt_pk_bf16_f32 v209, v102, v103
    v_mfma_f32_16x16x32_bf16 a[8:11], a[160:163], v[160:163], a[8:11]
    v_exp_f32 v104, v104
    v_mfma_f32_16x16x32_bf16 a[8:11], a[164:167], v[164:167], a[8:11]
    ds_read_b64_tr_b16 a[186:187], v13 offset:20480
    v_mfma_f32_16x16x32_bf16 a[8:11], a[168:171], v[168:171], a[8:11]
    v_exp_f32 v105, v105
    v_mfma_f32_16x16x32_bf16 a[8:11], a[172:175], v[172:175], a[8:11]
    ds_read_b64_tr_b16 a[188:189], v13 offset:24576
    v_cvt_pk_bf16_f32 v224, v104, v105
    v_mfma_f32_16x16x32_bf16 a[12:15], a[172:175], v[188:191], a[12:15]
    v_exp_f32 v106, v106
    v_mfma_f32_16x16x32_bf16 a[12:15], a[168:171], v[184:187], a[12:15]
    buffer_load_dwordx4 v7, s[28:31], s37 offen offset:1024 lds
    v_mfma_f32_16x16x32_bf16 a[12:15], a[164:167], v[180:183], a[12:15]
    v_exp_f32 v107, v107
    v_mfma_f32_16x16x32_bf16 a[12:15], a[160:163], v[176:179], a[12:15]
    ds_read_b64_tr_b16 a[190:191], v13 offset:28672
    v_cvt_pk_bf16_f32 v225, v106, v107
    v_smfmac_f32_16x16x64_bf16 v[64:67], v[60:63], v[128:135], v56
    s_waitcnt lgkmcnt(8)
    v_mfma_f32_16x16x32_bf16 v[96:99], a[144:147], a[192:195], v[80:83]
    v_exp_f32 v108, v108
    v_mfma_f32_16x16x32_bf16 v[96:99], a[148:151], a[196:199], v[96:99]
    ds_read_b128 a[128:131], v8 offset:40960
    v_mfma_f32_16x16x32_bf16 v[96:99], a[152:155], a[200:203], v[96:99]
    v_exp_f32 v109, v109
    v_mfma_f32_16x16x32_bf16 v[96:99], a[156:159], a[204:207], v[96:99]
    ds_read_b128 a[132:135], v9 offset:40960
    v_cvt_pk_bf16_f32 v240, v108, v109
    v_mfma_f32_16x16x32_bf16 v[100:103], a[156:159], a[220:223], v[84:87]
    v_exp_f32 v110, v110
    v_mfma_f32_16x16x32_bf16 v[100:103], a[152:155], a[216:219], v[100:103]
    buffer_load_dwordx4 v6, s[28:31], s37 offen offset:2048 lds
    v_mfma_f32_16x16x32_bf16 v[100:103], a[148:151], a[212:215], v[100:103]
    v_exp_f32 v111, v111
    v_mfma_f32_16x16x32_bf16 v[100:103], a[144:147], a[208:211], v[100:103]
    ds_read_b128 a[136:139], v10 offset:40960
    v_cvt_pk_bf16_f32 v241, v110, v111
    v_mfma_f32_16x16x32_bf16 v[104:107], a[144:147], a[224:227], v[88:91]
    v_exp_f32 v96, v96
    v_mfma_f32_16x16x32_bf16 v[104:107], a[148:151], a[228:231], v[104:107]
    ds_read_b128 a[140:143], v11 offset:40960
    s_waitcnt lgkmcnt(4)
    v_mfma_f32_16x16x32_bf16 v[104:107], a[152:155], a[232:235], v[104:107]
    v_exp_f32 v97, v97
    v_mfma_f32_16x16x32_bf16 v[104:107], a[156:159], a[236:239], v[104:107]
    ds_read_b64_tr_b16 a[160:161], v14 offset:0
    v_cvt_pk_bf16_f32 v194, v96, v97
    v_mfma_f32_16x16x32_bf16 v[108:111], a[156:159], a[252:255], v[92:95]
    v_exp_f32 v98, v98
    v_mfma_f32_16x16x32_bf16 v[108:111], a[152:155], a[248:251], v[108:111]
    buffer_load_dword v27, v54, s[24:27], s49 offen
    v_mfma_f32_16x16x32_bf16 v[108:111], a[148:151], a[244:247], v[108:111]
    v_exp_f32 v99, v99
    v_mfma_f32_16x16x32_bf16 v[108:111], a[144:147], a[240:243], v[108:111]
    ds_read_b64_tr_b16 a[162:163], v14 offset:4096
    v_cvt_pk_bf16_f32 v195, v98, v99
    v_mfma_f32_16x16x32_bf16 a[16:19], a[176:179], v[128:131], a[16:19]
    v_exp_f32 v100, v100
    v_mfma_f32_16x16x32_bf16 a[16:19], a[180:183], v[132:135], a[16:19]
    ds_read_b64_tr_b16 a[164:165], v14 offset:8192
    v_mfma_f32_16x16x32_bf16 a[16:19], a[184:187], v[136:139], a[16:19]
    v_exp_f32 v101, v101
    v_mfma_f32_16x16x32_bf16 a[16:19], a[188:191], v[140:143], a[16:19]
    ds_read_b64_tr_b16 a[166:167], v14 offset:12288
    v_cvt_pk_bf16_f32 v210, v100, v101
    v_mfma_f32_16x16x32_bf16 a[20:23], a[188:191], v[156:159], a[20:23]
    v_exp_f32 v102, v102
    v_mfma_f32_16x16x32_bf16 a[20:23], a[184:187], v[152:155], a[20:23]
    buffer_load_dwordx4 v7, s[28:31], s37 offen offset:3072 lds
    s_add_u32 s37, s37, 28672
    v_mfma_f32_16x16x32_bf16 a[20:23], a[180:183], v[148:151], a[20:23]
    v_exp_f32 v103, v103
    v_mfma_f32_16x16x32_bf16 a[20:23], a[176:179], v[144:147], a[20:23]
    ds_read_b64_tr_b16 a[168:169], v14 offset:16384
    v_cvt_pk_bf16_f32 v211, v102, v103
    v_mfma_f32_16x16x32_bf16 a[24:27], a[176:179], v[160:163], a[24:27]
    v_exp_f32 v104, v104
    v_mfma_f32_16x16x32_bf16 a[24:27], a[180:183], v[164:167], a[24:27]
    ds_read_b64_tr_b16 a[170:171], v14 offset:20480
    s_add_u32 m0, s50, 32768
    v_mfma_f32_16x16x32_bf16 a[24:27], a[184:187], v[168:171], a[24:27]
    v_exp_f32 v105, v105
    v_mfma_f32_16x16x32_bf16 a[24:27], a[188:191], v[172:175], a[24:27]
    ds_read_b64_tr_b16 a[172:173], v14 offset:24576
    v_cvt_pk_bf16_f32 v226, v104, v105
    v_mfma_f32_16x16x32_bf16 a[28:31], a[188:191], v[188:191], a[28:31]
    v_exp_f32 v106, v106
    v_mfma_f32_16x16x32_bf16 a[28:31], a[184:187], v[184:187], a[28:31]
    buffer_load_dwordx4 v2, s[24:27], s36 offen offset:0 lds
    v_mfma_f32_16x16x32_bf16 a[28:31], a[180:183], v[180:183], a[28:31]
    v_exp_f32 v107, v107
    v_mfma_f32_16x16x32_bf16 a[28:31], a[176:179], v[176:179], a[28:31]
    ds_read_b64_tr_b16 a[174:175], v14 offset:28672
    v_cvt_pk_bf16_f32 v227, v106, v107
    v_smfmac_f32_16x16x64_bf16 v[64:67], v[60:63], v[136:143], v56
    s_waitcnt lgkmcnt(8)
    v_mfma_f32_16x16x32_bf16 v[96:99], a[128:131], a[192:195], v[80:83]
    v_exp_f32 v108, v108
    v_mfma_f32_16x16x32_bf16 v[96:99], a[132:135], a[196:199], v[96:99]
    ds_read_b128 a[144:147], v8 offset:45056
    v_mfma_f32_16x16x32_bf16 v[96:99], a[136:139], a[200:203], v[96:99]
    v_exp_f32 v109, v109
    v_mfma_f32_16x16x32_bf16 v[96:99], a[140:143], a[204:207], v[96:99]
    ds_read_b128 a[148:151], v9 offset:45056
    v_cvt_pk_bf16_f32 v242, v108, v109
    v_mfma_f32_16x16x32_bf16 v[100:103], a[140:143], a[220:223], v[84:87]
    v_exp_f32 v110, v110
    v_mfma_f32_16x16x32_bf16 v[100:103], a[136:139], a[216:219], v[100:103]
    buffer_load_dwordx4 v3, s[24:27], s36 offen offset:1024 lds
    v_mfma_f32_16x16x32_bf16 v[100:103], a[132:135], a[212:215], v[100:103]
    v_exp_f32 v111, v111
    v_mfma_f32_16x16x32_bf16 v[100:103], a[128:131], a[208:211], v[100:103]
    ds_read_b128 a[152:155], v10 offset:45056
    v_cvt_pk_bf16_f32 v243, v110, v111
    v_mfma_f32_16x16x32_bf16 v[104:107], a[128:131], a[224:227], v[88:91]
    v_exp_f32 v96, v96
    v_mfma_f32_16x16x32_bf16 v[104:107], a[132:135], a[228:231], v[104:107]
    ds_read_b128 a[156:159], v11 offset:45056
    s_waitcnt lgkmcnt(4)
    v_mfma_f32_16x16x32_bf16 v[104:107], a[136:139], a[232:235], v[104:107]
    v_exp_f32 v97, v97
    v_mfma_f32_16x16x32_bf16 v[104:107], a[140:143], a[236:239], v[104:107]
    ds_read_b64_tr_b16 a[176:177], v15 offset:0
    v_cvt_pk_bf16_f32 v196, v96, v97
    v_mfma_f32_16x16x32_bf16 v[108:111], a[140:143], a[252:255], v[92:95]
    v_exp_f32 v98, v98
    v_mfma_f32_16x16x32_bf16 v[108:111], a[136:139], a[248:251], v[108:111]
    v_mfma_f32_16x16x32_bf16 v[108:111], a[132:135], a[244:247], v[108:111]
    v_exp_f32 v99, v99
    v_mfma_f32_16x16x32_bf16 v[108:111], a[128:131], a[240:243], v[108:111]
    ds_read_b64_tr_b16 a[178:179], v15 offset:4096
    v_cvt_pk_bf16_f32 v197, v98, v99
    v_mfma_f32_16x16x32_bf16 a[32:35], a[160:163], v[128:131], a[32:35]
    v_exp_f32 v100, v100
    v_mfma_f32_16x16x32_bf16 a[32:35], a[164:167], v[132:135], a[32:35]
    ds_read_b64_tr_b16 a[180:181], v15 offset:8192
    v_mfma_f32_16x16x32_bf16 a[32:35], a[168:171], v[136:139], a[32:35]
    v_exp_f32 v101, v101
    v_mfma_f32_16x16x32_bf16 a[32:35], a[172:175], v[140:143], a[32:35]
    ds_read_b64_tr_b16 a[182:183], v15 offset:12288
    v_cvt_pk_bf16_f32 v212, v100, v101
    v_mfma_f32_16x16x32_bf16 a[36:39], a[172:175], v[156:159], a[36:39]
    v_exp_f32 v102, v102
    v_mfma_f32_16x16x32_bf16 a[36:39], a[168:171], v[152:155], a[36:39]
    buffer_load_dwordx4 v4, s[24:27], s36 offen offset:2048 lds
    v_mfma_f32_16x16x32_bf16 a[36:39], a[164:167], v[148:151], a[36:39]
    v_exp_f32 v103, v103
    v_mfma_f32_16x16x32_bf16 a[36:39], a[160:163], v[144:147], a[36:39]
    ds_read_b64_tr_b16 a[184:185], v15 offset:16384
    v_cvt_pk_bf16_f32 v213, v102, v103
    v_mfma_f32_16x16x32_bf16 a[40:43], a[160:163], v[160:163], a[40:43]
    v_exp_f32 v104, v104
    v_mfma_f32_16x16x32_bf16 a[40:43], a[164:167], v[164:167], a[40:43]
    ds_read_b64_tr_b16 a[186:187], v15 offset:20480
    v_mfma_f32_16x16x32_bf16 a[40:43], a[168:171], v[168:171], a[40:43]
    v_exp_f32 v105, v105
    v_mfma_f32_16x16x32_bf16 a[40:43], a[172:175], v[172:175], a[40:43]
    ds_read_b64_tr_b16 a[188:189], v15 offset:24576
    v_cvt_pk_bf16_f32 v228, v104, v105
    v_mfma_f32_16x16x32_bf16 a[44:47], a[172:175], v[188:191], a[44:47]
    v_exp_f32 v106, v106
    v_mfma_f32_16x16x32_bf16 a[44:47], a[168:171], v[184:187], a[44:47]
    buffer_load_dwordx4 v5, s[24:27], s36 offen offset:3072 lds
    s_add_u32 s36, s36, 4096
    v_mfma_f32_16x16x32_bf16 a[44:47], a[164:167], v[180:183], a[44:47]
    v_exp_f32 v107, v107
    v_mfma_f32_16x16x32_bf16 a[44:47], a[160:163], v[176:179], a[44:47]
    ds_read_b64_tr_b16 a[190:191], v15 offset:28672
    v_cvt_pk_bf16_f32 v229, v106, v107
    v_smfmac_f32_16x16x64_bf16 v[68:71], v[60:63], v[144:151], v56
    s_waitcnt lgkmcnt(8)
    v_mfma_f32_16x16x32_bf16 v[96:99], a[144:147], a[192:195], v[80:83]
    v_exp_f32 v108, v108
    v_mfma_f32_16x16x32_bf16 v[96:99], a[148:151], a[196:199], v[96:99]
    ds_read_b128 a[128:131], v8 offset:49152
    s_add_u32 m0, s50, 36864
    v_mfma_f32_16x16x32_bf16 v[96:99], a[152:155], a[200:203], v[96:99]
    v_exp_f32 v109, v109
    v_mfma_f32_16x16x32_bf16 v[96:99], a[156:159], a[204:207], v[96:99]
    ds_read_b128 a[132:135], v9 offset:49152
    v_cvt_pk_bf16_f32 v244, v108, v109
    v_mfma_f32_16x16x32_bf16 v[100:103], a[156:159], a[220:223], v[84:87]
    v_exp_f32 v110, v110
    v_mfma_f32_16x16x32_bf16 v[100:103], a[152:155], a[216:219], v[100:103]
    buffer_load_dwordx4 v2, s[24:27], s36 offen offset:0 lds
    v_mfma_f32_16x16x32_bf16 v[100:103], a[148:151], a[212:215], v[100:103]
    v_exp_f32 v111, v111
    v_mfma_f32_16x16x32_bf16 v[100:103], a[144:147], a[208:211], v[100:103]
    ds_read_b128 a[136:139], v10 offset:49152
    v_cvt_pk_bf16_f32 v245, v110, v111
    v_mfma_f32_16x16x32_bf16 v[104:107], a[144:147], a[224:227], v[88:91]
    v_exp_f32 v96, v96
    v_mfma_f32_16x16x32_bf16 v[104:107], a[148:151], a[228:231], v[104:107]
    ds_read_b128 a[140:143], v11 offset:49152
    s_waitcnt lgkmcnt(4)
    v_mfma_f32_16x16x32_bf16 v[104:107], a[152:155], a[232:235], v[104:107]
    v_exp_f32 v97, v97
    v_mfma_f32_16x16x32_bf16 v[104:107], a[156:159], a[236:239], v[104:107]
    ds_read_b64_tr_b16 a[160:161], v16 offset:0
    v_cvt_pk_bf16_f32 v198, v96, v97
    v_mfma_f32_16x16x32_bf16 v[108:111], a[156:159], a[252:255], v[92:95]
    v_exp_f32 v98, v98
    v_mfma_f32_16x16x32_bf16 v[108:111], a[152:155], a[248:251], v[108:111]
    v_mfma_f32_16x16x32_bf16 v[108:111], a[148:151], a[244:247], v[108:111]
    v_exp_f32 v99, v99
    v_mfma_f32_16x16x32_bf16 v[108:111], a[144:147], a[240:243], v[108:111]
    ds_read_b64_tr_b16 a[162:163], v16 offset:4096
    v_cvt_pk_bf16_f32 v199, v98, v99
    v_mfma_f32_16x16x32_bf16 a[48:51], a[176:179], v[128:131], a[48:51]
    v_exp_f32 v100, v100
    v_mfma_f32_16x16x32_bf16 a[48:51], a[180:183], v[132:135], a[48:51]
    ds_read_b64_tr_b16 a[164:165], v16 offset:8192
    v_mfma_f32_16x16x32_bf16 a[48:51], a[184:187], v[136:139], a[48:51]
    v_exp_f32 v101, v101
    v_mfma_f32_16x16x32_bf16 a[48:51], a[188:191], v[140:143], a[48:51]
    ds_read_b64_tr_b16 a[166:167], v16 offset:12288
    v_cvt_pk_bf16_f32 v214, v100, v101
    v_mfma_f32_16x16x32_bf16 a[52:55], a[188:191], v[156:159], a[52:55]
    v_exp_f32 v102, v102
    v_mfma_f32_16x16x32_bf16 a[52:55], a[184:187], v[152:155], a[52:55]
    buffer_load_dwordx4 v3, s[24:27], s36 offen offset:1024 lds
    v_mfma_f32_16x16x32_bf16 a[52:55], a[180:183], v[148:151], a[52:55]
    v_exp_f32 v103, v103
    v_mfma_f32_16x16x32_bf16 a[52:55], a[176:179], v[144:147], a[52:55]
    ds_read_b64_tr_b16 a[168:169], v16 offset:16384
    v_cvt_pk_bf16_f32 v215, v102, v103
    v_mfma_f32_16x16x32_bf16 a[56:59], a[176:179], v[160:163], a[56:59]
    v_exp_f32 v104, v104
    v_mfma_f32_16x16x32_bf16 a[56:59], a[180:183], v[164:167], a[56:59]
    ds_read_b64_tr_b16 a[170:171], v16 offset:20480
    v_mfma_f32_16x16x32_bf16 a[56:59], a[184:187], v[168:171], a[56:59]
    v_exp_f32 v105, v105
    v_mfma_f32_16x16x32_bf16 a[56:59], a[188:191], v[172:175], a[56:59]
    ds_read_b64_tr_b16 a[172:173], v16 offset:24576
    v_cvt_pk_bf16_f32 v230, v104, v105
    v_mfma_f32_16x16x32_bf16 a[60:63], a[188:191], v[188:191], a[60:63]
    v_exp_f32 v106, v106
    v_mfma_f32_16x16x32_bf16 a[60:63], a[184:187], v[184:187], a[60:63]
    buffer_load_dwordx4 v4, s[24:27], s36 offen offset:2048 lds
    v_mfma_f32_16x16x32_bf16 a[60:63], a[180:183], v[180:183], a[60:63]
    v_exp_f32 v107, v107
    v_mfma_f32_16x16x32_bf16 a[60:63], a[176:179], v[176:179], a[60:63]
    ds_read_b64_tr_b16 a[174:175], v16 offset:28672
    v_cvt_pk_bf16_f32 v231, v106, v107
    v_smfmac_f32_16x16x64_bf16 v[68:71], v[60:63], v[152:159], v56
    s_waitcnt lgkmcnt(8)
    v_mfma_f32_16x16x32_bf16 v[96:99], a[128:131], a[192:195], v[80:83]
    v_exp_f32 v108, v108
    v_mfma_f32_16x16x32_bf16 v[96:99], a[132:135], a[196:199], v[96:99]
    ds_read_b128 a[144:147], v8 offset:53248
    v_mfma_f32_16x16x32_bf16 v[96:99], a[136:139], a[200:203], v[96:99]
    v_exp_f32 v109, v109
    v_mfma_f32_16x16x32_bf16 v[96:99], a[140:143], a[204:207], v[96:99]
    ds_read_b128 a[148:151], v9 offset:53248
    v_cvt_pk_bf16_f32 v246, v108, v109
    v_mfma_f32_16x16x32_bf16 v[100:103], a[140:143], a[220:223], v[84:87]
    v_exp_f32 v110, v110
    v_mfma_f32_16x16x32_bf16 v[100:103], a[136:139], a[216:219], v[100:103]
    buffer_load_dwordx4 v5, s[24:27], s36 offen offset:3072 lds
    s_add_u32 s36, s36, 28672
    v_mfma_f32_16x16x32_bf16 v[100:103], a[132:135], a[212:215], v[100:103]
    v_exp_f32 v111, v111
    v_mfma_f32_16x16x32_bf16 v[100:103], a[128:131], a[208:211], v[100:103]
    ds_read_b128 a[152:155], v10 offset:53248
    v_cvt_pk_bf16_f32 v247, v110, v111
    v_mfma_f32_16x16x32_bf16 v[104:107], a[128:131], a[224:227], v[88:91]
    v_exp_f32 v96, v96
    v_mfma_f32_16x16x32_bf16 v[104:107], a[132:135], a[228:231], v[104:107]
    ds_read_b128 a[156:159], v11 offset:53248
    s_waitcnt lgkmcnt(4)
    v_mfma_f32_16x16x32_bf16 v[104:107], a[136:139], a[232:235], v[104:107]
    v_exp_f32 v97, v97
    v_mfma_f32_16x16x32_bf16 v[104:107], a[140:143], a[236:239], v[104:107]
    ds_read_b64_tr_b16 a[176:177], v17 offset:0
    v_cvt_pk_bf16_f32 v200, v96, v97
    v_mfma_f32_16x16x32_bf16 v[108:111], a[140:143], a[252:255], v[92:95]
    v_exp_f32 v98, v98
    v_mfma_f32_16x16x32_bf16 v[108:111], a[136:139], a[248:251], v[108:111]
    v_mfma_f32_16x16x32_bf16 v[108:111], a[132:135], a[244:247], v[108:111]
    v_exp_f32 v99, v99
    v_mfma_f32_16x16x32_bf16 v[108:111], a[128:131], a[240:243], v[108:111]
    ds_read_b64_tr_b16 a[178:179], v17 offset:4096
    v_cvt_pk_bf16_f32 v201, v98, v99
    v_mfma_f32_16x16x32_bf16 a[64:67], a[160:163], v[128:131], a[64:67]
    v_exp_f32 v100, v100
    v_mfma_f32_16x16x32_bf16 a[64:67], a[164:167], v[132:135], a[64:67]
    ds_read_b64_tr_b16 a[180:181], v17 offset:8192
    v_mfma_f32_16x16x32_bf16 a[64:67], a[168:171], v[136:139], a[64:67]
    v_exp_f32 v101, v101
    v_mfma_f32_16x16x32_bf16 a[64:67], a[172:175], v[140:143], a[64:67]
    ds_read_b64_tr_b16 a[182:183], v17 offset:12288
    v_cvt_pk_bf16_f32 v216, v100, v101
    v_mfma_f32_16x16x32_bf16 a[68:71], a[172:175], v[156:159], a[68:71]
    v_exp_f32 v102, v102
    v_mfma_f32_16x16x32_bf16 a[68:71], a[168:171], v[152:155], a[68:71]
    v_mfma_f32_16x16x32_bf16 a[68:71], a[164:167], v[148:151], a[68:71]
    v_exp_f32 v103, v103
    v_mfma_f32_16x16x32_bf16 a[68:71], a[160:163], v[144:147], a[68:71]
    ds_read_b64_tr_b16 a[184:185], v17 offset:16384
    v_cvt_pk_bf16_f32 v217, v102, v103
    v_mfma_f32_16x16x32_bf16 a[72:75], a[160:163], v[160:163], a[72:75]
    v_exp_f32 v104, v104
    v_mfma_f32_16x16x32_bf16 a[72:75], a[164:167], v[164:167], a[72:75]
    ds_read_b64_tr_b16 a[186:187], v17 offset:20480
    v_mfma_f32_16x16x32_bf16 a[72:75], a[168:171], v[168:171], a[72:75]
    v_exp_f32 v105, v105
    v_mfma_f32_16x16x32_bf16 a[72:75], a[172:175], v[172:175], a[72:75]
    ds_read_b64_tr_b16 a[188:189], v17 offset:24576
    v_cvt_pk_bf16_f32 v232, v104, v105
    v_mfma_f32_16x16x32_bf16 a[76:79], a[172:175], v[188:191], a[76:79]
    v_exp_f32 v106, v106
    v_mfma_f32_16x16x32_bf16 a[76:79], a[168:171], v[184:187], a[76:79]
    v_mfma_f32_16x16x32_bf16 a[76:79], a[164:167], v[180:183], a[76:79]
    v_exp_f32 v107, v107
    v_mfma_f32_16x16x32_bf16 a[76:79], a[160:163], v[176:179], a[76:79]
    ds_read_b64_tr_b16 a[190:191], v17 offset:28672
    v_cvt_pk_bf16_f32 v233, v106, v107
    v_smfmac_f32_16x16x64_bf16 v[72:75], v[60:63], v[160:167], v56
    s_waitcnt lgkmcnt(8)
    v_mfma_f32_16x16x32_bf16 v[96:99], a[144:147], a[192:195], v[80:83]
    v_exp_f32 v108, v108
    v_mfma_f32_16x16x32_bf16 v[96:99], a[148:151], a[196:199], v[96:99]
    ds_read_b128 a[128:131], v8 offset:57344
    v_mfma_f32_16x16x32_bf16 v[96:99], a[152:155], a[200:203], v[96:99]
    v_exp_f32 v109, v109
    v_mfma_f32_16x16x32_bf16 v[96:99], a[156:159], a[204:207], v[96:99]
    ds_read_b128 a[132:135], v9 offset:57344
    v_cvt_pk_bf16_f32 v248, v108, v109
    v_mfma_f32_16x16x32_bf16 v[100:103], a[156:159], a[220:223], v[84:87]
    v_exp_f32 v110, v110
    v_mfma_f32_16x16x32_bf16 v[100:103], a[152:155], a[216:219], v[100:103]
    ds_read_b128 a[136:139], v10 offset:57344
    v_mfma_f32_16x16x32_bf16 v[100:103], a[148:151], a[212:215], v[100:103]
    v_exp_f32 v111, v111
    v_mfma_f32_16x16x32_bf16 v[100:103], a[144:147], a[208:211], v[100:103]
    ds_read_b128 a[140:143], v11 offset:57344
    v_cvt_pk_bf16_f32 v249, v110, v111
    v_mfma_f32_16x16x32_bf16 v[104:107], a[144:147], a[224:227], v[88:91]
    v_exp_f32 v96, v96
    v_mfma_f32_16x16x32_bf16 v[104:107], a[148:151], a[228:231], v[104:107]
    ds_read_b64_tr_b16 a[160:161], v18 offset:0
    s_waitcnt lgkmcnt(5)
    v_mfma_f32_16x16x32_bf16 v[104:107], a[152:155], a[232:235], v[104:107]
    v_exp_f32 v97, v97
    v_mfma_f32_16x16x32_bf16 v[104:107], a[156:159], a[236:239], v[104:107]
    ds_read_b64_tr_b16 a[162:163], v18 offset:4096
    v_cvt_pk_bf16_f32 v202, v96, v97
    v_mfma_f32_16x16x32_bf16 v[108:111], a[156:159], a[252:255], v[92:95]
    v_exp_f32 v98, v98
    v_mfma_f32_16x16x32_bf16 v[108:111], a[152:155], a[248:251], v[108:111]
    ds_read_b64_tr_b16 a[164:165], v18 offset:8192
    v_mfma_f32_16x16x32_bf16 v[108:111], a[148:151], a[244:247], v[108:111]
    v_exp_f32 v99, v99
    v_mfma_f32_16x16x32_bf16 v[108:111], a[144:147], a[240:243], v[108:111]
    ds_read_b64_tr_b16 a[166:167], v18 offset:12288
    v_cvt_pk_bf16_f32 v203, v98, v99
    v_mfma_f32_16x16x32_bf16 a[80:83], a[176:179], v[128:131], a[80:83]
    v_exp_f32 v100, v100
    v_mfma_f32_16x16x32_bf16 a[80:83], a[180:183], v[132:135], a[80:83]
    ds_read_b64_tr_b16 a[168:169], v18 offset:16384
    v_mfma_f32_16x16x32_bf16 a[80:83], a[184:187], v[136:139], a[80:83]
    v_exp_f32 v101, v101
    v_mfma_f32_16x16x32_bf16 a[80:83], a[188:191], v[140:143], a[80:83]
    ds_read_b64_tr_b16 a[170:171], v18 offset:20480
    v_cvt_pk_bf16_f32 v218, v100, v101
    v_mfma_f32_16x16x32_bf16 a[84:87], a[188:191], v[156:159], a[84:87]
    v_exp_f32 v102, v102
    v_mfma_f32_16x16x32_bf16 a[84:87], a[184:187], v[152:155], a[84:87]
    ds_read_b64_tr_b16 a[172:173], v18 offset:24576
    v_mfma_f32_16x16x32_bf16 a[84:87], a[180:183], v[148:151], a[84:87]
    v_exp_f32 v103, v103
    v_mfma_f32_16x16x32_bf16 a[84:87], a[176:179], v[144:147], a[84:87]
    ds_read_b64_tr_b16 a[174:175], v18 offset:28672
    v_cvt_pk_bf16_f32 v219, v102, v103
    v_mfma_f32_16x16x32_bf16 a[88:91], a[176:179], v[160:163], a[88:91]
    v_exp_f32 v104, v104
    v_mfma_f32_16x16x32_bf16 a[88:91], a[180:183], v[164:167], a[88:91]
    s_cmp_le_u32 s40, 3
    s_cselect_b32 s72, s48, 0x7f000000
    v_mfma_f32_16x16x32_bf16 a[88:91], a[184:187], v[168:171], a[88:91]
    v_exp_f32 v105, v105
    v_mfma_f32_16x16x32_bf16 a[88:91], a[188:191], v[172:175], a[88:91]
    v_cvt_pk_bf16_f32 v234, v104, v105
    v_mfma_f32_16x16x32_bf16 a[92:95], a[188:191], v[188:191], a[92:95]
    v_exp_f32 v106, v106
    v_mfma_f32_16x16x32_bf16 a[92:95], a[184:187], v[184:187], a[92:95]
    s_cselect_b32 s3, 262144, 0
    s_add_u32 s48, s48, s3
    v_mfma_f32_16x16x32_bf16 a[92:95], a[180:183], v[180:183], a[92:95]
    v_exp_f32 v107, v107
    v_mfma_f32_16x16x32_bf16 a[92:95], a[176:179], v[176:179], a[92:95]
    v_cvt_pk_bf16_f32 v235, v106, v107
    v_smfmac_f32_16x16x64_bf16 v[72:75], v[60:63], v[168:175], v56
    s_waitcnt lgkmcnt(0)
    v_mfma_f32_16x16x32_bf16 v[96:99], a[128:131], a[192:195], v[80:83]
    v_exp_f32 v108, v108
    v_mfma_f32_16x16x32_bf16 v[96:99], a[132:135], a[196:199], v[96:99]
    ds_read_b128 a[144:147], v8 offset:61440
    v_mfma_f32_16x16x32_bf16 v[96:99], a[136:139], a[200:203], v[96:99]
    v_exp_f32 v109, v109
    v_mfma_f32_16x16x32_bf16 v[96:99], a[140:143], a[204:207], v[96:99]
    ds_read_b128 a[148:151], v9 offset:61440
    v_cvt_pk_bf16_f32 v250, v108, v109
    v_mfma_f32_16x16x32_bf16 v[100:103], a[140:143], a[220:223], v[84:87]
    v_exp_f32 v110, v110
    v_mfma_f32_16x16x32_bf16 v[100:103], a[136:139], a[216:219], v[100:103]
    ds_read_b128 a[152:155], v10 offset:61440
    v_mfma_f32_16x16x32_bf16 v[100:103], a[132:135], a[212:215], v[100:103]
    v_exp_f32 v111, v111
    v_mfma_f32_16x16x32_bf16 v[100:103], a[128:131], a[208:211], v[100:103]
    ds_read_b128 a[156:159], v11 offset:61440
    v_cvt_pk_bf16_f32 v251, v110, v111
    v_mfma_f32_16x16x32_bf16 v[104:107], a[128:131], a[224:227], v[88:91]
    v_exp_f32 v96, v96
    v_mfma_f32_16x16x32_bf16 v[104:107], a[132:135], a[228:231], v[104:107]
    ds_read_b64_tr_b16 a[176:177], v19 offset:0
    v_mfma_f32_16x16x32_bf16 v[104:107], a[136:139], a[232:235], v[104:107]
    v_exp_f32 v97, v97
    v_mfma_f32_16x16x32_bf16 v[104:107], a[140:143], a[236:239], v[104:107]
    ds_read_b64_tr_b16 a[178:179], v19 offset:4096
    v_cvt_pk_bf16_f32 v204, v96, v97
    v_mfma_f32_16x16x32_bf16 v[108:111], a[140:143], a[252:255], v[92:95]
    v_exp_f32 v98, v98
    v_mfma_f32_16x16x32_bf16 v[108:111], a[136:139], a[248:251], v[108:111]
    ds_read_b64_tr_b16 a[180:181], v19 offset:8192
    v_mfma_f32_16x16x32_bf16 v[108:111], a[132:135], a[244:247], v[108:111]
    v_exp_f32 v99, v99
    v_mfma_f32_16x16x32_bf16 v[108:111], a[128:131], a[240:243], v[108:111]
    ds_read_b64_tr_b16 a[182:183], v19 offset:12288
    v_cvt_pk_bf16_f32 v205, v98, v99
    v_mfma_f32_16x16x32_bf16 a[96:99], a[160:163], v[128:131], a[96:99]
    v_exp_f32 v100, v100
    v_mfma_f32_16x16x32_bf16 a[96:99], a[164:167], v[132:135], a[96:99]
    ds_read_b64_tr_b16 a[184:185], v19 offset:16384
    v_mfma_f32_16x16x32_bf16 a[96:99], a[168:171], v[136:139], a[96:99]
    v_exp_f32 v101, v101
    v_mfma_f32_16x16x32_bf16 a[96:99], a[172:175], v[140:143], a[96:99]
    ds_read_b64_tr_b16 a[186:187], v19 offset:20480
    v_cvt_pk_bf16_f32 v220, v100, v101
    v_mfma_f32_16x16x32_bf16 a[100:103], a[172:175], v[156:159], a[100:103]
    v_exp_f32 v102, v102
    v_mfma_f32_16x16x32_bf16 a[100:103], a[168:171], v[152:155], a[100:103]
    ds_read_b64_tr_b16 a[188:189], v19 offset:24576
    v_mfma_f32_16x16x32_bf16 a[100:103], a[164:167], v[148:151], a[100:103]
    v_exp_f32 v103, v103
    v_mfma_f32_16x16x32_bf16 a[100:103], a[160:163], v[144:147], a[100:103]
    ds_read_b64_tr_b16 a[190:191], v19 offset:28672
    v_cvt_pk_bf16_f32 v221, v102, v103
    v_mfma_f32_16x16x32_bf16 a[104:107], a[160:163], v[160:163], a[104:107]
    v_exp_f32 v104, v104
    v_mfma_f32_16x16x32_bf16 a[104:107], a[164:167], v[164:167], a[104:107]
    v_mfma_f32_16x16x32_bf16 a[104:107], a[168:171], v[168:171], a[104:107]
    v_exp_f32 v105, v105
    v_mfma_f32_16x16x32_bf16 a[104:107], a[172:175], v[172:175], a[104:107]
    v_cvt_pk_bf16_f32 v236, v104, v105
    v_mfma_f32_16x16x32_bf16 a[108:111], a[172:175], v[188:191], a[108:111]
    v_exp_f32 v106, v106
    v_mfma_f32_16x16x32_bf16 a[108:111], a[168:171], v[184:187], a[108:111]
    v_mfma_f32_16x16x32_bf16 a[108:111], a[164:167], v[180:183], a[108:111]
    v_exp_f32 v107, v107
    v_mfma_f32_16x16x32_bf16 a[108:111], a[160:163], v[176:179], a[108:111]
    v_cvt_pk_bf16_f32 v237, v106, v107
    v_smfmac_f32_16x16x64_bf16 v[76:79], v[60:63], v[176:183], v56
    s_waitcnt vmcnt(0) lgkmcnt(0)
    s_barrier
    v_mfma_f32_16x16x32_bf16 v[96:99], a[144:147], a[192:195], v[80:83]
    v_exp_f32 v108, v108
    v_mfma_f32_16x16x32_bf16 v[96:99], a[148:151], a[196:199], v[96:99]
    ds_read_b128 a[128:131], v8 offset:0
    s_add_u32 m0, s50, 98304
    v_mfma_f32_16x16x32_bf16 v[96:99], a[152:155], a[200:203], v[96:99]
    v_exp_f32 v109, v109
    v_mfma_f32_16x16x32_bf16 v[96:99], a[156:159], a[204:207], v[96:99]
    ds_read_b128 a[132:135], v9 offset:0
    v_cvt_pk_bf16_f32 v252, v108, v109
    v_mfma_f32_16x16x32_bf16 v[100:103], a[156:159], a[220:223], v[84:87]
    v_exp_f32 v110, v110
    v_mfma_f32_16x16x32_bf16 v[100:103], a[152:155], a[216:219], v[100:103]
    buffer_load_dwordx4 v6, s[28:31], s37 offen offset:0 lds
    v_mfma_f32_16x16x32_bf16 v[100:103], a[148:151], a[212:215], v[100:103]
    v_exp_f32 v111, v111
    v_mfma_f32_16x16x32_bf16 v[100:103], a[144:147], a[208:211], v[100:103]
    ds_read_b128 a[136:139], v10 offset:0
    v_cvt_pk_bf16_f32 v253, v110, v111
    v_mfma_f32_16x16x32_bf16 v[104:107], a[144:147], a[224:227], v[88:91]
    v_exp_f32 v96, v96
    v_mfma_f32_16x16x32_bf16 v[104:107], a[148:151], a[228:231], v[104:107]
    ds_read_b128 a[140:143], v11 offset:0
    v_mfma_f32_16x16x32_bf16 v[104:107], a[152:155], a[232:235], v[104:107]
    v_exp_f32 v97, v97
    v_mfma_f32_16x16x32_bf16 v[104:107], a[156:159], a[236:239], v[104:107]
    ds_read_b64_tr_b16 a[160:161], v12 offset:32768
    v_cvt_pk_bf16_f32 v206, v96, v97
    v_mfma_f32_16x16x32_bf16 v[108:111], a[156:159], a[252:255], v[92:95]
    v_exp_f32 v98, v98
    v_mfma_f32_16x16x32_bf16 v[108:111], a[152:155], a[248:251], v[108:111]
    buffer_load_dword v26, v24, s[68:71], s72 offen
    v_mfma_f32_16x16x32_bf16 v[108:111], a[148:151], a[244:247], v[108:111]
    v_exp_f32 v99, v99
    v_mfma_f32_16x16x32_bf16 v[108:111], a[144:147], a[240:243], v[108:111]
    ds_read_b64_tr_b16 a[162:163], v12 offset:36864
    v_cvt_pk_bf16_f32 v207, v98, v99
    v_mfma_f32_16x16x32_bf16 a[112:115], a[176:179], v[128:131], a[112:115]
    v_exp_f32 v100, v100
    v_mfma_f32_16x16x32_bf16 a[112:115], a[180:183], v[132:135], a[112:115]
    ds_read_b64_tr_b16 a[164:165], v12 offset:40960
    v_mfma_f32_16x16x32_bf16 a[112:115], a[184:187], v[136:139], a[112:115]
    v_exp_f32 v101, v101
    v_mfma_f32_16x16x32_bf16 a[112:115], a[188:191], v[140:143], a[112:115]
    ds_read_b64_tr_b16 a[166:167], v12 offset:45056
    v_cvt_pk_bf16_f32 v222, v100, v101
    v_mfma_f32_16x16x32_bf16 a[116:119], a[188:191], v[156:159], a[116:119]
    v_exp_f32 v102, v102
    v_mfma_f32_16x16x32_bf16 a[116:119], a[184:187], v[152:155], a[116:119]
    buffer_load_dwordx4 v7, s[28:31], s37 offen offset:1024 lds
    v_mfma_f32_16x16x32_bf16 a[116:119], a[180:183], v[148:151], a[116:119]
    v_exp_f32 v103, v103
    v_mfma_f32_16x16x32_bf16 a[116:119], a[176:179], v[144:147], a[116:119]
    ds_read_b64_tr_b16 a[168:169], v12 offset:49152
    v_cvt_pk_bf16_f32 v223, v102, v103
    v_mfma_f32_16x16x32_bf16 a[120:123], a[176:179], v[160:163], a[120:123]
    v_exp_f32 v104, v104
    v_mfma_f32_16x16x32_bf16 a[120:123], a[180:183], v[164:167], a[120:123]
    ds_read_b64_tr_b16 a[170:171], v12 offset:53248
    v_mfma_f32_16x16x32_bf16 a[120:123], a[184:187], v[168:171], a[120:123]
    v_exp_f32 v105, v105
    v_mfma_f32_16x16x32_bf16 a[120:123], a[188:191], v[172:175], a[120:123]
    ds_read_b64_tr_b16 a[172:173], v12 offset:57344
    v_cvt_pk_bf16_f32 v238, v104, v105
    v_mfma_f32_16x16x32_bf16 a[124:127], a[188:191], v[188:191], a[124:127]
    v_exp_f32 v106, v106
    v_mfma_f32_16x16x32_bf16 a[124:127], a[184:187], v[184:187], a[124:127]
    buffer_load_dwordx4 v6, s[28:31], s37 offen offset:2048 lds
    v_mfma_f32_16x16x32_bf16 a[124:127], a[180:183], v[180:183], a[124:127]
    v_exp_f32 v107, v107
    v_mfma_f32_16x16x32_bf16 a[124:127], a[176:179], v[176:179], a[124:127]
    ds_read_b64_tr_b16 a[174:175], v12 offset:61440
    v_cvt_pk_bf16_f32 v239, v106, v107
    v_smfmac_f32_16x16x64_bf16 v[76:79], v[60:63], v[184:191], v56
    s_waitcnt lgkmcnt(8)
    v_mfma_f32_16x16x32_bf16 v[96:99], a[128:131], a[192:195], v[80:83]
    v_exp_f32 v108, v108
    v_mfma_f32_16x16x32_bf16 v[96:99], a[132:135], a[196:199], v[96:99]
    ds_read_b128 a[144:147], v8 offset:4096
    v_mfma_f32_16x16x32_bf16 v[96:99], a[136:139], a[200:203], v[96:99]
    v_exp_f32 v109, v109
    v_mfma_f32_16x16x32_bf16 v[96:99], a[140:143], a[204:207], v[96:99]
    ds_read_b128 a[148:151], v9 offset:4096
    v_cvt_pk_bf16_f32 v254, v108, v109
    v_mfma_f32_16x16x32_bf16 v[100:103], a[140:143], a[220:223], v[84:87]
    v_exp_f32 v110, v110
    v_mfma_f32_16x16x32_bf16 v[100:103], a[136:139], a[216:219], v[100:103]
    buffer_load_dwordx4 v7, s[28:31], s37 offen offset:3072 lds
    s_add_u32 s37, s37, 4096
    v_mfma_f32_16x16x32_bf16 v[100:103], a[132:135], a[212:215], v[100:103]
    v_exp_f32 v111, v111
    v_mfma_f32_16x16x32_bf16 v[100:103], a[128:131], a[208:211], v[100:103]
    ds_read_b128 a[152:155], v10 offset:4096
    v_cvt_pk_bf16_f32 v255, v110, v111
    v_mfma_f32_16x16x32_bf16 v[104:107], a[128:131], a[224:227], v[88:91]
    v_exp_f32 v96, v96
    v_mfma_f32_16x16x32_bf16 v[104:107], a[132:135], a[228:231], v[104:107]
    ds_read_b128 a[156:159], v11 offset:4096
    s_waitcnt lgkmcnt(4)
    v_mfma_f32_16x16x32_bf16 v[104:107], a[136:139], a[232:235], v[104:107]
    v_exp_f32 v97, v97
    v_mfma_f32_16x16x32_bf16 v[104:107], a[140:143], a[236:239], v[104:107]
    ds_read_b64_tr_b16 a[176:177], v13 offset:32768
    v_cvt_pk_bf16_f32 v128, v96, v97
    v_mfma_f32_16x16x32_bf16 v[108:111], a[140:143], a[252:255], v[92:95]
    v_exp_f32 v98, v98
    v_mfma_f32_16x16x32_bf16 v[108:111], a[136:139], a[248:251], v[108:111]
    v_mfma_f32_16x16x32_bf16 v[108:111], a[132:135], a[244:247], v[108:111]
    v_exp_f32 v99, v99
    v_mfma_f32_16x16x32_bf16 v[108:111], a[128:131], a[240:243], v[108:111]
    ds_read_b64_tr_b16 a[178:179], v13 offset:36864
    v_cvt_pk_bf16_f32 v129, v98, v99
    v_mfma_f32_16x16x32_bf16 a[0:3], a[160:163], v[192:195], a[0:3]
    v_exp_f32 v100, v100
    v_mfma_f32_16x16x32_bf16 a[0:3], a[164:167], v[196:199], a[0:3]
    ds_read_b64_tr_b16 a[180:181], v13 offset:40960
    s_add_u32 m0, s50, 102400
    v_mfma_f32_16x16x32_bf16 a[0:3], a[168:171], v[200:203], a[0:3]
    v_exp_f32 v101, v101
    v_mfma_f32_16x16x32_bf16 a[0:3], a[172:175], v[204:207], a[0:3]
    ds_read_b64_tr_b16 a[182:183], v13 offset:45056
    v_cvt_pk_bf16_f32 v144, v100, v101
    v_mfma_f32_16x16x32_bf16 a[4:7], a[172:175], v[220:223], a[4:7]
    v_exp_f32 v102, v102
    v_mfma_f32_16x16x32_bf16 a[4:7], a[168:171], v[216:219], a[4:7]
    buffer_load_dwordx4 v6, s[28:31], s37 offen offset:0 lds
    v_mfma_f32_16x16x32_bf16 a[4:7], a[164:167], v[212:215], a[4:7]
    v_exp_f32 v103, v103
    v_mfma_f32_16x16x32_bf16 a[4:7], a[160:163], v[208:211], a[4:7]
    ds_read_b64_tr_b16 a[184:185], v13 offset:49152
    v_cvt_pk_bf16_f32 v145, v102, v103
    v_mfma_f32_16x16x32_bf16 a[8:11], a[160:163], v[224:227], a[8:11]
    v_exp_f32 v104, v104
    v_mfma_f32_16x16x32_bf16 a[8:11], a[164:167], v[228:231], a[8:11]
    ds_read_b64_tr_b16 a[186:187], v13 offset:53248
    v_mfma_f32_16x16x32_bf16 a[8:11], a[168:171], v[232:235], a[8:11]
    v_exp_f32 v105, v105
    v_mfma_f32_16x16x32_bf16 a[8:11], a[172:175], v[236:239], a[8:11]
    ds_read_b64_tr_b16 a[188:189], v13 offset:57344
    v_cvt_pk_bf16_f32 v160, v104, v105
    v_mfma_f32_16x16x32_bf16 a[12:15], a[172:175], v[252:255], a[12:15]
    v_exp_f32 v106, v106
    v_mfma_f32_16x16x32_bf16 a[12:15], a[168:171], v[248:251], a[12:15]
    buffer_load_dwordx4 v7, s[28:31], s37 offen offset:1024 lds
    v_mfma_f32_16x16x32_bf16 a[12:15], a[164:167], v[244:247], a[12:15]
    v_exp_f32 v107, v107
    v_mfma_f32_16x16x32_bf16 a[12:15], a[160:163], v[240:243], a[12:15]
    ds_read_b64_tr_b16 a[190:191], v13 offset:61440
    v_cvt_pk_bf16_f32 v161, v106, v107
    v_smfmac_f32_16x16x64_bf16 v[64:67], v[60:63], v[192:199], v56
    s_waitcnt lgkmcnt(8)
    v_mfma_f32_16x16x32_bf16 v[96:99], a[144:147], a[192:195], v[80:83]
    v_exp_f32 v108, v108
    v_mfma_f32_16x16x32_bf16 v[96:99], a[148:151], a[196:199], v[96:99]
    ds_read_b128 a[128:131], v8 offset:8192
    v_mfma_f32_16x16x32_bf16 v[96:99], a[152:155], a[200:203], v[96:99]
    v_exp_f32 v109, v109
    v_mfma_f32_16x16x32_bf16 v[96:99], a[156:159], a[204:207], v[96:99]
    ds_read_b128 a[132:135], v9 offset:8192
    v_cvt_pk_bf16_f32 v176, v108, v109
    v_mfma_f32_16x16x32_bf16 v[100:103], a[156:159], a[220:223], v[84:87]
    v_exp_f32 v110, v110
    v_mfma_f32_16x16x32_bf16 v[100:103], a[152:155], a[216:219], v[100:103]
    buffer_load_dwordx4 v6, s[28:31], s37 offen offset:2048 lds
    v_mfma_f32_16x16x32_bf16 v[100:103], a[148:151], a[212:215], v[100:103]
    v_exp_f32 v111, v111
    v_mfma_f32_16x16x32_bf16 v[100:103], a[144:147], a[208:211], v[100:103]
    ds_read_b128 a[136:139], v10 offset:8192
    v_cvt_pk_bf16_f32 v177, v110, v111
    v_mfma_f32_16x16x32_bf16 v[104:107], a[144:147], a[224:227], v[88:91]
    v_exp_f32 v96, v96
    v_mfma_f32_16x16x32_bf16 v[104:107], a[148:151], a[228:231], v[104:107]
    ds_read_b128 a[140:143], v11 offset:8192
    s_waitcnt lgkmcnt(4)
    v_mfma_f32_16x16x32_bf16 v[104:107], a[152:155], a[232:235], v[104:107]
    v_exp_f32 v97, v97
    v_mfma_f32_16x16x32_bf16 v[104:107], a[156:159], a[236:239], v[104:107]
    ds_read_b64_tr_b16 a[160:161], v14 offset:32768
    v_cvt_pk_bf16_f32 v130, v96, v97
    v_mfma_f32_16x16x32_bf16 v[108:111], a[156:159], a[252:255], v[92:95]
    v_exp_f32 v98, v98
    v_mfma_f32_16x16x32_bf16 v[108:111], a[152:155], a[248:251], v[108:111]
    buffer_load_dword v27, v54, s[28:31], s49 offen
    v_mfma_f32_16x16x32_bf16 v[108:111], a[148:151], a[244:247], v[108:111]
    v_exp_f32 v99, v99
    v_mfma_f32_16x16x32_bf16 v[108:111], a[144:147], a[240:243], v[108:111]
    ds_read_b64_tr_b16 a[162:163], v14 offset:36864
    v_cvt_pk_bf16_f32 v131, v98, v99
    v_mfma_f32_16x16x32_bf16 a[16:19], a[176:179], v[192:195], a[16:19]
    v_exp_f32 v100, v100
    v_mfma_f32_16x16x32_bf16 a[16:19], a[180:183], v[196:199], a[16:19]
    ds_read_b64_tr_b16 a[164:165], v14 offset:40960
    v_mfma_f32_16x16x32_bf16 a[16:19], a[184:187], v[200:203], a[16:19]
    v_exp_f32 v101, v101
    v_mfma_f32_16x16x32_bf16 a[16:19], a[188:191], v[204:207], a[16:19]
    ds_read_b64_tr_b16 a[166:167], v14 offset:45056
    v_cvt_pk_bf16_f32 v146, v100, v101
    v_mfma_f32_16x16x32_bf16 a[20:23], a[188:191], v[220:223], a[20:23]
    v_exp_f32 v102, v102
    v_mfma_f32_16x16x32_bf16 a[20:23], a[184:187], v[216:219], a[20:23]
    buffer_load_dwordx4 v7, s[28:31], s37 offen offset:3072 lds
    s_add_u32 s37, s37, 28672
    v_mfma_f32_16x16x32_bf16 a[20:23], a[180:183], v[212:215], a[20:23]
    v_exp_f32 v103, v103
    v_mfma_f32_16x16x32_bf16 a[20:23], a[176:179], v[208:211], a[20:23]
    ds_read_b64_tr_b16 a[168:169], v14 offset:49152
    v_cvt_pk_bf16_f32 v147, v102, v103
    v_mfma_f32_16x16x32_bf16 a[24:27], a[176:179], v[224:227], a[24:27]
    v_exp_f32 v104, v104
    v_mfma_f32_16x16x32_bf16 a[24:27], a[180:183], v[228:231], a[24:27]
    ds_read_b64_tr_b16 a[170:171], v14 offset:53248
    s_add_u32 m0, s50, 65536
    v_mfma_f32_16x16x32_bf16 a[24:27], a[184:187], v[232:235], a[24:27]
    v_exp_f32 v105, v105
    v_mfma_f32_16x16x32_bf16 a[24:27], a[188:191], v[236:239], a[24:27]
    ds_read_b64_tr_b16 a[172:173], v14 offset:57344
    v_cvt_pk_bf16_f32 v162, v104, v105
    v_mfma_f32_16x16x32_bf16 a[28:31], a[188:191], v[252:255], a[28:31]
    v_exp_f32 v106, v106
    v_mfma_f32_16x16x32_bf16 a[28:31], a[184:187], v[248:251], a[28:31]
    buffer_load_dwordx4 v2, s[24:27], s36 offen offset:0 lds
    v_mfma_f32_16x16x32_bf16 a[28:31], a[180:183], v[244:247], a[28:31]
    v_exp_f32 v107, v107
    v_mfma_f32_16x16x32_bf16 a[28:31], a[176:179], v[240:243], a[28:31]
    ds_read_b64_tr_b16 a[174:175], v14 offset:61440
    v_cvt_pk_bf16_f32 v163, v106, v107
    v_smfmac_f32_16x16x64_bf16 v[64:67], v[60:63], v[200:207], v56
    s_add_u32 s49, s49, 65536
    s_waitcnt lgkmcnt(8)
    v_mfma_f32_16x16x32_bf16 v[96:99], a[128:131], a[192:195], v[80:83]
    v_exp_f32 v108, v108
    v_mfma_f32_16x16x32_bf16 v[96:99], a[132:135], a[196:199], v[96:99]
    ds_read_b128 a[144:147], v8 offset:12288
    v_mfma_f32_16x16x32_bf16 v[96:99], a[136:139], a[200:203], v[96:99]
    v_exp_f32 v109, v109
    v_mfma_f32_16x16x32_bf16 v[96:99], a[140:143], a[204:207], v[96:99]
    ds_read_b128 a[148:151], v9 offset:12288
    v_cvt_pk_bf16_f32 v178, v108, v109
    v_mfma_f32_16x16x32_bf16 v[100:103], a[140:143], a[220:223], v[84:87]
    v_exp_f32 v110, v110
    v_mfma_f32_16x16x32_bf16 v[100:103], a[136:139], a[216:219], v[100:103]
    buffer_load_dwordx4 v3, s[24:27], s36 offen offset:1024 lds
    v_mfma_f32_16x16x32_bf16 v[100:103], a[132:135], a[212:215], v[100:103]
    v_exp_f32 v111, v111
    v_mfma_f32_16x16x32_bf16 v[100:103], a[128:131], a[208:211], v[100:103]
    ds_read_b128 a[152:155], v10 offset:12288
    v_cvt_pk_bf16_f32 v179, v110, v111
    v_mfma_f32_16x16x32_bf16 v[104:107], a[128:131], a[224:227], v[88:91]
    v_exp_f32 v96, v96
    v_mfma_f32_16x16x32_bf16 v[104:107], a[132:135], a[228:231], v[104:107]
    ds_read_b128 a[156:159], v11 offset:12288
    s_waitcnt lgkmcnt(4)
    v_mfma_f32_16x16x32_bf16 v[104:107], a[136:139], a[232:235], v[104:107]
    v_exp_f32 v97, v97
    v_mfma_f32_16x16x32_bf16 v[104:107], a[140:143], a[236:239], v[104:107]
    ds_read_b64_tr_b16 a[176:177], v15 offset:32768
    v_cvt_pk_bf16_f32 v132, v96, v97
    v_mfma_f32_16x16x32_bf16 v[108:111], a[140:143], a[252:255], v[92:95]
    v_exp_f32 v98, v98
    v_mfma_f32_16x16x32_bf16 v[108:111], a[136:139], a[248:251], v[108:111]
    v_mfma_f32_16x16x32_bf16 v[108:111], a[132:135], a[244:247], v[108:111]
    v_exp_f32 v99, v99
    v_mfma_f32_16x16x32_bf16 v[108:111], a[128:131], a[240:243], v[108:111]
    ds_read_b64_tr_b16 a[178:179], v15 offset:36864
    v_cvt_pk_bf16_f32 v133, v98, v99
    v_mfma_f32_16x16x32_bf16 a[32:35], a[160:163], v[192:195], a[32:35]
    v_exp_f32 v100, v100
    v_mfma_f32_16x16x32_bf16 a[32:35], a[164:167], v[196:199], a[32:35]
    ds_read_b64_tr_b16 a[180:181], v15 offset:40960
    v_mfma_f32_16x16x32_bf16 a[32:35], a[168:171], v[200:203], a[32:35]
    v_exp_f32 v101, v101
    v_mfma_f32_16x16x32_bf16 a[32:35], a[172:175], v[204:207], a[32:35]
    ds_read_b64_tr_b16 a[182:183], v15 offset:45056
    v_cvt_pk_bf16_f32 v148, v100, v101
    v_mfma_f32_16x16x32_bf16 a[36:39], a[172:175], v[220:223], a[36:39]
    v_exp_f32 v102, v102
    v_mfma_f32_16x16x32_bf16 a[36:39], a[168:171], v[216:219], a[36:39]
    buffer_load_dwordx4 v4, s[24:27], s36 offen offset:2048 lds
    v_mfma_f32_16x16x32_bf16 a[36:39], a[164:167], v[212:215], a[36:39]
    v_exp_f32 v103, v103
    v_mfma_f32_16x16x32_bf16 a[36:39], a[160:163], v[208:211], a[36:39]
    ds_read_b64_tr_b16 a[184:185], v15 offset:49152
    v_cvt_pk_bf16_f32 v149, v102, v103
    v_mfma_f32_16x16x32_bf16 a[40:43], a[160:163], v[224:227], a[40:43]
    v_exp_f32 v104, v104
    v_mfma_f32_16x16x32_bf16 a[40:43], a[164:167], v[228:231], a[40:43]
    ds_read_b64_tr_b16 a[186:187], v15 offset:53248
    v_mfma_f32_16x16x32_bf16 a[40:43], a[168:171], v[232:235], a[40:43]
    v_exp_f32 v105, v105
    v_mfma_f32_16x16x32_bf16 a[40:43], a[172:175], v[236:239], a[40:43]
    ds_read_b64_tr_b16 a[188:189], v15 offset:57344
    v_cvt_pk_bf16_f32 v164, v104, v105
    v_mfma_f32_16x16x32_bf16 a[44:47], a[172:175], v[252:255], a[44:47]
    v_exp_f32 v106, v106
    v_mfma_f32_16x16x32_bf16 a[44:47], a[168:171], v[248:251], a[44:47]
    buffer_load_dwordx4 v5, s[24:27], s36 offen offset:3072 lds
    s_add_u32 s36, s36, 4096
    v_mfma_f32_16x16x32_bf16 a[44:47], a[164:167], v[244:247], a[44:47]
    v_exp_f32 v107, v107
    v_mfma_f32_16x16x32_bf16 a[44:47], a[160:163], v[240:243], a[44:47]
    ds_read_b64_tr_b16 a[190:191], v15 offset:61440
    v_cvt_pk_bf16_f32 v165, v106, v107
    v_smfmac_f32_16x16x64_bf16 v[68:71], v[60:63], v[208:215], v56
    s_waitcnt lgkmcnt(8)
    v_mfma_f32_16x16x32_bf16 v[96:99], a[144:147], a[192:195], v[80:83]
    v_exp_f32 v108, v108
    v_mfma_f32_16x16x32_bf16 v[96:99], a[148:151], a[196:199], v[96:99]
    ds_read_b128 a[128:131], v8 offset:16384
    s_add_u32 m0, s50, 69632
    v_mfma_f32_16x16x32_bf16 v[96:99], a[152:155], a[200:203], v[96:99]
    v_exp_f32 v109, v109
    v_mfma_f32_16x16x32_bf16 v[96:99], a[156:159], a[204:207], v[96:99]
    ds_read_b128 a[132:135], v9 offset:16384
    v_cvt_pk_bf16_f32 v180, v108, v109
    v_mfma_f32_16x16x32_bf16 v[100:103], a[156:159], a[220:223], v[84:87]
    v_exp_f32 v110, v110
    v_mfma_f32_16x16x32_bf16 v[100:103], a[152:155], a[216:219], v[100:103]
    buffer_load_dwordx4 v2, s[24:27], s36 offen offset:0 lds
    v_mfma_f32_16x16x32_bf16 v[100:103], a[148:151], a[212:215], v[100:103]
    v_exp_f32 v111, v111
    v_mfma_f32_16x16x32_bf16 v[100:103], a[144:147], a[208:211], v[100:103]
    ds_read_b128 a[136:139], v10 offset:16384
    v_cvt_pk_bf16_f32 v181, v110, v111
    v_mfma_f32_16x16x32_bf16 v[104:107], a[144:147], a[224:227], v[88:91]
    v_exp_f32 v96, v96
    v_mfma_f32_16x16x32_bf16 v[104:107], a[148:151], a[228:231], v[104:107]
    ds_read_b128 a[140:143], v11 offset:16384
    s_waitcnt lgkmcnt(4)
    v_mfma_f32_16x16x32_bf16 v[104:107], a[152:155], a[232:235], v[104:107]
    v_exp_f32 v97, v97
    v_mfma_f32_16x16x32_bf16 v[104:107], a[156:159], a[236:239], v[104:107]
    ds_read_b64_tr_b16 a[160:161], v16 offset:32768
    v_cvt_pk_bf16_f32 v134, v96, v97
    v_mfma_f32_16x16x32_bf16 v[108:111], a[156:159], a[252:255], v[92:95]
    v_exp_f32 v98, v98
    v_mfma_f32_16x16x32_bf16 v[108:111], a[152:155], a[248:251], v[108:111]
    v_mfma_f32_16x16x32_bf16 v[108:111], a[148:151], a[244:247], v[108:111]
    v_exp_f32 v99, v99
    v_mfma_f32_16x16x32_bf16 v[108:111], a[144:147], a[240:243], v[108:111]
    ds_read_b64_tr_b16 a[162:163], v16 offset:36864
    v_cvt_pk_bf16_f32 v135, v98, v99
    v_mfma_f32_16x16x32_bf16 a[48:51], a[176:179], v[192:195], a[48:51]
    v_exp_f32 v100, v100
    v_mfma_f32_16x16x32_bf16 a[48:51], a[180:183], v[196:199], a[48:51]
    ds_read_b64_tr_b16 a[164:165], v16 offset:40960
    v_mfma_f32_16x16x32_bf16 a[48:51], a[184:187], v[200:203], a[48:51]
    v_exp_f32 v101, v101
    v_mfma_f32_16x16x32_bf16 a[48:51], a[188:191], v[204:207], a[48:51]
    ds_read_b64_tr_b16 a[166:167], v16 offset:45056
    v_cvt_pk_bf16_f32 v150, v100, v101
    v_mfma_f32_16x16x32_bf16 a[52:55], a[188:191], v[220:223], a[52:55]
    v_exp_f32 v102, v102
    v_mfma_f32_16x16x32_bf16 a[52:55], a[184:187], v[216:219], a[52:55]
    buffer_load_dwordx4 v3, s[24:27], s36 offen offset:1024 lds
    v_mfma_f32_16x16x32_bf16 a[52:55], a[180:183], v[212:215], a[52:55]
    v_exp_f32 v103, v103
    v_mfma_f32_16x16x32_bf16 a[52:55], a[176:179], v[208:211], a[52:55]
    ds_read_b64_tr_b16 a[168:169], v16 offset:49152
    v_cvt_pk_bf16_f32 v151, v102, v103
    v_mfma_f32_16x16x32_bf16 a[56:59], a[176:179], v[224:227], a[56:59]
    v_exp_f32 v104, v104
    v_mfma_f32_16x16x32_bf16 a[56:59], a[180:183], v[228:231], a[56:59]
    ds_read_b64_tr_b16 a[170:171], v16 offset:53248
    v_mfma_f32_16x16x32_bf16 a[56:59], a[184:187], v[232:235], a[56:59]
    v_exp_f32 v105, v105
    v_mfma_f32_16x16x32_bf16 a[56:59], a[188:191], v[236:239], a[56:59]
    ds_read_b64_tr_b16 a[172:173], v16 offset:57344
    v_cvt_pk_bf16_f32 v166, v104, v105
    v_mfma_f32_16x16x32_bf16 a[60:63], a[188:191], v[252:255], a[60:63]
    v_exp_f32 v106, v106
    v_mfma_f32_16x16x32_bf16 a[60:63], a[184:187], v[248:251], a[60:63]
    buffer_load_dwordx4 v4, s[24:27], s36 offen offset:2048 lds
    v_mfma_f32_16x16x32_bf16 a[60:63], a[180:183], v[244:247], a[60:63]
    v_exp_f32 v107, v107
    v_mfma_f32_16x16x32_bf16 a[60:63], a[176:179], v[240:243], a[60:63]
    ds_read_b64_tr_b16 a[174:175], v16 offset:61440
    v_cvt_pk_bf16_f32 v167, v106, v107
    v_smfmac_f32_16x16x64_bf16 v[68:71], v[60:63], v[216:223], v56
    s_waitcnt lgkmcnt(8)
    v_mfma_f32_16x16x32_bf16 v[96:99], a[128:131], a[192:195], v[80:83]
    v_exp_f32 v108, v108
    v_mfma_f32_16x16x32_bf16 v[96:99], a[132:135], a[196:199], v[96:99]
    ds_read_b128 a[144:147], v8 offset:20480
    v_mfma_f32_16x16x32_bf16 v[96:99], a[136:139], a[200:203], v[96:99]
    v_exp_f32 v109, v109
    v_mfma_f32_16x16x32_bf16 v[96:99], a[140:143], a[204:207], v[96:99]
    ds_read_b128 a[148:151], v9 offset:20480
    v_cvt_pk_bf16_f32 v182, v108, v109
    v_mfma_f32_16x16x32_bf16 v[100:103], a[140:143], a[220:223], v[84:87]
    v_exp_f32 v110, v110
    v_mfma_f32_16x16x32_bf16 v[100:103], a[136:139], a[216:219], v[100:103]
    buffer_load_dwordx4 v5, s[24:27], s36 offen offset:3072 lds
    s_add_u32 s36, s36, 28672
    v_mfma_f32_16x16x32_bf16 v[100:103], a[132:135], a[212:215], v[100:103]
    v_exp_f32 v111, v111
    v_mfma_f32_16x16x32_bf16 v[100:103], a[128:131], a[208:211], v[100:103]
    ds_read_b128 a[152:155], v10 offset:20480
    v_cvt_pk_bf16_f32 v183, v110, v111
    v_mfma_f32_16x16x32_bf16 v[104:107], a[128:131], a[224:227], v[88:91]
    v_exp_f32 v96, v96
    v_mfma_f32_16x16x32_bf16 v[104:107], a[132:135], a[228:231], v[104:107]
    ds_read_b128 a[156:159], v11 offset:20480
    s_waitcnt lgkmcnt(4)
    v_mfma_f32_16x16x32_bf16 v[104:107], a[136:139], a[232:235], v[104:107]
    v_exp_f32 v97, v97
    v_mfma_f32_16x16x32_bf16 v[104:107], a[140:143], a[236:239], v[104:107]
    ds_read_b64_tr_b16 a[176:177], v17 offset:32768
    v_cvt_pk_bf16_f32 v136, v96, v97
    v_mfma_f32_16x16x32_bf16 v[108:111], a[140:143], a[252:255], v[92:95]
    v_exp_f32 v98, v98
    v_mfma_f32_16x16x32_bf16 v[108:111], a[136:139], a[248:251], v[108:111]
    v_mfma_f32_16x16x32_bf16 v[108:111], a[132:135], a[244:247], v[108:111]
    v_exp_f32 v99, v99
    v_mfma_f32_16x16x32_bf16 v[108:111], a[128:131], a[240:243], v[108:111]
    ds_read_b64_tr_b16 a[178:179], v17 offset:36864
    v_cvt_pk_bf16_f32 v137, v98, v99
    v_mfma_f32_16x16x32_bf16 a[64:67], a[160:163], v[192:195], a[64:67]
    v_exp_f32 v100, v100
    v_mfma_f32_16x16x32_bf16 a[64:67], a[164:167], v[196:199], a[64:67]
    ds_read_b64_tr_b16 a[180:181], v17 offset:40960
    v_mfma_f32_16x16x32_bf16 a[64:67], a[168:171], v[200:203], a[64:67]
    v_exp_f32 v101, v101
    v_mfma_f32_16x16x32_bf16 a[64:67], a[172:175], v[204:207], a[64:67]
    ds_read_b64_tr_b16 a[182:183], v17 offset:45056
    v_cvt_pk_bf16_f32 v152, v100, v101
    v_mfma_f32_16x16x32_bf16 a[68:71], a[172:175], v[220:223], a[68:71]
    v_exp_f32 v102, v102
    v_mfma_f32_16x16x32_bf16 a[68:71], a[168:171], v[216:219], a[68:71]
    v_mfma_f32_16x16x32_bf16 a[68:71], a[164:167], v[212:215], a[68:71]
    v_exp_f32 v103, v103
    v_mfma_f32_16x16x32_bf16 a[68:71], a[160:163], v[208:211], a[68:71]
    ds_read_b64_tr_b16 a[184:185], v17 offset:49152
    v_cvt_pk_bf16_f32 v153, v102, v103
    v_mfma_f32_16x16x32_bf16 a[72:75], a[160:163], v[224:227], a[72:75]
    v_exp_f32 v104, v104
    v_mfma_f32_16x16x32_bf16 a[72:75], a[164:167], v[228:231], a[72:75]
    ds_read_b64_tr_b16 a[186:187], v17 offset:53248
    v_mfma_f32_16x16x32_bf16 a[72:75], a[168:171], v[232:235], a[72:75]
    v_exp_f32 v105, v105
    v_mfma_f32_16x16x32_bf16 a[72:75], a[172:175], v[236:239], a[72:75]
    ds_read_b64_tr_b16 a[188:189], v17 offset:57344
    v_cvt_pk_bf16_f32 v168, v104, v105
    v_mfma_f32_16x16x32_bf16 a[76:79], a[172:175], v[252:255], a[76:79]
    v_exp_f32 v106, v106
    v_mfma_f32_16x16x32_bf16 a[76:79], a[168:171], v[248:251], a[76:79]
    v_mfma_f32_16x16x32_bf16 a[76:79], a[164:167], v[244:247], a[76:79]
    v_exp_f32 v107, v107
    v_mfma_f32_16x16x32_bf16 a[76:79], a[160:163], v[240:243], a[76:79]
    ds_read_b64_tr_b16 a[190:191], v17 offset:61440
    v_cvt_pk_bf16_f32 v169, v106, v107
    v_smfmac_f32_16x16x64_bf16 v[72:75], v[60:63], v[224:231], v56
    s_waitcnt lgkmcnt(8)
    v_mfma_f32_16x16x32_bf16 v[96:99], a[144:147], a[192:195], v[80:83]
    v_exp_f32 v108, v108
    v_mfma_f32_16x16x32_bf16 v[96:99], a[148:151], a[196:199], v[96:99]
    ds_read_b128 a[128:131], v8 offset:24576
    v_mfma_f32_16x16x32_bf16 v[96:99], a[152:155], a[200:203], v[96:99]
    v_exp_f32 v109, v109
    v_mfma_f32_16x16x32_bf16 v[96:99], a[156:159], a[204:207], v[96:99]
    ds_read_b128 a[132:135], v9 offset:24576
    v_cvt_pk_bf16_f32 v184, v108, v109
    v_mfma_f32_16x16x32_bf16 v[100:103], a[156:159], a[220:223], v[84:87]
    v_exp_f32 v110, v110
    v_mfma_f32_16x16x32_bf16 v[100:103], a[152:155], a[216:219], v[100:103]
    ds_read_b128 a[136:139], v10 offset:24576
    v_mfma_f32_16x16x32_bf16 v[100:103], a[148:151], a[212:215], v[100:103]
    v_exp_f32 v111, v111
    v_mfma_f32_16x16x32_bf16 v[100:103], a[144:147], a[208:211], v[100:103]
    ds_read_b128 a[140:143], v11 offset:24576
    v_cvt_pk_bf16_f32 v185, v110, v111
    v_mfma_f32_16x16x32_bf16 v[104:107], a[144:147], a[224:227], v[88:91]
    v_exp_f32 v96, v96
    v_mfma_f32_16x16x32_bf16 v[104:107], a[148:151], a[228:231], v[104:107]
    ds_read_b64_tr_b16 a[160:161], v18 offset:32768
    s_waitcnt lgkmcnt(5)
    v_mfma_f32_16x16x32_bf16 v[104:107], a[152:155], a[232:235], v[104:107]
    v_exp_f32 v97, v97
    v_mfma_f32_16x16x32_bf16 v[104:107], a[156:159], a[236:239], v[104:107]
    ds_read_b64_tr_b16 a[162:163], v18 offset:36864
    v_cvt_pk_bf16_f32 v138, v96, v97
    v_mfma_f32_16x16x32_bf16 v[108:111], a[156:159], a[252:255], v[92:95]
    v_exp_f32 v98, v98
    v_mfma_f32_16x16x32_bf16 v[108:111], a[152:155], a[248:251], v[108:111]
    ds_read_b64_tr_b16 a[164:165], v18 offset:40960
    v_mfma_f32_16x16x32_bf16 v[108:111], a[148:151], a[244:247], v[108:111]
    v_exp_f32 v99, v99
    v_mfma_f32_16x16x32_bf16 v[108:111], a[144:147], a[240:243], v[108:111]
    ds_read_b64_tr_b16 a[166:167], v18 offset:45056
    v_cvt_pk_bf16_f32 v139, v98, v99
    v_mfma_f32_16x16x32_bf16 a[80:83], a[176:179], v[192:195], a[80:83]
    v_exp_f32 v100, v100
    v_mfma_f32_16x16x32_bf16 a[80:83], a[180:183], v[196:199], a[80:83]
    ds_read_b64_tr_b16 a[168:169], v18 offset:49152
    v_mfma_f32_16x16x32_bf16 a[80:83], a[184:187], v[200:203], a[80:83]
    v_exp_f32 v101, v101
    v_mfma_f32_16x16x32_bf16 a[80:83], a[188:191], v[204:207], a[80:83]
    ds_read_b64_tr_b16 a[170:171], v18 offset:53248
    v_cvt_pk_bf16_f32 v154, v100, v101
    v_mfma_f32_16x16x32_bf16 a[84:87], a[188:191], v[220:223], a[84:87]
    v_exp_f32 v102, v102
    v_mfma_f32_16x16x32_bf16 a[84:87], a[184:187], v[216:219], a[84:87]
    ds_read_b64_tr_b16 a[172:173], v18 offset:57344
    v_mfma_f32_16x16x32_bf16 a[84:87], a[180:183], v[212:215], a[84:87]
    v_exp_f32 v103, v103
    v_mfma_f32_16x16x32_bf16 a[84:87], a[176:179], v[208:211], a[84:87]
    ds_read_b64_tr_b16 a[174:175], v18 offset:61440
    v_cvt_pk_bf16_f32 v155, v102, v103
    v_mfma_f32_16x16x32_bf16 a[88:91], a[176:179], v[224:227], a[88:91]
    v_exp_f32 v104, v104
    v_mfma_f32_16x16x32_bf16 a[88:91], a[180:183], v[228:231], a[88:91]
    s_cmp_le_u32 s40, 5
    s_cselect_b32 s72, s81, 0x7f000000
    v_mfma_f32_16x16x32_bf16 a[88:91], a[184:187], v[232:235], a[88:91]
    v_exp_f32 v105, v105
    v_mfma_f32_16x16x32_bf16 a[88:91], a[188:191], v[236:239], a[88:91]
    v_cvt_pk_bf16_f32 v170, v104, v105
    v_mfma_f32_16x16x32_bf16 a[92:95], a[188:191], v[252:255], a[92:95]
    v_exp_f32 v106, v106
    v_mfma_f32_16x16x32_bf16 a[92:95], a[184:187], v[248:251], a[92:95]
    s_cselect_b32 s3, 262144, 0
    s_add_u32 s81, s81, s3
    v_mfma_f32_16x16x32_bf16 a[92:95], a[180:183], v[244:247], a[92:95]
    v_exp_f32 v107, v107
    v_mfma_f32_16x16x32_bf16 a[92:95], a[176:179], v[240:243], a[92:95]
    v_cvt_pk_bf16_f32 v171, v106, v107
    v_smfmac_f32_16x16x64_bf16 v[72:75], v[60:63], v[232:239], v56
    s_waitcnt lgkmcnt(0)
    v_mfma_f32_16x16x32_bf16 v[96:99], a[128:131], a[192:195], v[80:83]
    v_exp_f32 v108, v108
    v_mfma_f32_16x16x32_bf16 v[96:99], a[132:135], a[196:199], v[96:99]
    ds_read_b128 a[144:147], v8 offset:28672
    v_mfma_f32_16x16x32_bf16 v[96:99], a[136:139], a[200:203], v[96:99]
    v_exp_f32 v109, v109
    v_mfma_f32_16x16x32_bf16 v[96:99], a[140:143], a[204:207], v[96:99]
    ds_read_b128 a[148:151], v9 offset:28672
    v_cvt_pk_bf16_f32 v186, v108, v109
    v_mfma_f32_16x16x32_bf16 v[100:103], a[140:143], a[220:223], v[84:87]
    v_exp_f32 v110, v110
    v_mfma_f32_16x16x32_bf16 v[100:103], a[136:139], a[216:219], v[100:103]
    ds_read_b128 a[152:155], v10 offset:28672
    v_mfma_f32_16x16x32_bf16 v[100:103], a[132:135], a[212:215], v[100:103]
    v_exp_f32 v111, v111
    v_mfma_f32_16x16x32_bf16 v[100:103], a[128:131], a[208:211], v[100:103]
    ds_read_b128 a[156:159], v11 offset:28672
    v_cvt_pk_bf16_f32 v187, v110, v111
    v_mfma_f32_16x16x32_bf16 v[104:107], a[128:131], a[224:227], v[88:91]
    v_exp_f32 v96, v96
    v_mfma_f32_16x16x32_bf16 v[104:107], a[132:135], a[228:231], v[104:107]
    ds_read_b64_tr_b16 a[176:177], v19 offset:32768
    v_mfma_f32_16x16x32_bf16 v[104:107], a[136:139], a[232:235], v[104:107]
    v_exp_f32 v97, v97
    v_mfma_f32_16x16x32_bf16 v[104:107], a[140:143], a[236:239], v[104:107]
    ds_read_b64_tr_b16 a[178:179], v19 offset:36864
    v_cvt_pk_bf16_f32 v140, v96, v97
    v_mfma_f32_16x16x32_bf16 v[108:111], a[140:143], a[252:255], v[92:95]
    v_exp_f32 v98, v98
    v_mfma_f32_16x16x32_bf16 v[108:111], a[136:139], a[248:251], v[108:111]
    ds_read_b64_tr_b16 a[180:181], v19 offset:40960
    v_mfma_f32_16x16x32_bf16 v[108:111], a[132:135], a[244:247], v[108:111]
    v_exp_f32 v99, v99
    v_mfma_f32_16x16x32_bf16 v[108:111], a[128:131], a[240:243], v[108:111]
    ds_read_b64_tr_b16 a[182:183], v19 offset:45056
    v_cvt_pk_bf16_f32 v141, v98, v99
    v_mfma_f32_16x16x32_bf16 a[96:99], a[160:163], v[192:195], a[96:99]
    v_exp_f32 v100, v100
    v_mfma_f32_16x16x32_bf16 a[96:99], a[164:167], v[196:199], a[96:99]
    ds_read_b64_tr_b16 a[184:185], v19 offset:49152
    v_mfma_f32_16x16x32_bf16 a[96:99], a[168:171], v[200:203], a[96:99]
    v_exp_f32 v101, v101
    v_mfma_f32_16x16x32_bf16 a[96:99], a[172:175], v[204:207], a[96:99]
    ds_read_b64_tr_b16 a[186:187], v19 offset:53248
    v_cvt_pk_bf16_f32 v156, v100, v101
    v_mfma_f32_16x16x32_bf16 a[100:103], a[172:175], v[220:223], a[100:103]
    v_exp_f32 v102, v102
    v_mfma_f32_16x16x32_bf16 a[100:103], a[168:171], v[216:219], a[100:103]
    ds_read_b64_tr_b16 a[188:189], v19 offset:57344
    v_mfma_f32_16x16x32_bf16 a[100:103], a[164:167], v[212:215], a[100:103]
    v_exp_f32 v103, v103
    v_mfma_f32_16x16x32_bf16 a[100:103], a[160:163], v[208:211], a[100:103]
    ds_read_b64_tr_b16 a[190:191], v19 offset:61440
    v_cvt_pk_bf16_f32 v157, v102, v103
    v_mfma_f32_16x16x32_bf16 a[104:107], a[160:163], v[224:227], a[104:107]
    v_exp_f32 v104, v104
    v_mfma_f32_16x16x32_bf16 a[104:107], a[164:167], v[228:231], a[104:107]
    s_sub_u32 s40, s40, 1
    v_mfma_f32_16x16x32_bf16 a[104:107], a[168:171], v[232:235], a[104:107]
    v_exp_f32 v105, v105
    v_mfma_f32_16x16x32_bf16 a[104:107], a[172:175], v[236:239], a[104:107]
    v_cvt_pk_bf16_f32 v172, v104, v105
    v_mfma_f32_16x16x32_bf16 a[108:111], a[172:175], v[252:255], a[108:111]
    v_exp_f32 v106, v106
    v_mfma_f32_16x16x32_bf16 a[108:111], a[168:171], v[248:251], a[108:111]
    v_mfma_f32_16x16x32_bf16 a[108:111], a[164:167], v[244:247], a[108:111]
    v_exp_f32 v107, v107
    v_mfma_f32_16x16x32_bf16 a[108:111], a[160:163], v[240:243], a[108:111]
    v_cvt_pk_bf16_f32 v173, v106, v107
    v_smfmac_f32_16x16x64_bf16 v[76:79], v[60:63], v[240:247], v56
    s_waitcnt vmcnt(0) lgkmcnt(0)
    s_barrier
    v_mfma_f32_16x16x32_bf16 v[96:99], a[144:147], a[192:195], v[80:83]
    v_exp_f32 v108, v108
    v_mfma_f32_16x16x32_bf16 v[96:99], a[148:151], a[196:199], v[96:99]
    ds_read_b128 a[128:131], v8 offset:32768
    s_add_u32 m0, s50, 131072
    v_mfma_f32_16x16x32_bf16 v[96:99], a[152:155], a[200:203], v[96:99]
    v_exp_f32 v109, v109
    v_mfma_f32_16x16x32_bf16 v[96:99], a[156:159], a[204:207], v[96:99]
    ds_read_b128 a[132:135], v9 offset:32768
    v_cvt_pk_bf16_f32 v188, v108, v109
    v_mfma_f32_16x16x32_bf16 v[100:103], a[156:159], a[220:223], v[84:87]
    v_exp_f32 v110, v110
    v_mfma_f32_16x16x32_bf16 v[100:103], a[152:155], a[216:219], v[100:103]
    buffer_load_dwordx4 v6, s[28:31], s37 offen offset:0 lds
    v_mfma_f32_16x16x32_bf16 v[100:103], a[148:151], a[212:215], v[100:103]
    v_exp_f32 v111, v111
    v_mfma_f32_16x16x32_bf16 v[100:103], a[144:147], a[208:211], v[100:103]
    ds_read_b128 a[136:139], v10 offset:32768
    v_cvt_pk_bf16_f32 v189, v110, v111
    v_mfma_f32_16x16x32_bf16 v[104:107], a[144:147], a[224:227], v[88:91]
    v_exp_f32 v96, v96
    v_mfma_f32_16x16x32_bf16 v[104:107], a[148:151], a[228:231], v[104:107]
    ds_read_b128 a[140:143], v11 offset:32768
    v_mfma_f32_16x16x32_bf16 v[104:107], a[152:155], a[232:235], v[104:107]
    v_exp_f32 v97, v97
    v_mfma_f32_16x16x32_bf16 v[104:107], a[156:159], a[236:239], v[104:107]
    ds_read_b64_tr_b16 a[160:161], v12 offset:0
    v_cvt_pk_bf16_f32 v142, v96, v97
    v_mfma_f32_16x16x32_bf16 v[108:111], a[156:159], a[252:255], v[92:95]
    v_exp_f32 v98, v98
    v_mfma_f32_16x16x32_bf16 v[108:111], a[152:155], a[248:251], v[108:111]
    buffer_load_dword v26, v24, s[60:63], s72 offen
    v_mfma_f32_16x16x32_bf16 v[108:111], a[148:151], a[244:247], v[108:111]
    v_exp_f32 v99, v99
    v_mfma_f32_16x16x32_bf16 v[108:111], a[144:147], a[240:243], v[108:111]
    ds_read_b64_tr_b16 a[162:163], v12 offset:4096
    v_cvt_pk_bf16_f32 v143, v98, v99
    v_mfma_f32_16x16x32_bf16 a[112:115], a[176:179], v[192:195], a[112:115]
    v_exp_f32 v100, v100
    v_mfma_f32_16x16x32_bf16 a[112:115], a[180:183], v[196:199], a[112:115]
    ds_read_b64_tr_b16 a[164:165], v12 offset:8192
    v_mfma_f32_16x16x32_bf16 a[112:115], a[184:187], v[200:203], a[112:115]
    v_exp_f32 v101, v101
    v_mfma_f32_16x16x32_bf16 a[112:115], a[188:191], v[204:207], a[112:115]
    ds_read_b64_tr_b16 a[166:167], v12 offset:12288
    v_cvt_pk_bf16_f32 v158, v100, v101
    v_mfma_f32_16x16x32_bf16 a[116:119], a[188:191], v[220:223], a[116:119]
    v_exp_f32 v102, v102
    v_mfma_f32_16x16x32_bf16 a[116:119], a[184:187], v[216:219], a[116:119]
    buffer_load_dwordx4 v7, s[28:31], s37 offen offset:1024 lds
    v_mfma_f32_16x16x32_bf16 a[116:119], a[180:183], v[212:215], a[116:119]
    v_exp_f32 v103, v103
    v_mfma_f32_16x16x32_bf16 a[116:119], a[176:179], v[208:211], a[116:119]
    ds_read_b64_tr_b16 a[168:169], v12 offset:16384
    v_cvt_pk_bf16_f32 v159, v102, v103
    v_mfma_f32_16x16x32_bf16 a[120:123], a[176:179], v[224:227], a[120:123]
    v_exp_f32 v104, v104
    v_mfma_f32_16x16x32_bf16 a[120:123], a[180:183], v[228:231], a[120:123]
    ds_read_b64_tr_b16 a[170:171], v12 offset:20480
    v_mfma_f32_16x16x32_bf16 a[120:123], a[184:187], v[232:235], a[120:123]
    v_exp_f32 v105, v105
    v_mfma_f32_16x16x32_bf16 a[120:123], a[188:191], v[236:239], a[120:123]
    ds_read_b64_tr_b16 a[172:173], v12 offset:24576
    v_cvt_pk_bf16_f32 v174, v104, v105
    v_mfma_f32_16x16x32_bf16 a[124:127], a[188:191], v[252:255], a[124:127]
    v_exp_f32 v106, v106
    v_mfma_f32_16x16x32_bf16 a[124:127], a[184:187], v[248:251], a[124:127]
    buffer_load_dwordx4 v6, s[28:31], s37 offen offset:2048 lds
    v_mfma_f32_16x16x32_bf16 a[124:127], a[180:183], v[244:247], a[124:127]
    v_exp_f32 v107, v107
    v_mfma_f32_16x16x32_bf16 a[124:127], a[176:179], v[240:243], a[124:127]
    ds_read_b64_tr_b16 a[174:175], v12 offset:28672
    v_cvt_pk_bf16_f32 v175, v106, v107
    v_smfmac_f32_16x16x64_bf16 v[76:79], v[60:63], v[248:255], v56
    s_cmp_lg_u32 s40, 0
    s_waitcnt lgkmcnt(8)
    s_cbranch_scc1 L_loop
    v_mfma_f32_16x16x32_bf16 v[96:99], a[128:131], a[192:195], v[80:83]
    v_exp_f32 v108, v108
    v_mfma_f32_16x16x32_bf16 v[96:99], a[132:135], a[196:199], v[96:99]
    ds_read_b128 a[144:147], v8 offset:36864
    v_mfma_f32_16x16x32_bf16 v[96:99], a[136:139], a[200:203], v[96:99]
    v_exp_f32 v109, v109
    v_mfma_f32_16x16x32_bf16 v[96:99], a[140:143], a[204:207], v[96:99]
    ds_read_b128 a[148:151], v9 offset:36864
    v_cvt_pk_bf16_f32 v190, v108, v109
    v_mfma_f32_16x16x32_bf16 v[100:103], a[140:143], a[220:223], v[84:87]
    v_exp_f32 v110, v110
    v_mfma_f32_16x16x32_bf16 v[100:103], a[136:139], a[216:219], v[100:103]
    buffer_load_dwordx4 v7, s[28:31], s37 offen offset:3072 lds
    ds_read_b128 a[152:155], v10 offset:36864
    s_add_u32 s37, s37, 4096
    v_mfma_f32_16x16x32_bf16 v[100:103], a[132:135], a[212:215], v[100:103]
    v_exp_f32 v111, v111
    v_mfma_f32_16x16x32_bf16 v[100:103], a[128:131], a[208:211], v[100:103]
    ds_read_b128 a[156:159], v11 offset:36864
    v_cvt_pk_bf16_f32 v191, v110, v111
    v_mfma_f32_16x16x32_bf16 v[104:107], a[128:131], a[224:227], v[88:91]
    v_exp_f32 v96, v96
    v_mfma_f32_16x16x32_bf16 v[104:107], a[132:135], a[228:231], v[104:107]
    ds_read_b64_tr_b16 a[176:177], v13 offset:0
    s_waitcnt lgkmcnt(5)
    v_mfma_f32_16x16x32_bf16 v[104:107], a[136:139], a[232:235], v[104:107]
    v_exp_f32 v97, v97
    v_mfma_f32_16x16x32_bf16 v[104:107], a[140:143], a[236:239], v[104:107]
    ds_read_b64_tr_b16 a[178:179], v13 offset:4096
    v_cvt_pk_bf16_f32 v192, v96, v97
    v_mfma_f32_16x16x32_bf16 v[108:111], a[140:143], a[252:255], v[92:95]
    v_exp_f32 v98, v98
    v_mfma_f32_16x16x32_bf16 v[108:111], a[136:139], a[248:251], v[108:111]
    ds_read_b64_tr_b16 a[180:181], v13 offset:8192
    v_mfma_f32_16x16x32_bf16 v[108:111], a[132:135], a[244:247], v[108:111]
    v_exp_f32 v99, v99
    v_mfma_f32_16x16x32_bf16 v[108:111], a[128:131], a[240:243], v[108:111]
    ds_read_b64_tr_b16 a[182:183], v13 offset:12288
    v_cvt_pk_bf16_f32 v193, v98, v99
    v_mfma_f32_16x16x32_bf16 a[0:3], a[160:163], v[128:131], a[0:3]
    v_exp_f32 v100, v100
    v_mfma_f32_16x16x32_bf16 a[0:3], a[164:167], v[132:135], a[0:3]
    ds_read_b64_tr_b16 a[184:185], v13 offset:16384
    s_add_u32 m0, s50, 135168
    v_mfma_f32_16x16x32_bf16 a[0:3], a[168:171], v[136:139], a[0:3]
    v_exp_f32 v101, v101
    v_mfma_f32_16x16x32_bf16 a[0:3], a[172:175], v[140:143], a[0:3]
    ds_read_b64_tr_b16 a[186:187], v13 offset:20480
    v_cvt_pk_bf16_f32 v208, v100, v101
    v_mfma_f32_16x16x32_bf16 a[4:7], a[172:175], v[156:159], a[4:7]
    v_exp_f32 v102, v102
    v_mfma_f32_16x16x32_bf16 a[4:7], a[168:171], v[152:155], a[4:7]
    buffer_load_dwordx4 v6, s[28:31], s37 offen offset:0 lds
    ds_read_b64_tr_b16 a[188:189], v13 offset:24576
    v_mfma_f32_16x16x32_bf16 a[4:7], a[164:167], v[148:151], a[4:7]
    v_exp_f32 v103, v103
    v_mfma_f32_16x16x32_bf16 a[4:7], a[160:163], v[144:147], a[4:7]
    ds_read_b64_tr_b16 a[190:191], v13 offset:28672
    v_cvt_pk_bf16_f32 v209, v102, v103
    v_mfma_f32_16x16x32_bf16 a[8:11], a[160:163], v[160:163], a[8:11]
    v_exp_f32 v104, v104
    v_mfma_f32_16x16x32_bf16 a[8:11], a[164:167], v[164:167], a[8:11]
    v_mfma_f32_16x16x32_bf16 a[8:11], a[168:171], v[168:171], a[8:11]
    v_exp_f32 v105, v105
    v_mfma_f32_16x16x32_bf16 a[8:11], a[172:175], v[172:175], a[8:11]
    buffer_load_dwordx2 v[114:115], v113, s[8:11], s82 offen sc1
    v_cvt_pk_bf16_f32 v224, v104, v105
    v_mfma_f32_16x16x32_bf16 a[12:15], a[172:175], v[188:191], a[12:15]
    v_exp_f32 v106, v106
    v_mfma_f32_16x16x32_bf16 a[12:15], a[168:171], v[184:187], a[12:15]
    buffer_load_dwordx4 v7, s[28:31], s37 offen offset:1024 lds
    v_mfma_f32_16x16x32_bf16 a[12:15], a[164:167], v[180:183], a[12:15]
    v_exp_f32 v107, v107
    v_mfma_f32_16x16x32_bf16 a[12:15], a[160:163], v[176:179], a[12:15]
    v_cvt_pk_bf16_f32 v225, v106, v107
    v_smfmac_f32_16x16x64_bf16 v[64:67], v[60:63], v[128:135], v56
    s_waitcnt lgkmcnt(0)
    v_mfma_f32_16x16x32_bf16 v[96:99], a[144:147], a[192:195], v[80:83]
    v_exp_f32 v108, v108
    v_mfma_f32_16x16x32_bf16 v[96:99], a[148:151], a[196:199], v[96:99]
    ds_read_b128 a[128:131], v8 offset:40960
    v_mfma_f32_16x16x32_bf16 v[96:99], a[152:155], a[200:203], v[96:99]
    v_exp_f32 v109, v109
    v_mfma_f32_16x16x32_bf16 v[96:99], a[156:159], a[204:207], v[96:99]
    ds_read_b128 a[132:135], v9 offset:40960
    v_cvt_pk_bf16_f32 v240, v108, v109
    v_mfma_f32_16x16x32_bf16 v[100:103], a[156:159], a[220:223], v[84:87]
    v_exp_f32 v110, v110
    v_mfma_f32_16x16x32_bf16 v[100:103], a[152:155], a[216:219], v[100:103]
    buffer_load_dwordx4 v6, s[28:31], s37 offen offset:2048 lds
    ds_read_b128 a[136:139], v10 offset:40960
    v_mfma_f32_16x16x32_bf16 v[100:103], a[148:151], a[212:215], v[100:103]
    v_exp_f32 v111, v111
    v_mfma_f32_16x16x32_bf16 v[100:103], a[144:147], a[208:211], v[100:103]
    ds_read_b128 a[140:143], v11 offset:40960
    v_cvt_pk_bf16_f32 v241, v110, v111
    v_mfma_f32_16x16x32_bf16 v[104:107], a[144:147], a[224:227], v[88:91]
    v_exp_f32 v96, v96
    v_mfma_f32_16x16x32_bf16 v[104:107], a[148:151], a[228:231], v[104:107]
    ds_read_b64_tr_b16 a[160:161], v14 offset:0
    v_mfma_f32_16x16x32_bf16 v[104:107], a[152:155], a[232:235], v[104:107]
    v_exp_f32 v97, v97
    v_mfma_f32_16x16x32_bf16 v[104:107], a[156:159], a[236:239], v[104:107]
    ds_read_b64_tr_b16 a[162:163], v14 offset:4096
    v_cvt_pk_bf16_f32 v194, v96, v97
    v_mfma_f32_16x16x32_bf16 v[108:111], a[156:159], a[252:255], v[92:95]
    v_exp_f32 v98, v98
    v_mfma_f32_16x16x32_bf16 v[108:111], a[152:155], a[248:251], v[108:111]
    ds_read_b64_tr_b16 a[164:165], v14 offset:8192
    v_mfma_f32_16x16x32_bf16 v[108:111], a[148:151], a[244:247], v[108:111]
    v_exp_f32 v99, v99
    v_mfma_f32_16x16x32_bf16 v[108:111], a[144:147], a[240:243], v[108:111]
    ds_read_b64_tr_b16 a[166:167], v14 offset:12288
    v_cvt_pk_bf16_f32 v195, v98, v99
    v_mfma_f32_16x16x32_bf16 a[16:19], a[176:179], v[128:131], a[16:19]
    v_exp_f32 v100, v100
    v_mfma_f32_16x16x32_bf16 a[16:19], a[180:183], v[132:135], a[16:19]
    ds_read_b64_tr_b16 a[168:169], v14 offset:16384
    v_mfma_f32_16x16x32_bf16 a[16:19], a[184:187], v[136:139], a[16:19]
    v_exp_f32 v101, v101
    v_mfma_f32_16x16x32_bf16 a[16:19], a[188:191], v[140:143], a[16:19]
    ds_read_b64_tr_b16 a[170:171], v14 offset:20480
    v_cvt_pk_bf16_f32 v210, v100, v101
    v_mfma_f32_16x16x32_bf16 a[20:23], a[188:191], v[156:159], a[20:23]
    v_exp_f32 v102, v102
    v_mfma_f32_16x16x32_bf16 a[20:23], a[184:187], v[152:155], a[20:23]
    buffer_load_dwordx4 v7, s[28:31], s37 offen offset:3072 lds
    ds_read_b64_tr_b16 a[172:173], v14 offset:24576
    s_add_u32 s37, s37, 28672
    v_mfma_f32_16x16x32_bf16 a[20:23], a[180:183], v[148:151], a[20:23]
    v_exp_f32 v103, v103
    v_mfma_f32_16x16x32_bf16 a[20:23], a[176:179], v[144:147], a[20:23]
    ds_read_b64_tr_b16 a[174:175], v14 offset:28672
    v_cvt_pk_bf16_f32 v211, v102, v103
    v_mfma_f32_16x16x32_bf16 a[24:27], a[176:179], v[160:163], a[24:27]
    v_exp_f32 v104, v104
    v_mfma_f32_16x16x32_bf16 a[24:27], a[180:183], v[164:167], a[24:27]
    s_add_u32 m0, s73, 0
    v_mfma_f32_16x16x32_bf16 a[24:27], a[184:187], v[168:171], a[24:27]
    v_exp_f32 v105, v105
    v_mfma_f32_16x16x32_bf16 a[24:27], a[188:191], v[172:175], a[24:27]
    buffer_load_dword v25, v24, s[16:19], s85 offen
    v_cvt_pk_bf16_f32 v226, v104, v105
    v_mfma_f32_16x16x32_bf16 a[28:31], a[188:191], v[188:191], a[28:31]
    v_exp_f32 v106, v106
    v_mfma_f32_16x16x32_bf16 a[28:31], a[184:187], v[184:187], a[28:31]
    buffer_load_dwordx4 v116, s[68:71], s75 offen offset:0 lds
    v_mfma_f32_16x16x32_bf16 a[28:31], a[180:183], v[180:183], a[28:31]
    v_exp_f32 v107, v107
    v_mfma_f32_16x16x32_bf16 a[28:31], a[176:179], v[176:179], a[28:31]
    v_cvt_pk_bf16_f32 v227, v106, v107
    v_smfmac_f32_16x16x64_bf16 v[64:67], v[60:63], v[136:143], v56
    s_waitcnt lgkmcnt(0)
    v_mfma_f32_16x16x32_bf16 v[96:99], a[128:131], a[192:195], v[80:83]
    v_exp_f32 v108, v108
    v_mfma_f32_16x16x32_bf16 v[96:99], a[132:135], a[196:199], v[96:99]
    ds_read_b128 a[144:147], v8 offset:45056
    v_mfma_f32_16x16x32_bf16 v[96:99], a[136:139], a[200:203], v[96:99]
    v_exp_f32 v109, v109
    v_mfma_f32_16x16x32_bf16 v[96:99], a[140:143], a[204:207], v[96:99]
    ds_read_b128 a[148:151], v9 offset:45056
    v_cvt_pk_bf16_f32 v242, v108, v109
    v_mfma_f32_16x16x32_bf16 v[100:103], a[140:143], a[220:223], v[84:87]
    v_exp_f32 v110, v110
    v_mfma_f32_16x16x32_bf16 v[100:103], a[136:139], a[216:219], v[100:103]
    buffer_load_dwordx4 v117, s[68:71], s75 offen offset:1024 lds
    ds_read_b128 a[152:155], v10 offset:45056
    v_mfma_f32_16x16x32_bf16 v[100:103], a[132:135], a[212:215], v[100:103]
    v_exp_f32 v111, v111
    v_mfma_f32_16x16x32_bf16 v[100:103], a[128:131], a[208:211], v[100:103]
    ds_read_b128 a[156:159], v11 offset:45056
    v_cvt_pk_bf16_f32 v243, v110, v111
    v_mfma_f32_16x16x32_bf16 v[104:107], a[128:131], a[224:227], v[88:91]
    v_exp_f32 v96, v96
    v_mfma_f32_16x16x32_bf16 v[104:107], a[132:135], a[228:231], v[104:107]
    ds_read_b64_tr_b16 a[176:177], v15 offset:0
    v_mfma_f32_16x16x32_bf16 v[104:107], a[136:139], a[232:235], v[104:107]
    v_exp_f32 v97, v97
    v_mfma_f32_16x16x32_bf16 v[104:107], a[140:143], a[236:239], v[104:107]
    ds_read_b64_tr_b16 a[178:179], v15 offset:4096
    v_cvt_pk_bf16_f32 v196, v96, v97
    v_mfma_f32_16x16x32_bf16 v[108:111], a[140:143], a[252:255], v[92:95]
    v_exp_f32 v98, v98
    v_mfma_f32_16x16x32_bf16 v[108:111], a[136:139], a[248:251], v[108:111]
    ds_read_b64_tr_b16 a[180:181], v15 offset:8192
    v_mfma_f32_16x16x32_bf16 v[108:111], a[132:135], a[244:247], v[108:111]
    v_exp_f32 v99, v99
    v_mfma_f32_16x16x32_bf16 v[108:111], a[128:131], a[240:243], v[108:111]
    ds_read_b64_tr_b16 a[182:183], v15 offset:12288
    v_cvt_pk_bf16_f32 v197, v98, v99
    v_mfma_f32_16x16x32_bf16 a[32:35], a[160:163], v[128:131], a[32:35]
    v_exp_f32 v100, v100
    v_mfma_f32_16x16x32_bf16 a[32:35], a[164:167], v[132:135], a[32:35]
    ds_read_b64_tr_b16 a[184:185], v15 offset:16384
    v_mfma_f32_16x16x32_bf16 a[32:35], a[168:171], v[136:139], a[32:35]
    v_exp_f32 v101, v101
    v_mfma_f32_16x16x32_bf16 a[32:35], a[172:175], v[140:143], a[32:35]
    ds_read_b64_tr_b16 a[186:187], v15 offset:20480
    v_cvt_pk_bf16_f32 v212, v100, v101
    v_mfma_f32_16x16x32_bf16 a[36:39], a[172:175], v[156:159], a[36:39]
    v_exp_f32 v102, v102
    v_mfma_f32_16x16x32_bf16 a[36:39], a[168:171], v[152:155], a[36:39]
    buffer_load_dwordx4 v118, s[68:71], s75 offen offset:2048 lds
    ds_read_b64_tr_b16 a[188:189], v15 offset:24576
    v_mfma_f32_16x16x32_bf16 a[36:39], a[164:167], v[148:151], a[36:39]
    v_exp_f32 v103, v103
    v_mfma_f32_16x16x32_bf16 a[36:39], a[160:163], v[144:147], a[36:39]
    ds_read_b64_tr_b16 a[190:191], v15 offset:28672
    v_cvt_pk_bf16_f32 v213, v102, v103
    v_mfma_f32_16x16x32_bf16 a[40:43], a[160:163], v[160:163], a[40:43]
    v_exp_f32 v104, v104
    v_mfma_f32_16x16x32_bf16 a[40:43], a[164:167], v[164:167], a[40:43]
    v_mfma_f32_16x16x32_bf16 a[40:43], a[168:171], v[168:171], a[40:43]
    v_exp_f32 v105, v105
    v_mfma_f32_16x16x32_bf16 a[40:43], a[172:175], v[172:175], a[40:43]
    v_cvt_pk_bf16_f32 v228, v104, v105
    v_mfma_f32_16x16x32_bf16 a[44:47], a[172:175], v[188:191], a[44:47]
    v_exp_f32 v106, v106
    v_mfma_f32_16x16x32_bf16 a[44:47], a[168:171], v[184:187], a[44:47]
    buffer_load_dwordx4 v119, s[68:71], s75 offen offset:3072 lds
    v_mfma_f32_16x16x32_bf16 a[44:47], a[164:167], v[180:183], a[44:47]
    v_exp_f32 v107, v107
    v_mfma_f32_16x16x32_bf16 a[44:47], a[160:163], v[176:179], a[44:47]
    v_cvt_pk_bf16_f32 v229, v106, v107
    v_smfmac_f32_16x16x64_bf16 v[68:71], v[60:63], v[144:151], v56
    s_waitcnt lgkmcnt(0)
    v_mfma_f32_16x16x32_bf16 v[96:99], a[144:147], a[192:195], v[80:83]
    v_exp_f32 v108, v108
    v_mfma_f32_16x16x32_bf16 v[96:99], a[148:151], a[196:199], v[96:99]
    ds_read_b128 a[128:131], v8 offset:49152
    s_add_u32 m0, s73, 4096
    v_mfma_f32_16x16x32_bf16 v[96:99], a[152:155], a[200:203], v[96:99]
    v_exp_f32 v109, v109
    v_mfma_f32_16x16x32_bf16 v[96:99], a[156:159], a[204:207], v[96:99]
    ds_read_b128 a[132:135], v9 offset:49152
    v_cvt_pk_bf16_f32 v244, v108, v109
    v_mfma_f32_16x16x32_bf16 v[100:103], a[156:159], a[220:223], v[84:87]
    v_exp_f32 v110, v110
    v_mfma_f32_16x16x32_bf16 v[100:103], a[152:155], a[216:219], v[100:103]
    buffer_load_dwordx4 v120, s[68:71], s75 offen offset:0 lds
    ds_read_b128 a[136:139], v10 offset:49152
    s_add_u32 s75, s75, 81920
    v_mfma_f32_16x16x32_bf16 v[100:103], a[148:151], a[212:215], v[100:103]
    v_exp_f32 v111, v111
    v_mfma_f32_16x16x32_bf16 v[100:103], a[144:147], a[208:211], v[100:103]
    ds_read_b128 a[140:143], v11 offset:49152
    v_cvt_pk_bf16_f32 v245, v110, v111
    v_mfma_f32_16x16x32_bf16 v[104:107], a[144:147], a[224:227], v[88:91]
    v_exp_f32 v96, v96
    v_mfma_f32_16x16x32_bf16 v[104:107], a[148:151], a[228:231], v[104:107]
    ds_read_b64_tr_b16 a[160:161], v16 offset:0
    v_mfma_f32_16x16x32_bf16 v[104:107], a[152:155], a[232:235], v[104:107]
    v_exp_f32 v97, v97
    v_mfma_f32_16x16x32_bf16 v[104:107], a[156:159], a[236:239], v[104:107]
    ds_read_b64_tr_b16 a[162:163], v16 offset:4096
    v_cvt_pk_bf16_f32 v198, v96, v97
    v_mfma_f32_16x16x32_bf16 v[108:111], a[156:159], a[252:255], v[92:95]
    v_exp_f32 v98, v98
    v_mfma_f32_16x16x32_bf16 v[108:111], a[152:155], a[248:251], v[108:111]
    ds_read_b64_tr_b16 a[164:165], v16 offset:8192
    v_mfma_f32_16x16x32_bf16 v[108:111], a[148:151], a[244:247], v[108:111]
    v_exp_f32 v99, v99
    v_mfma_f32_16x16x32_bf16 v[108:111], a[144:147], a[240:243], v[108:111]
    ds_read_b64_tr_b16 a[166:167], v16 offset:12288
    v_cvt_pk_bf16_f32 v199, v98, v99
    v_mfma_f32_16x16x32_bf16 a[48:51], a[176:179], v[128:131], a[48:51]
    v_exp_f32 v100, v100
    v_mfma_f32_16x16x32_bf16 a[48:51], a[180:183], v[132:135], a[48:51]
    ds_read_b64_tr_b16 a[168:169], v16 offset:16384
    s_add_u32 m0, s73, 20480
    v_mfma_f32_16x16x32_bf16 a[48:51], a[184:187], v[136:139], a[48:51]
    v_exp_f32 v101, v101
    v_mfma_f32_16x16x32_bf16 a[48:51], a[188:191], v[140:143], a[48:51]
    ds_read_b64_tr_b16 a[170:171], v16 offset:20480
    v_cvt_pk_bf16_f32 v214, v100, v101
    v_mfma_f32_16x16x32_bf16 a[52:55], a[188:191], v[156:159], a[52:55]
    v_exp_f32 v102, v102
    v_mfma_f32_16x16x32_bf16 a[52:55], a[184:187], v[152:155], a[52:55]
    buffer_load_dwordx4 v116, s[68:71], s75 offen offset:0 lds
    ds_read_b64_tr_b16 a[172:173], v16 offset:24576
    v_mfma_f32_16x16x32_bf16 a[52:55], a[180:183], v[148:151], a[52:55]
    v_exp_f32 v103, v103
    v_mfma_f32_16x16x32_bf16 a[52:55], a[176:179], v[144:147], a[52:55]
    ds_read_b64_tr_b16 a[174:175], v16 offset:28672
    v_cvt_pk_bf16_f32 v215, v102, v103
    v_mfma_f32_16x16x32_bf16 a[56:59], a[176:179], v[160:163], a[56:59]
    v_exp_f32 v104, v104
    v_mfma_f32_16x16x32_bf16 a[56:59], a[180:183], v[164:167], a[56:59]
    v_mfma_f32_16x16x32_bf16 a[56:59], a[184:187], v[168:171], a[56:59]
    v_exp_f32 v105, v105
    v_mfma_f32_16x16x32_bf16 a[56:59], a[188:191], v[172:175], a[56:59]
    v_cvt_pk_bf16_f32 v230, v104, v105
    v_mfma_f32_16x16x32_bf16 a[60:63], a[188:191], v[188:191], a[60:63]
    v_exp_f32 v106, v106
    v_mfma_f32_16x16x32_bf16 a[60:63], a[184:187], v[184:187], a[60:63]
    buffer_load_dwordx4 v117, s[68:71], s75 offen offset:1024 lds
    v_mfma_f32_16x16x32_bf16 a[60:63], a[180:183], v[180:183], a[60:63]
    v_exp_f32 v107, v107
    v_mfma_f32_16x16x32_bf16 a[60:63], a[176:179], v[176:179], a[60:63]
    v_cvt_pk_bf16_f32 v231, v106, v107
    v_smfmac_f32_16x16x64_bf16 v[68:71], v[60:63], v[152:159], v56
    s_waitcnt lgkmcnt(0)
    v_mfma_f32_16x16x32_bf16 v[96:99], a[128:131], a[192:195], v[80:83]
    v_exp_f32 v108, v108
    v_mfma_f32_16x16x32_bf16 v[96:99], a[132:135], a[196:199], v[96:99]
    ds_read_b128 a[144:147], v8 offset:53248
    v_mfma_f32_16x16x32_bf16 v[96:99], a[136:139], a[200:203], v[96:99]
    v_exp_f32 v109, v109
    v_mfma_f32_16x16x32_bf16 v[96:99], a[140:143], a[204:207], v[96:99]
    ds_read_b128 a[148:151], v9 offset:53248
    v_cvt_pk_bf16_f32 v246, v108, v109
    v_mfma_f32_16x16x32_bf16 v[100:103], a[140:143], a[220:223], v[84:87]
    v_exp_f32 v110, v110
    v_mfma_f32_16x16x32_bf16 v[100:103], a[136:139], a[216:219], v[100:103]
    buffer_load_dwordx4 v118, s[68:71], s75 offen offset:2048 lds
    ds_read_b128 a[152:155], v10 offset:53248
    v_mfma_f32_16x16x32_bf16 v[100:103], a[132:135], a[212:215], v[100:103]
    v_exp_f32 v111, v111
    v_mfma_f32_16x16x32_bf16 v[100:103], a[128:131], a[208:211], v[100:103]
    ds_read_b128 a[156:159], v11 offset:53248
    v_cvt_pk_bf16_f32 v247, v110, v111
    v_mfma_f32_16x16x32_bf16 v[104:107], a[128:131], a[224:227], v[88:91]
    v_exp_f32 v96, v96
    v_mfma_f32_16x16x32_bf16 v[104:107], a[132:135], a[228:231], v[104:107]
    ds_read_b64_tr_b16 a[176:177], v17 offset:0
    v_mfma_f32_16x16x32_bf16 v[104:107], a[136:139], a[232:235], v[104:107]
    v_exp_f32 v97, v97
    v_mfma_f32_16x16x32_bf16 v[104:107], a[140:143], a[236:239], v[104:107]
    ds_read_b64_tr_b16 a[178:179], v17 offset:4096
    v_cvt_pk_bf16_f32 v200, v96, v97
    v_mfma_f32_16x16x32_bf16 v[108:111], a[140:143], a[252:255], v[92:95]
    v_exp_f32 v98, v98
    v_mfma_f32_16x16x32_bf16 v[108:111], a[136:139], a[248:251], v[108:111]
    ds_read_b64_tr_b16 a[180:181], v17 offset:8192
    v_mfma_f32_16x16x32_bf16 v[108:111], a[132:135], a[244:247], v[108:111]
    v_exp_f32 v99, v99
    v_mfma_f32_16x16x32_bf16 v[108:111], a[128:131], a[240:243], v[108:111]
    ds_read_b64_tr_b16 a[182:183], v17 offset:12288
    v_cvt_pk_bf16_f32 v201, v98, v99
    v_mfma_f32_16x16x32_bf16 a[64:67], a[160:163], v[128:131], a[64:67]
    v_exp_f32 v100, v100
    v_mfma_f32_16x16x32_bf16 a[64:67], a[164:167], v[132:135], a[64:67]
    ds_read_b64_tr_b16 a[184:185], v17 offset:16384
    v_mfma_f32_16x16x32_bf16 a[64:67], a[168:171], v[136:139], a[64:67]
    v_exp_f32 v101, v101
    v_mfma_f32_16x16x32_bf16 a[64:67], a[172:175], v[140:143], a[64:67]
    ds_read_b64_tr_b16 a[186:187], v17 offset:20480
    v_cvt_pk_bf16_f32 v216, v100, v101
    v_mfma_f32_16x16x32_bf16 a[68:71], a[172:175], v[156:159], a[68:71]
    v_exp_f32 v102, v102
    v_mfma_f32_16x16x32_bf16 a[68:71], a[168:171], v[152:155], a[68:71]
    buffer_load_dwordx4 v119, s[68:71], s75 offen offset:3072 lds
    ds_read_b64_tr_b16 a[188:189], v17 offset:24576
    v_mfma_f32_16x16x32_bf16 a[68:71], a[164:167], v[148:151], a[68:71]
    v_exp_f32 v103, v103
    v_mfma_f32_16x16x32_bf16 a[68:71], a[160:163], v[144:147], a[68:71]
    ds_read_b64_tr_b16 a[190:191], v17 offset:28672
    v_cvt_pk_bf16_f32 v217, v102, v103
    v_mfma_f32_16x16x32_bf16 a[72:75], a[160:163], v[160:163], a[72:75]
    v_exp_f32 v104, v104
    v_mfma_f32_16x16x32_bf16 a[72:75], a[164:167], v[164:167], a[72:75]
    s_add_u32 m0, s73, 24576
    v_mfma_f32_16x16x32_bf16 a[72:75], a[168:171], v[168:171], a[72:75]
    v_exp_f32 v105, v105
    v_mfma_f32_16x16x32_bf16 a[72:75], a[172:175], v[172:175], a[72:75]
    v_cvt_pk_bf16_f32 v232, v104, v105
    v_mfma_f32_16x16x32_bf16 a[76:79], a[172:175], v[188:191], a[76:79]
    v_exp_f32 v106, v106
    v_mfma_f32_16x16x32_bf16 a[76:79], a[168:171], v[184:187], a[76:79]
    buffer_load_dwordx4 v120, s[68:71], s75 offen offset:0 lds
    s_add_u32 s75, s75, 81920
    v_mfma_f32_16x16x32_bf16 a[76:79], a[164:167], v[180:183], a[76:79]
    v_exp_f32 v107, v107
    v_mfma_f32_16x16x32_bf16 a[76:79], a[160:163], v[176:179], a[76:79]
    v_cvt_pk_bf16_f32 v233, v106, v107
    v_smfmac_f32_16x16x64_bf16 v[72:75], v[60:63], v[160:167], v56
    s_waitcnt lgkmcnt(0)
    v_mfma_f32_16x16x32_bf16 v[96:99], a[144:147], a[192:195], v[80:83]
    v_exp_f32 v108, v108
    v_mfma_f32_16x16x32_bf16 v[96:99], a[148:151], a[196:199], v[96:99]
    ds_read_b128 a[128:131], v8 offset:57344
    s_add_u32 m0, s73, 40960
    v_mfma_f32_16x16x32_bf16 v[96:99], a[152:155], a[200:203], v[96:99]
    v_exp_f32 v109, v109
    v_mfma_f32_16x16x32_bf16 v[96:99], a[156:159], a[204:207], v[96:99]
    ds_read_b128 a[132:135], v9 offset:57344
    v_cvt_pk_bf16_f32 v248, v108, v109
    v_mfma_f32_16x16x32_bf16 v[100:103], a[156:159], a[220:223], v[84:87]
    v_exp_f32 v110, v110
    v_mfma_f32_16x16x32_bf16 v[100:103], a[152:155], a[216:219], v[100:103]
    buffer_load_dwordx4 v116, s[68:71], s75 offen offset:0 lds
    ds_read_b128 a[136:139], v10 offset:57344
    v_mfma_f32_16x16x32_bf16 v[100:103], a[148:151], a[212:215], v[100:103]
    v_exp_f32 v111, v111
    v_mfma_f32_16x16x32_bf16 v[100:103], a[144:147], a[208:211], v[100:103]
    ds_read_b128 a[140:143], v11 offset:57344
    v_cvt_pk_bf16_f32 v249, v110, v111
    v_mfma_f32_16x16x32_bf16 v[104:107], a[144:147], a[224:227], v[88:91]
    v_exp_f32 v96, v96
    v_mfma_f32_16x16x32_bf16 v[104:107], a[148:151], a[228:231], v[104:107]
    ds_read_b64_tr_b16 a[160:161], v18 offset:0
    v_mfma_f32_16x16x32_bf16 v[104:107], a[152:155], a[232:235], v[104:107]
    v_exp_f32 v97, v97
    v_mfma_f32_16x16x32_bf16 v[104:107], a[156:159], a[236:239], v[104:107]
    ds_read_b64_tr_b16 a[162:163], v18 offset:4096
    v_cvt_pk_bf16_f32 v202, v96, v97
    v_mfma_f32_16x16x32_bf16 v[108:111], a[156:159], a[252:255], v[92:95]
    v_exp_f32 v98, v98
    v_mfma_f32_16x16x32_bf16 v[108:111], a[152:155], a[248:251], v[108:111]
    ds_read_b64_tr_b16 a[164:165], v18 offset:8192
    v_mfma_f32_16x16x32_bf16 v[108:111], a[148:151], a[244:247], v[108:111]
    v_exp_f32 v99, v99
    v_mfma_f32_16x16x32_bf16 v[108:111], a[144:147], a[240:243], v[108:111]
    ds_read_b64_tr_b16 a[166:167], v18 offset:12288
    v_cvt_pk_bf16_f32 v203, v98, v99
    v_mfma_f32_16x16x32_bf16 a[80:83], a[176:179], v[128:131], a[80:83]
    v_exp_f32 v100, v100
    v_mfma_f32_16x16x32_bf16 a[80:83], a[180:183], v[132:135], a[80:83]
    ds_read_b64_tr_b16 a[168:169], v18 offset:16384
    v_mfma_f32_16x16x32_bf16 a[80:83], a[184:187], v[136:139], a[80:83]
    v_exp_f32 v101, v101
    v_mfma_f32_16x16x32_bf16 a[80:83], a[188:191], v[140:143], a[80:83]
    ds_read_b64_tr_b16 a[170:171], v18 offset:20480
    v_cvt_pk_bf16_f32 v218, v100, v101
    v_mfma_f32_16x16x32_bf16 a[84:87], a[188:191], v[156:159], a[84:87]
    v_exp_f32 v102, v102
    v_mfma_f32_16x16x32_bf16 a[84:87], a[184:187], v[152:155], a[84:87]
    buffer_load_dwordx4 v117, s[68:71], s75 offen offset:1024 lds
    ds_read_b64_tr_b16 a[172:173], v18 offset:24576
    v_mfma_f32_16x16x32_bf16 a[84:87], a[180:183], v[148:151], a[84:87]
    v_exp_f32 v103, v103
    v_mfma_f32_16x16x32_bf16 a[84:87], a[176:179], v[144:147], a[84:87]
    ds_read_b64_tr_b16 a[174:175], v18 offset:28672
    v_cvt_pk_bf16_f32 v219, v102, v103
    v_mfma_f32_16x16x32_bf16 a[88:91], a[176:179], v[160:163], a[88:91]
    v_exp_f32 v104, v104
    v_mfma_f32_16x16x32_bf16 a[88:91], a[180:183], v[164:167], a[88:91]
    v_mfma_f32_16x16x32_bf16 a[88:91], a[184:187], v[168:171], a[88:91]
    v_exp_f32 v105, v105
    v_mfma_f32_16x16x32_bf16 a[88:91], a[188:191], v[172:175], a[88:91]
    v_cvt_pk_bf16_f32 v234, v104, v105
    v_mfma_f32_16x16x32_bf16 a[92:95], a[188:191], v[188:191], a[92:95]
    v_exp_f32 v106, v106
    v_mfma_f32_16x16x32_bf16 a[92:95], a[184:187], v[184:187], a[92:95]
    buffer_load_dwordx4 v118, s[68:71], s75 offen offset:2048 lds
    v_mfma_f32_16x16x32_bf16 a[92:95], a[180:183], v[180:183], a[92:95]
    v_exp_f32 v107, v107
    v_mfma_f32_16x16x32_bf16 a[92:95], a[176:179], v[176:179], a[92:95]
    v_cvt_pk_bf16_f32 v235, v106, v107
    v_smfmac_f32_16x16x64_bf16 v[72:75], v[60:63], v[168:175], v56
    s_waitcnt lgkmcnt(0)
    v_mfma_f32_16x16x32_bf16 v[96:99], a[128:131], a[192:195], v[80:83]
    v_exp_f32 v108, v108
    v_mfma_f32_16x16x32_bf16 v[96:99], a[132:135], a[196:199], v[96:99]
    ds_read_b128 a[144:147], v8 offset:61440
    v_mfma_f32_16x16x32_bf16 v[96:99], a[136:139], a[200:203], v[96:99]
    v_exp_f32 v109, v109
    v_mfma_f32_16x16x32_bf16 v[96:99], a[140:143], a[204:207], v[96:99]
    ds_read_b128 a[148:151], v9 offset:61440
    v_cvt_pk_bf16_f32 v250, v108, v109
    v_mfma_f32_16x16x32_bf16 v[100:103], a[140:143], a[220:223], v[84:87]
    v_exp_f32 v110, v110
    v_mfma_f32_16x16x32_bf16 v[100:103], a[136:139], a[216:219], v[100:103]
    buffer_load_dwordx4 v119, s[68:71], s75 offen offset:3072 lds
    ds_read_b128 a[152:155], v10 offset:61440
    v_mfma_f32_16x16x32_bf16 v[100:103], a[132:135], a[212:215], v[100:103]
    v_exp_f32 v111, v111
    v_mfma_f32_16x16x32_bf16 v[100:103], a[128:131], a[208:211], v[100:103]
    ds_read_b128 a[156:159], v11 offset:61440
    v_cvt_pk_bf16_f32 v251, v110, v111
    v_mfma_f32_16x16x32_bf16 v[104:107], a[128:131], a[224:227], v[88:91]
    v_exp_f32 v96, v96
    v_mfma_f32_16x16x32_bf16 v[104:107], a[132:135], a[228:231], v[104:107]
    ds_read_b64_tr_b16 a[176:177], v19 offset:0
    v_mfma_f32_16x16x32_bf16 v[104:107], a[136:139], a[232:235], v[104:107]
    v_exp_f32 v97, v97
    v_mfma_f32_16x16x32_bf16 v[104:107], a[140:143], a[236:239], v[104:107]
    ds_read_b64_tr_b16 a[178:179], v19 offset:4096
    v_cvt_pk_bf16_f32 v204, v96, v97
    v_mfma_f32_16x16x32_bf16 v[108:111], a[140:143], a[252:255], v[92:95]
    v_exp_f32 v98, v98
    v_mfma_f32_16x16x32_bf16 v[108:111], a[136:139], a[248:251], v[108:111]
    ds_read_b64_tr_b16 a[180:181], v19 offset:8192
    v_mfma_f32_16x16x32_bf16 v[108:111], a[132:135], a[244:247], v[108:111]
    v_exp_f32 v99, v99
    v_mfma_f32_16x16x32_bf16 v[108:111], a[128:131], a[240:243], v[108:111]
    ds_read_b64_tr_b16 a[182:183], v19 offset:12288
    v_cvt_pk_bf16_f32 v205, v98, v99
    v_mfma_f32_16x16x32_bf16 a[96:99], a[160:163], v[128:131], a[96:99]
    v_exp_f32 v100, v100
    v_mfma_f32_16x16x32_bf16 a[96:99], a[164:167], v[132:135], a[96:99]
    ds_read_b64_tr_b16 a[184:185], v19 offset:16384
    s_add_u32 m0, s73, 45056
    v_mfma_f32_16x16x32_bf16 a[96:99], a[168:171], v[136:139], a[96:99]
    v_exp_f32 v101, v101
    v_mfma_f32_16x16x32_bf16 a[96:99], a[172:175], v[140:143], a[96:99]
    ds_read_b64_tr_b16 a[186:187], v19 offset:20480
    v_cvt_pk_bf16_f32 v220, v100, v101
    v_mfma_f32_16x16x32_bf16 a[100:103], a[172:175], v[156:159], a[100:103]
    v_exp_f32 v102, v102
    v_mfma_f32_16x16x32_bf16 a[100:103], a[168:171], v[152:155], a[100:103]
    buffer_load_dwordx4 v120, s[68:71], s75 offen offset:0 lds
    ds_read_b64_tr_b16 a[188:189], v19 offset:24576
    s_add_u32 s75, s75, 81920
    v_mfma_f32_16x16x32_bf16 a[100:103], a[164:167], v[148:151], a[100:103]
    v_exp_f32 v103, v103
    v_mfma_f32_16x16x32_bf16 a[100:103], a[160:163], v[144:147], a[100:103]
    ds_read_b64_tr_b16 a[190:191], v19 offset:28672
    v_cvt_pk_bf16_f32 v221, v102, v103
    v_mfma_f32_16x16x32_bf16 a[104:107], a[160:163], v[160:163], a[104:107]
    v_exp_f32 v104, v104
    v_mfma_f32_16x16x32_bf16 a[104:107], a[164:167], v[164:167], a[104:107]
    v_mfma_f32_16x16x32_bf16 a[104:107], a[168:171], v[168:171], a[104:107]
    v_exp_f32 v105, v105
    v_mfma_f32_16x16x32_bf16 a[104:107], a[172:175], v[172:175], a[104:107]
    v_cvt_pk_bf16_f32 v236, v104, v105
    v_mfma_f32_16x16x32_bf16 a[108:111], a[172:175], v[188:191], a[108:111]
    v_exp_f32 v106, v106
    v_mfma_f32_16x16x32_bf16 a[108:111], a[168:171], v[184:187], a[108:111]
    v_mfma_f32_16x16x32_bf16 a[108:111], a[164:167], v[180:183], a[108:111]
    v_exp_f32 v107, v107
    v_mfma_f32_16x16x32_bf16 a[108:111], a[160:163], v[176:179], a[108:111]
    v_cvt_pk_bf16_f32 v237, v106, v107
    v_smfmac_f32_16x16x64_bf16 v[76:79], v[60:63], v[176:183], v56
    s_waitcnt vmcnt(16) lgkmcnt(0)
    s_barrier
    v_cmp_ne_u64 vcc, s[38:39], v[114:115]
    s_mov_b32 s42, 0
    s_cbranch_vccz Lpok1
Lspin1:
    buffer_load_dwordx2 v[114:115], v113, s[8:11], s82 offen sc1
    s_add_u32 s42, s42, 1
    s_waitcnt vmcnt(0)
    v_cmp_ne_u64 vcc, s[38:39], v[114:115]
    s_cmp_ge_u32 s42, 0x100000
    s_cbranch_scc1 Lpok1
    s_cbranch_vccnz Lspin1
Lpok1:
    v_mfma_f32_16x16x32_bf16 v[96:99], a[144:147], a[192:195], v[80:83]
    v_exp_f32 v108, v108
    v_mfma_f32_16x16x32_bf16 v[96:99], a[148:151], a[196:199], v[96:99]
    ds_read_b64_tr_b16 a[160:161], v12 offset:32768
    v_mfma_f32_16x16x32_bf16 v[96:99], a[152:155], a[200:203], v[96:99]
    v_exp_f32 v109, v109
    v_mfma_f32_16x16x32_bf16 v[96:99], a[156:159], a[204:207], v[96:99]
    ds_read_b64_tr_b16 a[162:163], v12 offset:36864
    v_cvt_pk_bf16_f32 v252, v108, v109
    v_mfma_f32_16x16x32_bf16 v[100:103], a[156:159], a[220:223], v[84:87]
    v_exp_f32 v110, v110
    v_mfma_f32_16x16x32_bf16 v[100:103], a[152:155], a[216:219], v[100:103]
    buffer_load_dwordx4 a[128:131], v20, s[64:67], s76 offen offset:0 sc1
    ds_read_b64_tr_b16 a[164:165], v12 offset:40960
    v_mfma_f32_16x16x32_bf16 v[100:103], a[148:151], a[212:215], v[100:103]
    v_exp_f32 v111, v111
    v_mfma_f32_16x16x32_bf16 v[100:103], a[144:147], a[208:211], v[100:103]
    ds_read_b64_tr_b16 a[166:167], v12 offset:45056
    v_cvt_pk_bf16_f32 v253, v110, v111
    v_mfma_f32_16x16x32_bf16 v[104:107], a[144:147], a[224:227], v[88:91]
    v_exp_f32 v96, v96
    v_mfma_f32_16x16x32_bf16 v[104:107], a[148:151], a[228:231], v[104:107]
    buffer_load_dwordx4 a[132:135], v21, s[64:67], s76 offen offset:0 sc1
    ds_read_b64_tr_b16 a[168:169], v12 offset:49152
    v_mfma_f32_16x16x32_bf16 v[104:107], a[152:155], a[232:235], v[104:107]
    v_exp_f32 v97, v97
    v_mfma_f32_16x16x32_bf16 v[104:107], a[156:159], a[236:239], v[104:107]
    ds_read_b64_tr_b16 a[170:171], v12 offset:53248
    v_cvt_pk_bf16_f32 v206, v96, v97
    v_mfma_f32_16x16x32_bf16 v[108:111], a[156:159], a[252:255], v[92:95]
    v_exp_f32 v98, v98
    v_mfma_f32_16x16x32_bf16 v[108:111], a[152:155], a[248:251], v[108:111]
    buffer_load_dwordx4 a[136:139], v22, s[64:67], s76 offen offset:0 sc1
    ds_read_b64_tr_b16 a[172:173], v12 offset:57344
    v_mfma_f32_16x16x32_bf16 v[108:111], a[148:151], a[244:247], v[108:111]
    v_exp_f32 v99, v99
    v_mfma_f32_16x16x32_bf16 v[108:111], a[144:147], a[240:243], v[108:111]
    ds_read_b64_tr_b16 a[174:175], v12 offset:61440
    v_cvt_pk_bf16_f32 v207, v98, v99
    v_mfma_f32_16x16x32_bf16 a[112:115], a[176:179], v[128:131], a[112:115]
    v_exp_f32 v100, v100
    v_mfma_f32_16x16x32_bf16 a[112:115], a[180:183], v[132:135], a[112:115]
    buffer_load_dwordx4 a[140:143], v23, s[64:67], s76 offen offset:0 sc1
    v_mfma_f32_16x16x32_bf16 a[112:115], a[184:187], v[136:139], a[112:115]
    v_exp_f32 v101, v101
    v_mfma_f32_16x16x32_bf16 a[112:115], a[188:191], v[140:143], a[112:115]
    s_add_u32 m0, s73, 81920
    v_cvt_pk_bf16_f32 v222, v100, v101
    v_mfma_f32_16x16x32_bf16 a[116:119], a[188:191], v[156:159], a[116:119]
    v_exp_f32 v102, v102
    v_mfma_f32_16x16x32_bf16 a[116:119], a[184:187], v[152:155], a[116:119]
    buffer_load_dwordx4 v116, s[68:71], s75 offen offset:0 lds
    v_mfma_f32_16x16x32_bf16 a[116:119], a[180:183], v[148:151], a[116:119]
    v_exp_f32 v103, v103
    v_mfma_f32_16x16x32_bf16 a[116:119], a[176:179], v[144:147], a[116:119]
    v_cvt_pk_bf16_f32 v223, v102, v103
    v_mfma_f32_16x16x32_bf16 a[120:123], a[176:179], v[160:163], a[120:123]
    v_exp_f32 v104, v104
    v_mfma_f32_16x16x32_bf16 a[120:123], a[180:183], v[164:167], a[120:123]
    buffer_load_dwordx4 v117, s[68:71], s75 offen offset:1024 lds
    v_mfma_f32_16x16x32_bf16 a[120:123], a[184:187], v[168:171], a[120:123]
    v_exp_f32 v105, v105
    v_mfma_f32_16x16x32_bf16 a[120:123], a[188:191], v[172:175], a[120:123]
    v_cvt_pk_bf16_f32 v238, v104, v105
    v_mfma_f32_16x16x32_bf16 a[124:127], a[188:191], v[188:191], a[124:127]
    v_exp_f32 v106, v106
    v_mfma_f32_16x16x32_bf16 a[124:127], a[184:187], v[184:187], a[124:127]
    buffer_load_dwordx4 a[144:147], v20, s[64:67], s76 offen offset:1024 sc1
    v_mfma_f32_16x16x32_bf16 a[124:127], a[180:183], v[180:183], a[124:127]
    v_exp_f32 v107, v107
    v_mfma_f32_16x16x32_bf16 a[124:127], a[176:179], v[176:179], a[124:127]
    v_cvt_pk_bf16_f32 v239, v106, v107
    v_smfmac_f32_16x16x64_bf16 v[76:79], v[60:63], v[184:191], v56
    s_waitcnt lgkmcnt(0)
    v_smfmac_f32_16x16x64_bf16 v[64:67], v[60:63], v[192:199], v56
    v_exp_f32 v108, v108
    v_smfmac_f32_16x16x64_bf16 v[64:67], v[60:63], v[200:207], v56
    v_exp_f32 v109, v109
    v_smfmac_f32_16x16x64_bf16 v[68:71], v[60:63], v[208:215], v56
    v_exp_f32 v110, v110
    v_smfmac_f32_16x16x64_bf16 v[68:71], v[60:63], v[216:223], v56
    v_exp_f32 v111, v111
    v_smfmac_f32_16x16x64_bf16 v[72:75], v[60:63], v[224:231], v56
    v_cvt_pk_bf16_f32 v254, v108, v109
    v_cvt_pk_bf16_f32 v255, v110, v111
    v_smfmac_f32_16x16x64_bf16 v[72:75], v[60:63], v[232:239], v56
    v_smfmac_f32_16x16x64_bf16 v[76:79], v[60:63], v[240:247], v56
    buffer_load_dwordx4 a[148:151], v21, s[64:67], s76 offen offset:1024 sc1
    v_smfmac_f32_16x16x64_bf16 v[76:79], v[60:63], v[248:255], v56
    s_waitcnt lgkmcnt(0)
    v_mfma_f32_16x16x32_bf16 a[0:3], a[160:163], v[192:195], a[0:3]
    ds_read_b64_tr_b16 a[176:177], v13 offset:32768
    s_lshl_b32 s4, s32, 2
    s_add_u32 s4, s4, 61440
    v_mfma_f32_16x16x32_bf16 a[0:3], a[164:167], v[196:199], a[0:3]
    ds_read_b64_tr_b16 a[178:179], v13 offset:36864
    v_mov_b32 v37, s4
    v_mov_b32 v38, 61440
    v_mfma_f32_16x16x32_bf16 a[0:3], a[168:171], v[200:203], a[0:3]
    buffer_load_dwordx4 a[152:155], v22, s[64:67], s76 offen offset:1024 sc1
    ds_read_b64_tr_b16 a[180:181], v13 offset:40960
    v_add_f32 v64, v64, v65
    v_mfma_f32_16x16x32_bf16 a[0:3], a[172:175], v[204:207], a[0:3]
    ds_read_b64_tr_b16 a[182:183], v13 offset:45056
    v_add_f32 v68, v68, v69
    v_add_f32 v72, v72, v73
    v_mfma_f32_16x16x32_bf16 a[4:7], a[172:175], v[220:223], a[4:7]
    ds_read_b64_tr_b16 a[184:185], v13 offset:49152
    v_add_f32 v76, v76, v77
    v_add_f32 v36, v64, v68
    v_mfma_f32_16x16x32_bf16 a[4:7], a[168:171], v[216:219], a[4:7]
    buffer_load_dwordx4 a[156:159], v23, s[64:67], s76 offen offset:1024 sc1
    ds_read_b64_tr_b16 a[186:187], v13 offset:53248
    s_add_u32 s76, s76, 16384
    v_mfma_f32_16x16x32_bf16 a[4:7], a[164:167], v[212:215], a[4:7]
    ds_read_b64_tr_b16 a[188:189], v13 offset:57344
    v_add_f32 v36, v36, v72
    v_add_f32 v36, v36, v76
    v_mfma_f32_16x16x32_bf16 a[4:7], a[160:163], v[208:211], a[4:7]
    ds_read_b64_tr_b16 a[190:191], v13 offset:61440
    v_cmp_ngt_f32 vcc, 0x5d800000, v36
    v_mfma_f32_16x16x32_bf16 a[8:11], a[160:163], v[224:227], a[8:11]
    v_rcp_f32 v64, v64
    v_mfma_f32_16x16x32_bf16 a[8:11], a[164:167], v[228:231], a[8:11]
    buffer_load_dwordx4 v118, s[68:71], s75 offen offset:2048 lds
    s_cmp_lg_u64 vcc, 0
    s_cselect_b32 s3, 1, 0
    v_mfma_f32_16x16x32_bf16 a[8:11], a[168:171], v[232:235], a[8:11]
    v_mov_b32 v36, s3
    ds_write_b32 v37, v36
    v_mfma_f32_16x16x32_bf16 a[8:11], a[172:175], v[236:239], a[8:11]
    v_mfma_f32_16x16x32_bf16 a[12:15], a[172:175], v[252:255], a[12:15]
    buffer_load_dwordx4 v119, s[68:71], s75 offen offset:3072 lds
    v_mfma_f32_16x16x32_bf16 a[12:15], a[168:171], v[248:251], a[12:15]
    v_mfma_f32_16x16x32_bf16 a[12:15], a[164:167], v[244:247], a[12:15]
    s_add_u32 m0, s73, 86016
    v_mfma_f32_16x16x32_bf16 a[12:15], a[160:163], v[240:243], a[12:15]
    buffer_load_dwordx4 v120, s[68:71], s75 offen offset:0 lds
    s_add_u32 s75, s75, 81920
    s_waitcnt lgkmcnt(0)
    s_barrier
    v_mfma_f32_16x16x32_bf16 a[16:19], a[176:179], v[192:195], a[16:19]
    ds_read_b64_tr_b16 a[160:161], v14 offset:32768
    v_rcp_f32 v68, v68
    v_mfma_f32_16x16x32_bf16 a[16:19], a[180:183], v[196:199], a[16:19]
    ds_read_b64_tr_b16 a[162:163], v14 offset:36864
    s_add_u32 m0, s73, 102400
    v_rcp_f32 v72, v72
    v_mfma_f32_16x16x32_bf16 a[16:19], a[184:187], v[200:203], a[16:19]
    buffer_load_dwordx4 v116, s[68:71], s75 offen offset:0 lds
    ds_read_b64_tr_b16 a[164:165], v14 offset:40960
    v_rcp_f32 v76, v76
    v_mfma_f32_16x16x32_bf16 a[16:19], a[188:191], v[204:207], a[16:19]
    ds_read_b64_tr_b16 a[166:167], v14 offset:45056
    v_mfma_f32_16x16x32_bf16 a[20:23], a[188:191], v[220:223], a[20:23]
    ds_read_b64_tr_b16 a[168:169], v14 offset:49152
    v_mfma_f32_16x16x32_bf16 a[20:23], a[184:187], v[216:219], a[20:23]
    buffer_load_dwordx4 v117, s[68:71], s75 offen offset:1024 lds
    ds_read_b64_tr_b16 a[170:171], v14 offset:53248
    v_mfma_f32_16x16x32_bf16 a[20:23], a[180:183], v[212:215], a[20:23]
    ds_read_b64_tr_b16 a[172:173], v14 offset:57344
    v_mfma_f32_16x16x32_bf16 a[20:23], a[176:179], v[208:211], a[20:23]
    ds_read_b64_tr_b16 a[174:175], v14 offset:61440
    v_mfma_f32_16x16x32_bf16 a[24:27], a[176:179], v[224:227], a[24:27]
    ds_read_b128 v[40:43], v38
    v_mfma_f32_16x16x32_bf16 a[24:27], a[180:183], v[228:231], a[24:27]
    buffer_load_dwordx4 v118, s[68:71], s75 offen offset:2048 lds
    v_mfma_f32_16x16x32_bf16 a[24:27], a[184:187], v[232:235], a[24:27]
    v_mfma_f32_16x16x32_bf16 a[24:27], a[188:191], v[236:239], a[24:27]
    v_mfma_f32_16x16x32_bf16 a[28:31], a[188:191], v[252:255], a[28:31]
    buffer_load_dwordx4 v119, s[68:71], s75 offen offset:3072 lds
    v_mfma_f32_16x16x32_bf16 a[28:31], a[184:187], v[248:251], a[28:31]
    v_mfma_f32_16x16x32_bf16 a[28:31], a[180:183], v[244:247], a[28:31]
    s_add_u32 m0, s73, 106496
    v_mfma_f32_16x16x32_bf16 a[28:31], a[176:179], v[240:243], a[28:31]
    buffer_load_dwordx4 v120, s[68:71], s75 offen offset:0 lds
    s_add_u32 s75, s75, 81920
    s_waitcnt lgkmcnt(0)
    v_or_b32 v40, v40, v41
    v_or3_b32 v40, v40, v42, v43
    s_nop 0
    v_readfirstlane_b32 s3, v40
    s_andn2_b32 s3, s3, s41
    s_cbranch_scc1 L_fallback
    v_mfma_f32_16x16x32_bf16 a[32:35], a[160:163], v[192:195], a[32:35]
    ds_read_b64_tr_b16 a[176:177], v15 offset:32768
    v_accvgpr_read_b32 v36, a0
    v_accvgpr_read_b32 v37, a1
    v_accvgpr_read_b32 v38, a2
    v_mfma_f32_16x16x32_bf16 a[32:35], a[164:167], v[196:199], a[32:35]
    ds_read_b64_tr_b16 a[178:179], v15 offset:36864
    v_accvgpr_read_b32 v39, a3
    v_accvgpr_read_b32 v40, a16
    v_accvgpr_read_b32 v41, a17
    v_mfma_f32_16x16x32_bf16 a[32:35], a[168:171], v[200:203], a[32:35]
    ds_read_b64_tr_b16 a[180:181], v15 offset:40960
    v_accvgpr_read_b32 v42, a18
    v_accvgpr_read_b32 v43, a19
    v_mul_f32 v36, v36, v64
    v_mfma_f32_16x16x32_bf16 a[32:35], a[172:175], v[204:207], a[32:35]
    ds_read_b64_tr_b16 a[182:183], v15 offset:45056
    v_mul_f32 v37, v37, v64
    v_mul_f32 v38, v38, v64
    v_mul_f32 v39, v39, v64
    v_mfma_f32_16x16x32_bf16 a[36:39], a[172:175], v[220:223], a[36:39]
    ds_read_b64_tr_b16 a[184:185], v15 offset:49152
    v_mul_f32 v40, v40, v64
    v_mul_f32 v41, v41, v64
    v_mul_f32 v42, v42, v64
    v_mfma_f32_16x16x32_bf16 a[36:39], a[168:171], v[216:219], a[36:39]
    ds_read_b64_tr_b16 a[186:187], v15 offset:53248
    v_mul_f32 v43, v43, v64
    v_cvt_pk_bf16_f32 v80, v36, v37
    v_cvt_pk_bf16_f32 v81, v38, v39
    v_mfma_f32_16x16x32_bf16 a[36:39], a[164:167], v[212:215], a[36:39]
    ds_read_b64_tr_b16 a[188:189], v15 offset:57344
    v_cvt_pk_bf16_f32 v82, v40, v41
    v_cvt_pk_bf16_f32 v83, v42, v43
    buffer_store_dwordx4 v[80:83], v1, s[8:11], s78 offen offset:0 sc1
    v_mfma_f32_16x16x32_bf16 a[36:39], a[160:163], v[208:211], a[36:39]
    ds_read_b64_tr_b16 a[190:191], v15 offset:61440
    v_accvgpr_read_b32 v44, a4
    v_accvgpr_read_b32 v45, a5
    v_accvgpr_read_b32 v46, a6
    v_mfma_f32_16x16x32_bf16 a[40:43], a[160:163], v[224:227], a[40:43]
    v_accvgpr_read_b32 v47, a7
    v_accvgpr_read_b32 v48, a20
    v_accvgpr_read_b32 v49, a21
    v_accvgpr_read_b32 v50, a22
    v_mfma_f32_16x16x32_bf16 a[40:43], a[164:167], v[228:231], a[40:43]
    buffer_load_dwordx4 a[192:195], v20, s[64:67], s76 offen offset:0 sc1
    v_accvgpr_read_b32 v51, a23
    v_mul_f32 v44, v44, v68
    v_mul_f32 v45, v45, v68
    v_mfma_f32_16x16x32_bf16 a[40:43], a[168:171], v[232:235], a[40:43]
    v_mul_f32 v46, v46, v68
    v_mul_f32 v47, v47, v68
    v_mul_f32 v48, v48, v68
    v_mul_f32 v49, v49, v68
    v_mfma_f32_16x16x32_bf16 a[40:43], a[172:175], v[236:239], a[40:43]
    v_mul_f32 v50, v50, v68
    v_mul_f32 v51, v51, v68
    v_cvt_pk_bf16_f32 v84, v44, v45
    v_cvt_pk_bf16_f32 v85, v46, v47
    v_mfma_f32_16x16x32_bf16 a[44:47], a[172:175], v[252:255], a[44:47]
    v_cvt_pk_bf16_f32 v86, v48, v49
    v_cvt_pk_bf16_f32 v87, v50, v51
    buffer_store_dwordx4 v[84:87], v1, s[8:11], s78 offen offset:1024 sc1
    v_accvgpr_read_b32 v36, a8
    v_mfma_f32_16x16x32_bf16 a[44:47], a[168:171], v[248:251], a[44:47]
    v_accvgpr_read_b32 v37, a9
    v_accvgpr_read_b32 v38, a10
    v_accvgpr_read_b32 v39, a11
    v_accvgpr_read_b32 v40, a24
    v_mfma_f32_16x16x32_bf16 a[44:47], a[164:167], v[244:247], a[44:47]
    buffer_load_dwordx4 a[196:199], v21, s[64:67], s76 offen offset:0 sc1
    v_accvgpr_read_b32 v41, a25
    v_accvgpr_read_b32 v42, a26
    v_accvgpr_read_b32 v43, a27
    v_mfma_f32_16x16x32_bf16 a[44:47], a[160:163], v[240:243], a[44:47]
    s_waitcnt lgkmcnt(0)
    v_mfma_f32_16x16x32_bf16 a[48:51], a[176:179], v[192:195], a[48:51]
    ds_read_b64_tr_b16 a[160:161], v16 offset:32768
    v_mul_f32 v36, v36, v72
    v_mul_f32 v37, v37, v72
    v_mul_f32 v38, v38, v72
    v_mfma_f32_16x16x32_bf16 a[48:51], a[180:183], v[196:199], a[48:51]
    ds_read_b64_tr_b16 a[162:163], v16 offset:36864
    v_mul_f32 v39, v39, v72
    v_mul_f32 v40, v40, v72
    v_mul_f32 v41, v41, v72
    v_mfma_f32_16x16x32_bf16 a[48:51], a[184:187], v[200:203], a[48:51]
    ds_read_b64_tr_b16 a[164:165], v16 offset:40960
    v_mul_f32 v42, v42, v72
    v_mul_f32 v43, v43, v72
    v_cvt_pk_bf16_f32 v88, v36, v37
    v_mfma_f32_16x16x32_bf16 a[48:51], a[188:191], v[204:207], a[48:51]
    ds_read_b64_tr_b16 a[166:167], v16 offset:45056
    v_cvt_pk_bf16_f32 v89, v38, v39
    v_cvt_pk_bf16_f32 v90, v40, v41
    v_cvt_pk_bf16_f32 v91, v42, v43
    v_mfma_f32_16x16x32_bf16 a[52:55], a[188:191], v[220:223], a[52:55]
    ds_read_b64_tr_b16 a[168:169], v16 offset:49152
    buffer_store_dwordx4 v[88:91], v1, s[8:11], s78 offen offset:2048 sc1
    v_accvgpr_read_b32 v44, a12
    v_accvgpr_read_b32 v45, a13
    v_mfma_f32_16x16x32_bf16 a[52:55], a[184:187], v[216:219], a[52:55]
    ds_read_b64_tr_b16 a[170:171], v16 offset:53248
    v_accvgpr_read_b32 v46, a14
    v_accvgpr_read_b32 v47, a15
    v_accvgpr_read_b32 v48, a28
    v_mfma_f32_16x16x32_bf16 a[52:55], a[180:183], v[212:215], a[52:55]
    ds_read_b64_tr_b16 a[172:173], v16 offset:57344
    v_accvgpr_read_b32 v49, a29
    v_accvgpr_read_b32 v50, a30
    v_accvgpr_read_b32 v51, a31
    v_mfma_f32_16x16x32_bf16 a[52:55], a[176:179], v[208:211], a[52:55]
    ds_read_b64_tr_b16 a[174:175], v16 offset:61440
    v_mul_f32 v44, v44, v76
    v_mul_f32 v45, v45, v76
    v_mul_f32 v46, v46, v76
    v_mfma_f32_16x16x32_bf16 a[56:59], a[176:179], v[224:227], a[56:59]
    v_mul_f32 v47, v47, v76
    v_mul_f32 v48, v48, v76
    v_mul_f32 v49, v49, v76
    v_mul_f32 v50, v50, v76
    v_mfma_f32_16x16x32_bf16 a[56:59], a[180:183], v[228:231], a[56:59]
    buffer_load_dwordx4 a[208:211], v20, s[64:67], s76 offen offset:1024 sc1
    v_mul_f32 v51, v51, v76
    v_cvt_pk_bf16_f32 v92, v44, v45
    v_cvt_pk_bf16_f32 v93, v46, v47
    v_mfma_f32_16x16x32_bf16 a[56:59], a[184:187], v[232:235], a[56:59]
    v_cvt_pk_bf16_f32 v94, v48, v49
    v_cvt_pk_bf16_f32 v95, v50, v51
    buffer_store_dwordx4 v[92:95], v1, s[8:11], s78 offen offset:3072 sc1
    s_add_u32 s78, s78, 4096
    v_mfma_f32_16x16x32_bf16 a[56:59], a[188:191], v[236:239], a[56:59]
    v_mfma_f32_16x16x32_bf16 a[60:63], a[188:191], v[252:255], a[60:63]
    v_mfma_f32_16x16x32_bf16 a[60:63], a[184:187], v[248:251], a[60:63]
    v_mfma_f32_16x16x32_bf16 a[60:63], a[180:183], v[244:247], a[60:63]
    buffer_load_dwordx4 a[212:215], v21, s[64:67], s76 offen offset:1024 sc1
    s_add_u32 s76, s76, 8192
    v_mfma_f32_16x16x32_bf16 a[60:63], a[176:179], v[240:243], a[60:63]
    s_waitcnt lgkmcnt(0)
    v_mfma_f32_16x16x32_bf16 a[64:67], a[160:163], v[192:195], a[64:67]
    ds_read_b64_tr_b16 a[176:177], v17 offset:32768
    v_accvgpr_read_b32 v36, a32
    v_accvgpr_read_b32 v37, a33
    v_accvgpr_read_b32 v38, a34
    v_mfma_f32_16x16x32_bf16 a[64:67], a[164:167], v[196:199], a[64:67]
    ds_read_b64_tr_b16 a[178:179], v17 offset:36864
    v_accvgpr_read_b32 v39, a35
    v_accvgpr_read_b32 v40, a48
    v_accvgpr_read_b32 v41, a49
    v_mfma_f32_16x16x32_bf16 a[64:67], a[168:171], v[200:203], a[64:67]
    ds_read_b64_tr_b16 a[180:181], v17 offset:40960
    v_accvgpr_read_b32 v42, a50
    v_accvgpr_read_b32 v43, a51
    v_mul_f32 v36, v36, v64
    v_mfma_f32_16x16x32_bf16 a[64:67], a[172:175], v[204:207], a[64:67]
    ds_read_b64_tr_b16 a[182:183], v17 offset:45056
    v_mul_f32 v37, v37, v64
    v_mul_f32 v38, v38, v64
    v_mul_f32 v39, v39, v64
    v_mfma_f32_16x16x32_bf16 a[68:71], a[172:175], v[220:223], a[68:71]
    ds_read_b64_tr_b16 a[184:185], v17 offset:49152
    v_mul_f32 v40, v40, v64
    v_mul_f32 v41, v41, v64
    v_mul_f32 v42, v42, v64
    v_mfma_f32_16x16x32_bf16 a[68:71], a[168:171], v[216:219], a[68:71]
    ds_read_b64_tr_b16 a[186:187], v17 offset:53248
    v_mul_f32 v43, v43, v64
    v_cvt_pk_bf16_f32 v80, v36, v37
    v_cvt_pk_bf16_f32 v81, v38, v39
    v_mfma_f32_16x16x32_bf16 a[68:71], a[164:167], v[212:215], a[68:71]
    ds_read_b64_tr_b16 a[188:189], v17 offset:57344
    v_cvt_pk_bf16_f32 v82, v40, v41
    v_cvt_pk_bf16_f32 v83, v42, v43
    buffer_store_dwordx4 v[80:83], v1, s[8:11], s78 offen offset:0 sc1
    v_mfma_f32_16x16x32_bf16 a[68:71], a[160:163], v[208:211], a[68:71]
    ds_read_b64_tr_b16 a[190:191], v17 offset:61440
    v_accvgpr_read_b32 v44, a36
    v_accvgpr_read_b32 v45, a37
    v_accvgpr_read_b32 v46, a38
    v_mfma_f32_16x16x32_bf16 a[72:75], a[160:163], v[224:227], a[72:75]
    v_accvgpr_read_b32 v47, a39
    v_accvgpr_read_b32 v48, a52
    v_accvgpr_read_b32 v49, a53
    v_accvgpr_read_b32 v50, a54
    v_mfma_f32_16x16x32_bf16 a[72:75], a[164:167], v[228:231], a[72:75]
    v_accvgpr_read_b32 v51, a55
    v_mul_f32 v44, v44, v68
    v_mul_f32 v45, v45, v68
    v_mul_f32 v46, v46, v68
    v_mfma_f32_16x16x32_bf16 a[72:75], a[168:171], v[232:235], a[72:75]
    v_mul_f32 v47, v47, v68
    v_mul_f32 v48, v48, v68
    v_mul_f32 v49, v49, v68
    v_mul_f32 v50, v50, v68
    v_mfma_f32_16x16x32_bf16 a[72:75], a[172:175], v[236:239], a[72:75]
    v_mul_f32 v51, v51, v68
    v_cvt_pk_bf16_f32 v84, v44, v45
    v_cvt_pk_bf16_f32 v85, v46, v47
    v_cvt_pk_bf16_f32 v86, v48, v49
    v_mfma_f32_16x16x32_bf16 a[76:79], a[172:175], v[252:255], a[76:79]
    v_cvt_pk_bf16_f32 v87, v50, v51
    buffer_store_dwordx4 v[84:87], v1, s[8:11], s78 offen offset:1024 sc1
    v_accvgpr_read_b32 v36, a40
    v_accvgpr_read_b32 v37, a41
    v_mfma_f32_16x16x32_bf16 a[76:79], a[168:171], v[248:251], a[76:79]
    v_accvgpr_read_b32 v38, a42
    v_accvgpr_read_b32 v39, a43
    v_accvgpr_read_b32 v40, a56
    v_accvgpr_read_b32 v41, a57
    v_mfma_f32_16x16x32_bf16 a[76:79], a[164:167], v[244:247], a[76:79]
    v_accvgpr_read_b32 v42, a58
    v_accvgpr_read_b32 v43, a59
    v_mul_f32 v36, v36, v72
    v_mul_f32 v37, v37, v72
    v_mfma_f32_16x16x32_bf16 a[76:79], a[160:163], v[240:243], a[76:79]
    s_waitcnt lgkmcnt(0)
    v_mfma_f32_16x16x32_bf16 a[80:83], a[176:179], v[192:195], a[80:83]
    ds_read_b64_tr_b16 a[160:161], v18 offset:32768
    v_mul_f32 v38, v38, v72
    v_mul_f32 v39, v39, v72
    v_mul_f32 v40, v40, v72
    v_mfma_f32_16x16x32_bf16 a[80:83], a[180:183], v[196:199], a[80:83]
    ds_read_b64_tr_b16 a[162:163], v18 offset:36864
    v_mul_f32 v41, v41, v72
    v_mul_f32 v42, v42, v72
    v_mul_f32 v43, v43, v72
    v_mfma_f32_16x16x32_bf16 a[80:83], a[184:187], v[200:203], a[80:83]
    ds_read_b64_tr_b16 a[164:165], v18 offset:40960
    v_cvt_pk_bf16_f32 v88, v36, v37
    v_cvt_pk_bf16_f32 v89, v38, v39
    v_cvt_pk_bf16_f32 v90, v40, v41
    v_mfma_f32_16x16x32_bf16 a[80:83], a[188:191], v[204:207], a[80:83]
    ds_read_b64_tr_b16 a[166:167], v18 offset:45056
    v_cvt_pk_bf16_f32 v91, v42, v43
    buffer_store_dwordx4 v[88:91], v1, s[8:11], s78 offen offset:2048 sc1
    v_accvgpr_read_b32 v44, a44
    v_mfma_f32_16x16x32_bf16 a[84:87], a[188:191], v[220:223], a[84:87]
    ds_read_b64_tr_b16 a[168:169], v18 offset:49152
    v_accvgpr_read_b32 v45, a45
    v_accvgpr_read_b32 v46, a46
    v_accvgpr_read_b32 v47, a47
    v_mfma_f32_16x16x32_bf16 a[84:87], a[184:187], v[216:219], a[84:87]
    ds_read_b64_tr_b16 a[170:171], v18 offset:53248
    v_accvgpr_read_b32 v48, a60
    v_accvgpr_read_b32 v49, a61
    v_accvgpr_read_b32 v50, a62
    v_mfma_f32_16x16x32_bf16 a[84:87], a[180:183], v[212:215], a[84:87]
    ds_read_b64_tr_b16 a[172:173], v18 offset:57344
    v_accvgpr_read_b32 v51, a63
    v_mul_f32 v44, v44, v76
    v_mul_f32 v45, v45, v76
    v_mfma_f32_16x16x32_bf16 a[84:87], a[176:179], v[208:211], a[84:87]
    ds_read_b64_tr_b16 a[174:175], v18 offset:61440
    v_mul_f32 v46, v46, v76
    v_mul_f32 v47, v47, v76
    v_mul_f32 v48, v48, v76
    v_mfma_f32_16x16x32_bf16 a[88:91], a[176:179], v[224:227], a[88:91]
    v_mul_f32 v49, v49, v76
    v_mul_f32 v50, v50, v76
    v_mul_f32 v51, v51, v76
    v_cvt_pk_bf16_f32 v92, v44, v45
    v_mfma_f32_16x16x32_bf16 a[88:91], a[180:183], v[228:231], a[88:91]
    v_cvt_pk_bf16_f32 v93, v46, v47
    v_cvt_pk_bf16_f32 v94, v48, v49
    v_cvt_pk_bf16_f32 v95, v50, v51
    buffer_store_dwordx4 v[92:95], v1, s[8:11], s78 offen offset:3072 sc1
    v_mfma_f32_16x16x32_bf16 a[88:91], a[184:187], v[232:235], a[88:91]
    s_add_u32 s78, s78, 4096
    v_mfma_f32_16x16x32_bf16 a[88:91], a[188:191], v[236:239], a[88:91]
    v_mfma_f32_16x16x32_bf16 a[92:95], a[188:191], v[252:255], a[92:95]
    v_mfma_f32_16x16x32_bf16 a[92:95], a[184:187], v[248:251], a[92:95]
    v_mfma_f32_16x16x32_bf16 a[92:95], a[180:183], v[244:247], a[92:95]
    v_mfma_f32_16x16x32_bf16 a[92:95], a[176:179], v[240:243], a[92:95]
    s_waitcnt lgkmcnt(0)
    v_mfma_f32_16x16x32_bf16 a[96:99], a[160:163], v[192:195], a[96:99]
    ds_read_b64_tr_b16 a[176:177], v19 offset:32768
    v_accvgpr_read_b32 v36, a64
    v_accvgpr_read_b32 v37, a65
    v_accvgpr_read_b32 v38, a66
    v_mfma_f32_16x16x32_bf16 a[96:99], a[164:167], v[196:199], a[96:99]
    ds_read_b64_tr_b16 a[178:179], v19 offset:36864
    v_accvgpr_read_b32 v39, a67
    v_accvgpr_read_b32 v40, a80
    v_accvgpr_read_b32 v41, a81
    v_mfma_f32_16x16x32_bf16 a[96:99], a[168:171], v[200:203], a[96:99]
    ds_read_b64_tr_b16 a[180:181], v19 offset:40960
    v_accvgpr_read_b32 v42, a82
    v_accvgpr_read_b32 v43, a83
    v_mul_f32 v36, v36, v64
    v_mfma_f32_16x16x32_bf16 a[96:99], a[172:175], v[204:207], a[96:99]
    ds_read_b64_tr_b16 a[182:183], v19 offset:45056
    v_mul_f32 v37, v37, v64
    v_mul_f32 v38, v38, v64
    v_mul_f32 v39, v39, v64
    v_mfma_f32_16x16x32_bf16 a[100:103], a[172:175], v[220:223], a[100:103]
    ds_read_b64_tr_b16 a[184:185], v19 offset:49152
    v_mul_f32 v40, v40, v64
    v_mul_f32 v41, v41, v64
    v_mul_f32 v42, v42, v64
    v_mfma_f32_16x16x32_bf16 a[100:103], a[168:171], v[216:219], a[100:103]
    ds_read_b64_tr_b16 a[186:187], v19 offset:53248
    v_mul_f32 v43, v43, v64
    v_cvt_pk_bf16_f32 v80, v36, v37
    v_cvt_pk_bf16_f32 v81, v38, v39
    v_mfma_f32_16x16x32_bf16 a[100:103], a[164:167], v[212:215], a[100:103]
    ds_read_b64_tr_b16 a[188:189], v19 offset:57344
    v_cvt_pk_bf16_f32 v82, v40, v41
    v_cvt_pk_bf16_f32 v83, v42, v43
    buffer_store_dwordx4 v[80:83], v1, s[8:11], s78 offen offset:0 sc1
    v_mfma_f32_16x16x32_bf16 a[100:103], a[160:163], v[208:211], a[100:103]
    ds_read_b64_tr_b16 a[190:191], v19 offset:61440
    v_accvgpr_read_b32 v44, a68
    v_accvgpr_read_b32 v45, a69
    v_accvgpr_read_b32 v46, a70
    v_mfma_f32_16x16x32_bf16 a[104:107], a[160:163], v[224:227], a[104:107]
    v_accvgpr_read_b32 v47, a71
    v_accvgpr_read_b32 v48, a84
    v_accvgpr_read_b32 v49, a85
    v_accvgpr_read_b32 v50, a86
    v_mfma_f32_16x16x32_bf16 a[104:107], a[164:167], v[228:231], a[104:107]
    v_accvgpr_read_b32 v51, a87
    v_mul_f32 v44, v44, v68
    v_mul_f32 v45, v45, v68
    v_mul_f32 v46, v46, v68
    v_mfma_f32_16x16x32_bf16 a[104:107], a[168:171], v[232:235], a[104:107]
    v_mul_f32 v47, v47, v68
    v_mul_f32 v48, v48, v68
    v_mul_f32 v49, v49, v68
    v_mul_f32 v50, v50, v68
    v_mfma_f32_16x16x32_bf16 a[104:107], a[172:175], v[236:239], a[104:107]
    v_mul_f32 v51, v51, v68
    v_cvt_pk_bf16_f32 v84, v44, v45
    v_cvt_pk_bf16_f32 v85, v46, v47
    v_cvt_pk_bf16_f32 v86, v48, v49
    v_mfma_f32_16x16x32_bf16 a[108:111], a[172:175], v[252:255], a[108:111]
    v_cvt_pk_bf16_f32 v87, v50, v51
    buffer_store_dwordx4 v[84:87], v1, s[8:11], s78 offen offset:1024 sc1
    v_accvgpr_read_b32 v36, a72
    v_accvgpr_read_b32 v37, a73
    v_mfma_f32_16x16x32_bf16 a[108:111], a[168:171], v[248:251], a[108:111]
    v_accvgpr_read_b32 v38, a74
    v_accvgpr_read_b32 v39, a75
    v_accvgpr_read_b32 v40, a88
    v_accvgpr_read_b32 v41, a89
    v_mfma_f32_16x16x32_bf16 a[108:111], a[164:167], v[244:247], a[108:111]
    v_accvgpr_read_b32 v42, a90
    v_accvgpr_read_b32 v43, a91
    v_mul_f32 v36, v36, v72
    v_mul_f32 v37, v37, v72
    v_mfma_f32_16x16x32_bf16 a[108:111], a[160:163], v[240:243], a[108:111]
    s_waitcnt vmcnt(37) lgkmcnt(0)
    s_barrier
    v_mfma_f32_16x16x32_bf16 a[112:115], a[176:179], v[192:195], a[112:115]
    ds_read_b64_tr_b16 v[96:97], v121 offset:0
    v_mul_f32 v38, v38, v72
    v_mul_f32 v39, v39, v72
    v_mul_f32 v40, v40, v72
    v_mfma_f32_16x16x32_bf16 a[112:115], a[180:183], v[196:199], a[112:115]
    ds_read_b64_tr_b16 v[98:99], v121 offset:5120
    v_mul_f32 v41, v41, v72
    v_mul_f32 v42, v42, v72
    v_mul_f32 v43, v43, v72
    v_mfma_f32_16x16x32_bf16 a[112:115], a[184:187], v[200:203], a[112:115]
    ds_read_b64_tr_b16 v[100:101], v121 offset:10240
    v_cvt_pk_bf16_f32 v88, v36, v37
    v_cvt_pk_bf16_f32 v89, v38, v39
    v_cvt_pk_bf16_f32 v90, v40, v41
    v_mfma_f32_16x16x32_bf16 a[112:115], a[188:191], v[204:207], a[112:115]
    ds_read_b64_tr_b16 v[102:103], v121 offset:15360
    v_cvt_pk_bf16_f32 v91, v42, v43
    buffer_store_dwordx4 v[88:91], v1, s[8:11], s78 offen offset:2048 sc1
    v_accvgpr_read_b32 v44, a76
    v_mfma_f32_16x16x32_bf16 a[116:119], a[188:191], v[220:223], a[116:119]
    ds_read_b64_tr_b16 v[104:105], v121 offset:20480
    v_accvgpr_read_b32 v45, a77
    v_accvgpr_read_b32 v46, a78
    v_accvgpr_read_b32 v47, a79
    v_mfma_f32_16x16x32_bf16 a[116:119], a[184:187], v[216:219], a[116:119]
    ds_read_b64_tr_b16 v[106:107], v121 offset:25600
    v_accvgpr_read_b32 v48, a92
    v_accvgpr_read_b32 v49, a93
    v_accvgpr_read_b32 v50, a94
    v_mfma_f32_16x16x32_bf16 a[116:119], a[180:183], v[212:215], a[116:119]
    ds_read_b64_tr_b16 v[108:109], v121 offset:30720
    v_accvgpr_read_b32 v51, a95
    v_mul_f32 v44, v44, v76
    v_mul_f32 v45, v45, v76
    v_mfma_f32_16x16x32_bf16 a[116:119], a[176:179], v[208:211], a[116:119]
    ds_read_b64_tr_b16 v[110:111], v121 offset:35840
    v_mul_f32 v46, v46, v76
    v_mul_f32 v47, v47, v76
    v_mul_f32 v48, v48, v76
    v_mfma_f32_16x16x32_bf16 a[120:123], a[176:179], v[224:227], a[120:123]
    v_mul_f32 v49, v49, v76
    v_mul_f32 v50, v50, v76
    v_mul_f32 v51, v51, v76
    v_cvt_pk_bf16_f32 v92, v44, v45
    v_mfma_f32_16x16x32_bf16 a[120:123], a[180:183], v[228:231], a[120:123]
    v_cvt_pk_bf16_f32 v93, v46, v47
    v_cvt_pk_bf16_f32 v94, v48, v49
    v_cvt_pk_bf16_f32 v95, v50, v51
    buffer_store_dwordx4 v[92:95], v1, s[8:11], s78 offen offset:3072 sc1
    v_mfma_f32_16x16x32_bf16 a[120:123], a[184:187], v[232:235], a[120:123]
    s_add_u32 s78, s78, 4096
    v_mfma_f32_16x16x32_bf16 a[120:123], a[188:191], v[236:239], a[120:123]
    v_mfma_f32_16x16x32_bf16 a[124:127], a[188:191], v[252:255], a[124:127]
    v_mfma_f32_16x16x32_bf16 a[124:127], a[184:187], v[248:251], a[124:127]
    v_mfma_f32_16x16x32_bf16 a[124:127], a[180:183], v[244:247], a[124:127]
    v_mfma_f32_16x16x32_bf16 a[124:127], a[176:179], v[240:243], a[124:127]
    s_waitcnt vmcnt(24) lgkmcnt(0)
    ds_read_b64_tr_b16 v[208:209], v122 offset:0
    ds_read_b64_tr_b16 v[210:211], v122 offset:5120
    ds_read_b64_tr_b16 v[212:213], v122 offset:10240
    ds_read_b64_tr_b16 v[214:215], v122 offset:15360
    ds_read_b64_tr_b16 v[216:217], v122 offset:20480
    ds_read_b64_tr_b16 v[218:219], v122 offset:25600
    ds_read_b64_tr_b16 v[220:221], v122 offset:30720
    ds_read_b64_tr_b16 v[222:223], v122 offset:35840
    v_mfma_f32_16x16x32_bf16 v[128:131], v[96:99], a[128:131], 0
    ds_read_b64_tr_b16 v[224:225], v121 offset:64
    v_accvgpr_read_b32 v36, a96
    v_accvgpr_read_b32 v37, a97
    v_mfma_f32_16x16x32_bf16 v[128:131], v[100:103], a[132:135], v[128:131]
    ds_read_b64_tr_b16 v[226:227], v121 offset:5184
    v_accvgpr_read_b32 v38, a98
    v_accvgpr_read_b32 v39, a99
    v_mfma_f32_16x16x32_bf16 v[128:131], v[104:107], a[136:139], v[128:131]
    ds_read_b64_tr_b16 v[228:229], v121 offset:10304
    v_accvgpr_read_b32 v40, a112
    v_accvgpr_read_b32 v41, a113
    v_mfma_f32_16x16x32_bf16 v[128:131], v[108:111], a[140:143], v[128:131]
    ds_read_b64_tr_b16 v[230:231], v121 offset:15424
    v_accvgpr_read_b32 v42, a114
    v_accvgpr_read_b32 v43, a115
    v_mfma_f32_16x16x32_bf16 v[132:135], v[108:111], a[156:159], 0
    ds_read_b64_tr_b16 v[232:233], v121 offset:20544
    v_mul_f32 v36, v36, v64
    v_mul_f32 v37, v37, v64
    v_mfma_f32_16x16x32_bf16 v[132:135], v[104:107], a[152:155], v[132:135]
    ds_read_b64_tr_b16 v[234:235], v121 offset:25664
    v_mul_f32 v38, v38, v64
    v_mul_f32 v39, v39, v64
    v_mfma_f32_16x16x32_bf16 v[132:135], v[100:103], a[148:151], v[132:135]
    ds_read_b64_tr_b16 v[236:237], v121 offset:30784
    v_mul_f32 v40, v40, v64
    v_mul_f32 v41, v41, v64
    v_mfma_f32_16x16x32_bf16 v[132:135], v[96:99], a[144:147], v[132:135]
    ds_read_b64_tr_b16 v[238:239], v121 offset:35904
    s_waitcnt lgkmcnt(8)
    v_mfma_f32_16x16x32_bf16 v[140:143], v[208:211], a[144:147], 0
    ds_read_b64_tr_b16 v[240:241], v122 offset:64
    v_mul_f32 v42, v42, v64
    v_mul_f32 v43, v43, v64
    v_mfma_f32_16x16x32_bf16 v[140:143], v[212:215], a[148:151], v[140:143]
    ds_read_b64_tr_b16 v[242:243], v122 offset:5184
    v_cvt_pk_bf16_f32 v80, v36, v37
    v_cvt_pk_bf16_f32 v81, v38, v39
    v_mfma_f32_16x16x32_bf16 v[140:143], v[216:219], a[152:155], v[140:143]
    ds_read_b64_tr_b16 v[244:245], v122 offset:10304
    v_cvt_pk_bf16_f32 v82, v40, v41
    v_cvt_pk_bf16_f32 v83, v42, v43
    v_mfma_f32_16x16x32_bf16 v[140:143], v[220:223], a[156:159], v[140:143]
    ds_read_b64_tr_b16 v[246:247], v122 offset:15424
    buffer_store_dwordx4 v[80:83], v1, s[8:11], s78 offen offset:0 sc1
    v_accvgpr_read_b32 v44, a100
    v_mfma_f32_16x16x32_bf16 v[136:139], v[220:223], a[140:143], 0
    ds_read_b64_tr_b16 v[248:249], v122 offset:20544
    v_accvgpr_read_b32 v45, a101
    v_accvgpr_read_b32 v46, a102
    v_mfma_f32_16x16x32_bf16 v[136:139], v[216:219], a[136:139], v[136:139]
    ds_read_b64_tr_b16 v[250:251], v122 offset:25664
    v_accvgpr_read_b32 v47, a103
    v_accvgpr_read_b32 v48, a116
    v_mfma_f32_16x16x32_bf16 v[136:139], v[212:215], a[132:135], v[136:139]
    ds_read_b64_tr_b16 v[252:253], v122 offset:30784
    v_accvgpr_read_b32 v49, a117
    v_accvgpr_read_b32 v50, a118
    v_mfma_f32_16x16x32_bf16 v[136:139], v[208:211], a[128:131], v[136:139]
    ds_read_b64_tr_b16 v[254:255], v122 offset:35904
    s_waitcnt lgkmcnt(8)
    v_mfma_f32_16x16x32_bf16 v[144:147], v[224:227], a[128:131], 0
    ds_read_b64_tr_b16 v[96:97], v121 offset:128
    v_accvgpr_read_b32 v51, a119
    v_mul_f32 v44, v44, v68
    v_mfma_f32_16x16x32_bf16 v[144:147], v[228:231], a[132:135], v[144:147]
    ds_read_b64_tr_b16 v[98:99], v121 offset:5248
    v_mul_f32 v45, v45, v68
    v_mul_f32 v46, v46, v68
    v_mfma_f32_16x16x32_bf16 v[144:147], v[232:235], a[136:139], v[144:147]
    ds_read_b64_tr_b16 v[100:101], v121 offset:10368
    v_mul_f32 v47, v47, v68
    v_mul_f32 v48, v48, v68
    v_mfma_f32_16x16x32_bf16 v[144:147], v[236:239], a[140:143], v[144:147]
    ds_read_b64_tr_b16 v[102:103], v121 offset:15488
    v_mul_f32 v49, v49, v68
    v_mul_f32 v50, v50, v68
    v_mfma_f32_16x16x32_bf16 v[148:151], v[236:239], a[156:159], 0
    ds_read_b64_tr_b16 v[104:105], v121 offset:20608
    v_mul_f32 v51, v51, v68
    v_cvt_pk_bf16_f32 v84, v44, v45
    v_mfma_f32_16x16x32_bf16 v[148:151], v[232:235], a[152:155], v[148:151]
    ds_read_b64_tr_b16 v[106:107], v121 offset:25728
    v_cvt_pk_bf16_f32 v85, v46, v47
    v_cvt_pk_bf16_f32 v86, v48, v49
    v_mfma_f32_16x16x32_bf16 v[148:151], v[228:231], a[148:151], v[148:151]
    ds_read_b64_tr_b16 v[108:109], v121 offset:30848
    v_cvt_pk_bf16_f32 v87, v50, v51
    buffer_store_dwordx4 v[84:87], v1, s[8:11], s78 offen offset:1024 sc1
    v_mfma_f32_16x16x32_bf16 v[148:151], v[224:227], a[144:147], v[148:151]
    ds_read_b64_tr_b16 v[110:111], v121 offset:35968
    s_waitcnt lgkmcnt(8)
    v_mfma_f32_16x16x32_bf16 v[156:159], v[240:243], a[144:147], 0
    ds_read_b64_tr_b16 v[208:209], v122 offset:128
    v_accvgpr_read_b32 v36, a104
    v_accvgpr_read_b32 v37, a105
    v_mfma_f32_16x16x32_bf16 v[156:159], v[244:247], a[148:151], v[156:159]
    ds_read_b64_tr_b16 v[210:211], v122 offset:5248
    v_accvgpr_read_b32 v38, a106
    v_accvgpr_read_b32 v39, a107
    v_mfma_f32_16x16x32_bf16 v[156:159], v[248:251], a[152:155], v[156:159]
    ds_read_b64_tr_b16 v[212:213], v122 offset:10368
    v_accvgpr_read_b32 v40, a120
    v_accvgpr_read_b32 v41, a121
    v_mfma_f32_16x16x32_bf16 v[156:159], v[252:255], a[156:159], v[156:159]
    ds_read_b64_tr_b16 v[214:215], v122 offset:15488
    v_accvgpr_read_b32 v42, a122
    v_accvgpr_read_b32 v43, a123
    v_mfma_f32_16x16x32_bf16 v[152:155], v[252:255], a[140:143], 0
    ds_read_b64_tr_b16 v[216:217], v122 offset:20608
    v_mul_f32 v36, v36, v72
    v_mul_f32 v37, v37, v72
    v_mfma_f32_16x16x32_bf16 v[152:155], v[248:251], a[136:139], v[152:155]
    ds_read_b64_tr_b16 v[218:219], v122 offset:25728
    v_mul_f32 v38, v38, v72
    v_mul_f32 v39, v39, v72
    v_mfma_f32_16x16x32_bf16 v[152:155], v[244:247], a[132:135], v[152:155]
    ds_read_b64_tr_b16 v[220:221], v122 offset:30848
    v_mul_f32 v40, v40, v72
    v_mul_f32 v41, v41, v72
    v_mfma_f32_16x16x32_bf16 v[152:155], v[240:243], a[128:131], v[152:155]
    ds_read_b64_tr_b16 v[222:223], v122 offset:35968
    s_waitcnt lgkmcnt(8)
    v_mfma_f32_16x16x32_bf16 v[160:163], v[96:99], a[128:131], 0
    ds_read_b64_tr_b16 v[224:225], v121 offset:192
    v_mul_f32 v42, v42, v72
    v_mul_f32 v43, v43, v72
    v_mfma_f32_16x16x32_bf16 v[160:163], v[100:103], a[132:135], v[160:163]
    ds_read_b64_tr_b16 v[226:227], v121 offset:5312
    buffer_load_dwordx4 a[224:227], v20, s[64:67], s76 offen offset:0 sc1
    v_cvt_pk_bf16_f32 v88, v36, v37
    v_mfma_f32_16x16x32_bf16 v[160:163], v[104:107], a[136:139], v[160:163]
    ds_read_b64_tr_b16 v[228:229], v121 offset:10432
    v_cvt_pk_bf16_f32 v89, v38, v39
    v_cvt_pk_bf16_f32 v90, v40, v41
    v_mfma_f32_16x16x32_bf16 v[160:163], v[108:111], a[140:143], v[160:163]
    ds_read_b64_tr_b16 v[230:231], v121 offset:15552
    v_cvt_pk_bf16_f32 v91, v42, v43
    buffer_store_dwordx4 v[88:91], v1, s[8:11], s78 offen offset:2048 sc1
    v_mfma_f32_16x16x32_bf16 v[164:167], v[108:111], a[156:159], 0
    ds_read_b64_tr_b16 v[232:233], v121 offset:20672
    v_accvgpr_read_b32 v44, a108
    v_accvgpr_read_b32 v45, a109
    v_mfma_f32_16x16x32_bf16 v[164:167], v[104:107], a[152:155], v[164:167]
    ds_read_b64_tr_b16 v[234:235], v121 offset:25792
    buffer_load_dwordx4 a[228:231], v21, s[64:67], s76 offen offset:0 sc1
    v_accvgpr_read_b32 v46, a110
    v_mfma_f32_16x16x32_bf16 v[164:167], v[100:103], a[148:151], v[164:167]
    ds_read_b64_tr_b16 v[236:237], v121 offset:30912
    v_accvgpr_read_b32 v47, a111
    v_accvgpr_read_b32 v48, a124
    v_mfma_f32_16x16x32_bf16 v[164:167], v[96:99], a[144:147], v[164:167]
    ds_read_b64_tr_b16 v[238:239], v121 offset:36032
    s_waitcnt lgkmcnt(8)
    v_mfma_f32_16x16x32_bf16 v[172:175], v[208:211], a[144:147], 0
    ds_read_b64_tr_b16 v[240:241], v122 offset:192
    v_accvgpr_read_b32 v49, a125
    v_accvgpr_read_b32 v50, a126
    v_mfma_f32_16x16x32_bf16 v[172:175], v[212:215], a[148:151], v[172:175]
    ds_read_b64_tr_b16 v[242:243], v122 offset:5312
    buffer_load_dwordx4 a[232:235], v22, s[64:67], s76 offen offset:0 sc1
    v_accvgpr_read_b32 v51, a127
    v_mfma_f32_16x16x32_bf16 v[172:175], v[216:219], a[152:155], v[172:175]
    ds_read_b64_tr_b16 v[244:245], v122 offset:10432
    v_mul_f32 v44, v44, v76
    v_mul_f32 v45, v45, v76
    v_mfma_f32_16x16x32_bf16 v[172:175], v[220:223], a[156:159], v[172:175]
    ds_read_b64_tr_b16 v[246:247], v122 offset:15552
    v_mul_f32 v46, v46, v76
    v_mul_f32 v47, v47, v76
    v_mfma_f32_16x16x32_bf16 v[168:171], v[220:223], a[140:143], 0
    ds_read_b64_tr_b16 v[248:249], v122 offset:20672
    v_mul_f32 v48, v48, v76
    v_mul_f32 v49, v49, v76
    v_mfma_f32_16x16x32_bf16 v[168:171], v[216:219], a[136:139], v[168:171]
    ds_read_b64_tr_b16 v[250:251], v122 offset:25792
    buffer_load_dwordx4 a[236:239], v23, s[64:67], s76 offen offset:0 sc1
    v_mul_f32 v50, v50, v76
    v_mfma_f32_16x16x32_bf16 v[168:171], v[212:215], a[132:135], v[168:171]
    ds_read_b64_tr_b16 v[252:253], v122 offset:30912
    v_mul_f32 v51, v51, v76
    v_cvt_pk_bf16_f32 v92, v44, v45
    v_mfma_f32_16x16x32_bf16 v[168:171], v[208:211], a[128:131], v[168:171]
    ds_read_b64_tr_b16 v[254:255], v122 offset:36032
    s_waitcnt lgkmcnt(8)
    v_mfma_f32_16x16x32_bf16 v[176:179], v[224:227], a[128:131], 0
    ds_read_b64_tr_b16 v[96:97], v121 offset:256
    v_cvt_pk_bf16_f32 v93, v46, v47
    v_cvt_pk_bf16_f32 v94, v48, v49
    v_mfma_f32_16x16x32_bf16 v[176:179], v[228:231], a[132:135], v[176:179]
    ds_read_b64_tr_b16 v[98:99], v121 offset:5376
    buffer_load_dwordx4 a[240:243], v20, s[64:67], s76 offen offset:1024 sc1
    v_cvt_pk_bf16_f32 v95, v50, v51
    v_mfma_f32_16x16x32_bf16 v[176:179], v[232:235], a[136:139], v[176:179]
    ds_read_b64_tr_b16 v[100:101], v121 offset:10496
    buffer_store_dwordx4 v[92:95], v1, s[8:11], s78 offen offset:3072 sc1
    s_add_u32 s78, s78, 4096
    v_mfma_f32_16x16x32_bf16 v[176:179], v[236:239], a[140:143], v[176:179]
    ds_read_b64_tr_b16 v[102:103], v121 offset:15616
    v_mfma_f32_16x16x32_bf16 v[180:183], v[236:239], a[156:159], 0
    ds_read_b64_tr_b16 v[104:105], v121 offset:20736
    v_mfma_f32_16x16x32_bf16 v[180:183], v[232:235], a[152:155], v[180:183]
    ds_read_b64_tr_b16 v[106:107], v121 offset:25856
    buffer_load_dwordx4 a[244:247], v21, s[64:67], s76 offen offset:1024 sc1
    v_mfma_f32_16x16x32_bf16 v[180:183], v[228:231], a[148:151], v[180:183]
    ds_read_b64_tr_b16 v[108:109], v121 offset:30976
    v_mfma_f32_16x16x32_bf16 v[180:183], v[224:227], a[144:147], v[180:183]
    ds_read_b64_tr_b16 v[110:111], v121 offset:36096
    s_waitcnt lgkmcnt(8)
    v_mfma_f32_16x16x32_bf16 v[188:191], v[240:243], a[144:147], 0
    ds_read_b64_tr_b16 v[208:209], v122 offset:256
    v_mfma_f32_16x16x32_bf16 v[188:191], v[244:247], a[148:151], v[188:191]
    ds_read_b64_tr_b16 v[210:211], v122 offset:5376
    buffer_load_dwordx4 a[248:251], v22, s[64:67], s76 offen offset:1024 sc1
    v_mfma_f32_16x16x32_bf16 v[188:191], v[248:251], a[152:155], v[188:191]
    ds_read_b64_tr_b16 v[212:213], v122 offset:10496
    v_mfma_f32_16x16x32_bf16 v[188:191], v[252:255], a[156:159], v[188:191]
    ds_read_b64_tr_b16 v[214:215], v122 offset:15616
    v_mfma_f32_16x16x32_bf16 v[184:187], v[252:255], a[140:143], 0
    ds_read_b64_tr_b16 v[216:217], v122 offset:20736
    v_mfma_f32_16x16x32_bf16 v[184:187], v[248:251], a[136:139], v[184:187]
    ds_read_b64_tr_b16 v[218:219], v122 offset:25856
    buffer_load_dwordx4 a[252:255], v23, s[64:67], s76 offen offset:1024 sc1
    s_add_u32 s76, s76, 16384
    v_mfma_f32_16x16x32_bf16 v[184:187], v[244:247], a[132:135], v[184:187]
    ds_read_b64_tr_b16 v[220:221], v122 offset:30976
    v_mfma_f32_16x16x32_bf16 v[184:187], v[240:243], a[128:131], v[184:187]
    ds_read_b64_tr_b16 v[222:223], v122 offset:36096
    s_waitcnt lgkmcnt(8)
    s_barrier
    v_mfma_f32_16x16x32_bf16 v[192:195], v[96:99], a[128:131], 0
    ds_read_b64_tr_b16 v[224:225], v121 offset:40960
    s_add_u32 m0, s73, 122880
    v_mfma_f32_16x16x32_bf16 v[192:195], v[100:103], a[132:135], v[192:195]
    ds_read_b64_tr_b16 v[226:227], v121 offset:46080
    buffer_load_dwordx4 v116, s[68:71], s75 offen offset:0 lds
    v_mfma_f32_16x16x32_bf16 v[192:195], v[104:107], a[136:139], v[192:195]
    ds_read_b64_tr_b16 v[228:229], v121 offset:51200
    v_mfma_f32_16x16x32_bf16 v[192:195], v[108:111], a[140:143], v[192:195]
    ds_read_b64_tr_b16 v[230:231], v121 offset:56320
    v_mfma_f32_16x16x32_bf16 v[196:199], v[108:111], a[156:159], 0
    ds_read_b64_tr_b16 v[232:233], v122 offset:40960
    v_mfma_f32_16x16x32_bf16 v[196:199], v[104:107], a[152:155], v[196:199]
    ds_read_b64_tr_b16 v[234:235], v122 offset:46080
    buffer_load_dwordx4 v117, s[68:71], s75 offen offset:1024 lds
    v_mfma_f32_16x16x32_bf16 v[196:199], v[100:103], a[148:151], v[196:199]
    ds_read_b64_tr_b16 v[236:237], v122 offset:51200
    v_mfma_f32_16x16x32_bf16 v[196:199], v[96:99], a[144:147], v[196:199]
    ds_read_b64_tr_b16 v[238:239], v122 offset:56320
    s_waitcnt lgkmcnt(8)
    v_mfma_f32_16x16x32_bf16 v[204:207], v[208:211], a[144:147], 0
    ds_read_b64_tr_b16 v[240:241], v121 offset:41024
    v_mfma_f32_16x16x32_bf16 v[204:207], v[212:215], a[148:151], v[204:207]
    ds_read_b64_tr_b16 v[242:243], v121 offset:46144
    buffer_load_dwordx4 v118, s[68:71], s75 offen offset:2048 lds
    v_mfma_f32_16x16x32_bf16 v[204:207], v[216:219], a[152:155], v[204:207]
    ds_read_b64_tr_b16 v[244:245], v121 offset:51264
    v_mfma_f32_16x16x32_bf16 v[204:207], v[220:223], a[156:159], v[204:207]
    ds_read_b64_tr_b16 v[246:247], v121 offset:56384
    v_mfma_f32_16x16x32_bf16 v[200:203], v[220:223], a[140:143], 0
    ds_read_b64_tr_b16 v[248:249], v122 offset:41024
    v_mfma_f32_16x16x32_bf16 v[200:203], v[216:219], a[136:139], v[200:203]
    ds_read_b64_tr_b16 v[250:251], v122 offset:46144
    buffer_load_dwordx4 v119, s[68:71], s75 offen offset:3072 lds
    v_mfma_f32_16x16x32_bf16 v[200:203], v[212:215], a[132:135], v[200:203]
    ds_read_b64_tr_b16 v[252:253], v122 offset:51264
    v_mfma_f32_16x16x32_bf16 v[200:203], v[208:211], a[128:131], v[200:203]
    ds_read_b64_tr_b16 v[254:255], v122 offset:56384
    s_waitcnt vmcnt(24) lgkmcnt(8)
    v_mfma_f32_16x16x32_bf16 v[128:131], v[224:227], a[192:195], v[128:131]
    ds_read_b64_tr_b16 v[96:97], v121 offset:41088
    s_add_u32 m0, s73, 126976
    v_mfma_f32_16x16x32_bf16 v[128:131], v[228:231], a[196:199], v[128:131]
    ds_read_b64_tr_b16 v[98:99], v121 offset:46208
    buffer_load_dwordx4 v120, s[68:71], s75 offen offset:0 lds
    s_add_u32 s75, s75, 81920
    v_mfma_f32_16x16x32_bf16 v[132:135], v[228:231], a[212:215], v[132:135]
    ds_read_b64_tr_b16 v[100:101], v121 offset:51328
    v_mfma_f32_16x16x32_bf16 v[132:135], v[224:227], a[208:211], v[132:135]
    ds_read_b64_tr_b16 v[102:103], v121 offset:56448
    v_mfma_f32_16x16x32_bf16 v[136:139], v[232:235], a[192:195], v[136:139]
    ds_read_b64_tr_b16 v[104:105], v122 offset:41088
    s_add_u32 m0, s73, 143360
    v_mfma_f32_16x16x32_bf16 v[136:139], v[236:239], a[196:199], v[136:139]
    ds_read_b64_tr_b16 v[106:107], v122 offset:46208
    buffer_load_dwordx4 v116, s[68:71], s75 offen offset:0 lds
    v_mfma_f32_16x16x32_bf16 v[140:143], v[236:239], a[212:215], v[140:143]
    ds_read_b64_tr_b16 v[108:109], v122 offset:51328
    v_mfma_f32_16x16x32_bf16 v[140:143], v[232:235], a[208:211], v[140:143]
    ds_read_b64_tr_b16 v[110:111], v122 offset:56448
    s_waitcnt lgkmcnt(8)
    v_mfma_f32_16x16x32_bf16 v[144:147], v[240:243], a[192:195], v[144:147]
    ds_read_b64_tr_b16 v[208:209], v121 offset:41152
    v_mfma_f32_16x16x32_bf16 v[144:147], v[244:247], a[196:199], v[144:147]
    ds_read_b64_tr_b16 v[210:211], v121 offset:46272
    buffer_load_dwordx4 v117, s[68:71], s75 offen offset:1024 lds
    v_mfma_f32_16x16x32_bf16 v[148:151], v[244:247], a[212:215], v[148:151]
    ds_read_b64_tr_b16 v[212:213], v121 offset:51392
    v_mfma_f32_16x16x32_bf16 v[148:151], v[240:243], a[208:211], v[148:151]
    ds_read_b64_tr_b16 v[214:215], v121 offset:56512
    v_mfma_f32_16x16x32_bf16 v[152:155], v[248:251], a[192:195], v[152:155]
    ds_read_b64_tr_b16 v[216:217], v122 offset:41152
    v_mfma_f32_16x16x32_bf16 v[152:155], v[252:255], a[196:199], v[152:155]
    ds_read_b64_tr_b16 v[218:219], v122 offset:46272
    buffer_load_dwordx4 v118, s[68:71], s75 offen offset:2048 lds
    v_mfma_f32_16x16x32_bf16 v[156:159], v[252:255], a[212:215], v[156:159]
    ds_read_b64_tr_b16 v[220:221], v122 offset:51392
    v_mfma_f32_16x16x32_bf16 v[156:159], v[248:251], a[208:211], v[156:159]
    ds_read_b64_tr_b16 v[222:223], v122 offset:56512
    s_waitcnt lgkmcnt(8)
    v_mfma_f32_16x16x32_bf16 v[160:163], v[96:99], a[192:195], v[160:163]
    ds_read_b64_tr_b16 v[224:225], v121 offset:41216
    v_mfma_f32_16x16x32_bf16 v[160:163], v[100:103], a[196:199], v[160:163]
    ds_read_b64_tr_b16 v[226:227], v121 offset:46336
    buffer_load_dwordx4 v119, s[68:71], s75 offen offset:3072 lds
    v_mfma_f32_16x16x32_bf16 v[164:167], v[100:103], a[212:215], v[164:167]
    ds_read_b64_tr_b16 v[228:229], v121 offset:51456
    v_mfma_f32_16x16x32_bf16 v[164:167], v[96:99], a[208:211], v[164:167]
    ds_read_b64_tr_b16 v[230:231], v121 offset:56576
    v_mfma_f32_16x16x32_bf16 v[168:171], v[104:107], a[192:195], v[168:171]
    ds_read_b64_tr_b16 v[232:233], v122 offset:41216
    s_add_u32 m0, s73, 147456
    v_mfma_f32_16x16x32_bf16 v[168:171], v[108:111], a[196:199], v[168:171]
    ds_read_b64_tr_b16 v[234:235], v122 offset:46336
    buffer_load_dwordx4 v120, s[68:71], s75 offen offset:0 lds
    s_add_u32 s75, s75, 81920
    v_mfma_f32_16x16x32_bf16 v[172:175], v[108:111], a[212:215], v[172:175]
    ds_read_b64_tr_b16 v[236:237], v122 offset:51456
    v_mfma_f32_16x16x32_bf16 v[172:175], v[104:107], a[208:211], v[172:175]
    ds_read_b64_tr_b16 v[238:239], v122 offset:56576
    s_waitcnt lgkmcnt(8)
    s_barrier
    s_waitcnt vmcnt(13)
    s_add_u32 s72, s51, 262144
    buffer_store_dwordx2 v[58:59], v57, s[8:11], s72 offen sc1
    v_mfma_f32_16x16x32_bf16 v[176:179], v[208:211], a[192:195], v[176:179]
    ds_read_b64_tr_b16 v[240:241], v123 offset:20480
    v_mfma_f32_16x16x32_bf16 v[176:179], v[212:215], a[196:199], v[176:179]
    ds_read_b64_tr_b16 v[242:243], v123 offset:25600
    buffer_load_dwordx4 a[160:163], v20, s[64:67], s76 offen offset:0 sc1
    v_mfma_f32_16x16x32_bf16 v[180:183], v[212:215], a[212:215], v[180:183]
    ds_read_b64_tr_b16 v[244:245], v123 offset:30720
    v_mfma_f32_16x16x32_bf16 v[180:183], v[208:211], a[208:211], v[180:183]
    ds_read_b64_tr_b16 v[246:247], v123 offset:35840
    v_mfma_f32_16x16x32_bf16 v[184:187], v[216:219], a[192:195], v[184:187]
    ds_read_b64_tr_b16 v[248:249], v123 offset:40960
    v_mfma_f32_16x16x32_bf16 v[184:187], v[220:223], a[196:199], v[184:187]
    ds_read_b64_tr_b16 v[250:251], v123 offset:46080
    buffer_load_dwordx4 a[164:167], v21, s[64:67], s76 offen offset:0 sc1
    v_mfma_f32_16x16x32_bf16 v[188:191], v[220:223], a[212:215], v[188:191]
    ds_read_b64_tr_b16 v[252:253], v123 offset:51200
    v_mfma_f32_16x16x32_bf16 v[188:191], v[216:219], a[208:211], v[188:191]
    ds_read_b64_tr_b16 v[254:255], v123 offset:56320
    s_waitcnt lgkmcnt(8)
    v_mfma_f32_16x16x32_bf16 v[192:195], v[224:227], a[192:195], v[192:195]
    ds_read_b64_tr_b16 v[96:97], v124 offset:20480
    v_mfma_f32_16x16x32_bf16 v[192:195], v[228:231], a[196:199], v[192:195]
    ds_read_b64_tr_b16 v[98:99], v124 offset:25600
    buffer_load_dwordx4 a[168:171], v22, s[64:67], s76 offen offset:0 sc1
    v_mfma_f32_16x16x32_bf16 v[196:199], v[228:231], a[212:215], v[196:199]
    ds_read_b64_tr_b16 v[100:101], v124 offset:30720
    v_mfma_f32_16x16x32_bf16 v[196:199], v[224:227], a[208:211], v[196:199]
    ds_read_b64_tr_b16 v[102:103], v124 offset:35840
    v_mfma_f32_16x16x32_bf16 v[200:203], v[232:235], a[192:195], v[200:203]
    ds_read_b64_tr_b16 v[104:105], v124 offset:40960
    v_mfma_f32_16x16x32_bf16 v[200:203], v[236:239], a[196:199], v[200:203]
    ds_read_b64_tr_b16 v[106:107], v124 offset:46080
    buffer_load_dwordx4 a[172:175], v23, s[64:67], s76 offen offset:0 sc1
    v_mfma_f32_16x16x32_bf16 v[204:207], v[236:239], a[212:215], v[204:207]
    ds_read_b64_tr_b16 v[108:109], v124 offset:51200
    v_mfma_f32_16x16x32_bf16 v[204:207], v[232:235], a[208:211], v[204:207]
    ds_read_b64_tr_b16 v[110:111], v124 offset:56320
    s_waitcnt vmcnt(15) lgkmcnt(8)
    v_mfma_f32_16x16x32_bf16 v[128:131], v[240:243], a[224:227], v[128:131]
    ds_read_b64_tr_b16 v[208:209], v123 offset:20544
    v_and_b32 v113, 7, v0
    v_mfma_f32_16x16x32_bf16 v[128:131], v[244:247], a[228:231], v[128:131]
    ds_read_b64_tr_b16 v[210:211], v123 offset:25664
    buffer_load_dwordx4 a[176:179], v20, s[64:67], s76 offen offset:1024 sc1
    v_mfma_f32_16x16x32_bf16 v[128:131], v[248:251], a[232:235], v[128:131]
    ds_read_b64_tr_b16 v[212:213], v123 offset:30784
    v_lshlrev_b32 v113, 9, v113
    v_mfma_f32_16x16x32_bf16 v[128:131], v[252:255], a[236:239], v[128:131]
    ds_read_b64_tr_b16 v[214:215], v123 offset:35904
    v_and_b32 v48, 1, v0
    v_mfma_f32_16x16x32_bf16 v[132:135], v[252:255], a[252:255], v[132:135]
    ds_read_b64_tr_b16 v[216:217], v123 offset:41024
    v_lshlrev_b32 v48, 4, v48
    v_mfma_f32_16x16x32_bf16 v[132:135], v[248:251], a[248:251], v[132:135]
    ds_read_b64_tr_b16 v[218:219], v123 offset:46144
    buffer_load_dwordx4 a[180:183], v21, s[64:67], s76 offen offset:1024 sc1
    v_mfma_f32_16x16x32_bf16 v[132:135], v[244:247], a[244:247], v[132:135]
    ds_read_b64_tr_b16 v[220:221], v123 offset:51264
    v_mov_b32 v49, 0x3f80
    v_mfma_f32_16x16x32_bf16 v[132:135], v[240:243], a[240:243], v[132:135]
    ds_read_b64_tr_b16 v[222:223], v123 offset:56384
    s_waitcnt lgkmcnt(8)
    v_mfma_f32_16x16x32_bf16 v[140:143], v[96:99], a[240:243], v[140:143]
    ds_read_b64_tr_b16 v[224:225], v124 offset:20544
    v_lshlrev_b32 v49, v48, v49
    v_mfma_f32_16x16x32_bf16 v[140:143], v[100:103], a[244:247], v[140:143]
    ds_read_b64_tr_b16 v[226:227], v124 offset:25664
    buffer_load_dwordx4 a[184:187], v22, s[64:67], s76 offen offset:1024 sc1
    v_mfma_f32_16x16x32_bf16 v[140:143], v[104:107], a[248:251], v[140:143]
    ds_read_b64_tr_b16 v[228:229], v124 offset:30784
    v_bfe_u32 v48, v0, 1, 1
    v_mfma_f32_16x16x32_bf16 v[140:143], v[108:111], a[252:255], v[140:143]
    ds_read_b64_tr_b16 v[230:231], v124 offset:35904
    v_bfe_u32 v51, v0, 3, 1
    v_mfma_f32_16x16x32_bf16 v[136:139], v[108:111], a[236:239], v[136:139]
    ds_read_b64_tr_b16 v[232:233], v124 offset:41024
    v_lshl_or_b32 v48, v51, 1, v48
    v_mfma_f32_16x16x32_bf16 v[136:139], v[104:107], a[232:235], v[136:139]
    ds_read_b64_tr_b16 v[234:235], v124 offset:46144
    buffer_load_dwordx4 a[188:191], v23, s[64:67], s76 offen offset:1024 sc1
    s_add_u32 s76, s76, 16384
    v_mfma_f32_16x16x32_bf16 v[136:139], v[100:103], a[228:231], v[136:139]
    ds_read_b64_tr_b16 v[236:237], v124 offset:51264
    v_bfe_u32 v51, v0, 2, 1
    v_mfma_f32_16x16x32_bf16 v[136:139], v[96:99], a[224:227], v[136:139]
    ds_read_b64_tr_b16 v[238:239], v124 offset:56384
    s_waitcnt lgkmcnt(8)
    v_mfma_f32_16x16x32_bf16 v[144:147], v[208:211], a[224:227], v[144:147]
    ds_read_b64_tr_b16 v[240:241], v123 offset:20608
    s_add_u32 m0, s73, 0
    v_mfma_f32_16x16x32_bf16 v[144:147], v[212:215], a[228:231], v[144:147]
    ds_read_b64_tr_b16 v[242:243], v123 offset:25728
    buffer_load_dwordx4 v116, s[60:63], s74 offen offset:0 lds
    v_mfma_f32_16x16x32_bf16 v[144:147], v[216:219], a[232:235], v[144:147]
    ds_read_b64_tr_b16 v[244:245], v123 offset:30848
    v_lshlrev_b32 v51, 1, v51
    v_mfma_f32_16x16x32_bf16 v[144:147], v[220:223], a[236:239], v[144:147]
    ds_read_b64_tr_b16 v[246:247], v123 offset:35968
    v_xor_b32 v51, v51, v52
    v_mfma_f32_16x16x32_bf16 v[148:151], v[220:223], a[252:255], v[148:151]
    ds_read_b64_tr_b16 v[248:249], v123 offset:41088
    v_lshl_or_b32 v48, v51, 2, v48
    v_mfma_f32_16x16x32_bf16 v[148:151], v[216:219], a[248:251], v[148:151]
    ds_read_b64_tr_b16 v[250:251], v123 offset:46208
    buffer_load_dwordx4 v117, s[60:63], s74 offen offset:1024 lds
    v_mfma_f32_16x16x32_bf16 v[148:151], v[212:215], a[244:247], v[148:151]
    ds_read_b64_tr_b16 v[252:253], v123 offset:51328
    v_cmp_eq_u32 s[6:7], 0, v48
    v_mfma_f32_16x16x32_bf16 v[148:151], v[208:211], a[240:243], v[148:151]
    ds_read_b64_tr_b16 v[254:255], v123 offset:56448
    s_waitcnt lgkmcnt(8)
    v_mfma_f32_16x16x32_bf16 v[156:159], v[224:227], a[240:243], v[156:159]
    ds_read_b64_tr_b16 v[96:97], v124 offset:20608
    s_nop 0
    v_mfma_f32_16x16x32_bf16 v[156:159], v[228:231], a[244:247], v[156:159]
    ds_read_b64_tr_b16 v[98:99], v124 offset:25728
    buffer_load_dwordx4 v118, s[60:63], s74 offen offset:2048 lds
    v_mfma_f32_16x16x32_bf16 v[156:159], v[232:235], a[248:251], v[156:159]
    ds_read_b64_tr_b16 v[100:101], v124 offset:30848
    s_nop 0
    v_mfma_f32_16x16x32_bf16 v[156:159], v[236:239], a[252:255], v[156:159]
    ds_read_b64_tr_b16 v[102:103], v124 offset:35968
    v_cndmask_b32 v80, 0, v49, s[6:7]
    v_mfma_f32_16x16x32_bf16 v[152:155], v[236:239], a[236:239], v[152:155]
    ds_read_b64_tr_b16 v[104:105], v124 offset:41088
    v_cmp_eq_u32 s[6:7], 1, v48
    v_mfma_f32_16x16x32_bf16 v[152:155], v[232:235], a[232:235], v[152:155]
    ds_read_b64_tr_b16 v[106:107], v124 offset:46208
    buffer_load_dwordx4 v119, s[60:63], s74 offen offset:3072 lds
    v_mfma_f32_16x16x32_bf16 v[152:155], v[228:231], a[228:231], v[152:155]
    ds_read_b64_tr_b16 v[108:109], v124 offset:51328
    s_nop 0
    v_mfma_f32_16x16x32_bf16 v[152:155], v[224:227], a[224:227], v[152:155]
    ds_read_b64_tr_b16 v[110:111], v124 offset:56448
    s_waitcnt lgkmcnt(8)
    v_mfma_f32_16x16x32_bf16 v[160:163], v[240:243], a[224:227], v[160:163]
    ds_read_b64_tr_b16 v[208:209], v123 offset:20672
    s_add_u32 m0, s73, 4096
    v_mfma_f32_16x16x32_bf16 v[160:163], v[244:247], a[228:231], v[160:163]
    ds_read_b64_tr_b16 v[210:211], v123 offset:25792
    buffer_load_dwordx4 v120, s[60:63], s74 offen offset:0 lds
    s_add_u32 s74, s74, 81920
    v_mfma_f32_16x16x32_bf16 v[160:163], v[248:251], a[232:235], v[160:163]
    ds_read_b64_tr_b16 v[212:213], v123 offset:30912
    s_nop 0
    v_mfma_f32_16x16x32_bf16 v[160:163], v[252:255], a[236:239], v[160:163]
    ds_read_b64_tr_b16 v[214:215], v123 offset:36032
    buffer_load_dwordx2 v[114:115], v113, s[8:11], s83 offen sc1
    v_mfma_f32_16x16x32_bf16 v[164:167], v[252:255], a[252:255], v[164:167]
    ds_read_b64_tr_b16 v[216:217], v123 offset:41152
    s_add_u32 m0, s73, 20480
    v_mfma_f32_16x16x32_bf16 v[164:167], v[248:251], a[248:251], v[164:167]
    ds_read_b64_tr_b16 v[218:219], v123 offset:46272
    buffer_load_dwordx4 v116, s[60:63], s74 offen offset:0 lds
    v_mfma_f32_16x16x32_bf16 v[164:167], v[244:247], a[244:247], v[164:167]
    ds_read_b64_tr_b16 v[220:221], v123 offset:51392
    v_cndmask_b32 v81, 0, v49, s[6:7]
    v_mfma_f32_16x16x32_bf16 v[164:167], v[240:243], a[240:243], v[164:167]
    ds_read_b64_tr_b16 v[222:223], v123 offset:56512
    s_waitcnt lgkmcnt(8)
    v_mfma_f32_16x16x32_bf16 v[172:175], v[96:99], a[240:243], v[172:175]
    ds_read_b64_tr_b16 v[224:225], v124 offset:20672
    v_cmp_eq_u32 s[6:7], 2, v48
    v_mfma_f32_16x16x32_bf16 v[172:175], v[100:103], a[244:247], v[172:175]
    ds_read_b64_tr_b16 v[226:227], v124 offset:25792
    buffer_load_dwordx4 v117, s[60:63], s74 offen offset:1024 lds
    v_mfma_f32_16x16x32_bf16 v[172:175], v[104:107], a[248:251], v[172:175]
    ds_read_b64_tr_b16 v[228:229], v124 offset:30912
    s_nop 0
    v_mfma_f32_16x16x32_bf16 v[172:175], v[108:111], a[252:255], v[172:175]
    ds_read_b64_tr_b16 v[230:231], v124 offset:36032
    s_nop 0
    v_mfma_f32_16x16x32_bf16 v[168:171], v[108:111], a[236:239], v[168:171]
    ds_read_b64_tr_b16 v[232:233], v124 offset:41152
    v_cndmask_b32 v82, 0, v49, s[6:7]
    v_mfma_f32_16x16x32_bf16 v[168:171], v[104:107], a[232:235], v[168:171]
    ds_read_b64_tr_b16 v[234:235], v124 offset:46272
    buffer_load_dwordx4 v118, s[60:63], s74 offen offset:2048 lds
    v_mfma_f32_16x16x32_bf16 v[168:171], v[100:103], a[228:231], v[168:171]
    ds_read_b64_tr_b16 v[236:237], v124 offset:51392
    v_cmp_eq_u32 s[6:7], 3, v48
    v_mfma_f32_16x16x32_bf16 v[168:171], v[96:99], a[224:227], v[168:171]
    ds_read_b64_tr_b16 v[238:239], v124 offset:56512
    s_waitcnt lgkmcnt(8)
    v_mfma_f32_16x16x32_bf16 v[176:179], v[208:211], a[224:227], v[176:179]
    ds_read_b64_tr_b16 v[240:241], v123 offset:20736
    s_nop 0
    v_mfma_f32_16x16x32_bf16 v[176:179], v[212:215], a[228:231], v[176:179]
    ds_read_b64_tr_b16 v[242:243], v123 offset:25856
    buffer_load_dwordx4 v119, s[60:63], s74 offen offset:3072 lds
    v_mfma_f32_16x16x32_bf16 v[176:179], v[216:219], a[232:235], v[176:179]
    ds_read_b64_tr_b16 v[244:245], v123 offset:30976
    s_nop 0
    v_mfma_f32_16x16x32_bf16 v[176:179], v[220:223], a[236:239], v[176:179]
    ds_read_b64_tr_b16 v[246:247], v123 offset:36096
    v_cndmask_b32 v83, 0, v49, s[6:7]
    v_mfma_f32_16x16x32_bf16 v[180:183], v[220:223], a[252:255], v[180:183]
    ds_read_b64_tr_b16 v[248:249], v123 offset:41216
    s_add_u32 m0, s73, 24576
    v_mfma_f32_16x16x32_bf16 v[180:183], v[216:219], a[248:251], v[180:183]
    ds_read_b64_tr_b16 v[250:251], v123 offset:46336
    buffer_load_dwordx4 v120, s[60:63], s74 offen offset:0 lds
    s_add_u32 s74, s74, 81920
    v_mfma_f32_16x16x32_bf16 v[180:183], v[212:215], a[244:247], v[180:183]
    ds_read_b64_tr_b16 v[252:253], v123 offset:51456
    v_cmp_eq_u32 s[6:7], 4, v48
    v_mfma_f32_16x16x32_bf16 v[180:183], v[208:211], a[240:243], v[180:183]
    ds_read_b64_tr_b16 v[254:255], v123 offset:56576
    s_waitcnt lgkmcnt(8)
    v_mfma_f32_16x16x32_bf16 v[188:191], v[224:227], a[240:243], v[188:191]
    ds_read_b64_tr_b16 v[96:97], v124 offset:20736
    s_nop 0
    v_mfma_f32_16x16x32_bf16 v[188:191], v[228:231], a[244:247], v[188:191]
    ds_read_b64_tr_b16 v[98:99], v124 offset:25856
    s_nop 0
    v_mfma_f32_16x16x32_bf16 v[188:191], v[232:235], a[248:251], v[188:191]
    ds_read_b64_tr_b16 v[100:101], v124 offset:30976
    v_cndmask_b32 v84, 0, v49, s[6:7]
    v_mfma_f32_16x16x32_bf16 v[188:191], v[236:239], a[252:255], v[188:191]
    ds_read_b64_tr_b16 v[102:103], v124 offset:36096
    v_cmp_eq_u32 s[6:7], 5, v48
    v_mfma_f32_16x16x32_bf16 v[184:187], v[236:239], a[236:239], v[184:187]
    ds_read_b64_tr_b16 v[104:105], v124 offset:41216
    s_nop 0
    v_mfma_f32_16x16x32_bf16 v[184:187], v[232:235], a[232:235], v[184:187]
    ds_read_b64_tr_b16 v[106:107], v124 offset:46336
    s_nop 0
    v_mfma_f32_16x16x32_bf16 v[184:187], v[228:231], a[228:231], v[184:187]
    ds_read_b64_tr_b16 v[108:109], v124 offset:51456
    v_cndmask_b32 v85, 0, v49, s[6:7]
    v_mfma_f32_16x16x32_bf16 v[184:187], v[224:227], a[224:227], v[184:187]
    ds_read_b64_tr_b16 v[110:111], v124 offset:56576
    s_waitcnt vmcnt(20) lgkmcnt(8)
    s_barrier
    v_mfma_f32_16x16x32_bf16 v[192:195], v[240:243], a[224:227], v[192:195]
    ds_read_b64_tr_b16 v[208:209], v125 offset:0
    v_cmp_eq_u32 s[6:7], 6, v48
    v_mfma_f32_16x16x32_bf16 v[192:195], v[244:247], a[228:231], v[192:195]
    ds_read_b64_tr_b16 v[210:211], v125 offset:5120
    s_nop 0
    v_mfma_f32_16x16x32_bf16 v[192:195], v[248:251], a[232:235], v[192:195]
    ds_read_b64_tr_b16 v[212:213], v125 offset:10240
    s_nop 0
    v_mfma_f32_16x16x32_bf16 v[192:195], v[252:255], a[236:239], v[192:195]
    ds_read_b64_tr_b16 v[214:215], v125 offset:15360
    v_cndmask_b32 v86, 0, v49, s[6:7]
    v_mfma_f32_16x16x32_bf16 v[196:199], v[252:255], a[252:255], v[196:199]
    ds_read_b64_tr_b16 v[216:217], v125 offset:20480
    v_cmp_eq_u32 s[6:7], 7, v48
    v_mfma_f32_16x16x32_bf16 v[196:199], v[248:251], a[248:251], v[196:199]
    ds_read_b64_tr_b16 v[218:219], v125 offset:25600
    s_nop 0
    v_mfma_f32_16x16x32_bf16 v[196:199], v[244:247], a[244:247], v[196:199]
    ds_read_b64_tr_b16 v[220:221], v125 offset:30720
    s_nop 0
    v_mfma_f32_16x16x32_bf16 v[196:199], v[240:243], a[240:243], v[196:199]
    ds_read_b64_tr_b16 v[222:223], v125 offset:35840
    s_waitcnt lgkmcnt(8)
    s_waitcnt vmcnt(5)
    v_cmp_ne_u64 vcc, s[38:39], v[114:115]
    s_mov_b32 s42, 0
    s_cbranch_vccz Lpok2
Lspin2:
    buffer_load_dwordx2 v[114:115], v113, s[8:11], s83 offen sc1
    s_add_u32 s42, s42, 1
    s_waitcnt vmcnt(0)
    v_cmp_ne_u64 vcc, s[38:39], v[114:115]
    s_cmp_ge_u32 s42, 0x100000
    s_cbranch_scc1 Lpok2
    s_cbranch_vccnz Lspin2
Lpok2:
    v_mfma_f32_16x16x32_bf16 v[204:207], v[96:99], a[240:243], v[204:207]
    ds_read_b64_tr_b16 v[224:225], v126 offset:0
    v_cndmask_b32 v87, 0, v49, s[6:7]
    v_mfma_f32_16x16x32_bf16 v[204:207], v[100:103], a[244:247], v[204:207]
    ds_read_b64_tr_b16 v[226:227], v126 offset:5120
    buffer_load_dwordx4 a[128:131], v20, s[8:11], s77 offen offset:0 sc1
    v_mfma_f32_16x16x32_bf16 v[204:207], v[104:107], a[248:251], v[204:207]
    ds_read_b64_tr_b16 v[228:229], v126 offset:10240
    s_cmp_lt_u32 s32, 2
    s_cselect_b32 s14, 75497472, 0
    v_mfma_f32_16x16x32_bf16 v[204:207], v[108:111], a[252:255], v[204:207]
    ds_read_b64_tr_b16 v[230:231], v126 offset:15360
    s_mul_i32 s84, s32, 10240
    v_mfma_f32_16x16x32_bf16 v[200:203], v[108:111], a[236:239], v[200:203]
    ds_read_b64_tr_b16 v[232:233], v126 offset:20480
    v_add_u32 v18, s84, v1
    v_mfma_f32_16x16x32_bf16 v[200:203], v[104:107], a[232:235], v[200:203]
    ds_read_b64_tr_b16 v[234:235], v126 offset:25600
    buffer_load_dwordx4 a[132:135], v21, s[8:11], s77 offen offset:0 sc1
    v_mfma_f32_16x16x32_bf16 v[200:203], v[100:103], a[228:231], v[200:203]
    ds_read_b64_tr_b16 v[236:237], v126 offset:30720
    s_mul_i32 s84, s35, 10
    v_mfma_f32_16x16x32_bf16 v[200:203], v[96:99], a[224:227], v[200:203]
    ds_read_b64_tr_b16 v[238:239], v126 offset:35840
    s_waitcnt lgkmcnt(8)
    v_mfma_f32_16x16x32_bf16 v[128:131], v[208:211], a[160:163], v[128:131]
    ds_read_b64_tr_b16 v[240:241], v125 offset:64
    s_add_u32 s84, s84, s32
    v_mfma_f32_16x16x32_bf16 v[128:131], v[212:215], a[164:167], v[128:131]
    ds_read_b64_tr_b16 v[242:243], v125 offset:5184
    buffer_load_dwordx4 a[136:139], v22, s[8:11], s77 offen offset:0 sc1
    v_mfma_f32_16x16x32_bf16 v[128:131], v[216:219], a[168:171], v[128:131]
    ds_read_b64_tr_b16 v[244:245], v125 offset:10304
    s_lshl_b32 s84, s84, 10
    v_mfma_f32_16x16x32_bf16 v[128:131], v[220:223], a[172:175], v[128:131]
    ds_read_b64_tr_b16 v[246:247], v125 offset:15424
    buffer_load_dwordx4 a[140:143], v23, s[8:11], s77 offen offset:0 sc1
    v_mfma_f32_16x16x32_bf16 v[132:135], v[220:223], a[188:191], v[132:135]
    ds_read_b64_tr_b16 v[248:249], v125 offset:20544
    v_add_u32 v19, s84, v1
    v_mfma_f32_16x16x32_bf16 v[132:135], v[216:219], a[184:187], v[132:135]
    ds_read_b64_tr_b16 v[250:251], v125 offset:25664
    v_mfma_f32_16x16x32_bf16 v[132:135], v[212:215], a[180:183], v[132:135]
    ds_read_b64_tr_b16 v[252:253], v125 offset:30784
    buffer_load_dwordx4 a[144:147], v20, s[8:11], s77 offen offset:1024 sc1
    v_mfma_f32_16x16x32_bf16 v[132:135], v[208:211], a[176:179], v[132:135]
    ds_read_b64_tr_b16 v[254:255], v125 offset:35904
    s_waitcnt lgkmcnt(8)
    v_mfma_f32_16x16x32_bf16 v[140:143], v[224:227], a[176:179], v[140:143]
    ds_read_b64_tr_b16 v[96:97], v126 offset:64
    v_mfma_f32_16x16x32_bf16 v[140:143], v[228:231], a[180:183], v[140:143]
    ds_read_b64_tr_b16 v[98:99], v126 offset:5184
    buffer_load_dwordx4 a[148:151], v21, s[8:11], s77 offen offset:1024 sc1
    v_mfma_f32_16x16x32_bf16 v[140:143], v[232:235], a[184:187], v[140:143]
    ds_read_b64_tr_b16 v[100:101], v126 offset:10304
    v_mfma_f32_16x16x32_bf16 v[140:143], v[236:239], a[188:191], v[140:143]
    ds_read_b64_tr_b16 v[102:103], v126 offset:15424
    buffer_load_dwordx4 a[152:155], v22, s[8:11], s77 offen offset:1024 sc1
    v_mfma_f32_16x16x32_bf16 v[136:139], v[236:239], a[172:175], v[136:139]
    ds_read_b64_tr_b16 v[104:105], v126 offset:20544
    v_mfma_f32_16x16x32_bf16 v[136:139], v[232:235], a[168:171], v[136:139]
    ds_read_b64_tr_b16 v[106:107], v126 offset:25664
    v_mfma_f32_16x16x32_bf16 v[136:139], v[228:231], a[164:167], v[136:139]
    ds_read_b64_tr_b16 v[108:109], v126 offset:30784
    buffer_load_dwordx4 a[156:159], v23, s[8:11], s77 offen offset:1024 sc1
    s_add_u32 s77, s77, 65536
    v_mfma_f32_16x16x32_bf16 v[136:139], v[224:227], a[160:163], v[136:139]
    ds_read_b64_tr_b16 v[110:111], v126 offset:35904
    s_waitcnt lgkmcnt(8)
    v_mfma_f32_16x16x32_bf16 v[144:147], v[240:243], a[160:163], v[144:147]
    ds_read_b64_tr_b16 v[208:209], v125 offset:128
    s_add_u32 m0, s73, 40960
    v_mfma_f32_16x16x32_bf16 v[144:147], v[244:247], a[164:167], v[144:147]
    ds_read_b64_tr_b16 v[210:211], v125 offset:5248
    buffer_load_dwordx4 v116, s[60:63], s74 offen offset:0 lds
    v_mfma_f32_16x16x32_bf16 v[144:147], v[248:251], a[168:171], v[144:147]
    ds_read_b64_tr_b16 v[212:213], v125 offset:10368
    v_mfma_f32_16x16x32_bf16 v[144:147], v[252:255], a[172:175], v[144:147]
    ds_read_b64_tr_b16 v[214:215], v125 offset:15488
    buffer_load_dwordx4 v117, s[60:63], s74 offen offset:1024 lds
    v_mfma_f32_16x16x32_bf16 v[148:151], v[252:255], a[188:191], v[148:151]
    ds_read_b64_tr_b16 v[216:217], v125 offset:20608
    v_mfma_f32_16x16x32_bf16 v[148:151], v[248:251], a[184:187], v[148:151]
    ds_read_b64_tr_b16 v[218:219], v125 offset:25728
    v_mfma_f32_16x16x32_bf16 v[148:151], v[244:247], a[180:183], v[148:151]
    ds_read_b64_tr_b16 v[220:221], v125 offset:30848
    buffer_load_dwordx4 v118, s[60:63], s74 offen offset:2048 lds
    v_mfma_f32_16x16x32_bf16 v[148:151], v[240:243], a[176:179], v[148:151]
    ds_read_b64_tr_b16 v[222:223], v125 offset:35968
    s_waitcnt lgkmcnt(8)
    v_mfma_f32_16x16x32_bf16 v[156:159], v[96:99], a[176:179], v[156:159]
    ds_read_b64_tr_b16 v[224:225], v126 offset:128
    v_cvt_pk_bf16_f32 v2, v128, v129
    v_mfma_f32_16x16x32_bf16 v[156:159], v[100:103], a[180:183], v[156:159]
    ds_read_b64_tr_b16 v[226:227], v126 offset:5248
    buffer_load_dwordx4 v119, s[60:63], s74 offen offset:3072 lds
    v_mfma_f32_16x16x32_bf16 v[156:159], v[104:107], a[184:187], v[156:159]
    ds_read_b64_tr_b16 v[228:229], v126 offset:10368
    s_add_u32 m0, s73, 45056
    v_mfma_f32_16x16x32_bf16 v[156:159], v[108:111], a[188:191], v[156:159]
    ds_read_b64_tr_b16 v[230:231], v126 offset:15488
    buffer_load_dwordx4 v120, s[60:63], s74 offen offset:0 lds
    s_add_u32 s74, s74, 81920
    v_mfma_f32_16x16x32_bf16 v[152:155], v[108:111], a[172:175], v[152:155]
    ds_read_b64_tr_b16 v[232:233], v126 offset:20608
    v_cvt_pk_bf16_f32 v3, v130, v131
    v_mfma_f32_16x16x32_bf16 v[152:155], v[104:107], a[168:171], v[152:155]
    ds_read_b64_tr_b16 v[234:235], v126 offset:25728
    s_add_u32 m0, s73, 61440
    v_mfma_f32_16x16x32_bf16 v[152:155], v[100:103], a[164:167], v[152:155]
    ds_read_b64_tr_b16 v[236:237], v126 offset:30848
    buffer_load_dwordx4 v116, s[60:63], s74 offen offset:0 lds
    v_mfma_f32_16x16x32_bf16 v[152:155], v[96:99], a[160:163], v[152:155]
    ds_read_b64_tr_b16 v[238:239], v126 offset:35968
    s_waitcnt lgkmcnt(8)
    v_mfma_f32_16x16x32_bf16 v[160:163], v[208:211], a[160:163], v[160:163]
    ds_read_b64_tr_b16 v[240:241], v125 offset:192
    v_cvt_pk_bf16_f32 v4, v136, v137
    v_mfma_f32_16x16x32_bf16 v[160:163], v[212:215], a[164:167], v[160:163]
    ds_read_b64_tr_b16 v[242:243], v125 offset:5312
    buffer_load_dwordx4 v117, s[60:63], s74 offen offset:1024 lds
    v_mfma_f32_16x16x32_bf16 v[160:163], v[216:219], a[168:171], v[160:163]
    ds_read_b64_tr_b16 v[244:245], v125 offset:10432
    v_cvt_pk_bf16_f32 v5, v138, v139
    v_mfma_f32_16x16x32_bf16 v[160:163], v[220:223], a[172:175], v[160:163]
    ds_read_b64_tr_b16 v[246:247], v125 offset:15552
    buffer_load_dwordx4 v118, s[60:63], s74 offen offset:2048 lds
    v_mfma_f32_16x16x32_bf16 v[164:167], v[220:223], a[188:191], v[164:167]
    ds_read_b64_tr_b16 v[248:249], v125 offset:20672
    v_cvt_pk_bf16_f32 v30, v132, v133
    v_mfma_f32_16x16x32_bf16 v[164:167], v[216:219], a[184:187], v[164:167]
    ds_read_b64_tr_b16 v[250:251], v125 offset:25792
    v_cvt_pk_bf16_f32 v31, v134, v135
    v_mfma_f32_16x16x32_bf16 v[164:167], v[212:215], a[180:183], v[164:167]
    ds_read_b64_tr_b16 v[252:253], v125 offset:30912
    buffer_load_dwordx4 v119, s[60:63], s74 offen offset:3072 lds
    v_mfma_f32_16x16x32_bf16 v[164:167], v[208:211], a[176:179], v[164:167]
    ds_read_b64_tr_b16 v[254:255], v125 offset:36032
    s_waitcnt lgkmcnt(8)
    v_mfma_f32_16x16x32_bf16 v[172:175], v[224:227], a[176:179], v[172:175]
    ds_read_b64_tr_b16 v[96:97], v126 offset:192
    s_add_u32 m0, s73, 65536
    v_mfma_f32_16x16x32_bf16 v[172:175], v[228:231], a[180:183], v[172:175]
    ds_read_b64_tr_b16 v[98:99], v126 offset:5312
    buffer_load_dwordx4 v120, s[60:63], s74 offen offset:0 lds
    s_add_u32 s74, s74, 81920
    v_mfma_f32_16x16x32_bf16 v[172:175], v[232:235], a[184:187], v[172:175]
    ds_read_b64_tr_b16 v[100:101], v126 offset:10432
    v_cvt_pk_bf16_f32 v32, v140, v141
    v_mfma_f32_16x16x32_bf16 v[172:175], v[236:239], a[188:191], v[172:175]
    ds_read_b64_tr_b16 v[102:103], v126 offset:15552
    buffer_load_dwordx4 a[192:195], v20, s[8:11], s77 offen offset:0 sc1
    v_mfma_f32_16x16x32_bf16 v[168:171], v[236:239], a[172:175], v[168:171]
    ds_read_b64_tr_b16 v[104:105], v126 offset:20672
    v_cvt_pk_bf16_f32 v33, v142, v143
    v_mfma_f32_16x16x32_bf16 v[168:171], v[232:235], a[168:171], v[168:171]
    ds_read_b64_tr_b16 v[106:107], v126 offset:25792
    v_cvt_pk_bf16_f32 v6, v144, v145
    v_mfma_f32_16x16x32_bf16 v[168:171], v[228:231], a[164:167], v[168:171]
    ds_read_b64_tr_b16 v[108:109], v126 offset:30912
    buffer_load_dwordx4 a[196:199], v21, s[8:11], s77 offen offset:0 sc1
    v_mfma_f32_16x16x32_bf16 v[168:171], v[224:227], a[160:163], v[168:171]
    ds_read_b64_tr_b16 v[110:111], v126 offset:36032
    s_waitcnt lgkmcnt(8)
    v_mfma_f32_16x16x32_bf16 v[176:179], v[240:243], a[160:163], v[176:179]
    ds_read_b64_tr_b16 v[208:209], v125 offset:256
    v_cvt_pk_bf16_f32 v7, v146, v147
    v_mfma_f32_16x16x32_bf16 v[176:179], v[244:247], a[164:167], v[176:179]
    ds_read_b64_tr_b16 v[210:211], v125 offset:5376
    buffer_load_dwordx4 a[200:203], v22, s[8:11], s77 offen offset:0 sc1
    v_mfma_f32_16x16x32_bf16 v[176:179], v[248:251], a[168:171], v[176:179]
    ds_read_b64_tr_b16 v[212:213], v125 offset:10496
    v_cvt_pk_bf16_f32 v8, v152, v153
    v_mfma_f32_16x16x32_bf16 v[176:179], v[252:255], a[172:175], v[176:179]
    ds_read_b64_tr_b16 v[214:215], v125 offset:15616
    v_cvt_pk_bf16_f32 v9, v154, v155
    v_mfma_f32_16x16x32_bf16 v[180:183], v[252:255], a[188:191], v[180:183]
    ds_read_b64_tr_b16 v[216:217], v125 offset:20736
    v_cvt_pk_bf16_f32 v34, v148, v149
    v_mfma_f32_16x16x32_bf16 v[180:183], v[248:251], a[184:187], v[180:183]
    ds_read_b64_tr_b16 v[218:219], v125 offset:25856
    buffer_load_dwordx4 a[204:207], v23, s[8:11], s77 offen offset:0 sc1
    v_mfma_f32_16x16x32_bf16 v[180:183], v[244:247], a[180:183], v[180:183]
    ds_read_b64_tr_b16 v[220:221], v125 offset:30976
    v_cvt_pk_bf16_f32 v35, v150, v151
    v_mfma_f32_16x16x32_bf16 v[180:183], v[240:243], a[176:179], v[180:183]
    ds_read_b64_tr_b16 v[222:223], v125 offset:36096
    s_waitcnt lgkmcnt(8)
    v_mfma_f32_16x16x32_bf16 v[188:191], v[96:99], a[176:179], v[188:191]
    ds_read_b64_tr_b16 v[224:225], v126 offset:256
    v_cvt_pk_bf16_f32 v36, v156, v157
    v_mfma_f32_16x16x32_bf16 v[188:191], v[100:103], a[180:183], v[188:191]
    ds_read_b64_tr_b16 v[226:227], v126 offset:5376
    buffer_load_dwordx4 a[208:211], v20, s[8:11], s77 offen offset:1024 sc1
    v_mfma_f32_16x16x32_bf16 v[188:191], v[104:107], a[184:187], v[188:191]
    ds_read_b64_tr_b16 v[228:229], v126 offset:10496
    v_cvt_pk_bf16_f32 v37, v158, v159
    v_mfma_f32_16x16x32_bf16 v[188:191], v[108:111], a[188:191], v[188:191]
    ds_read_b64_tr_b16 v[230:231], v126 offset:15616
    s_add_u32 s4, s79, 50331648
    v_mfma_f32_16x16x32_bf16 v[184:187], v[108:111], a[172:175], v[184:187]
    ds_read_b64_tr_b16 v[232:233], v126 offset:20736
    buffer_store_dwordx4 v[2:5], v1, s[20:23], s4 offen sc1
    v_mfma_f32_16x16x32_bf16 v[184:187], v[104:107], a[168:171], v[184:187]
    ds_read_b64_tr_b16 v[234:235], v126 offset:25856
    buffer_load_dwordx4 a[212:215], v21, s[8:11], s77 offen offset:1024 sc1
    v_mfma_f32_16x16x32_bf16 v[184:187], v[100:103], a[164:167], v[184:187]
    ds_read_b64_tr_b16 v[236:237], v126 offset:30976
    v_cvt_pk_bf16_f32 v10, v160, v161
    v_mfma_f32_16x16x32_bf16 v[184:187], v[96:99], a[160:163], v[184:187]
    ds_read_b64_tr_b16 v[238:239], v126 offset:36096
    s_waitcnt vmcnt(25) lgkmcnt(8)
    s_barrier
    v_mfma_f32_16x16x32_bf16 v[192:195], v[208:211], a[160:163], v[192:195]
    ds_read_b64_tr_b16 v[240:241], v121 offset:0
    v_cvt_pk_bf16_f32 v11, v162, v163
    v_mfma_f32_16x16x32_bf16 v[192:195], v[212:215], a[164:167], v[192:195]
    ds_read_b64_tr_b16 v[242:243], v121 offset:5120
    buffer_load_dwordx4 a[216:219], v22, s[8:11], s77 offen offset:1024 sc1
    v_mfma_f32_16x16x32_bf16 v[192:195], v[216:219], a[168:171], v[192:195]
    ds_read_b64_tr_b16 v[244:245], v121 offset:10240
    v_cvt_pk_bf16_f32 v12, v168, v169
    v_mfma_f32_16x16x32_bf16 v[192:195], v[220:223], a[172:175], v[192:195]
    ds_read_b64_tr_b16 v[246:247], v121 offset:15360
    v_cvt_pk_bf16_f32 v13, v170, v171
    v_mfma_f32_16x16x32_bf16 v[196:199], v[220:223], a[188:191], v[196:199]
    ds_read_b64_tr_b16 v[248:249], v121 offset:20480
    v_cvt_pk_bf16_f32 v38, v164, v165
    v_mfma_f32_16x16x32_bf16 v[196:199], v[216:219], a[184:187], v[196:199]
    ds_read_b64_tr_b16 v[250:251], v121 offset:25600
    buffer_load_dwordx4 a[220:223], v23, s[8:11], s77 offen offset:1024 sc1
    s_add_u32 s77, s77, 65536
    v_mfma_f32_16x16x32_bf16 v[196:199], v[212:215], a[180:183], v[196:199]
    ds_read_b64_tr_b16 v[252:253], v121 offset:30720
    v_cvt_pk_bf16_f32 v39, v166, v167
    v_mfma_f32_16x16x32_bf16 v[196:199], v[208:211], a[176:179], v[196:199]
    ds_read_b64_tr_b16 v[254:255], v121 offset:35840
    s_waitcnt lgkmcnt(8)
    v_mfma_f32_16x16x32_bf16 v[204:207], v[224:227], a[176:179], v[204:207]
    ds_read_b64_tr_b16 v[96:97], v122 offset:0
    v_cvt_pk_bf16_f32 v40, v172, v173
    v_mfma_f32_16x16x32_bf16 v[204:207], v[228:231], a[180:183], v[204:207]
    ds_read_b64_tr_b16 v[98:99], v122 offset:5120
    v_cvt_pk_bf16_f32 v41, v174, v175
    v_mfma_f32_16x16x32_bf16 v[204:207], v[232:235], a[184:187], v[204:207]
    ds_read_b64_tr_b16 v[100:101], v122 offset:10240
    v_cvt_pk_bf16_f32 v14, v176, v177
    v_mfma_f32_16x16x32_bf16 v[204:207], v[236:239], a[188:191], v[204:207]
    ds_read_b64_tr_b16 v[102:103], v122 offset:15360
    v_cvt_pk_bf16_f32 v15, v178, v179
    v_mfma_f32_16x16x32_bf16 v[200:203], v[236:239], a[172:175], v[200:203]
    ds_read_b64_tr_b16 v[104:105], v122 offset:20480
    v_cvt_pk_bf16_f32 v16, v184, v185
    v_mfma_f32_16x16x32_bf16 v[200:203], v[232:235], a[168:171], v[200:203]
    ds_read_b64_tr_b16 v[106:107], v122 offset:25600
    v_cvt_pk_bf16_f32 v17, v186, v187
    v_mfma_f32_16x16x32_bf16 v[200:203], v[228:231], a[164:167], v[200:203]
    ds_read_b64_tr_b16 v[108:109], v122 offset:30720
    v_cvt_pk_bf16_f32 v42, v180, v181
    v_mfma_f32_16x16x32_bf16 v[200:203], v[224:227], a[160:163], v[200:203]
    ds_read_b64_tr_b16 v[110:111], v122 offset:35840
    s_waitcnt vmcnt(19) lgkmcnt(8)
    v_mfma_f32_16x16x32_bf16 v[128:131], v[240:243], a[128:131], 0
    ds_read_b64_tr_b16 v[208:209], v121 offset:64
    s_add_u32 m0, s73, 81920
    v_mfma_f32_16x16x32_bf16 v[128:131], v[244:247], a[132:135], v[128:131]
    ds_read_b64_tr_b16 v[210:211], v121 offset:5184
    buffer_load_dwordx4 v116, s[60:63], s74 offen offset:0 lds
    v_mfma_f32_16x16x32_bf16 v[128:131], v[248:251], a[136:139], v[128:131]
    ds_read_b64_tr_b16 v[212:213], v121 offset:10304
    v_cvt_pk_bf16_f32 v43, v182, v183
    v_mfma_f32_16x16x32_bf16 v[128:131], v[252:255], a[140:143], v[128:131]
    ds_read_b64_tr_b16 v[214:215], v121 offset:15424
    v_cvt_pk_bf16_f32 v44, v188, v189
    v_mfma_f32_16x16x32_bf16 v[132:135], v[252:255], a[156:159], 0
    ds_read_b64_tr_b16 v[216:217], v121 offset:20544
    v_cvt_pk_bf16_f32 v45, v190, v191
    v_mfma_f32_16x16x32_bf16 v[132:135], v[248:251], a[152:155], v[132:135]
    ds_read_b64_tr_b16 v[218:219], v121 offset:25664
    buffer_load_dwordx4 v117, s[60:63], s74 offen offset:1024 lds
    v_mfma_f32_16x16x32_bf16 v[132:135], v[244:247], a[148:151], v[132:135]
    ds_read_b64_tr_b16 v[220:221], v121 offset:30784
    s_add_u32 s4, s79, 50352128
    v_mfma_f32_16x16x32_bf16 v[132:135], v[240:243], a[144:147], v[132:135]
    ds_read_b64_tr_b16 v[222:223], v121 offset:35904
    s_waitcnt lgkmcnt(8)
    v_mfma_f32_16x16x32_bf16 v[140:143], v[96:99], a[144:147], 0
    ds_read_b64_tr_b16 v[224:225], v122 offset:64
    buffer_store_dwordx4 v[30:33], v1, s[20:23], s4 offen sc1
    v_mfma_f32_16x16x32_bf16 v[140:143], v[100:103], a[148:151], v[140:143]
    ds_read_b64_tr_b16 v[226:227], v122 offset:5184
    buffer_load_dwordx4 v118, s[60:63], s74 offen offset:2048 lds
    v_mfma_f32_16x16x32_bf16 v[140:143], v[104:107], a[152:155], v[140:143]
    ds_read_b64_tr_b16 v[228:229], v122 offset:10304
    v_cvt_pk_bf16_f32 v26, v192, v193
    v_mfma_f32_16x16x32_bf16 v[140:143], v[108:111], a[156:159], v[140:143]
    ds_read_b64_tr_b16 v[230:231], v122 offset:15424
    v_cvt_pk_bf16_f32 v27, v194, v195
    v_mfma_f32_16x16x32_bf16 v[136:139], v[108:111], a[140:143], 0
    ds_read_b64_tr_b16 v[232:233], v122 offset:20544
    v_cvt_pk_bf16_f32 v28, v200, v201
    v_mfma_f32_16x16x32_bf16 v[136:139], v[104:107], a[136:139], v[136:139]
    ds_read_b64_tr_b16 v[234:235], v122 offset:25664
    buffer_load_dwordx4 v119, s[60:63], s74 offen offset:3072 lds
    v_mfma_f32_16x16x32_bf16 v[136:139], v[100:103], a[132:135], v[136:139]
    ds_read_b64_tr_b16 v[236:237], v122 offset:30784
    v_cvt_pk_bf16_f32 v29, v202, v203
    v_mfma_f32_16x16x32_bf16 v[136:139], v[96:99], a[128:131], v[136:139]
    ds_read_b64_tr_b16 v[238:239], v122 offset:35904
    s_waitcnt lgkmcnt(8)
    v_mfma_f32_16x16x32_bf16 v[144:147], v[208:211], a[128:131], 0
    ds_read_b64_tr_b16 v[240:241], v121 offset:128
    s_add_u32 m0, s73, 86016
    v_mfma_f32_16x16x32_bf16 v[144:147], v[212:215], a[132:135], v[144:147]
    ds_read_b64_tr_b16 v[242:243], v121 offset:5248
    buffer_load_dwordx4 v120, s[60:63], s74 offen offset:0 lds
    s_add_u32 s74, s74, 81920
    v_mfma_f32_16x16x32_bf16 v[144:147], v[216:219], a[136:139], v[144:147]
    ds_read_b64_tr_b16 v[244:245], v121 offset:10368
    v_cvt_pk_bf16_f32 v46, v196, v197
    v_mfma_f32_16x16x32_bf16 v[144:147], v[220:223], a[140:143], v[144:147]
    ds_read_b64_tr_b16 v[246:247], v121 offset:15488
    v_cvt_pk_bf16_f32 v47, v198, v199
    v_mfma_f32_16x16x32_bf16 v[148:151], v[220:223], a[156:159], 0
    ds_read_b64_tr_b16 v[248:249], v121 offset:20608
    s_add_u32 m0, s73, 102400
    v_mfma_f32_16x16x32_bf16 v[148:151], v[216:219], a[152:155], v[148:151]
    ds_read_b64_tr_b16 v[250:251], v121 offset:25728
    buffer_load_dwordx4 v116, s[60:63], s74 offen offset:0 lds
    v_mfma_f32_16x16x32_bf16 v[148:151], v[212:215], a[148:151], v[148:151]
    ds_read_b64_tr_b16 v[252:253], v121 offset:30848
    v_cvt_pk_bf16_f32 v48, v204, v205
    v_mfma_f32_16x16x32_bf16 v[148:151], v[208:211], a[144:147], v[148:151]
    ds_read_b64_tr_b16 v[254:255], v121 offset:35968
    s_waitcnt lgkmcnt(8)
    v_mfma_f32_16x16x32_bf16 v[156:159], v[224:227], a[144:147], 0
    ds_read_b64_tr_b16 v[96:97], v122 offset:128
    v_cvt_pk_bf16_f32 v49, v206, v207
    v_mfma_f32_16x16x32_bf16 v[156:159], v[228:231], a[148:151], v[156:159]
    ds_read_b64_tr_b16 v[98:99], v122 offset:5248
    buffer_load_dwordx4 v117, s[60:63], s74 offen offset:1024 lds
    v_mfma_f32_16x16x32_bf16 v[156:159], v[232:235], a[152:155], v[156:159]
    ds_read_b64_tr_b16 v[100:101], v122 offset:10368
    v_mfma_f32_16x16x32_bf16 v[156:159], v[236:239], a[156:159], v[156:159]
    ds_read_b64_tr_b16 v[102:103], v122 offset:15488
    v_mfma_f32_16x16x32_bf16 v[152:155], v[236:239], a[140:143], 0
    ds_read_b64_tr_b16 v[104:105], v122 offset:20608
    v_mfma_f32_16x16x32_bf16 v[152:155], v[232:235], a[136:139], v[152:155]
    ds_read_b64_tr_b16 v[106:107], v122 offset:25728
    buffer_load_dwordx4 v118, s[60:63], s74 offen offset:2048 lds
    v_mfma_f32_16x16x32_bf16 v[152:155], v[228:231], a[132:135], v[152:155]
    ds_read_b64_tr_b16 v[108:109], v122 offset:30848
    v_mfma_f32_16x16x32_bf16 v[152:155], v[224:227], a[128:131], v[152:155]
    ds_read_b64_tr_b16 v[110:111], v122 offset:35968
    s_waitcnt lgkmcnt(8)
    v_mfma_f32_16x16x32_bf16 v[160:163], v[240:243], a[128:131], 0
    ds_read_b64_tr_b16 v[208:209], v121 offset:192
    s_add_u32 s4, s79, 50335744
    v_mfma_f32_16x16x32_bf16 v[160:163], v[244:247], a[132:135], v[160:163]
    ds_read_b64_tr_b16 v[210:211], v121 offset:5312
    buffer_load_dwordx4 v119, s[60:63], s74 offen offset:3072 lds
    v_mfma_f32_16x16x32_bf16 v[160:163], v[248:251], a[136:139], v[160:163]
    ds_read_b64_tr_b16 v[212:213], v121 offset:10432
    buffer_store_dwordx4 v[6:9], v1, s[20:23], s4 offen sc1
    v_mfma_f32_16x16x32_bf16 v[160:163], v[252:255], a[140:143], v[160:163]
    ds_read_b64_tr_b16 v[214:215], v121 offset:15552
    v_mfma_f32_16x16x32_bf16 v[164:167], v[252:255], a[156:159], 0
    ds_read_b64_tr_b16 v[216:217], v121 offset:20672
    s_add_u32 m0, s73, 106496
    v_mfma_f32_16x16x32_bf16 v[164:167], v[248:251], a[152:155], v[164:167]
    ds_read_b64_tr_b16 v[218:219], v121 offset:25792
    buffer_load_dwordx4 v120, s[60:63], s74 offen offset:0 lds
    s_add_u32 s74, s74, 81920
    v_mfma_f32_16x16x32_bf16 v[164:167], v[244:247], a[148:151], v[164:167]
    ds_read_b64_tr_b16 v[220:221], v121 offset:30912
    v_mfma_f32_16x16x32_bf16 v[164:167], v[240:243], a[144:147], v[164:167]
    ds_read_b64_tr_b16 v[222:223], v121 offset:36032
    s_waitcnt lgkmcnt(8)
    v_mfma_f32_16x16x32_bf16 v[172:175], v[96:99], a[144:147], 0
    ds_read_b64_tr_b16 v[224:225], v122 offset:192
    v_mfma_f32_16x16x32_bf16 v[172:175], v[100:103], a[148:151], v[172:175]
    ds_read_b64_tr_b16 v[226:227], v122 offset:5312
    buffer_load_dwordx4 a[224:227], v20, s[8:11], s77 offen offset:0 sc1
    v_mfma_f32_16x16x32_bf16 v[172:175], v[104:107], a[152:155], v[172:175]
    ds_read_b64_tr_b16 v[228:229], v122 offset:10432
    v_mfma_f32_16x16x32_bf16 v[172:175], v[108:111], a[156:159], v[172:175]
    ds_read_b64_tr_b16 v[230:231], v122 offset:15552
    v_mfma_f32_16x16x32_bf16 v[168:171], v[108:111], a[140:143], 0
    ds_read_b64_tr_b16 v[232:233], v122 offset:20672
    v_mfma_f32_16x16x32_bf16 v[168:171], v[104:107], a[136:139], v[168:171]
    ds_read_b64_tr_b16 v[234:235], v122 offset:25792
    buffer_load_dwordx4 a[228:231], v21, s[8:11], s77 offen offset:0 sc1
    v_mfma_f32_16x16x32_bf16 v[168:171], v[100:103], a[132:135], v[168:171]
    ds_read_b64_tr_b16 v[236:237], v122 offset:30912
    v_mfma_f32_16x16x32_bf16 v[168:171], v[96:99], a[128:131], v[168:171]
    ds_read_b64_tr_b16 v[238:239], v122 offset:36032
    s_waitcnt lgkmcnt(8)
    v_mfma_f32_16x16x32_bf16 v[176:179], v[208:211], a[128:131], 0
    ds_read_b64_tr_b16 v[240:241], v121 offset:256
    v_mfma_f32_16x16x32_bf16 v[176:179], v[212:215], a[132:135], v[176:179]
    ds_read_b64_tr_b16 v[242:243], v121 offset:5376
    buffer_load_dwordx4 a[232:235], v22, s[8:11], s77 offen offset:0 sc1
    v_mfma_f32_16x16x32_bf16 v[176:179], v[216:219], a[136:139], v[176:179]
    ds_read_b64_tr_b16 v[244:245], v121 offset:10496
    v_mfma_f32_16x16x32_bf16 v[176:179], v[220:223], a[140:143], v[176:179]
    ds_read_b64_tr_b16 v[246:247], v121 offset:15616
    v_mfma_f32_16x16x32_bf16 v[180:183], v[220:223], a[156:159], 0
    ds_read_b64_tr_b16 v[248:249], v121 offset:20736
    v_mfma_f32_16x16x32_bf16 v[180:183], v[216:219], a[152:155], v[180:183]
    ds_read_b64_tr_b16 v[250:251], v121 offset:25856
    buffer_load_dwordx4 a[236:239], v23, s[8:11], s77 offen offset:0 sc1
    v_mfma_f32_16x16x32_bf16 v[180:183], v[212:215], a[148:151], v[180:183]
    ds_read_b64_tr_b16 v[252:253], v121 offset:30976
    v_mfma_f32_16x16x32_bf16 v[180:183], v[208:211], a[144:147], v[180:183]
    ds_read_b64_tr_b16 v[254:255], v121 offset:36096
    s_waitcnt lgkmcnt(8)
    v_mfma_f32_16x16x32_bf16 v[188:191], v[224:227], a[144:147], 0
    ds_read_b64_tr_b16 v[96:97], v122 offset:256
    v_mfma_f32_16x16x32_bf16 v[188:191], v[228:231], a[148:151], v[188:191]
    ds_read_b64_tr_b16 v[98:99], v122 offset:5376
    buffer_load_dwordx4 a[240:243], v20, s[8:11], s77 offen offset:1024 sc1
    v_mfma_f32_16x16x32_bf16 v[188:191], v[232:235], a[152:155], v[188:191]
    ds_read_b64_tr_b16 v[100:101], v122 offset:10496
    v_mfma_f32_16x16x32_bf16 v[188:191], v[236:239], a[156:159], v[188:191]
    ds_read_b64_tr_b16 v[102:103], v122 offset:15616
    v_mfma_f32_16x16x32_bf16 v[184:187], v[236:239], a[140:143], 0
    ds_read_b64_tr_b16 v[104:105], v122 offset:20736
    v_mfma_f32_16x16x32_bf16 v[184:187], v[232:235], a[136:139], v[184:187]
    ds_read_b64_tr_b16 v[106:107], v122 offset:25856
    buffer_load_dwordx4 a[244:247], v21, s[8:11], s77 offen offset:1024 sc1
    v_mfma_f32_16x16x32_bf16 v[184:187], v[228:231], a[132:135], v[184:187]
    ds_read_b64_tr_b16 v[108:109], v122 offset:30976
    v_mfma_f32_16x16x32_bf16 v[184:187], v[224:227], a[128:131], v[184:187]
    ds_read_b64_tr_b16 v[110:111], v122 offset:36096
    s_waitcnt vmcnt(27) lgkmcnt(8)
    s_barrier
    v_mfma_f32_16x16x32_bf16 v[192:195], v[240:243], a[128:131], 0
    ds_read_b64_tr_b16 v[208:209], v121 offset:40960
    s_add_u32 s4, s79, 50356224
    v_mfma_f32_16x16x32_bf16 v[192:195], v[244:247], a[132:135], v[192:195]
    ds_read_b64_tr_b16 v[210:211], v121 offset:46080
    buffer_load_dwordx4 a[248:251], v22, s[8:11], s77 offen offset:1024 sc1
    v_mfma_f32_16x16x32_bf16 v[192:195], v[248:251], a[136:139], v[192:195]
    ds_read_b64_tr_b16 v[212:213], v121 offset:51200
    buffer_store_dwordx4 v[34:37], v1, s[20:23], s4 offen sc1
    v_mfma_f32_16x16x32_bf16 v[192:195], v[252:255], a[140:143], v[192:195]
    ds_read_b64_tr_b16 v[214:215], v121 offset:56320
    v_mfma_f32_16x16x32_bf16 v[196:199], v[252:255], a[156:159], 0
    ds_read_b64_tr_b16 v[216:217], v123 offset:0
    v_mfma_f32_16x16x32_bf16 v[196:199], v[248:251], a[152:155], v[196:199]
    ds_read_b64_tr_b16 v[218:219], v123 offset:5120
    buffer_load_dwordx4 a[252:255], v23, s[8:11], s77 offen offset:1024 sc1
    s_add_u32 s77, s77, 65536
    v_mfma_f32_16x16x32_bf16 v[196:199], v[244:247], a[148:151], v[196:199]
    ds_read_b64_tr_b16 v[220:221], v123 offset:10240
    v_mfma_f32_16x16x32_bf16 v[196:199], v[240:243], a[144:147], v[196:199]
    ds_read_b64_tr_b16 v[222:223], v123 offset:15360
    s_waitcnt lgkmcnt(8)
    v_mfma_f32_16x16x32_bf16 v[204:207], v[96:99], a[144:147], 0
    ds_read_b64_tr_b16 v[224:225], v122 offset:40960
    v_mfma_f32_16x16x32_bf16 v[204:207], v[100:103], a[148:151], v[204:207]
    ds_read_b64_tr_b16 v[226:227], v122 offset:46080
    v_mfma_f32_16x16x32_bf16 v[204:207], v[104:107], a[152:155], v[204:207]
    ds_read_b64_tr_b16 v[228:229], v122 offset:51200
    v_mfma_f32_16x16x32_bf16 v[204:207], v[108:111], a[156:159], v[204:207]
    ds_read_b64_tr_b16 v[230:231], v122 offset:56320
    v_mfma_f32_16x16x32_bf16 v[200:203], v[108:111], a[140:143], 0
    ds_read_b64_tr_b16 v[232:233], v124 offset:0
    v_mfma_f32_16x16x32_bf16 v[200:203], v[104:107], a[136:139], v[200:203]
    ds_read_b64_tr_b16 v[234:235], v124 offset:5120
    v_mfma_f32_16x16x32_bf16 v[200:203], v[100:103], a[132:135], v[200:203]
    ds_read_b64_tr_b16 v[236:237], v124 offset:10240
    v_mfma_f32_16x16x32_bf16 v[200:203], v[96:99], a[128:131], v[200:203]
    ds_read_b64_tr_b16 v[238:239], v124 offset:15360
    s_waitcnt vmcnt(21) lgkmcnt(8)
    v_mfma_f32_16x16x32_bf16 v[128:131], v[208:211], a[192:195], v[128:131]
    ds_read_b64_tr_b16 v[240:241], v121 offset:41024
    s_add_u32 m0, s73, 122880
    v_mfma_f32_16x16x32_bf16 v[128:131], v[212:215], a[196:199], v[128:131]
    ds_read_b64_tr_b16 v[242:243], v121 offset:46144
    buffer_load_dwordx4 v116, s[60:63], s74 offen offset:0 lds
    v_mfma_f32_16x16x32_bf16 v[128:131], v[216:219], a[200:203], v[128:131]
    ds_read_b64_tr_b16 v[244:245], v121 offset:51264
    v_lshlrev_b32 v113, 9, v55
    v_mfma_f32_16x16x32_bf16 v[128:131], v[220:223], a[204:207], v[128:131]
    ds_read_b64_tr_b16 v[246:247], v121 offset:56384
    v_mfma_f32_16x16x32_bf16 v[132:135], v[220:223], a[220:223], v[132:135]
    ds_read_b64_tr_b16 v[248:249], v123 offset:64
    v_mfma_f32_16x16x32_bf16 v[132:135], v[216:219], a[216:219], v[132:135]
    ds_read_b64_tr_b16 v[250:251], v123 offset:5184
    buffer_load_dwordx4 v117, s[60:63], s74 offen offset:1024 lds
    v_mfma_f32_16x16x32_bf16 v[132:135], v[212:215], a[212:215], v[132:135]
    ds_read_b64_tr_b16 v[252:253], v123 offset:10304
    v_mfma_f32_16x16x32_bf16 v[132:135], v[208:211], a[208:211], v[132:135]
    ds_read_b64_tr_b16 v[254:255], v123 offset:15424
    s_waitcnt lgkmcnt(8)
    v_mfma_f32_16x16x32_bf16 v[140:143], v[224:227], a[208:211], v[140:143]
    ds_read_b64_tr_b16 v[96:97], v122 offset:41024
    v_mfma_f32_16x16x32_bf16 v[140:143], v[228:231], a[212:215], v[140:143]
    ds_read_b64_tr_b16 v[98:99], v122 offset:46144
    buffer_load_dwordx4 v118, s[60:63], s74 offen offset:2048 lds
    v_mfma_f32_16x16x32_bf16 v[140:143], v[232:235], a[216:219], v[140:143]
    ds_read_b64_tr_b16 v[100:101], v122 offset:51264
    v_mfma_f32_16x16x32_bf16 v[140:143], v[236:239], a[220:223], v[140:143]
    ds_read_b64_tr_b16 v[102:103], v122 offset:56384
    v_mfma_f32_16x16x32_bf16 v[136:139], v[236:239], a[204:207], v[136:139]
    ds_read_b64_tr_b16 v[104:105], v124 offset:64
    v_mfma_f32_16x16x32_bf16 v[136:139], v[232:235], a[200:203], v[136:139]
    ds_read_b64_tr_b16 v[106:107], v124 offset:5184
    buffer_load_dwordx4 v119, s[60:63], s74 offen offset:3072 lds
    v_mfma_f32_16x16x32_bf16 v[136:139], v[228:231], a[196:199], v[136:139]
    ds_read_b64_tr_b16 v[108:109], v124 offset:10304
    v_mfma_f32_16x16x32_bf16 v[136:139], v[224:227], a[192:195], v[136:139]
    ds_read_b64_tr_b16 v[110:111], v124 offset:15424
    s_waitcnt lgkmcnt(8)
    v_mfma_f32_16x16x32_bf16 v[144:147], v[240:243], a[192:195], v[144:147]
    ds_read_b64_tr_b16 v[208:209], v121 offset:41088
    s_add_u32 m0, s73, 126976
    v_mfma_f32_16x16x32_bf16 v[144:147], v[244:247], a[196:199], v[144:147]
    ds_read_b64_tr_b16 v[210:211], v121 offset:46208
    buffer_load_dwordx4 v120, s[60:63], s74 offen offset:0 lds
    s_add_u32 s74, s74, 81920
    v_mfma_f32_16x16x32_bf16 v[144:147], v[248:251], a[200:203], v[144:147]
    ds_read_b64_tr_b16 v[212:213], v121 offset:51328
    s_add_u32 s4, s79, 50339840
    v_mfma_f32_16x16x32_bf16 v[144:147], v[252:255], a[204:207], v[144:147]
    ds_read_b64_tr_b16 v[214:215], v121 offset:56448
    buffer_store_dwordx4 v[10:13], v1, s[20:23], s4 offen sc1
    v_mfma_f32_16x16x32_bf16 v[148:151], v[252:255], a[220:223], v[148:151]
    ds_read_b64_tr_b16 v[216:217], v123 offset:128
    s_add_u32 m0, s73, 143360
    v_mfma_f32_16x16x32_bf16 v[148:151], v[248:251], a[216:219], v[148:151]
    ds_read_b64_tr_b16 v[218:219], v123 offset:5248
    buffer_load_dwordx4 v116, s[60:63], s74 offen offset:0 lds
    v_mfma_f32_16x16x32_bf16 v[148:151], v[244:247], a[212:215], v[148:151]
    ds_read_b64_tr_b16 v[220:221], v123 offset:10368
    v_mfma_f32_16x16x32_bf16 v[148:151], v[240:243], a[208:211], v[148:151]
    ds_read_b64_tr_b16 v[222:223], v123 offset:15488
    s_waitcnt lgkmcnt(8)
    v_mfma_f32_16x16x32_bf16 v[156:159], v[96:99], a[208:211], v[156:159]
    ds_read_b64_tr_b16 v[224:225], v122 offset:41088
    v_mfma_f32_16x16x32_bf16 v[156:159], v[100:103], a[212:215], v[156:159]
    ds_read_b64_tr_b16 v[226:227], v122 offset:46208
    buffer_load_dwordx4 v117, s[60:63], s74 offen offset:1024 lds
    v_mfma_f32_16x16x32_bf16 v[156:159], v[104:107], a[216:219], v[156:159]
    ds_read_b64_tr_b16 v[228:229], v122 offset:51328
    v_mfma_f32_16x16x32_bf16 v[156:159], v[108:111], a[220:223], v[156:159]
    ds_read_b64_tr_b16 v[230:231], v122 offset:56448
    v_mfma_f32_16x16x32_bf16 v[152:155], v[108:111], a[204:207], v[152:155]
    ds_read_b64_tr_b16 v[232:233], v124 offset:128
    v_mfma_f32_16x16x32_bf16 v[152:155], v[104:107], a[200:203], v[152:155]
    ds_read_b64_tr_b16 v[234:235], v124 offset:5248
    buffer_load_dwordx4 v118, s[60:63], s74 offen offset:2048 lds
    v_mfma_f32_16x16x32_bf16 v[152:155], v[100:103], a[196:199], v[152:155]
    ds_read_b64_tr_b16 v[236:237], v124 offset:10368
    v_mfma_f32_16x16x32_bf16 v[152:155], v[96:99], a[192:195], v[152:155]
    ds_read_b64_tr_b16 v[238:239], v124 offset:15488
    s_waitcnt lgkmcnt(8)
    v_mfma_f32_16x16x32_bf16 v[160:163], v[208:211], a[192:195], v[160:163]
    ds_read_b64_tr_b16 v[240:241], v121 offset:41152
    v_mfma_f32_16x16x32_bf16 v[160:163], v[212:215], a[196:199], v[160:163]
    ds_read_b64_tr_b16 v[242:243], v121 offset:46272
    buffer_load_dwordx4 v119, s[60:63], s74 offen offset:3072 lds
    v_mfma_f32_16x16x32_bf16 v[160:163], v[216:219], a[200:203], v[160:163]
    ds_read_b64_tr_b16 v[244:245], v121 offset:51392
    v_mfma_f32_16x16x32_bf16 v[160:163], v[220:223], a[204:207], v[160:163]
    ds_read_b64_tr_b16 v[246:247], v121 offset:56512
    v_mfma_f32_16x16x32_bf16 v[164:167], v[220:223], a[220:223], v[164:167]
    ds_read_b64_tr_b16 v[248:249], v123 offset:192
    s_add_u32 m0, s73, 147456
    v_mfma_f32_16x16x32_bf16 v[164:167], v[216:219], a[216:219], v[164:167]
    ds_read_b64_tr_b16 v[250:251], v123 offset:5312
    buffer_load_dwordx4 v120, s[60:63], s74 offen offset:0 lds
    s_add_u32 s74, s74, 81920
    v_mfma_f32_16x16x32_bf16 v[164:167], v[212:215], a[212:215], v[164:167]
    ds_read_b64_tr_b16 v[252:253], v123 offset:10432
    v_mfma_f32_16x16x32_bf16 v[164:167], v[208:211], a[208:211], v[164:167]
    ds_read_b64_tr_b16 v[254:255], v123 offset:15552
    s_waitcnt lgkmcnt(8)
    v_mfma_f32_16x16x32_bf16 v[172:175], v[224:227], a[208:211], v[172:175]
    ds_read_b64_tr_b16 v[96:97], v122 offset:41152
    v_mfma_f32_16x16x32_bf16 v[172:175], v[228:231], a[212:215], v[172:175]
    ds_read_b64_tr_b16 v[98:99], v122 offset:46272
    buffer_load_dwordx4 a[160:163], v20, s[8:11], s77 offen offset:0 sc1
    v_mfma_f32_16x16x32_bf16 v[172:175], v[232:235], a[216:219], v[172:175]
    ds_read_b64_tr_b16 v[100:101], v122 offset:51392
    v_mfma_f32_16x16x32_bf16 v[172:175], v[236:239], a[220:223], v[172:175]
    ds_read_b64_tr_b16 v[102:103], v122 offset:56512
    v_mfma_f32_16x16x32_bf16 v[168:171], v[236:239], a[204:207], v[168:171]
    ds_read_b64_tr_b16 v[104:105], v124 offset:192
    v_mfma_f32_16x16x32_bf16 v[168:171], v[232:235], a[200:203], v[168:171]
    ds_read_b64_tr_b16 v[106:107], v124 offset:5312
    buffer_load_dwordx4 a[164:167], v21, s[8:11], s77 offen offset:0 sc1
    v_mfma_f32_16x16x32_bf16 v[168:171], v[228:231], a[196:199], v[168:171]
    ds_read_b64_tr_b16 v[108:109], v124 offset:10432
    v_mfma_f32_16x16x32_bf16 v[168:171], v[224:227], a[192:195], v[168:171]
    ds_read_b64_tr_b16 v[110:111], v124 offset:15552
    s_waitcnt lgkmcnt(8)
    v_mfma_f32_16x16x32_bf16 v[176:179], v[240:243], a[192:195], v[176:179]
    ds_read_b64_tr_b16 v[208:209], v121 offset:41216
    s_add_u32 s4, s79, 50360320
    v_mfma_f32_16x16x32_bf16 v[176:179], v[244:247], a[196:199], v[176:179]
    ds_read_b64_tr_b16 v[210:211], v121 offset:46336
    buffer_load_dwordx4 a[168:171], v22, s[8:11], s77 offen offset:0 sc1
    v_mfma_f32_16x16x32_bf16 v[176:179], v[248:251], a[200:203], v[176:179]
    ds_read_b64_tr_b16 v[212:213], v121 offset:51456
    buffer_store_dwordx4 v[38:41], v1, s[20:23], s4 offen sc1
    v_mfma_f32_16x16x32_bf16 v[176:179], v[252:255], a[204:207], v[176:179]
    ds_read_b64_tr_b16 v[214:215], v121 offset:56576
    v_mfma_f32_16x16x32_bf16 v[180:183], v[252:255], a[220:223], v[180:183]
    ds_read_b64_tr_b16 v[216:217], v123 offset:256
    v_mfma_f32_16x16x32_bf16 v[180:183], v[248:251], a[216:219], v[180:183]
    ds_read_b64_tr_b16 v[218:219], v123 offset:5376
    buffer_load_dwordx4 a[172:175], v23, s[8:11], s77 offen offset:0 sc1
    v_mfma_f32_16x16x32_bf16 v[180:183], v[244:247], a[212:215], v[180:183]
    ds_read_b64_tr_b16 v[220:221], v123 offset:10496
    v_mfma_f32_16x16x32_bf16 v[180:183], v[240:243], a[208:211], v[180:183]
    ds_read_b64_tr_b16 v[222:223], v123 offset:15616
    s_waitcnt lgkmcnt(8)
    v_mfma_f32_16x16x32_bf16 v[188:191], v[96:99], a[208:211], v[188:191]
    ds_read_b64_tr_b16 v[224:225], v122 offset:41216
    v_mfma_f32_16x16x32_bf16 v[188:191], v[100:103], a[212:215], v[188:191]
    ds_read_b64_tr_b16 v[226:227], v122 offset:46336
    buffer_load_dwordx4 a[176:179], v20, s[8:11], s77 offen offset:1024 sc1
    v_mfma_f32_16x16x32_bf16 v[188:191], v[104:107], a[216:219], v[188:191]
    ds_read_b64_tr_b16 v[228:229], v122 offset:51456
    v_mfma_f32_16x16x32_bf16 v[188:191], v[108:111], a[220:223], v[188:191]
    ds_read_b64_tr_b16 v[230:231], v122 offset:56576
    v_mfma_f32_16x16x32_bf16 v[184:187], v[108:111], a[204:207], v[184:187]
    ds_read_b64_tr_b16 v[232:233], v124 offset:256
    v_mfma_f32_16x16x32_bf16 v[184:187], v[104:107], a[200:203], v[184:187]
    ds_read_b64_tr_b16 v[234:235], v124 offset:5376
    buffer_load_dwordx4 a[180:183], v21, s[8:11], s77 offen offset:1024 sc1
    v_mfma_f32_16x16x32_bf16 v[184:187], v[100:103], a[196:199], v[184:187]
    ds_read_b64_tr_b16 v[236:237], v124 offset:10496
    v_mfma_f32_16x16x32_bf16 v[184:187], v[96:99], a[192:195], v[184:187]
    ds_read_b64_tr_b16 v[238:239], v124 offset:15616
    s_waitcnt vmcnt(27) lgkmcnt(8)
    s_barrier
    v_mfma_f32_16x16x32_bf16 v[192:195], v[208:211], a[192:195], v[192:195]
    ds_read_b64_tr_b16 v[240:241], v123 offset:20480
    v_mfma_f32_16x16x32_bf16 v[192:195], v[212:215], a[196:199], v[192:195]
    ds_read_b64_tr_b16 v[242:243], v123 offset:25600
    buffer_load_dwordx4 a[184:187], v22, s[8:11], s77 offen offset:1024 sc1
    v_mfma_f32_16x16x32_bf16 v[192:195], v[216:219], a[200:203], v[192:195]
    ds_read_b64_tr_b16 v[244:245], v123 offset:30720
    v_mfma_f32_16x16x32_bf16 v[192:195], v[220:223], a[204:207], v[192:195]
    ds_read_b64_tr_b16 v[246:247], v123 offset:35840
    v_mfma_f32_16x16x32_bf16 v[196:199], v[220:223], a[220:223], v[196:199]
    ds_read_b64_tr_b16 v[248:249], v123 offset:40960
    v_mfma_f32_16x16x32_bf16 v[196:199], v[216:219], a[216:219], v[196:199]
    ds_read_b64_tr_b16 v[250:251], v123 offset:46080
    buffer_load_dwordx4 a[188:191], v23, s[8:11], s77 offen offset:1024 sc1
    s_add_u32 s77, s77, 65536
    v_mfma_f32_16x16x32_bf16 v[196:199], v[212:215], a[212:215], v[196:199]
    ds_read_b64_tr_b16 v[252:253], v123 offset:51200
    v_mfma_f32_16x16x32_bf16 v[196:199], v[208:211], a[208:211], v[196:199]
    ds_read_b64_tr_b16 v[254:255], v123 offset:56320
    s_waitcnt lgkmcnt(8)
    v_mfma_f32_16x16x32_bf16 v[204:207], v[224:227], a[208:211], v[204:207]
    ds_read_b64_tr_b16 v[96:97], v124 offset:20480
    v_mfma_f32_16x16x32_bf16 v[204:207], v[228:231], a[212:215], v[204:207]
    ds_read_b64_tr_b16 v[98:99], v124 offset:25600
    v_mfma_f32_16x16x32_bf16 v[204:207], v[232:235], a[216:219], v[204:207]
    ds_read_b64_tr_b16 v[100:101], v124 offset:30720
    v_mfma_f32_16x16x32_bf16 v[204:207], v[236:239], a[220:223], v[204:207]
    ds_read_b64_tr_b16 v[102:103], v124 offset:35840
    v_mfma_f32_16x16x32_bf16 v[200:203], v[236:239], a[204:207], v[200:203]
    ds_read_b64_tr_b16 v[104:105], v124 offset:40960
    v_mfma_f32_16x16x32_bf16 v[200:203], v[232:235], a[200:203], v[200:203]
    ds_read_b64_tr_b16 v[106:107], v124 offset:46080
    v_mfma_f32_16x16x32_bf16 v[200:203], v[228:231], a[196:199], v[200:203]
    ds_read_b64_tr_b16 v[108:109], v124 offset:51200
    v_mfma_f32_16x16x32_bf16 v[200:203], v[224:227], a[192:195], v[200:203]
    ds_read_b64_tr_b16 v[110:111], v124 offset:56320
    s_waitcnt vmcnt(20) lgkmcnt(8)
    v_mfma_f32_16x16x32_bf16 v[128:131], v[240:243], a[224:227], v[128:131]
    ds_read_b64_tr_b16 v[208:209], v123 offset:20544
    s_add_u32 m0, s73, 0
    v_mfma_f32_16x16x32_bf16 v[128:131], v[244:247], a[228:231], v[128:131]
    ds_read_b64_tr_b16 v[210:211], v123 offset:25664
    buffer_load_dwordx4 v116, s[60:63], s74 offen offset:0 lds
    v_mfma_f32_16x16x32_bf16 v[128:131], v[248:251], a[232:235], v[128:131]
    ds_read_b64_tr_b16 v[212:213], v123 offset:30784
    s_add_u32 s4, s79, 50343936
    v_mfma_f32_16x16x32_bf16 v[128:131], v[252:255], a[236:239], v[128:131]
    ds_read_b64_tr_b16 v[214:215], v123 offset:35904
    buffer_store_dwordx4 v[14:17], v1, s[20:23], s4 offen sc1
    v_mfma_f32_16x16x32_bf16 v[132:135], v[252:255], a[252:255], v[132:135]
    ds_read_b64_tr_b16 v[216:217], v123 offset:41024
    v_mfma_f32_16x16x32_bf16 v[132:135], v[248:251], a[248:251], v[132:135]
    ds_read_b64_tr_b16 v[218:219], v123 offset:46144
    buffer_load_dwordx4 v117, s[60:63], s74 offen offset:1024 lds
    v_mfma_f32_16x16x32_bf16 v[132:135], v[244:247], a[244:247], v[132:135]
    ds_read_b64_tr_b16 v[220:221], v123 offset:51264
    v_mfma_f32_16x16x32_bf16 v[132:135], v[240:243], a[240:243], v[132:135]
    ds_read_b64_tr_b16 v[222:223], v123 offset:56384
    s_waitcnt lgkmcnt(8)
    v_mfma_f32_16x16x32_bf16 v[140:143], v[96:99], a[240:243], v[140:143]
    ds_read_b64_tr_b16 v[224:225], v124 offset:20544
    v_mfma_f32_16x16x32_bf16 v[140:143], v[100:103], a[244:247], v[140:143]
    ds_read_b64_tr_b16 v[226:227], v124 offset:25664
    buffer_load_dwordx4 v118, s[60:63], s74 offen offset:2048 lds
    v_mfma_f32_16x16x32_bf16 v[140:143], v[104:107], a[248:251], v[140:143]
    ds_read_b64_tr_b16 v[228:229], v124 offset:30784
    v_mfma_f32_16x16x32_bf16 v[140:143], v[108:111], a[252:255], v[140:143]
    ds_read_b64_tr_b16 v[230:231], v124 offset:35904
    v_mfma_f32_16x16x32_bf16 v[136:139], v[108:111], a[236:239], v[136:139]
    ds_read_b64_tr_b16 v[232:233], v124 offset:41024
    v_mfma_f32_16x16x32_bf16 v[136:139], v[104:107], a[232:235], v[136:139]
    ds_read_b64_tr_b16 v[234:235], v124 offset:46144
    buffer_load_dwordx4 v119, s[60:63], s74 offen offset:3072 lds
    v_mfma_f32_16x16x32_bf16 v[136:139], v[100:103], a[228:231], v[136:139]
    ds_read_b64_tr_b16 v[236:237], v124 offset:51264
    v_mfma_f32_16x16x32_bf16 v[136:139], v[96:99], a[224:227], v[136:139]
    ds_read_b64_tr_b16 v[238:239], v124 offset:56384
    s_waitcnt lgkmcnt(8)
    v_mfma_f32_16x16x32_bf16 v[144:147], v[208:211], a[224:227], v[144:147]
    ds_read_b64_tr_b16 v[240:241], v123 offset:20608
    s_add_u32 m0, s73, 4096
    v_mfma_f32_16x16x32_bf16 v[144:147], v[212:215], a[228:231], v[144:147]
    ds_read_b64_tr_b16 v[242:243], v123 offset:25728
    buffer_load_dwordx4 v120, s[60:63], s74 offen offset:0 lds
    s_add_u32 s74, s74, 81920
    v_mfma_f32_16x16x32_bf16 v[144:147], v[216:219], a[232:235], v[144:147]
    ds_read_b64_tr_b16 v[244:245], v123 offset:30848
    v_mfma_f32_16x16x32_bf16 v[144:147], v[220:223], a[236:239], v[144:147]
    ds_read_b64_tr_b16 v[246:247], v123 offset:35968
    v_mfma_f32_16x16x32_bf16 v[148:151], v[220:223], a[252:255], v[148:151]
    ds_read_b64_tr_b16 v[248:249], v123 offset:41088
    s_add_u32 m0, s73, 20480
    v_mfma_f32_16x16x32_bf16 v[148:151], v[216:219], a[248:251], v[148:151]
    ds_read_b64_tr_b16 v[250:251], v123 offset:46208
    buffer_load_dwordx4 v116, s[60:63], s74 offen offset:0 lds
    v_mfma_f32_16x16x32_bf16 v[148:151], v[212:215], a[244:247], v[148:151]
    ds_read_b64_tr_b16 v[252:253], v123 offset:51328
    v_mfma_f32_16x16x32_bf16 v[148:151], v[208:211], a[240:243], v[148:151]
    ds_read_b64_tr_b16 v[254:255], v123 offset:56448
    s_waitcnt lgkmcnt(8)
    v_mfma_f32_16x16x32_bf16 v[156:159], v[224:227], a[240:243], v[156:159]
    ds_read_b64_tr_b16 v[96:97], v124 offset:20608
    v_mfma_f32_16x16x32_bf16 v[156:159], v[228:231], a[244:247], v[156:159]
    ds_read_b64_tr_b16 v[98:99], v124 offset:25728
    buffer_load_dwordx4 v117, s[60:63], s74 offen offset:1024 lds
    v_mfma_f32_16x16x32_bf16 v[156:159], v[232:235], a[248:251], v[156:159]
    ds_read_b64_tr_b16 v[100:101], v124 offset:30848
    v_mfma_f32_16x16x32_bf16 v[156:159], v[236:239], a[252:255], v[156:159]
    ds_read_b64_tr_b16 v[102:103], v124 offset:35968
    v_mfma_f32_16x16x32_bf16 v[152:155], v[236:239], a[236:239], v[152:155]
    ds_read_b64_tr_b16 v[104:105], v124 offset:41088
    v_mfma_f32_16x16x32_bf16 v[152:155], v[232:235], a[232:235], v[152:155]
    ds_read_b64_tr_b16 v[106:107], v124 offset:46208
    buffer_load_dwordx4 v118, s[60:63], s74 offen offset:2048 lds
    v_mfma_f32_16x16x32_bf16 v[152:155], v[228:231], a[228:231], v[152:155]
    ds_read_b64_tr_b16 v[108:109], v124 offset:51328
    v_mfma_f32_16x16x32_bf16 v[152:155], v[224:227], a[224:227], v[152:155]
    ds_read_b64_tr_b16 v[110:111], v124 offset:56448
    s_waitcnt lgkmcnt(8)
    v_mfma_f32_16x16x32_bf16 v[160:163], v[240:243], a[224:227], v[160:163]
    ds_read_b64_tr_b16 v[208:209], v123 offset:20672
    s_add_u32 s4, s79, 50364416
    v_mfma_f32_16x16x32_bf16 v[160:163], v[244:247], a[228:231], v[160:163]
    ds_read_b64_tr_b16 v[210:211], v123 offset:25792
    buffer_load_dwordx4 v119, s[60:63], s74 offen offset:3072 lds
    v_mfma_f32_16x16x32_bf16 v[160:163], v[248:251], a[232:235], v[160:163]
    ds_read_b64_tr_b16 v[212:213], v123 offset:30912
    buffer_store_dwordx4 v[42:45], v1, s[20:23], s4 offen sc1
    v_mfma_f32_16x16x32_bf16 v[160:163], v[252:255], a[236:239], v[160:163]
    ds_read_b64_tr_b16 v[214:215], v123 offset:36032
    v_mfma_f32_16x16x32_bf16 v[164:167], v[252:255], a[252:255], v[164:167]
    ds_read_b64_tr_b16 v[216:217], v123 offset:41152
    s_add_u32 m0, s73, 24576
    v_mfma_f32_16x16x32_bf16 v[164:167], v[248:251], a[248:251], v[164:167]
    ds_read_b64_tr_b16 v[218:219], v123 offset:46272
    buffer_load_dwordx4 v120, s[60:63], s74 offen offset:0 lds
    s_add_u32 s74, s74, 81920
    v_mfma_f32_16x16x32_bf16 v[164:167], v[244:247], a[244:247], v[164:167]
    ds_read_b64_tr_b16 v[220:221], v123 offset:51392
    v_mfma_f32_16x16x32_bf16 v[164:167], v[240:243], a[240:243], v[164:167]
    ds_read_b64_tr_b16 v[222:223], v123 offset:56512
    s_waitcnt lgkmcnt(8)
    v_mfma_f32_16x16x32_bf16 v[172:175], v[96:99], a[240:243], v[172:175]
    ds_read_b64_tr_b16 v[224:225], v124 offset:20672
    v_mfma_f32_16x16x32_bf16 v[172:175], v[100:103], a[244:247], v[172:175]
    ds_read_b64_tr_b16 v[226:227], v124 offset:25792
    buffer_load_dwordx4 a[128:131], v20, s[8:11], s77 offen offset:0 sc1
    v_mfma_f32_16x16x32_bf16 v[172:175], v[104:107], a[248:251], v[172:175]
    ds_read_b64_tr_b16 v[228:229], v124 offset:30912
    v_mfma_f32_16x16x32_bf16 v[172:175], v[108:111], a[252:255], v[172:175]
    ds_read_b64_tr_b16 v[230:231], v124 offset:36032
    v_mfma_f32_16x16x32_bf16 v[168:171], v[108:111], a[236:239], v[168:171]
    ds_read_b64_tr_b16 v[232:233], v124 offset:41152
    v_mfma_f32_16x16x32_bf16 v[168:171], v[104:107], a[232:235], v[168:171]
    ds_read_b64_tr_b16 v[234:235], v124 offset:46272
    buffer_load_dwordx4 a[132:135], v21, s[8:11], s77 offen offset:0 sc1
    v_mfma_f32_16x16x32_bf16 v[168:171], v[100:103], a[228:231], v[168:171]
    ds_read_b64_tr_b16 v[236:237], v124 offset:51392
    v_mfma_f32_16x16x32_bf16 v[168:171], v[96:99], a[224:227], v[168:171]
    ds_read_b64_tr_b16 v[238:239], v124 offset:56512
    s_waitcnt lgkmcnt(8)
    v_mfma_f32_16x16x32_bf16 v[176:179], v[208:211], a[224:227], v[176:179]
    ds_read_b64_tr_b16 v[240:241], v123 offset:20736
    v_mfma_f32_16x16x32_bf16 v[176:179], v[212:215], a[228:231], v[176:179]
    ds_read_b64_tr_b16 v[242:243], v123 offset:25856
    buffer_load_dwordx4 a[136:139], v22, s[8:11], s77 offen offset:0 sc1
    v_mfma_f32_16x16x32_bf16 v[176:179], v[216:219], a[232:235], v[176:179]
    ds_read_b64_tr_b16 v[244:245], v123 offset:30976
    v_mfma_f32_16x16x32_bf16 v[176:179], v[220:223], a[236:239], v[176:179]
    ds_read_b64_tr_b16 v[246:247], v123 offset:36096
    v_mfma_f32_16x16x32_bf16 v[180:183], v[220:223], a[252:255], v[180:183]
    ds_read_b64_tr_b16 v[248:249], v123 offset:41216
    v_mfma_f32_16x16x32_bf16 v[180:183], v[216:219], a[248:251], v[180:183]
    ds_read_b64_tr_b16 v[250:251], v123 offset:46336
    buffer_load_dwordx4 a[140:143], v23, s[8:11], s77 offen offset:0 sc1
    v_mfma_f32_16x16x32_bf16 v[180:183], v[212:215], a[244:247], v[180:183]
    ds_read_b64_tr_b16 v[252:253], v123 offset:51456
    v_mfma_f32_16x16x32_bf16 v[180:183], v[208:211], a[240:243], v[180:183]
    ds_read_b64_tr_b16 v[254:255], v123 offset:56576
    s_waitcnt lgkmcnt(8)
    v_mfma_f32_16x16x32_bf16 v[188:191], v[224:227], a[240:243], v[188:191]
    ds_read_b64_tr_b16 v[96:97], v124 offset:20736
    v_mfma_f32_16x16x32_bf16 v[188:191], v[228:231], a[244:247], v[188:191]
    ds_read_b64_tr_b16 v[98:99], v124 offset:25856
    buffer_load_dwordx4 a[144:147], v20, s[8:11], s77 offen offset:1024 sc1
    v_mfma_f32_16x16x32_bf16 v[188:191], v[232:235], a[248:251], v[188:191]
    ds_read_b64_tr_b16 v[100:101], v124 offset:30976
    v_mfma_f32_16x16x32_bf16 v[188:191], v[236:239], a[252:255], v[188:191]
    ds_read_b64_tr_b16 v[102:103], v124 offset:36096
    v_mfma_f32_16x16x32_bf16 v[184:187], v[236:239], a[236:239], v[184:187]
    ds_read_b64_tr_b16 v[104:105], v124 offset:41216
    v_mfma_f32_16x16x32_bf16 v[184:187], v[232:235], a[232:235], v[184:187]
    ds_read_b64_tr_b16 v[106:107], v124 offset:46336
    buffer_load_dwordx4 a[148:151], v21, s[8:11], s77 offen offset:1024 sc1
    v_mfma_f32_16x16x32_bf16 v[184:187], v[228:231], a[228:231], v[184:187]
    ds_read_b64_tr_b16 v[108:109], v124 offset:51456
    v_mfma_f32_16x16x32_bf16 v[184:187], v[224:227], a[224:227], v[184:187]
    ds_read_b64_tr_b16 v[110:111], v124 offset:56576
    s_waitcnt vmcnt(27) lgkmcnt(8)
    s_barrier
    v_mfma_f32_16x16x32_bf16 v[192:195], v[240:243], a[224:227], v[192:195]
    ds_read_b64_tr_b16 v[208:209], v125 offset:0
    s_add_u32 s4, s79, 50348032
    v_mfma_f32_16x16x32_bf16 v[192:195], v[244:247], a[228:231], v[192:195]
    ds_read_b64_tr_b16 v[210:211], v125 offset:5120
    buffer_load_dwordx4 a[152:155], v22, s[8:11], s77 offen offset:1024 sc1
    v_mfma_f32_16x16x32_bf16 v[192:195], v[248:251], a[232:235], v[192:195]
    ds_read_b64_tr_b16 v[212:213], v125 offset:10240
    buffer_store_dwordx4 v[26:29], v1, s[20:23], s4 offen sc1
    v_mfma_f32_16x16x32_bf16 v[192:195], v[252:255], a[236:239], v[192:195]
    ds_read_b64_tr_b16 v[214:215], v125 offset:15360
    v_mfma_f32_16x16x32_bf16 v[196:199], v[252:255], a[252:255], v[196:199]
    ds_read_b64_tr_b16 v[216:217], v125 offset:20480
    v_mfma_f32_16x16x32_bf16 v[196:199], v[248:251], a[248:251], v[196:199]
    ds_read_b64_tr_b16 v[218:219], v125 offset:25600
    buffer_load_dwordx4 a[156:159], v23, s[8:11], s77 offen offset:1024 sc1
    s_add_u32 s77, s77, 65536
    v_mfma_f32_16x16x32_bf16 v[196:199], v[244:247], a[244:247], v[196:199]
    ds_read_b64_tr_b16 v[220:221], v125 offset:30720
    v_mfma_f32_16x16x32_bf16 v[196:199], v[240:243], a[240:243], v[196:199]
    ds_read_b64_tr_b16 v[222:223], v125 offset:35840
    s_waitcnt lgkmcnt(8)
    v_mfma_f32_16x16x32_bf16 v[204:207], v[96:99], a[240:243], v[204:207]
    ds_read_b64_tr_b16 v[224:225], v126 offset:0
    v_mfma_f32_16x16x32_bf16 v[204:207], v[100:103], a[244:247], v[204:207]
    ds_read_b64_tr_b16 v[226:227], v126 offset:5120
    v_mfma_f32_16x16x32_bf16 v[204:207], v[104:107], a[248:251], v[204:207]
    ds_read_b64_tr_b16 v[228:229], v126 offset:10240
    v_mfma_f32_16x16x32_bf16 v[204:207], v[108:111], a[252:255], v[204:207]
    ds_read_b64_tr_b16 v[230:231], v126 offset:15360
    v_mfma_f32_16x16x32_bf16 v[200:203], v[108:111], a[236:239], v[200:203]
    ds_read_b64_tr_b16 v[232:233], v126 offset:20480
    v_mfma_f32_16x16x32_bf16 v[200:203], v[104:107], a[232:235], v[200:203]
    ds_read_b64_tr_b16 v[234:235], v126 offset:25600
    v_mfma_f32_16x16x32_bf16 v[200:203], v[100:103], a[228:231], v[200:203]
    ds_read_b64_tr_b16 v[236:237], v126 offset:30720
    v_mfma_f32_16x16x32_bf16 v[200:203], v[96:99], a[224:227], v[200:203]
    ds_read_b64_tr_b16 v[238:239], v126 offset:35840
    s_waitcnt vmcnt(21) lgkmcnt(8)
    v_mfma_f32_16x16x32_bf16 v[128:131], v[208:211], a[160:163], v[128:131]
    ds_read_b64_tr_b16 v[240:241], v125 offset:64
    s_add_u32 m0, s73, 40960
    v_mfma_f32_16x16x32_bf16 v[128:131], v[212:215], a[164:167], v[128:131]
    ds_read_b64_tr_b16 v[242:243], v125 offset:5184
    buffer_load_dwordx4 v116, s[60:63], s74 offen offset:0 lds
    v_mfma_f32_16x16x32_bf16 v[128:131], v[216:219], a[168:171], v[128:131]
    ds_read_b64_tr_b16 v[244:245], v125 offset:10304
    v_mfma_f32_16x16x32_bf16 v[128:131], v[220:223], a[172:175], v[128:131]
    ds_read_b64_tr_b16 v[246:247], v125 offset:15424
    v_mfma_f32_16x16x32_bf16 v[132:135], v[220:223], a[188:191], v[132:135]
    ds_read_b64_tr_b16 v[248:249], v125 offset:20544
    v_mfma_f32_16x16x32_bf16 v[132:135], v[216:219], a[184:187], v[132:135]
    ds_read_b64_tr_b16 v[250:251], v125 offset:25664
    buffer_load_dwordx4 v117, s[60:63], s74 offen offset:1024 lds
    v_mfma_f32_16x16x32_bf16 v[132:135], v[212:215], a[180:183], v[132:135]
    ds_read_b64_tr_b16 v[252:253], v125 offset:30784
    v_mfma_f32_16x16x32_bf16 v[132:135], v[208:211], a[176:179], v[132:135]
    ds_read_b64_tr_b16 v[254:255], v125 offset:35904
    s_waitcnt lgkmcnt(8)
    v_mfma_f32_16x16x32_bf16 v[140:143], v[224:227], a[176:179], v[140:143]
    ds_read_b64_tr_b16 v[96:97], v126 offset:64
    v_mfma_f32_16x16x32_bf16 v[140:143], v[228:231], a[180:183], v[140:143]
    ds_read_b64_tr_b16 v[98:99], v126 offset:5184
    buffer_load_dwordx4 v118, s[60:63], s74 offen offset:2048 lds
    v_mfma_f32_16x16x32_bf16 v[140:143], v[232:235], a[184:187], v[140:143]
    ds_read_b64_tr_b16 v[100:101], v126 offset:10304
    v_mfma_f32_16x16x32_bf16 v[140:143], v[236:239], a[188:191], v[140:143]
    ds_read_b64_tr_b16 v[102:103], v126 offset:15424
    v_mfma_f32_16x16x32_bf16 v[136:139], v[236:239], a[172:175], v[136:139]
    ds_read_b64_tr_b16 v[104:105], v126 offset:20544
    v_mfma_f32_16x16x32_bf16 v[136:139], v[232:235], a[168:171], v[136:139]
    ds_read_b64_tr_b16 v[106:107], v126 offset:25664
    buffer_load_dwordx4 v119, s[60:63], s74 offen offset:3072 lds
    v_mfma_f32_16x16x32_bf16 v[136:139], v[228:231], a[164:167], v[136:139]
    ds_read_b64_tr_b16 v[108:109], v126 offset:30784
    v_mfma_f32_16x16x32_bf16 v[136:139], v[224:227], a[160:163], v[136:139]
    ds_read_b64_tr_b16 v[110:111], v126 offset:35904
    s_waitcnt lgkmcnt(8)
    v_mfma_f32_16x16x32_bf16 v[144:147], v[240:243], a[160:163], v[144:147]
    ds_read_b64_tr_b16 v[208:209], v125 offset:128
    s_add_u32 m0, s73, 45056
    v_mfma_f32_16x16x32_bf16 v[144:147], v[244:247], a[164:167], v[144:147]
    ds_read_b64_tr_b16 v[210:211], v125 offset:5248
    buffer_load_dwordx4 v120, s[60:63], s74 offen offset:0 lds
    s_add_u32 s74, s74, 81920
    v_mfma_f32_16x16x32_bf16 v[144:147], v[248:251], a[168:171], v[144:147]
    ds_read_b64_tr_b16 v[212:213], v125 offset:10368
    s_add_u32 s4, s79, 50368512
    v_mfma_f32_16x16x32_bf16 v[144:147], v[252:255], a[172:175], v[144:147]
    ds_read_b64_tr_b16 v[214:215], v125 offset:15488
    buffer_store_dwordx4 v[46:49], v1, s[20:23], s4 offen sc1
    v_mfma_f32_16x16x32_bf16 v[148:151], v[252:255], a[188:191], v[148:151]
    ds_read_b64_tr_b16 v[216:217], v125 offset:20608
    s_add_u32 m0, s73, 61440
    v_mfma_f32_16x16x32_bf16 v[148:151], v[248:251], a[184:187], v[148:151]
    ds_read_b64_tr_b16 v[218:219], v125 offset:25728
    buffer_load_dwordx4 v116, s[60:63], s74 offen offset:0 lds
    v_mfma_f32_16x16x32_bf16 v[148:151], v[244:247], a[180:183], v[148:151]
    ds_read_b64_tr_b16 v[220:221], v125 offset:30848
    v_mfma_f32_16x16x32_bf16 v[148:151], v[240:243], a[176:179], v[148:151]
    ds_read_b64_tr_b16 v[222:223], v125 offset:35968
    s_waitcnt lgkmcnt(8)
    v_mfma_f32_16x16x32_bf16 v[156:159], v[96:99], a[176:179], v[156:159]
    ds_read_b64_tr_b16 v[224:225], v126 offset:128
    v_mfma_f32_16x16x32_bf16 v[156:159], v[100:103], a[180:183], v[156:159]
    ds_read_b64_tr_b16 v[226:227], v126 offset:5248
    buffer_load_dwordx4 v117, s[60:63], s74 offen offset:1024 lds
    v_mfma_f32_16x16x32_bf16 v[156:159], v[104:107], a[184:187], v[156:159]
    ds_read_b64_tr_b16 v[228:229], v126 offset:10368
    v_mfma_f32_16x16x32_bf16 v[156:159], v[108:111], a[188:191], v[156:159]
    ds_read_b64_tr_b16 v[230:231], v126 offset:15488
    v_mfma_f32_16x16x32_bf16 v[152:155], v[108:111], a[172:175], v[152:155]
    ds_read_b64_tr_b16 v[232:233], v126 offset:20608
    v_mfma_f32_16x16x32_bf16 v[152:155], v[104:107], a[168:171], v[152:155]
    ds_read_b64_tr_b16 v[234:235], v126 offset:25728
    buffer_load_dwordx4 v118, s[60:63], s74 offen offset:2048 lds
    v_mfma_f32_16x16x32_bf16 v[152:155], v[100:103], a[164:167], v[152:155]
    ds_read_b64_tr_b16 v[236:237], v126 offset:30848
    v_mfma_f32_16x16x32_bf16 v[152:155], v[96:99], a[160:163], v[152:155]
    ds_read_b64_tr_b16 v[238:239], v126 offset:35968
    s_waitcnt lgkmcnt(8)
    v_mfma_f32_16x16x32_bf16 v[160:163], v[208:211], a[160:163], v[160:163]
    ds_read_b64_tr_b16 v[240:241], v125 offset:192
    v_mfma_f32_16x16x32_bf16 v[160:163], v[212:215], a[164:167], v[160:163]
    ds_read_b64_tr_b16 v[242:243], v125 offset:5312
    buffer_load_dwordx4 v119, s[60:63], s74 offen offset:3072 lds
    v_mfma_f32_16x16x32_bf16 v[160:163], v[216:219], a[168:171], v[160:163]
    ds_read_b64_tr_b16 v[244:245], v125 offset:10432
    v_mfma_f32_16x16x32_bf16 v[160:163], v[220:223], a[172:175], v[160:163]
    ds_read_b64_tr_b16 v[246:247], v125 offset:15552
    v_mfma_f32_16x16x32_bf16 v[164:167], v[220:223], a[188:191], v[164:167]
    ds_read_b64_tr_b16 v[248:249], v125 offset:20672
    s_add_u32 m0, s73, 65536
    v_mfma_f32_16x16x32_bf16 v[164:167], v[216:219], a[184:187], v[164:167]
    ds_read_b64_tr_b16 v[250:251], v125 offset:25792
    buffer_load_dwordx4 v120, s[60:63], s74 offen offset:0 lds
    s_add_u32 s74, s74, 81920
    v_mfma_f32_16x16x32_bf16 v[164:167], v[212:215], a[180:183], v[164:167]
    ds_read_b64_tr_b16 v[252:253], v125 offset:30912
    v_mfma_f32_16x16x32_bf16 v[164:167], v[208:211], a[176:179], v[164:167]
    ds_read_b64_tr_b16 v[254:255], v125 offset:36032
    s_waitcnt lgkmcnt(8)
    v_mfma_f32_16x16x32_bf16 v[172:175], v[224:227], a[176:179], v[172:175]
    ds_read_b64_tr_b16 v[96:97], v126 offset:192
    v_mfma_f32_16x16x32_bf16 v[172:175], v[228:231], a[180:183], v[172:175]
    ds_read_b64_tr_b16 v[98:99], v126 offset:5312
    buffer_load_dwordx4 a[192:195], v20, s[8:11], s77 offen offset:0 sc1
    v_mfma_f32_16x16x32_bf16 v[172:175], v[232:235], a[184:187], v[172:175]
    ds_read_b64_tr_b16 v[100:101], v126 offset:10432
    v_mfma_f32_16x16x32_bf16 v[172:175], v[236:239], a[188:191], v[172:175]
    ds_read_b64_tr_b16 v[102:103], v126 offset:15552
    v_mfma_f32_16x16x32_bf16 v[168:171], v[236:239], a[172:175], v[168:171]
    ds_read_b64_tr_b16 v[104:105], v126 offset:20672
    v_mfma_f32_16x16x32_bf16 v[168:171], v[232:235], a[168:171], v[168:171]
    ds_read_b64_tr_b16 v[106:107], v126 offset:25792
    buffer_load_dwordx4 a[196:199], v21, s[8:11], s77 offen offset:0 sc1
    v_mfma_f32_16x16x32_bf16 v[168:171], v[228:231], a[164:167], v[168:171]
    ds_read_b64_tr_b16 v[108:109], v126 offset:30912
    v_mfma_f32_16x16x32_bf16 v[168:171], v[224:227], a[160:163], v[168:171]
    ds_read_b64_tr_b16 v[110:111], v126 offset:36032
    s_waitcnt lgkmcnt(8)
    v_mfma_f32_16x16x32_bf16 v[176:179], v[240:243], a[160:163], v[176:179]
    ds_read_b64_tr_b16 v[208:209], v125 offset:256
    v_mfma_f32_16x16x32_bf16 v[176:179], v[244:247], a[164:167], v[176:179]
    ds_read_b64_tr_b16 v[210:211], v125 offset:5376
    buffer_load_dwordx4 a[200:203], v22, s[8:11], s77 offen offset:0 sc1
    v_mfma_f32_16x16x32_bf16 v[176:179], v[248:251], a[168:171], v[176:179]
    ds_read_b64_tr_b16 v[212:213], v125 offset:10496
    v_mfma_f32_16x16x32_bf16 v[176:179], v[252:255], a[172:175], v[176:179]
    ds_read_b64_tr_b16 v[214:215], v125 offset:15616
    v_mfma_f32_16x16x32_bf16 v[180:183], v[252:255], a[188:191], v[180:183]
    ds_read_b64_tr_b16 v[216:217], v125 offset:20736
    v_mfma_f32_16x16x32_bf16 v[180:183], v[248:251], a[184:187], v[180:183]
    ds_read_b64_tr_b16 v[218:219], v125 offset:25856
    buffer_load_dwordx4 a[204:207], v23, s[8:11], s77 offen offset:0 sc1
    v_mfma_f32_16x16x32_bf16 v[180:183], v[244:247], a[180:183], v[180:183]
    ds_read_b64_tr_b16 v[220:221], v125 offset:30976
    v_mfma_f32_16x16x32_bf16 v[180:183], v[240:243], a[176:179], v[180:183]
    ds_read_b64_tr_b16 v[222:223], v125 offset:36096
    s_waitcnt lgkmcnt(8)
    v_mfma_f32_16x16x32_bf16 v[188:191], v[96:99], a[176:179], v[188:191]
    ds_read_b64_tr_b16 v[224:225], v126 offset:256
    v_mfma_f32_16x16x32_bf16 v[188:191], v[100:103], a[180:183], v[188:191]
    ds_read_b64_tr_b16 v[226:227], v126 offset:5376
    buffer_load_dwordx4 a[208:211], v20, s[8:11], s77 offen offset:1024 sc1
    v_mfma_f32_16x16x32_bf16 v[188:191], v[104:107], a[184:187], v[188:191]
    ds_read_b64_tr_b16 v[228:229], v126 offset:10496
    v_mfma_f32_16x16x32_bf16 v[188:191], v[108:111], a[188:191], v[188:191]
    ds_read_b64_tr_b16 v[230:231], v126 offset:15616
    v_mfma_f32_16x16x32_bf16 v[184:187], v[108:111], a[172:175], v[184:187]
    ds_read_b64_tr_b16 v[232:233], v126 offset:20736
    v_mfma_f32_16x16x32_bf16 v[184:187], v[104:107], a[168:171], v[184:187]
    ds_read_b64_tr_b16 v[234:235], v126 offset:25856
    buffer_load_dwordx4 a[212:215], v21, s[8:11], s77 offen offset:1024 sc1
    v_mfma_f32_16x16x32_bf16 v[184:187], v[100:103], a[164:167], v[184:187]
    ds_read_b64_tr_b16 v[236:237], v126 offset:30976
    v_mfma_f32_16x16x32_bf16 v[184:187], v[96:99], a[160:163], v[184:187]
    ds_read_b64_tr_b16 v[238:239], v126 offset:36096
    s_waitcnt vmcnt(26) lgkmcnt(8)
    s_barrier
    v_mfma_f32_16x16x32_bf16 v[192:195], v[208:211], a[160:163], v[192:195]
    ds_read_b64_tr_b16 v[240:241], v121 offset:0
    v_mfma_f32_16x16x32_bf16 v[192:195], v[212:215], a[164:167], v[192:195]
    ds_read_b64_tr_b16 v[242:243], v121 offset:5120
    buffer_load_dwordx4 a[216:219], v22, s[8:11], s77 offen offset:1024 sc1
    v_mfma_f32_16x16x32_bf16 v[192:195], v[216:219], a[168:171], v[192:195]
    ds_read_b64_tr_b16 v[244:245], v121 offset:10240
    v_mfma_f32_16x16x32_bf16 v[192:195], v[220:223], a[172:175], v[192:195]
    ds_read_b64_tr_b16 v[246:247], v121 offset:15360
    v_mfma_f32_16x16x32_bf16 v[196:199], v[220:223], a[188:191], v[196:199]
    ds_read_b64_tr_b16 v[248:249], v121 offset:20480
    v_mfma_f32_16x16x32_bf16 v[196:199], v[216:219], a[184:187], v[196:199]
    ds_read_b64_tr_b16 v[250:251], v121 offset:25600
    buffer_load_dwordx4 a[220:223], v23, s[8:11], s77 offen offset:1024 sc1
    s_add_u32 s77, s77, 65536
    v_mfma_f32_16x16x32_bf16 v[196:199], v[212:215], a[180:183], v[196:199]
    ds_read_b64_tr_b16 v[252:253], v121 offset:30720
    v_mfma_f32_16x16x32_bf16 v[196:199], v[208:211], a[176:179], v[196:199]
    ds_read_b64_tr_b16 v[254:255], v121 offset:35840
    s_waitcnt lgkmcnt(8)
    s_waitcnt vmcnt(13)
    s_add_u32 s72, s51, 393216
    buffer_store_dwordx2 v[58:59], v57, s[8:11], s72 offen sc1
    v_mfma_f32_16x16x32_bf16 v[204:207], v[224:227], a[176:179], v[204:207]
    ds_read_b64_tr_b16 v[96:97], v122 offset:0
    v_mfma_f32_16x16x32_bf16 v[204:207], v[228:231], a[180:183], v[204:207]
    ds_read_b64_tr_b16 v[98:99], v122 offset:5120
    v_mfma_f32_16x16x32_bf16 v[204:207], v[232:235], a[184:187], v[204:207]
    ds_read_b64_tr_b16 v[100:101], v122 offset:10240
    v_mfma_f32_16x16x32_bf16 v[204:207], v[236:239], a[188:191], v[204:207]
    ds_read_b64_tr_b16 v[102:103], v122 offset:15360
    v_mfma_f32_16x16x32_bf16 v[200:203], v[236:239], a[172:175], v[200:203]
    ds_read_b64_tr_b16 v[104:105], v122 offset:20480
    v_mfma_f32_16x16x32_bf16 v[200:203], v[232:235], a[168:171], v[200:203]
    ds_read_b64_tr_b16 v[106:107], v122 offset:25600
    v_mfma_f32_16x16x32_bf16 v[200:203], v[228:231], a[164:167], v[200:203]
    ds_read_b64_tr_b16 v[108:109], v122 offset:30720
    v_mfma_f32_16x16x32_bf16 v[200:203], v[224:227], a[160:163], v[200:203]
    ds_read_b64_tr_b16 v[110:111], v122 offset:35840
    s_waitcnt lgkmcnt(8)
    v_mfma_f32_16x16x32_bf16 v[128:131], v[240:243], a[128:131], v[128:131]
    ds_read_b64_tr_b16 v[208:209], v121 offset:64
    s_add_u32 m0, s73, 81920
    v_mfma_f32_16x16x32_bf16 v[128:131], v[244:247], a[132:135], v[128:131]
    ds_read_b64_tr_b16 v[210:211], v121 offset:5184
    buffer_load_dwordx4 v116, s[60:63], s74 offen offset:0 lds
    v_mfma_f32_16x16x32_bf16 v[128:131], v[248:251], a[136:139], v[128:131]
    ds_read_b64_tr_b16 v[212:213], v121 offset:10304
    v_mfma_f32_16x16x32_bf16 v[128:131], v[252:255], a[140:143], v[128:131]
    ds_read_b64_tr_b16 v[214:215], v121 offset:15424
    v_mfma_f32_16x16x32_bf16 v[132:135], v[252:255], a[156:159], v[132:135]
    ds_read_b64_tr_b16 v[216:217], v121 offset:20544
    v_mfma_f32_16x16x32_bf16 v[132:135], v[248:251], a[152:155], v[132:135]
    ds_read_b64_tr_b16 v[218:219], v121 offset:25664
    buffer_load_dwordx4 v117, s[60:63], s74 offen offset:1024 lds
    v_mfma_f32_16x16x32_bf16 v[132:135], v[244:247], a[148:151], v[132:135]
    ds_read_b64_tr_b16 v[220:221], v121 offset:30784
    v_mfma_f32_16x16x32_bf16 v[132:135], v[240:243], a[144:147], v[132:135]
    ds_read_b64_tr_b16 v[222:223], v121 offset:35904
    s_waitcnt lgkmcnt(8)
    v_mfma_f32_16x16x32_bf16 v[140:143], v[96:99], a[144:147], v[140:143]
    ds_read_b64_tr_b16 v[224:225], v122 offset:64
    v_mfma_f32_16x16x32_bf16 v[140:143], v[100:103], a[148:151], v[140:143]
    ds_read_b64_tr_b16 v[226:227], v122 offset:5184
    buffer_load_dwordx4 v118, s[60:63], s74 offen offset:2048 lds
    v_mfma_f32_16x16x32_bf16 v[140:143], v[104:107], a[152:155], v[140:143]
    ds_read_b64_tr_b16 v[228:229], v122 offset:10304
    v_mfma_f32_16x16x32_bf16 v[140:143], v[108:111], a[156:159], v[140:143]
    ds_read_b64_tr_b16 v[230:231], v122 offset:15424
    v_mfma_f32_16x16x32_bf16 v[136:139], v[108:111], a[140:143], v[136:139]
    ds_read_b64_tr_b16 v[232:233], v122 offset:20544
    v_mfma_f32_16x16x32_bf16 v[136:139], v[104:107], a[136:139], v[136:139]
    ds_read_b64_tr_b16 v[234:235], v122 offset:25664
    buffer_load_dwordx4 v119, s[60:63], s74 offen offset:3072 lds
    v_mfma_f32_16x16x32_bf16 v[136:139], v[100:103], a[132:135], v[136:139]
    ds_read_b64_tr_b16 v[236:237], v122 offset:30784
    v_mfma_f32_16x16x32_bf16 v[136:139], v[96:99], a[128:131], v[136:139]
    ds_read_b64_tr_b16 v[238:239], v122 offset:35904
    s_waitcnt lgkmcnt(8)
    v_mfma_f32_16x16x32_bf16 v[144:147], v[208:211], a[128:131], v[144:147]
    ds_read_b64_tr_b16 v[240:241], v121 offset:128
    s_add_u32 m0, s73, 86016
    v_mfma_f32_16x16x32_bf16 v[144:147], v[212:215], a[132:135], v[144:147]
    ds_read_b64_tr_b16 v[242:243], v121 offset:5248
    buffer_load_dwordx4 v120, s[60:63], s74 offen offset:0 lds
    s_add_u32 s74, s74, 81920
    v_mfma_f32_16x16x32_bf16 v[144:147], v[216:219], a[136:139], v[144:147]
    ds_read_b64_tr_b16 v[244:245], v121 offset:10368
    v_mfma_f32_16x16x32_bf16 v[144:147], v[220:223], a[140:143], v[144:147]
    ds_read_b64_tr_b16 v[246:247], v121 offset:15488
    v_mfma_f32_16x16x32_bf16 v[148:151], v[220:223], a[156:159], v[148:151]
    ds_read_b64_tr_b16 v[248:249], v121 offset:20608
    s_add_u32 m0, s73, 102400
    v_mfma_f32_16x16x32_bf16 v[148:151], v[216:219], a[152:155], v[148:151]
    ds_read_b64_tr_b16 v[250:251], v121 offset:25728
    buffer_load_dwordx4 v116, s[60:63], s74 offen offset:0 lds
    v_mfma_f32_16x16x32_bf16 v[148:151], v[212:215], a[148:151], v[148:151]
    ds_read_b64_tr_b16 v[252:253], v121 offset:30848
    v_mfma_f32_16x16x32_bf16 v[148:151], v[208:211], a[144:147], v[148:151]
    ds_read_b64_tr_b16 v[254:255], v121 offset:35968
    s_waitcnt lgkmcnt(8)
    v_mfma_f32_16x16x32_bf16 v[156:159], v[224:227], a[144:147], v[156:159]
    ds_read_b64_tr_b16 v[96:97], v122 offset:128
    v_mfma_f32_16x16x32_bf16 v[156:159], v[228:231], a[148:151], v[156:159]
    ds_read_b64_tr_b16 v[98:99], v122 offset:5248
    buffer_load_dwordx4 v117, s[60:63], s74 offen offset:1024 lds
    v_mfma_f32_16x16x32_bf16 v[156:159], v[232:235], a[152:155], v[156:159]
    ds_read_b64_tr_b16 v[100:101], v122 offset:10368
    v_mfma_f32_16x16x32_bf16 v[156:159], v[236:239], a[156:159], v[156:159]
    ds_read_b64_tr_b16 v[102:103], v122 offset:15488
    v_mfma_f32_16x16x32_bf16 v[152:155], v[236:239], a[140:143], v[152:155]
    ds_read_b64_tr_b16 v[104:105], v122 offset:20608
    v_mfma_f32_16x16x32_bf16 v[152:155], v[232:235], a[136:139], v[152:155]
    ds_read_b64_tr_b16 v[106:107], v122 offset:25728
    buffer_load_dwordx4 v118, s[60:63], s74 offen offset:2048 lds
    v_mfma_f32_16x16x32_bf16 v[152:155], v[228:231], a[132:135], v[152:155]
    ds_read_b64_tr_b16 v[108:109], v122 offset:30848
    v_mfma_f32_16x16x32_bf16 v[152:155], v[224:227], a[128:131], v[152:155]
    ds_read_b64_tr_b16 v[110:111], v122 offset:35968
    s_waitcnt lgkmcnt(8)
    v_mfma_f32_16x16x32_bf16 v[160:163], v[240:243], a[128:131], v[160:163]
    ds_read_b64_tr_b16 v[208:209], v121 offset:192
    v_mfma_f32_16x16x32_bf16 v[160:163], v[244:247], a[132:135], v[160:163]
    ds_read_b64_tr_b16 v[210:211], v121 offset:5312
    buffer_load_dwordx4 v119, s[60:63], s74 offen offset:3072 lds
    v_mfma_f32_16x16x32_bf16 v[160:163], v[248:251], a[136:139], v[160:163]
    ds_read_b64_tr_b16 v[212:213], v121 offset:10432
    v_mfma_f32_16x16x32_bf16 v[160:163], v[252:255], a[140:143], v[160:163]
    ds_read_b64_tr_b16 v[214:215], v121 offset:15552
    v_mfma_f32_16x16x32_bf16 v[164:167], v[252:255], a[156:159], v[164:167]
    ds_read_b64_tr_b16 v[216:217], v121 offset:20672
    s_add_u32 m0, s73, 106496
    v_mfma_f32_16x16x32_bf16 v[164:167], v[248:251], a[152:155], v[164:167]
    ds_read_b64_tr_b16 v[218:219], v121 offset:25792
    buffer_load_dwordx4 v120, s[60:63], s74 offen offset:0 lds
    s_add_u32 s74, s74, 81920
    v_mfma_f32_16x16x32_bf16 v[164:167], v[244:247], a[148:151], v[164:167]
    ds_read_b64_tr_b16 v[220:221], v121 offset:30912
    v_mfma_f32_16x16x32_bf16 v[164:167], v[240:243], a[144:147], v[164:167]
    ds_read_b64_tr_b16 v[222:223], v121 offset:36032
    s_waitcnt lgkmcnt(8)
    v_mfma_f32_16x16x32_bf16 v[172:175], v[96:99], a[144:147], v[172:175]
    ds_read_b64_tr_b16 v[224:225], v122 offset:192
    v_mfma_f32_16x16x32_bf16 v[172:175], v[100:103], a[148:151], v[172:175]
    ds_read_b64_tr_b16 v[226:227], v122 offset:5312
    buffer_load_dwordx4 a[224:227], v20, s[8:11], s77 offen offset:0 sc1
    v_mfma_f32_16x16x32_bf16 v[172:175], v[104:107], a[152:155], v[172:175]
    ds_read_b64_tr_b16 v[228:229], v122 offset:10432
    v_mfma_f32_16x16x32_bf16 v[172:175], v[108:111], a[156:159], v[172:175]
    ds_read_b64_tr_b16 v[230:231], v122 offset:15552
    v_mfma_f32_16x16x32_bf16 v[168:171], v[108:111], a[140:143], v[168:171]
    ds_read_b64_tr_b16 v[232:233], v122 offset:20672
    v_mfma_f32_16x16x32_bf16 v[168:171], v[104:107], a[136:139], v[168:171]
    ds_read_b64_tr_b16 v[234:235], v122 offset:25792
    buffer_load_dwordx4 a[228:231], v21, s[8:11], s77 offen offset:0 sc1
    v_mfma_f32_16x16x32_bf16 v[168:171], v[100:103], a[132:135], v[168:171]
    ds_read_b64_tr_b16 v[236:237], v122 offset:30912
    v_mfma_f32_16x16x32_bf16 v[168:171], v[96:99], a[128:131], v[168:171]
    ds_read_b64_tr_b16 v[238:239], v122 offset:36032
    s_waitcnt lgkmcnt(8)
    v_mfma_f32_16x16x32_bf16 v[176:179], v[208:211], a[128:131], v[176:179]
    ds_read_b64_tr_b16 v[240:241], v121 offset:256
    v_mfma_f32_16x16x32_bf16 v[176:179], v[212:215], a[132:135], v[176:179]
    ds_read_b64_tr_b16 v[242:243], v121 offset:5376
    buffer_load_dwordx4 a[232:235], v22, s[8:11], s77 offen offset:0 sc1
    v_mfma_f32_16x16x32_bf16 v[176:179], v[216:219], a[136:139], v[176:179]
    ds_read_b64_tr_b16 v[244:245], v121 offset:10496
    v_mfma_f32_16x16x32_bf16 v[176:179], v[220:223], a[140:143], v[176:179]
    ds_read_b64_tr_b16 v[246:247], v121 offset:15616
    v_mfma_f32_16x16x32_bf16 v[180:183], v[220:223], a[156:159], v[180:183]
    ds_read_b64_tr_b16 v[248:249], v121 offset:20736
    v_mfma_f32_16x16x32_bf16 v[180:183], v[216:219], a[152:155], v[180:183]
    ds_read_b64_tr_b16 v[250:251], v121 offset:25856
    buffer_load_dwordx4 a[236:239], v23, s[8:11], s77 offen offset:0 sc1
    v_mfma_f32_16x16x32_bf16 v[180:183], v[212:215], a[148:151], v[180:183]
    ds_read_b64_tr_b16 v[252:253], v121 offset:30976
    v_mfma_f32_16x16x32_bf16 v[180:183], v[208:211], a[144:147], v[180:183]
    ds_read_b64_tr_b16 v[254:255], v121 offset:36096
    s_waitcnt lgkmcnt(8)
    v_mfma_f32_16x16x32_bf16 v[188:191], v[224:227], a[144:147], v[188:191]
    ds_read_b64_tr_b16 v[96:97], v122 offset:256
    v_mfma_f32_16x16x32_bf16 v[188:191], v[228:231], a[148:151], v[188:191]
    ds_read_b64_tr_b16 v[98:99], v122 offset:5376
    buffer_load_dwordx4 a[240:243], v20, s[8:11], s77 offen offset:1024 sc1
    v_mfma_f32_16x16x32_bf16 v[188:191], v[232:235], a[152:155], v[188:191]
    ds_read_b64_tr_b16 v[100:101], v122 offset:10496
    v_mfma_f32_16x16x32_bf16 v[188:191], v[236:239], a[156:159], v[188:191]
    ds_read_b64_tr_b16 v[102:103], v122 offset:15616
    v_mfma_f32_16x16x32_bf16 v[184:187], v[236:239], a[140:143], v[184:187]
    ds_read_b64_tr_b16 v[104:105], v122 offset:20736
    v_mfma_f32_16x16x32_bf16 v[184:187], v[232:235], a[136:139], v[184:187]
    ds_read_b64_tr_b16 v[106:107], v122 offset:25856
    buffer_load_dwordx4 a[244:247], v21, s[8:11], s77 offen offset:1024 sc1
    v_mfma_f32_16x16x32_bf16 v[184:187], v[228:231], a[132:135], v[184:187]
    ds_read_b64_tr_b16 v[108:109], v122 offset:30976
    v_mfma_f32_16x16x32_bf16 v[184:187], v[224:227], a[128:131], v[184:187]
    ds_read_b64_tr_b16 v[110:111], v122 offset:36096
    s_waitcnt vmcnt(25) lgkmcnt(8)
    s_barrier
    v_mfma_f32_16x16x32_bf16 v[192:195], v[240:243], a[128:131], v[192:195]
    ds_read_b64_tr_b16 v[208:209], v121 offset:40960
    v_mfma_f32_16x16x32_bf16 v[192:195], v[244:247], a[132:135], v[192:195]
    ds_read_b64_tr_b16 v[210:211], v121 offset:46080
    buffer_load_dwordx4 a[248:251], v22, s[8:11], s77 offen offset:1024 sc1
    v_mfma_f32_16x16x32_bf16 v[192:195], v[248:251], a[136:139], v[192:195]
    ds_read_b64_tr_b16 v[212:213], v121 offset:51200
    v_mfma_f32_16x16x32_bf16 v[192:195], v[252:255], a[140:143], v[192:195]
    ds_read_b64_tr_b16 v[214:215], v121 offset:56320
    v_mfma_f32_16x16x32_bf16 v[196:199], v[252:255], a[156:159], v[196:199]
    ds_read_b64_tr_b16 v[216:217], v123 offset:0
    v_mfma_f32_16x16x32_bf16 v[196:199], v[248:251], a[152:155], v[196:199]
    ds_read_b64_tr_b16 v[218:219], v123 offset:5120
    buffer_load_dwordx4 a[252:255], v23, s[8:11], s77 offen offset:1024 sc1
    s_add_u32 s77, s77, 65536
    v_mfma_f32_16x16x32_bf16 v[196:199], v[244:247], a[148:151], v[196:199]
    ds_read_b64_tr_b16 v[220:221], v123 offset:10240
    v_mfma_f32_16x16x32_bf16 v[196:199], v[240:243], a[144:147], v[196:199]
    ds_read_b64_tr_b16 v[222:223], v123 offset:15360
    s_waitcnt lgkmcnt(8)
    v_mfma_f32_16x16x32_bf16 v[204:207], v[96:99], a[144:147], v[204:207]
    ds_read_b64_tr_b16 v[224:225], v122 offset:40960
    v_mfma_f32_16x16x32_bf16 v[204:207], v[100:103], a[148:151], v[204:207]
    ds_read_b64_tr_b16 v[226:227], v122 offset:46080
    v_mfma_f32_16x16x32_bf16 v[204:207], v[104:107], a[152:155], v[204:207]
    ds_read_b64_tr_b16 v[228:229], v122 offset:51200
    v_mfma_f32_16x16x32_bf16 v[204:207], v[108:111], a[156:159], v[204:207]
    ds_read_b64_tr_b16 v[230:231], v122 offset:56320
    v_mfma_f32_16x16x32_bf16 v[200:203], v[108:111], a[140:143], v[200:203]
    ds_read_b64_tr_b16 v[232:233], v124 offset:0
    v_mfma_f32_16x16x32_bf16 v[200:203], v[104:107], a[136:139], v[200:203]
    ds_read_b64_tr_b16 v[234:235], v124 offset:5120
    v_mfma_f32_16x16x32_bf16 v[200:203], v[100:103], a[132:135], v[200:203]
    ds_read_b64_tr_b16 v[236:237], v124 offset:10240
    v_mfma_f32_16x16x32_bf16 v[200:203], v[96:99], a[128:131], v[200:203]
    ds_read_b64_tr_b16 v[238:239], v124 offset:15360
    s_waitcnt vmcnt(19) lgkmcnt(8)
    v_mfma_f32_16x16x32_bf16 v[128:131], v[208:211], a[192:195], v[128:131]
    ds_read_b64_tr_b16 v[240:241], v121 offset:41024
    s_add_u32 m0, s73, 122880
    v_mfma_f32_16x16x32_bf16 v[128:131], v[212:215], a[196:199], v[128:131]
    ds_read_b64_tr_b16 v[242:243], v121 offset:46144
    buffer_load_dwordx4 v116, s[60:63], s74 offen offset:0 lds
    v_mfma_f32_16x16x32_bf16 v[128:131], v[216:219], a[200:203], v[128:131]
    ds_read_b64_tr_b16 v[244:245], v121 offset:51264
    v_mfma_f32_16x16x32_bf16 v[128:131], v[220:223], a[204:207], v[128:131]
    ds_read_b64_tr_b16 v[246:247], v121 offset:56384
    v_mfma_f32_16x16x32_bf16 v[132:135], v[220:223], a[220:223], v[132:135]
    ds_read_b64_tr_b16 v[248:249], v123 offset:64
    v_mfma_f32_16x16x32_bf16 v[132:135], v[216:219], a[216:219], v[132:135]
    ds_read_b64_tr_b16 v[250:251], v123 offset:5184
    buffer_load_dwordx4 v117, s[60:63], s74 offen offset:1024 lds
    v_mfma_f32_16x16x32_bf16 v[132:135], v[212:215], a[212:215], v[132:135]
    ds_read_b64_tr_b16 v[252:253], v123 offset:10304
    v_mfma_f32_16x16x32_bf16 v[132:135], v[208:211], a[208:211], v[132:135]
    ds_read_b64_tr_b16 v[254:255], v123 offset:15424
    s_waitcnt lgkmcnt(8)
    v_mfma_f32_16x16x32_bf16 v[140:143], v[224:227], a[208:211], v[140:143]
    ds_read_b64_tr_b16 v[96:97], v122 offset:41024
    v_mfma_f32_16x16x32_bf16 v[140:143], v[228:231], a[212:215], v[140:143]
    ds_read_b64_tr_b16 v[98:99], v122 offset:46144
    buffer_load_dwordx4 v118, s[60:63], s74 offen offset:2048 lds
    v_mfma_f32_16x16x32_bf16 v[140:143], v[232:235], a[216:219], v[140:143]
    ds_read_b64_tr_b16 v[100:101], v122 offset:51264
    v_mfma_f32_16x16x32_bf16 v[140:143], v[236:239], a[220:223], v[140:143]
    ds_read_b64_tr_b16 v[102:103], v122 offset:56384
    v_mfma_f32_16x16x32_bf16 v[136:139], v[236:239], a[204:207], v[136:139]
    ds_read_b64_tr_b16 v[104:105], v124 offset:64
    v_mfma_f32_16x16x32_bf16 v[136:139], v[232:235], a[200:203], v[136:139]
    ds_read_b64_tr_b16 v[106:107], v124 offset:5184
    buffer_load_dwordx4 v119, s[60:63], s74 offen offset:3072 lds
    v_mfma_f32_16x16x32_bf16 v[136:139], v[228:231], a[196:199], v[136:139]
    ds_read_b64_tr_b16 v[108:109], v124 offset:10304
    v_mfma_f32_16x16x32_bf16 v[136:139], v[224:227], a[192:195], v[136:139]
    ds_read_b64_tr_b16 v[110:111], v124 offset:15424
    s_waitcnt lgkmcnt(8)
    v_mfma_f32_16x16x32_bf16 v[144:147], v[240:243], a[192:195], v[144:147]
    ds_read_b64_tr_b16 v[208:209], v121 offset:41088
    s_add_u32 m0, s73, 126976
    v_mfma_f32_16x16x32_bf16 v[144:147], v[244:247], a[196:199], v[144:147]
    ds_read_b64_tr_b16 v[210:211], v121 offset:46208
    buffer_load_dwordx4 v120, s[60:63], s74 offen offset:0 lds
    s_add_u32 s74, s74, 81920
    v_mfma_f32_16x16x32_bf16 v[144:147], v[248:251], a[200:203], v[144:147]
    ds_read_b64_tr_b16 v[212:213], v121 offset:51328
    v_mfma_f32_16x16x32_bf16 v[144:147], v[252:255], a[204:207], v[144:147]
    ds_read_b64_tr_b16 v[214:215], v121 offset:56448
    buffer_load_dwordx2 v[114:115], v113, s[8:11], s47 offen sc1
    v_mfma_f32_16x16x32_bf16 v[148:151], v[252:255], a[220:223], v[148:151]
    ds_read_b64_tr_b16 v[216:217], v123 offset:128
    s_add_u32 m0, s73, 143360
    v_mfma_f32_16x16x32_bf16 v[148:151], v[248:251], a[216:219], v[148:151]
    ds_read_b64_tr_b16 v[218:219], v123 offset:5248
    buffer_load_dwordx4 v116, s[60:63], s74 offen offset:0 lds
    v_mfma_f32_16x16x32_bf16 v[148:151], v[244:247], a[212:215], v[148:151]
    ds_read_b64_tr_b16 v[220:221], v123 offset:10368
    v_mfma_f32_16x16x32_bf16 v[148:151], v[240:243], a[208:211], v[148:151]
    ds_read_b64_tr_b16 v[222:223], v123 offset:15488
    s_waitcnt lgkmcnt(8)
    v_mfma_f32_16x16x32_bf16 v[156:159], v[96:99], a[208:211], v[156:159]
    ds_read_b64_tr_b16 v[224:225], v122 offset:41088
    v_mfma_f32_16x16x32_bf16 v[156:159], v[100:103], a[212:215], v[156:159]
    ds_read_b64_tr_b16 v[226:227], v122 offset:46208
    buffer_load_dwordx4 v117, s[60:63], s74 offen offset:1024 lds
    v_mfma_f32_16x16x32_bf16 v[156:159], v[104:107], a[216:219], v[156:159]
    ds_read_b64_tr_b16 v[228:229], v122 offset:51328
    v_mfma_f32_16x16x32_bf16 v[156:159], v[108:111], a[220:223], v[156:159]
    ds_read_b64_tr_b16 v[230:231], v122 offset:56448
    v_mfma_f32_16x16x32_bf16 v[152:155], v[108:111], a[204:207], v[152:155]
    ds_read_b64_tr_b16 v[232:233], v124 offset:128
    v_mfma_f32_16x16x32_bf16 v[152:155], v[104:107], a[200:203], v[152:155]
    ds_read_b64_tr_b16 v[234:235], v124 offset:5248
    buffer_load_dwordx4 v118, s[60:63], s74 offen offset:2048 lds
    v_mfma_f32_16x16x32_bf16 v[152:155], v[100:103], a[196:199], v[152:155]
    ds_read_b64_tr_b16 v[236:237], v124 offset:10368
    v_mfma_f32_16x16x32_bf16 v[152:155], v[96:99], a[192:195], v[152:155]
    ds_read_b64_tr_b16 v[238:239], v124 offset:15488
    s_waitcnt lgkmcnt(8)
    v_mfma_f32_16x16x32_bf16 v[160:163], v[208:211], a[192:195], v[160:163]
    ds_read_b64_tr_b16 v[240:241], v121 offset:41152
    v_mfma_f32_16x16x32_bf16 v[160:163], v[212:215], a[196:199], v[160:163]
    ds_read_b64_tr_b16 v[242:243], v121 offset:46272
    buffer_load_dwordx4 v119, s[60:63], s74 offen offset:3072 lds
    v_mfma_f32_16x16x32_bf16 v[160:163], v[216:219], a[200:203], v[160:163]
    ds_read_b64_tr_b16 v[244:245], v121 offset:51392
    v_mfma_f32_16x16x32_bf16 v[160:163], v[220:223], a[204:207], v[160:163]
    ds_read_b64_tr_b16 v[246:247], v121 offset:56512
    v_mfma_f32_16x16x32_bf16 v[164:167], v[220:223], a[220:223], v[164:167]
    ds_read_b64_tr_b16 v[248:249], v123 offset:192
    s_add_u32 m0, s73, 147456
    v_mfma_f32_16x16x32_bf16 v[164:167], v[216:219], a[216:219], v[164:167]
    ds_read_b64_tr_b16 v[250:251], v123 offset:5312
    buffer_load_dwordx4 v120, s[60:63], s74 offen offset:0 lds
    s_add_u32 s74, s74, 81920
    v_mfma_f32_16x16x32_bf16 v[164:167], v[212:215], a[212:215], v[164:167]
    ds_read_b64_tr_b16 v[252:253], v123 offset:10432
    v_mfma_f32_16x16x32_bf16 v[164:167], v[208:211], a[208:211], v[164:167]
    ds_read_b64_tr_b16 v[254:255], v123 offset:15552
    s_waitcnt lgkmcnt(8)
    v_mfma_f32_16x16x32_bf16 v[172:175], v[224:227], a[208:211], v[172:175]
    ds_read_b64_tr_b16 v[96:97], v122 offset:41152
    v_mfma_f32_16x16x32_bf16 v[172:175], v[228:231], a[212:215], v[172:175]
    ds_read_b64_tr_b16 v[98:99], v122 offset:46272
    buffer_load_dwordx4 a[160:163], v20, s[8:11], s77 offen offset:0 sc1
    v_mfma_f32_16x16x32_bf16 v[172:175], v[232:235], a[216:219], v[172:175]
    ds_read_b64_tr_b16 v[100:101], v122 offset:51392
    v_mfma_f32_16x16x32_bf16 v[172:175], v[236:239], a[220:223], v[172:175]
    ds_read_b64_tr_b16 v[102:103], v122 offset:56512
    v_mfma_f32_16x16x32_bf16 v[168:171], v[236:239], a[204:207], v[168:171]
    ds_read_b64_tr_b16 v[104:105], v124 offset:192
    v_mfma_f32_16x16x32_bf16 v[168:171], v[232:235], a[200:203], v[168:171]
    ds_read_b64_tr_b16 v[106:107], v124 offset:5312
    buffer_load_dwordx4 a[164:167], v21, s[8:11], s77 offen offset:0 sc1
    v_mfma_f32_16x16x32_bf16 v[168:171], v[228:231], a[196:199], v[168:171]
    ds_read_b64_tr_b16 v[108:109], v124 offset:10432
    v_mfma_f32_16x16x32_bf16 v[168:171], v[224:227], a[192:195], v[168:171]
    ds_read_b64_tr_b16 v[110:111], v124 offset:15552
    s_waitcnt lgkmcnt(8)
    v_mfma_f32_16x16x32_bf16 v[176:179], v[240:243], a[192:195], v[176:179]
    ds_read_b64_tr_b16 v[208:209], v121 offset:41216
    v_mfma_f32_16x16x32_bf16 v[176:179], v[244:247], a[196:199], v[176:179]
    ds_read_b64_tr_b16 v[210:211], v121 offset:46336
    buffer_load_dwordx4 a[168:171], v22, s[8:11], s77 offen offset:0 sc1
    v_mfma_f32_16x16x32_bf16 v[176:179], v[248:251], a[200:203], v[176:179]
    ds_read_b64_tr_b16 v[212:213], v121 offset:51456
    v_mfma_f32_16x16x32_bf16 v[176:179], v[252:255], a[204:207], v[176:179]
    ds_read_b64_tr_b16 v[214:215], v121 offset:56576
    v_mfma_f32_16x16x32_bf16 v[180:183], v[252:255], a[220:223], v[180:183]
    ds_read_b64_tr_b16 v[216:217], v123 offset:256
    v_mfma_f32_16x16x32_bf16 v[180:183], v[248:251], a[216:219], v[180:183]
    ds_read_b64_tr_b16 v[218:219], v123 offset:5376
    buffer_load_dwordx4 a[172:175], v23, s[8:11], s77 offen offset:0 sc1
    v_mfma_f32_16x16x32_bf16 v[180:183], v[244:247], a[212:215], v[180:183]
    ds_read_b64_tr_b16 v[220:221], v123 offset:10496
    v_mfma_f32_16x16x32_bf16 v[180:183], v[240:243], a[208:211], v[180:183]
    ds_read_b64_tr_b16 v[222:223], v123 offset:15616
    s_waitcnt lgkmcnt(8)
    s_waitcnt vmcnt(9)
    v_cmp_ne_u64 vcc, s[38:39], v[114:115]
    s_mov_b32 s42, 0
    s_cbranch_vccz Lpok3
Lspin3:
    buffer_load_dwordx2 v[114:115], v113, s[8:11], s47 offen sc1
    s_add_u32 s42, s42, 1
    s_waitcnt vmcnt(0)
    v_cmp_ne_u64 vcc, s[38:39], v[114:115]
    s_cmp_ge_u32 s42, 0x100000
    s_cbranch_scc1 Lpok3
    s_cbranch_vccnz Lspin3
Lpok3:
    v_mfma_f32_16x16x32_bf16 v[188:191], v[96:99], a[208:211], v[188:191]
    ds_read_b64_tr_b16 v[224:225], v122 offset:41216
    v_mfma_f32_16x16x32_bf16 v[188:191], v[100:103], a[212:215], v[188:191]
    ds_read_b64_tr_b16 v[226:227], v122 offset:46336
    buffer_load_dwordx4 a[176:179], v20, s[8:11], s77 offen offset:1024 sc1
    v_mfma_f32_16x16x32_bf16 v[188:191], v[104:107], a[216:219], v[188:191]
    ds_read_b64_tr_b16 v[228:229], v122 offset:51456
    s_add_u32 s5, s80, 50331648
    v_mfma_f32_16x16x32_bf16 v[188:191], v[108:111], a[220:223], v[188:191]
    ds_read_b64_tr_b16 v[230:231], v122 offset:56576
    buffer_load_dwordx4 a[4:7], v1, s[8:11], s5 offen offset:1024 sc1
    v_mfma_f32_16x16x32_bf16 v[184:187], v[108:111], a[204:207], v[184:187]
    ds_read_b64_tr_b16 v[232:233], v124 offset:256
    v_mfma_f32_16x16x32_bf16 v[184:187], v[104:107], a[200:203], v[184:187]
    ds_read_b64_tr_b16 v[234:235], v124 offset:5376
    buffer_load_dwordx4 a[180:183], v21, s[8:11], s77 offen offset:1024 sc1
    v_mfma_f32_16x16x32_bf16 v[184:187], v[100:103], a[196:199], v[184:187]
    ds_read_b64_tr_b16 v[236:237], v124 offset:10496
    v_mfma_f32_16x16x32_bf16 v[184:187], v[96:99], a[192:195], v[184:187]
    ds_read_b64_tr_b16 v[238:239], v124 offset:15616
    s_waitcnt lgkmcnt(8)
    s_barrier
    v_mfma_f32_16x16x32_bf16 v[192:195], v[208:211], a[192:195], v[192:195]
    ds_read_b64_tr_b16 v[240:241], v123 offset:20480
    v_mfma_f32_16x16x32_bf16 v[192:195], v[212:215], a[196:199], v[192:195]
    ds_read_b64_tr_b16 v[242:243], v123 offset:25600
    buffer_load_dwordx4 a[184:187], v22, s[8:11], s77 offen offset:1024 sc1
    v_mfma_f32_16x16x32_bf16 v[192:195], v[216:219], a[200:203], v[192:195]
    ds_read_b64_tr_b16 v[244:245], v123 offset:30720
    v_mfma_f32_16x16x32_bf16 v[192:195], v[220:223], a[204:207], v[192:195]
    ds_read_b64_tr_b16 v[246:247], v123 offset:35840
    buffer_load_dwordx4 a[8:11], v1, s[8:11], s5 offen offset:2048 sc1
    v_mfma_f32_16x16x32_bf16 v[196:199], v[220:223], a[220:223], v[196:199]
    ds_read_b64_tr_b16 v[248:249], v123 offset:40960
    v_mfma_f32_16x16x32_bf16 v[196:199], v[216:219], a[216:219], v[196:199]
    ds_read_b64_tr_b16 v[250:251], v123 offset:46080
    buffer_load_dwordx4 a[188:191], v23, s[8:11], s77 offen offset:1024 sc1
    s_add_u32 s77, s77, 65536
    v_mfma_f32_16x16x32_bf16 v[196:199], v[212:215], a[212:215], v[196:199]
    ds_read_b64_tr_b16 v[252:253], v123 offset:51200
    v_mfma_f32_16x16x32_bf16 v[196:199], v[208:211], a[208:211], v[196:199]
    ds_read_b64_tr_b16 v[254:255], v123 offset:56320
    s_waitcnt lgkmcnt(8)
    v_mfma_f32_16x16x32_bf16 v[204:207], v[224:227], a[208:211], v[204:207]
    ds_read_b64_tr_b16 v[96:97], v124 offset:20480
    v_mfma_f32_16x16x32_bf16 v[204:207], v[228:231], a[212:215], v[204:207]
    ds_read_b64_tr_b16 v[98:99], v124 offset:25600
    v_mfma_f32_16x16x32_bf16 v[204:207], v[232:235], a[216:219], v[204:207]
    ds_read_b64_tr_b16 v[100:101], v124 offset:30720
    v_mfma_f32_16x16x32_bf16 v[204:207], v[236:239], a[220:223], v[204:207]
    ds_read_b64_tr_b16 v[102:103], v124 offset:35840
    buffer_load_dwordx4 a[12:15], v1, s[8:11], s5 offen offset:3072 sc1
    v_mfma_f32_16x16x32_bf16 v[200:203], v[236:239], a[204:207], v[200:203]
    ds_read_b64_tr_b16 v[104:105], v124 offset:40960
    v_mfma_f32_16x16x32_bf16 v[200:203], v[232:235], a[200:203], v[200:203]
    ds_read_b64_tr_b16 v[106:107], v124 offset:46080
    v_mfma_f32_16x16x32_bf16 v[200:203], v[228:231], a[196:199], v[200:203]
    ds_read_b64_tr_b16 v[108:109], v124 offset:51200
    v_mfma_f32_16x16x32_bf16 v[200:203], v[224:227], a[192:195], v[200:203]
    ds_read_b64_tr_b16 v[110:111], v124 offset:56320
    s_waitcnt lgkmcnt(8)
    v_mfma_f32_16x16x32_bf16 v[128:131], v[240:243], a[224:227], v[128:131]
    ds_read_b64_tr_b16 v[208:209], v123 offset:20544
    ds_write_b128 v18, v[2:5] offset:0
    v_mfma_f32_16x16x32_bf16 v[128:131], v[244:247], a[228:231], v[128:131]
    ds_read_b64_tr_b16 v[210:211], v123 offset:25664
    v_mfma_f32_16x16x32_bf16 v[128:131], v[248:251], a[232:235], v[128:131]
    ds_read_b64_tr_b16 v[212:213], v123 offset:30784
    s_add_u32 s5, s80, 50348032
    v_mfma_f32_16x16x32_bf16 v[128:131], v[252:255], a[236:239], v[128:131]
    ds_read_b64_tr_b16 v[214:215], v123 offset:35904
    buffer_load_dwordx4 a[20:23], v1, s[8:11], s5 offen offset:1024 sc1
    v_mfma_f32_16x16x32_bf16 v[132:135], v[252:255], a[252:255], v[132:135]
    ds_read_b64_tr_b16 v[216:217], v123 offset:41024
    v_mfma_f32_16x16x32_bf16 v[132:135], v[248:251], a[248:251], v[132:135]
    ds_read_b64_tr_b16 v[218:219], v123 offset:46144
    v_mfma_f32_16x16x32_bf16 v[132:135], v[244:247], a[244:247], v[132:135]
    ds_read_b64_tr_b16 v[220:221], v123 offset:51264
    v_mfma_f32_16x16x32_bf16 v[132:135], v[240:243], a[240:243], v[132:135]
    ds_read_b64_tr_b16 v[222:223], v123 offset:56384
    s_waitcnt lgkmcnt(8)
    v_mfma_f32_16x16x32_bf16 v[140:143], v[96:99], a[240:243], v[140:143]
    ds_read_b64_tr_b16 v[224:225], v124 offset:20544
    ds_write_b128 v18, v[30:33] offset:5120
    v_mfma_f32_16x16x32_bf16 v[140:143], v[100:103], a[244:247], v[140:143]
    ds_read_b64_tr_b16 v[226:227], v124 offset:25664
    v_mfma_f32_16x16x32_bf16 v[140:143], v[104:107], a[248:251], v[140:143]
    ds_read_b64_tr_b16 v[228:229], v124 offset:30784
    v_mfma_f32_16x16x32_bf16 v[140:143], v[108:111], a[252:255], v[140:143]
    ds_read_b64_tr_b16 v[230:231], v124 offset:35904
    buffer_load_dwordx4 a[24:27], v1, s[8:11], s5 offen offset:2048 sc1
    v_mfma_f32_16x16x32_bf16 v[136:139], v[108:111], a[236:239], v[136:139]
    ds_read_b64_tr_b16 v[232:233], v124 offset:41024
    v_mfma_f32_16x16x32_bf16 v[136:139], v[104:107], a[232:235], v[136:139]
    ds_read_b64_tr_b16 v[234:235], v124 offset:46144
    v_mfma_f32_16x16x32_bf16 v[136:139], v[100:103], a[228:231], v[136:139]
    ds_read_b64_tr_b16 v[236:237], v124 offset:51264
    v_mfma_f32_16x16x32_bf16 v[136:139], v[96:99], a[224:227], v[136:139]
    ds_read_b64_tr_b16 v[238:239], v124 offset:56384
    s_waitcnt lgkmcnt(8)
    v_mfma_f32_16x16x32_bf16 v[144:147], v[208:211], a[224:227], v[144:147]
    ds_read_b64_tr_b16 v[240:241], v123 offset:20608
    ds_write_b128 v18, v[6:9] offset:1024
    v_mfma_f32_16x16x32_bf16 v[144:147], v[212:215], a[228:231], v[144:147]
    ds_read_b64_tr_b16 v[242:243], v123 offset:25728
    v_mfma_f32_16x16x32_bf16 v[144:147], v[216:219], a[232:235], v[144:147]
    ds_read_b64_tr_b16 v[244:245], v123 offset:30848
    v_mfma_f32_16x16x32_bf16 v[144:147], v[220:223], a[236:239], v[144:147]
    ds_read_b64_tr_b16 v[246:247], v123 offset:35968
    buffer_load_dwordx4 a[28:31], v1, s[8:11], s5 offen offset:3072 sc1
    v_mfma_f32_16x16x32_bf16 v[148:151], v[220:223], a[252:255], v[148:151]
    ds_read_b64_tr_b16 v[248:249], v123 offset:41088
    v_mfma_f32_16x16x32_bf16 v[148:151], v[216:219], a[248:251], v[148:151]
    ds_read_b64_tr_b16 v[250:251], v123 offset:46208
    v_mfma_f32_16x16x32_bf16 v[148:151], v[212:215], a[244:247], v[148:151]
    ds_read_b64_tr_b16 v[252:253], v123 offset:51328
    v_mfma_f32_16x16x32_bf16 v[148:151], v[208:211], a[240:243], v[148:151]
    ds_read_b64_tr_b16 v[254:255], v123 offset:56448
    s_waitcnt lgkmcnt(8)
    v_mfma_f32_16x16x32_bf16 v[156:159], v[224:227], a[240:243], v[156:159]
    ds_read_b64_tr_b16 v[96:97], v124 offset:20608
    ds_write_b128 v18, v[34:37] offset:6144
    v_mfma_f32_16x16x32_bf16 v[156:159], v[228:231], a[244:247], v[156:159]
    ds_read_b64_tr_b16 v[98:99], v124 offset:25728
    v_mfma_f32_16x16x32_bf16 v[156:159], v[232:235], a[248:251], v[156:159]
    ds_read_b64_tr_b16 v[100:101], v124 offset:30848
    s_add_u32 s5, s80, 50364416
    v_mfma_f32_16x16x32_bf16 v[156:159], v[236:239], a[252:255], v[156:159]
    ds_read_b64_tr_b16 v[102:103], v124 offset:35968
    buffer_load_dwordx4 a[36:39], v1, s[12:15], s5 offen offset:1024 sc1
    v_mfma_f32_16x16x32_bf16 v[152:155], v[236:239], a[236:239], v[152:155]
    ds_read_b64_tr_b16 v[104:105], v124 offset:41088
    v_mfma_f32_16x16x32_bf16 v[152:155], v[232:235], a[232:235], v[152:155]
    ds_read_b64_tr_b16 v[106:107], v124 offset:46208
    v_mfma_f32_16x16x32_bf16 v[152:155], v[228:231], a[228:231], v[152:155]
    ds_read_b64_tr_b16 v[108:109], v124 offset:51328
    v_mfma_f32_16x16x32_bf16 v[152:155], v[224:227], a[224:227], v[152:155]
    ds_read_b64_tr_b16 v[110:111], v124 offset:56448
    s_waitcnt lgkmcnt(8)
    v_mfma_f32_16x16x32_bf16 v[160:163], v[240:243], a[224:227], v[160:163]
    ds_read_b64_tr_b16 v[208:209], v123 offset:20672
    ds_write_b128 v18, v[10:13] offset:2048
    v_mfma_f32_16x16x32_bf16 v[160:163], v[244:247], a[228:231], v[160:163]
    ds_read_b64_tr_b16 v[210:211], v123 offset:25792
    v_mfma_f32_16x16x32_bf16 v[160:163], v[248:251], a[232:235], v[160:163]
    ds_read_b64_tr_b16 v[212:213], v123 offset:30912
    v_mfma_f32_16x16x32_bf16 v[160:163], v[252:255], a[236:239], v[160:163]
    ds_read_b64_tr_b16 v[214:215], v123 offset:36032
    buffer_load_dwordx4 a[40:43], v1, s[12:15], s5 offen offset:2048 sc1
    v_mfma_f32_16x16x32_bf16 v[164:167], v[252:255], a[252:255], v[164:167]
    ds_read_b64_tr_b16 v[216:217], v123 offset:41152
    v_mfma_f32_16x16x32_bf16 v[164:167], v[248:251], a[248:251], v[164:167]
    ds_read_b64_tr_b16 v[218:219], v123 offset:46272
    v_mfma_f32_16x16x32_bf16 v[164:167], v[244:247], a[244:247], v[164:167]
    ds_read_b64_tr_b16 v[220:221], v123 offset:51392
    v_mfma_f32_16x16x32_bf16 v[164:167], v[240:243], a[240:243], v[164:167]
    ds_read_b64_tr_b16 v[222:223], v123 offset:56512
    s_waitcnt lgkmcnt(8)
    v_mfma_f32_16x16x32_bf16 v[172:175], v[96:99], a[240:243], v[172:175]
    ds_read_b64_tr_b16 v[224:225], v124 offset:20672
    ds_write_b128 v18, v[38:41] offset:7168
    v_mfma_f32_16x16x32_bf16 v[172:175], v[100:103], a[244:247], v[172:175]
    ds_read_b64_tr_b16 v[226:227], v124 offset:25792
    v_mfma_f32_16x16x32_bf16 v[172:175], v[104:107], a[248:251], v[172:175]
    ds_read_b64_tr_b16 v[228:229], v124 offset:30912
    v_mfma_f32_16x16x32_bf16 v[172:175], v[108:111], a[252:255], v[172:175]
    ds_read_b64_tr_b16 v[230:231], v124 offset:36032
    buffer_load_dwordx4 a[44:47], v1, s[12:15], s5 offen offset:3072 sc1
    v_mfma_f32_16x16x32_bf16 v[168:171], v[108:111], a[236:239], v[168:171]
    ds_read_b64_tr_b16 v[232:233], v124 offset:41152
    v_mfma_f32_16x16x32_bf16 v[168:171], v[104:107], a[232:235], v[168:171]
    ds_read_b64_tr_b16 v[234:235], v124 offset:46272
    v_mfma_f32_16x16x32_bf16 v[168:171], v[100:103], a[228:231], v[168:171]
    ds_read_b64_tr_b16 v[236:237], v124 offset:51392
    v_mfma_f32_16x16x32_bf16 v[168:171], v[96:99], a[224:227], v[168:171]
    ds_read_b64_tr_b16 v[238:239], v124 offset:56512
    s_waitcnt lgkmcnt(8)
    v_mfma_f32_16x16x32_bf16 v[176:179], v[208:211], a[224:227], v[176:179]
    ds_read_b64_tr_b16 v[240:241], v123 offset:20736
    ds_write_b128 v18, v[14:17] offset:3072
    v_mfma_f32_16x16x32_bf16 v[176:179], v[212:215], a[228:231], v[176:179]
    ds_read_b64_tr_b16 v[242:243], v123 offset:25856
    v_mfma_f32_16x16x32_bf16 v[176:179], v[216:219], a[232:235], v[176:179]
    ds_read_b64_tr_b16 v[244:245], v123 offset:30976
    v_mfma_f32_16x16x32_bf16 v[176:179], v[220:223], a[236:239], v[176:179]
    ds_read_b64_tr_b16 v[246:247], v123 offset:36096
    v_mfma_f32_16x16x32_bf16 v[180:183], v[220:223], a[252:255], v[180:183]
    ds_read_b64_tr_b16 v[248:249], v123 offset:41216
    v_mfma_f32_16x16x32_bf16 v[180:183], v[216:219], a[248:251], v[180:183]
    ds_read_b64_tr_b16 v[250:251], v123 offset:46336
    v_mfma_f32_16x16x32_bf16 v[180:183], v[212:215], a[244:247], v[180:183]
    ds_read_b64_tr_b16 v[252:253], v123 offset:51456
    v_mfma_f32_16x16x32_bf16 v[180:183], v[208:211], a[240:243], v[180:183]
    ds_read_b64_tr_b16 v[254:255], v123 offset:56576
    s_waitcnt lgkmcnt(8)
    v_mfma_f32_16x16x32_bf16 v[188:191], v[224:227], a[240:243], v[188:191]
    ds_read_b64_tr_b16 v[96:97], v124 offset:20736
    ds_write_b128 v18, v[42:45] offset:8192
    v_mfma_f32_16x16x32_bf16 v[188:191], v[228:231], a[244:247], v[188:191]
    ds_read_b64_tr_b16 v[98:99], v124 offset:25856
    v_mfma_f32_16x16x32_bf16 v[188:191], v[232:235], a[248:251], v[188:191]
    ds_read_b64_tr_b16 v[100:101], v124 offset:30976
    v_mfma_f32_16x16x32_bf16 v[188:191], v[236:239], a[252:255], v[188:191]
    ds_read_b64_tr_b16 v[102:103], v124 offset:36096
    v_mfma_f32_16x16x32_bf16 v[184:187], v[236:239], a[236:239], v[184:187]
    ds_read_b64_tr_b16 v[104:105], v124 offset:41216
    v_mfma_f32_16x16x32_bf16 v[184:187], v[232:235], a[232:235], v[184:187]
    ds_read_b64_tr_b16 v[106:107], v124 offset:46336
    v_mfma_f32_16x16x32_bf16 v[184:187], v[228:231], a[228:231], v[184:187]
    ds_read_b64_tr_b16 v[108:109], v124 offset:51456
    v_mfma_f32_16x16x32_bf16 v[184:187], v[224:227], a[224:227], v[184:187]
    ds_read_b64_tr_b16 v[110:111], v124 offset:56576
    s_waitcnt vmcnt(17) lgkmcnt(8)
    s_barrier
    v_mfma_f32_16x16x32_bf16 v[192:195], v[240:243], a[224:227], v[192:195]
    ds_read_b64_tr_b16 v[208:209], v125 offset:0
    ds_write_b128 v18, v[26:29] offset:4096
    v_mfma_f32_16x16x32_bf16 v[192:195], v[244:247], a[228:231], v[192:195]
    ds_read_b64_tr_b16 v[210:211], v125 offset:5120
    v_mfma_f32_16x16x32_bf16 v[192:195], v[248:251], a[232:235], v[192:195]
    ds_read_b64_tr_b16 v[212:213], v125 offset:10240
    v_mfma_f32_16x16x32_bf16 v[192:195], v[252:255], a[236:239], v[192:195]
    ds_read_b64_tr_b16 v[214:215], v125 offset:15360
    v_mfma_f32_16x16x32_bf16 v[196:199], v[252:255], a[252:255], v[196:199]
    ds_read_b64_tr_b16 v[216:217], v125 offset:20480
    v_mfma_f32_16x16x32_bf16 v[196:199], v[248:251], a[248:251], v[196:199]
    ds_read_b64_tr_b16 v[218:219], v125 offset:25600
    v_mfma_f32_16x16x32_bf16 v[196:199], v[244:247], a[244:247], v[196:199]
    ds_read_b64_tr_b16 v[220:221], v125 offset:30720
    v_mfma_f32_16x16x32_bf16 v[196:199], v[240:243], a[240:243], v[196:199]
    ds_read_b64_tr_b16 v[222:223], v125 offset:35840
    s_waitcnt lgkmcnt(8)
    v_mfma_f32_16x16x32_bf16 v[204:207], v[96:99], a[240:243], v[204:207]
    ds_read_b64_tr_b16 v[224:225], v126 offset:0
    ds_write_b128 v18, v[46:49] offset:9216
    v_mfma_f32_16x16x32_bf16 v[204:207], v[100:103], a[244:247], v[204:207]
    ds_read_b64_tr_b16 v[226:227], v126 offset:5120
    v_mfma_f32_16x16x32_bf16 v[204:207], v[104:107], a[248:251], v[204:207]
    ds_read_b64_tr_b16 v[228:229], v126 offset:10240
    v_mfma_f32_16x16x32_bf16 v[204:207], v[108:111], a[252:255], v[204:207]
    ds_read_b64_tr_b16 v[230:231], v126 offset:15360
    v_mfma_f32_16x16x32_bf16 v[200:203], v[108:111], a[236:239], v[200:203]
    ds_read_b64_tr_b16 v[232:233], v126 offset:20480
    v_mfma_f32_16x16x32_bf16 v[200:203], v[104:107], a[232:235], v[200:203]
    ds_read_b64_tr_b16 v[234:235], v126 offset:25600
    v_mfma_f32_16x16x32_bf16 v[200:203], v[100:103], a[228:231], v[200:203]
    ds_read_b64_tr_b16 v[236:237], v126 offset:30720
    v_mfma_f32_16x16x32_bf16 v[200:203], v[96:99], a[224:227], v[200:203]
    ds_read_b64_tr_b16 v[238:239], v126 offset:35840
    s_waitcnt vmcnt(7) lgkmcnt(8)
    v_mfma_f32_16x16x32_bf16 v[128:131], v[208:211], a[160:163], v[128:131]
    ds_read_b64_tr_b16 v[240:241], v125 offset:64
    v_mfma_f32_16x16x32_bf16 v[128:131], v[212:215], a[164:167], v[128:131]
    ds_read_b64_tr_b16 v[242:243], v125 offset:5184
    v_mfma_f32_16x16x32_bf16 v[128:131], v[216:219], a[168:171], v[128:131]
    ds_read_b64_tr_b16 v[244:245], v125 offset:10304
    v_mfma_f32_16x16x32_bf16 v[128:131], v[220:223], a[172:175], v[128:131]
    ds_read_b64_tr_b16 v[246:247], v125 offset:15424
    buffer_load_dwordx4 v[64:67], v127, s[52:55], s44 offen
    v_mfma_f32_16x16x32_bf16 v[132:135], v[220:223], a[188:191], v[132:135]
    ds_read_b64_tr_b16 v[248:249], v125 offset:20544
    v_mfma_f32_16x16x32_bf16 v[132:135], v[216:219], a[184:187], v[132:135]
    ds_read_b64_tr_b16 v[250:251], v125 offset:25664
    v_mfma_f32_16x16x32_bf16 v[132:135], v[212:215], a[180:183], v[132:135]
    ds_read_b64_tr_b16 v[252:253], v125 offset:30784
    v_mfma_f32_16x16x32_bf16 v[132:135], v[208:211], a[176:179], v[132:135]
    ds_read_b64_tr_b16 v[254:255], v125 offset:35904
    s_waitcnt lgkmcnt(8)
    v_mfma_f32_16x16x32_bf16 v[140:143], v[224:227], a[176:179], v[140:143]
    ds_read_b64_tr_b16 v[96:97], v126 offset:64
    v_mfma_f32_16x16x32_bf16 v[140:143], v[228:231], a[180:183], v[140:143]
    ds_read_b64_tr_b16 v[98:99], v126 offset:5184
    v_mfma_f32_16x16x32_bf16 v[140:143], v[232:235], a[184:187], v[140:143]
    ds_read_b64_tr_b16 v[100:101], v126 offset:10304
    v_mfma_f32_16x16x32_bf16 v[140:143], v[236:239], a[188:191], v[140:143]
    ds_read_b64_tr_b16 v[102:103], v126 offset:15424
    buffer_load_dwordx4 v[68:71], v127, s[52:55], s45 offen
    v_mfma_f32_16x16x32_bf16 v[136:139], v[236:239], a[172:175], v[136:139]
    ds_read_b64_tr_b16 v[104:105], v126 offset:20544
    v_mfma_f32_16x16x32_bf16 v[136:139], v[232:235], a[168:171], v[136:139]
    ds_read_b64_tr_b16 v[106:107], v126 offset:25664
    v_mfma_f32_16x16x32_bf16 v[136:139], v[228:231], a[164:167], v[136:139]
    ds_read_b64_tr_b16 v[108:109], v126 offset:30784
    v_mfma_f32_16x16x32_bf16 v[136:139], v[224:227], a[160:163], v[136:139]
    ds_read_b64_tr_b16 v[110:111], v126 offset:35904
    s_waitcnt lgkmcnt(8)
    v_mfma_f32_16x16x32_bf16 v[144:147], v[240:243], a[160:163], v[144:147]
    ds_read_b64_tr_b16 v[208:209], v125 offset:128
    v_mfma_f32_16x16x32_bf16 v[144:147], v[244:247], a[164:167], v[144:147]
    ds_read_b64_tr_b16 v[210:211], v125 offset:5248
    v_mfma_f32_16x16x32_bf16 v[144:147], v[248:251], a[168:171], v[144:147]
    ds_read_b64_tr_b16 v[212:213], v125 offset:10368
    v_mfma_f32_16x16x32_bf16 v[144:147], v[252:255], a[172:175], v[144:147]
    ds_read_b64_tr_b16 v[214:215], v125 offset:15488
    buffer_load_dwordx4 v[72:75], v127, s[52:55], s46 offen
    v_mfma_f32_16x16x32_bf16 v[148:151], v[252:255], a[188:191], v[148:151]
    ds_read_b64_tr_b16 v[216:217], v125 offset:20608
    v_mfma_f32_16x16x32_bf16 v[148:151], v[248:251], a[184:187], v[148:151]
    ds_read_b64_tr_b16 v[218:219], v125 offset:25728
    v_mfma_f32_16x16x32_bf16 v[148:151], v[244:247], a[180:183], v[148:151]
    ds_read_b64_tr_b16 v[220:221], v125 offset:30848
    v_mfma_f32_16x16x32_bf16 v[148:151], v[240:243], a[176:179], v[148:151]
    ds_read_b64_tr_b16 v[222:223], v125 offset:35968
    s_waitcnt lgkmcnt(8)
    v_mfma_f32_16x16x32_bf16 v[156:159], v[96:99], a[176:179], v[156:159]
    ds_read_b64_tr_b16 v[224:225], v126 offset:128
    v_cvt_pk_bf16_f32 v2, v128, v129
    v_cvt_pk_bf16_f32 v3, v130, v131
    v_mfma_f32_16x16x32_bf16 v[156:159], v[100:103], a[180:183], v[156:159]
    ds_read_b64_tr_b16 v[226:227], v126 offset:5248
    v_cvt_pk_bf16_f32 v4, v136, v137
    v_cvt_pk_bf16_f32 v5, v138, v139
    v_mfma_f32_16x16x32_bf16 v[156:159], v[104:107], a[184:187], v[156:159]
    ds_read_b64_tr_b16 v[228:229], v126 offset:10368
    s_add_u32 s4, s79, 29360128
    buffer_store_dwordx4 v[2:5], v1, s[20:23], s4 offen sc1
    v_mfma_f32_16x16x32_bf16 v[156:159], v[108:111], a[188:191], v[156:159]
    ds_read_b64_tr_b16 v[230:231], v126 offset:15488
    ds_write_b128 v18, v[2:5] offset:40960
    v_cvt_pk_bf16_f32 v30, v132, v133
    v_mfma_f32_16x16x32_bf16 v[152:155], v[108:111], a[172:175], v[152:155]
    ds_read_b64_tr_b16 v[232:233], v126 offset:20608
    v_cvt_pk_bf16_f32 v31, v134, v135
    v_cvt_pk_bf16_f32 v32, v140, v141
    v_mfma_f32_16x16x32_bf16 v[152:155], v[104:107], a[168:171], v[152:155]
    ds_read_b64_tr_b16 v[234:235], v126 offset:25728
    v_cvt_pk_bf16_f32 v33, v142, v143
    s_add_u32 s4, s79, 29380608
    v_mfma_f32_16x16x32_bf16 v[152:155], v[100:103], a[164:167], v[152:155]
    ds_read_b64_tr_b16 v[236:237], v126 offset:30848
    buffer_store_dwordx4 v[30:33], v1, s[20:23], s4 offen sc1
    ds_write_b128 v18, v[30:33] offset:46080
    v_mfma_f32_16x16x32_bf16 v[152:155], v[96:99], a[160:163], v[152:155]
    ds_read_b64_tr_b16 v[238:239], v126 offset:35968
    s_waitcnt lgkmcnt(8)
    v_mfma_f32_16x16x32_bf16 v[160:163], v[208:211], a[160:163], v[160:163]
    ds_read_b64_tr_b16 v[240:241], v125 offset:192
    v_mfma_f32_16x16x32_bf16 v[160:163], v[212:215], a[164:167], v[160:163]
    ds_read_b64_tr_b16 v[242:243], v125 offset:5312
    v_mfma_f32_16x16x32_bf16 v[160:163], v[216:219], a[168:171], v[160:163]
    ds_read_b64_tr_b16 v[244:245], v125 offset:10432
    v_mfma_f32_16x16x32_bf16 v[160:163], v[220:223], a[172:175], v[160:163]
    ds_read_b64_tr_b16 v[246:247], v125 offset:15552
    v_mfma_f32_16x16x32_bf16 v[164:167], v[220:223], a[188:191], v[164:167]
    ds_read_b64_tr_b16 v[248:249], v125 offset:20672
    v_mfma_f32_16x16x32_bf16 v[164:167], v[216:219], a[184:187], v[164:167]
    ds_read_b64_tr_b16 v[250:251], v125 offset:25792
    v_mfma_f32_16x16x32_bf16 v[164:167], v[212:215], a[180:183], v[164:167]
    ds_read_b64_tr_b16 v[252:253], v125 offset:30912
    v_mfma_f32_16x16x32_bf16 v[164:167], v[208:211], a[176:179], v[164:167]
    ds_read_b64_tr_b16 v[254:255], v125 offset:36032
    s_waitcnt lgkmcnt(8)
    v_mfma_f32_16x16x32_bf16 v[172:175], v[224:227], a[176:179], v[172:175]
    ds_read_b64_tr_b16 v[96:97], v126 offset:192
    v_cvt_pk_bf16_f32 v6, v144, v145
    v_cvt_pk_bf16_f32 v7, v146, v147
    v_mfma_f32_16x16x32_bf16 v[172:175], v[228:231], a[180:183], v[172:175]
    ds_read_b64_tr_b16 v[98:99], v126 offset:5312
    v_cvt_pk_bf16_f32 v8, v152, v153
    v_cvt_pk_bf16_f32 v9, v154, v155
    v_mfma_f32_16x16x32_bf16 v[172:175], v[232:235], a[184:187], v[172:175]
    ds_read_b64_tr_b16 v[100:101], v126 offset:10432
    s_add_u32 s4, s79, 29364224
    buffer_store_dwordx4 v[6:9], v1, s[20:23], s4 offen sc1
    v_mfma_f32_16x16x32_bf16 v[172:175], v[236:239], a[188:191], v[172:175]
    ds_read_b64_tr_b16 v[102:103], v126 offset:15552
    ds_write_b128 v18, v[6:9] offset:41984
    v_cvt_pk_bf16_f32 v34, v148, v149
    v_mfma_f32_16x16x32_bf16 v[168:171], v[236:239], a[172:175], v[168:171]
    ds_read_b64_tr_b16 v[104:105], v126 offset:20672
    v_cvt_pk_bf16_f32 v35, v150, v151
    v_cvt_pk_bf16_f32 v36, v156, v157
    v_mfma_f32_16x16x32_bf16 v[168:171], v[232:235], a[168:171], v[168:171]
    ds_read_b64_tr_b16 v[106:107], v126 offset:25792
    v_cvt_pk_bf16_f32 v37, v158, v159
    s_add_u32 s4, s79, 29384704
    v_mfma_f32_16x16x32_bf16 v[168:171], v[228:231], a[164:167], v[168:171]
    ds_read_b64_tr_b16 v[108:109], v126 offset:30912
    buffer_store_dwordx4 v[34:37], v1, s[20:23], s4 offen sc1
    ds_write_b128 v18, v[34:37] offset:47104
    v_mfma_f32_16x16x32_bf16 v[168:171], v[224:227], a[160:163], v[168:171]
    ds_read_b64_tr_b16 v[110:111], v126 offset:36032
    s_waitcnt lgkmcnt(8)
    v_mfma_f32_16x16x32_bf16 v[176:179], v[240:243], a[160:163], v[176:179]
    ds_read_b64_tr_b16 v[208:209], v125 offset:256
    v_mfma_f32_16x16x32_bf16 v[176:179], v[244:247], a[164:167], v[176:179]
    ds_read_b64_tr_b16 v[210:211], v125 offset:5376
    v_mfma_f32_16x16x32_bf16 v[176:179], v[248:251], a[168:171], v[176:179]
    ds_read_b64_tr_b16 v[212:213], v125 offset:10496
    v_mfma_f32_16x16x32_bf16 v[176:179], v[252:255], a[172:175], v[176:179]
    ds_read_b64_tr_b16 v[214:215], v125 offset:15616
    v_mfma_f32_16x16x32_bf16 v[180:183], v[252:255], a[188:191], v[180:183]
    ds_read_b64_tr_b16 v[216:217], v125 offset:20736
    v_mfma_f32_16x16x32_bf16 v[180:183], v[248:251], a[184:187], v[180:183]
    ds_read_b64_tr_b16 v[218:219], v125 offset:25856
    v_mfma_f32_16x16x32_bf16 v[180:183], v[244:247], a[180:183], v[180:183]
    ds_read_b64_tr_b16 v[220:221], v125 offset:30976
    v_mfma_f32_16x16x32_bf16 v[180:183], v[240:243], a[176:179], v[180:183]
    ds_read_b64_tr_b16 v[222:223], v125 offset:36096
    s_waitcnt lgkmcnt(8)
    v_mfma_f32_16x16x32_bf16 v[188:191], v[96:99], a[176:179], v[188:191]
    ds_read_b64_tr_b16 v[224:225], v126 offset:256
    v_cvt_pk_bf16_f32 v10, v160, v161
    v_cvt_pk_bf16_f32 v11, v162, v163
    v_mfma_f32_16x16x32_bf16 v[188:191], v[100:103], a[180:183], v[188:191]
    ds_read_b64_tr_b16 v[226:227], v126 offset:5376
    v_cvt_pk_bf16_f32 v12, v168, v169
    v_cvt_pk_bf16_f32 v13, v170, v171
    v_mfma_f32_16x16x32_bf16 v[188:191], v[104:107], a[184:187], v[188:191]
    ds_read_b64_tr_b16 v[228:229], v126 offset:10496
    s_add_u32 s4, s79, 29368320
    buffer_store_dwordx4 v[10:13], v1, s[20:23], s4 offen sc1
    v_mfma_f32_16x16x32_bf16 v[188:191], v[108:111], a[188:191], v[188:191]
    ds_read_b64_tr_b16 v[230:231], v126 offset:15616
    ds_write_b128 v18, v[10:13] offset:43008
    v_cvt_pk_bf16_f32 v38, v164, v165
    v_mfma_f32_16x16x32_bf16 v[184:187], v[108:111], a[172:175], v[184:187]
    ds_read_b64_tr_b16 v[232:233], v126 offset:20736
    v_cvt_pk_bf16_f32 v39, v166, v167
    v_cvt_pk_bf16_f32 v40, v172, v173
    v_mfma_f32_16x16x32_bf16 v[184:187], v[104:107], a[168:171], v[184:187]
    ds_read_b64_tr_b16 v[234:235], v126 offset:25856
    v_cvt_pk_bf16_f32 v41, v174, v175
    s_add_u32 s4, s79, 29388800
    v_mfma_f32_16x16x32_bf16 v[184:187], v[100:103], a[164:167], v[184:187]
    ds_read_b64_tr_b16 v[236:237], v126 offset:30976
    buffer_store_dwordx4 v[38:41], v1, s[20:23], s4 offen sc1
    ds_write_b128 v18, v[38:41] offset:48128
    v_mfma_f32_16x16x32_bf16 v[184:187], v[96:99], a[160:163], v[184:187]
    ds_read_b64_tr_b16 v[238:239], v126 offset:36096
    s_waitcnt lgkmcnt(8)
    v_mfma_f32_16x16x32_bf16 v[192:195], v[208:211], a[160:163], v[192:195]
    v_mfma_f32_16x16x32_bf16 v[192:195], v[212:215], a[164:167], v[192:195]
    v_mfma_f32_16x16x32_bf16 v[192:195], v[216:219], a[168:171], v[192:195]
    v_mfma_f32_16x16x32_bf16 v[192:195], v[220:223], a[172:175], v[192:195]
    v_mfma_f32_16x16x32_bf16 v[196:199], v[220:223], a[188:191], v[196:199]
    v_mfma_f32_16x16x32_bf16 v[196:199], v[216:219], a[184:187], v[196:199]
    v_mfma_f32_16x16x32_bf16 v[196:199], v[212:215], a[180:183], v[196:199]
    v_mfma_f32_16x16x32_bf16 v[196:199], v[208:211], a[176:179], v[196:199]
    s_waitcnt lgkmcnt(0)
    v_mfma_f32_16x16x32_bf16 v[204:207], v[224:227], a[176:179], v[204:207]
    v_cvt_pk_bf16_f32 v14, v176, v177
    v_cvt_pk_bf16_f32 v15, v178, v179
    v_cvt_pk_bf16_f32 v16, v184, v185
    v_mfma_f32_16x16x32_bf16 v[204:207], v[228:231], a[180:183], v[204:207]
    v_cvt_pk_bf16_f32 v17, v186, v187
    s_add_u32 s4, s79, 29372416
    buffer_store_dwordx4 v[14:17], v1, s[20:23], s4 offen sc1
    v_mfma_f32_16x16x32_bf16 v[204:207], v[232:235], a[184:187], v[204:207]
    ds_write_b128 v18, v[14:17] offset:44032
    v_cvt_pk_bf16_f32 v42, v180, v181
    v_cvt_pk_bf16_f32 v43, v182, v183
    v_mfma_f32_16x16x32_bf16 v[204:207], v[236:239], a[188:191], v[204:207]
    v_cvt_pk_bf16_f32 v44, v188, v189
    v_cvt_pk_bf16_f32 v45, v190, v191
    s_add_u32 s4, s79, 29392896
    v_mfma_f32_16x16x32_bf16 v[200:203], v[236:239], a[172:175], v[200:203]
    buffer_store_dwordx4 v[42:45], v1, s[20:23], s4 offen sc1
    ds_write_b128 v18, v[42:45] offset:49152
    v_mfma_f32_16x16x32_bf16 v[200:203], v[232:235], a[168:171], v[200:203]
    v_mfma_f32_16x16x32_bf16 v[200:203], v[228:231], a[164:167], v[200:203]
    v_mfma_f32_16x16x32_bf16 v[200:203], v[224:227], a[160:163], v[200:203]
    s_waitcnt lgkmcnt(0)
    s_nop 4
    v_cvt_pk_bf16_f32 v26, v192, v193
    v_cvt_pk_bf16_f32 v27, v194, v195
    v_cvt_pk_bf16_f32 v28, v200, v201
    v_cvt_pk_bf16_f32 v29, v202, v203
    s_add_u32 s4, s79, 29376512
    buffer_store_dwordx4 v[26:29], v1, s[20:23], s4 offen sc1
    ds_write_b128 v18, v[26:29] offset:45056
    v_cvt_pk_bf16_f32 v46, v196, v197
    v_cvt_pk_bf16_f32 v47, v198, v199
    v_cvt_pk_bf16_f32 v48, v204, v205
    v_cvt_pk_bf16_f32 v49, v206, v207
    s_add_u32 s4, s79, 29396992
    buffer_store_dwordx4 v[46:49], v1, s[20:23], s4 offen sc1
    ds_write_b128 v18, v[46:49] offset:50176
    s_waitcnt vmcnt(10) lgkmcnt(0)
    s_barrier
    ds_read_b128 a[0:3], v19 offset:0
    ds_read_b128 a[16:19], v19 offset:4096
    ds_read_b128 a[32:35], v19 offset:8192
    ds_read_b128 a[48:51], v19 offset:40960
    ds_read_b128 a[64:67], v19 offset:45056
    ds_read_b128 a[80:83], v19 offset:49152
    s_add_u32 s47, s47, 0x20000
    s_mov_b32 s5, 0xbfb8aa3b
    s_waitcnt lgkmcnt(0)
    v_mfma_f32_16x16x32_bf16 v[88:91], v[80:83], a[0:3], 0
    v_mfma_f32_16x16x32_bf16 v[88:91], v[80:83], a[4:7], v[88:91]
    v_mfma_f32_16x16x32_bf16 v[88:91], v[80:83], a[8:11], v[88:91]
    v_mfma_f32_16x16x32_bf16 v[88:91], v[80:83], a[12:15], v[88:91]
    v_mfma_f32_16x16x32_bf16 v[92:95], v[84:87], a[0:3], 0
    v_mfma_f32_16x16x32_bf16 v[92:95], v[84:87], a[4:7], v[92:95]
    v_mfma_f32_16x16x32_bf16 v[92:95], v[84:87], a[8:11], v[92:95]
    v_mfma_f32_16x16x32_bf16 v[92:95], v[84:87], a[12:15], v[92:95]
    v_mfma_f32_16x16x32_bf16 v[26:29], v[80:83], a[16:19], 0
    v_mfma_f32_16x16x32_bf16 v[26:29], v[80:83], a[20:23], v[26:29]
    v_mfma_f32_16x16x32_bf16 v[26:29], v[80:83], a[24:27], v[26:29]
    v_mfma_f32_16x16x32_bf16 v[26:29], v[80:83], a[28:31], v[26:29]
    v_mfma_f32_16x16x32_bf16 v[30:33], v[84:87], a[16:19], 0
    v_mfma_f32_16x16x32_bf16 v[30:33], v[84:87], a[20:23], v[30:33]
    v_mfma_f32_16x16x32_bf16 v[30:33], v[84:87], a[24:27], v[30:33]
    v_mfma_f32_16x16x32_bf16 v[30:33], v[84:87], a[28:31], v[30:33]
    v_mfma_f32_16x16x32_bf16 v[44:47], v[80:83], a[32:35], 0
    v_mfma_f32_16x16x32_bf16 v[44:47], v[80:83], a[36:39], v[44:47]
    v_mfma_f32_16x16x32_bf16 v[44:47], v[80:83], a[40:43], v[44:47]
    v_mfma_f32_16x16x32_bf16 v[44:47], v[80:83], a[44:47], v[44:47]
    v_mfma_f32_16x16x32_bf16 v[48:51], v[84:87], a[32:35], 0
    v_mfma_f32_16x16x32_bf16 v[48:51], v[84:87], a[36:39], v[48:51]
    v_mfma_f32_16x16x32_bf16 v[48:51], v[84:87], a[40:43], v[48:51]
    v_mfma_f32_16x16x32_bf16 v[48:51], v[84:87], a[44:47], v[48:51]
    s_waitcnt vmcnt(0)
    s_add_u32 s72, s51, 524288
    buffer_store_dwordx2 v[58:59], v57, s[8:11], s72 offen sc1
    v_lshlrev_b32 v136, 16, v64
    v_and_b32 v137, 0xffff0000, v64
    v_lshlrev_b32 v138, 16, v65
    v_and_b32 v139, 0xffff0000, v65
    v_lshlrev_b32 v140, 16, v66
    v_and_b32 v141, 0xffff0000, v66
    v_lshlrev_b32 v142, 16, v67
    v_and_b32 v143, 0xffff0000, v67
    v_lshlrev_b32 v144, 16, v68
    v_and_b32 v145, 0xffff0000, v68
    v_lshlrev_b32 v146, 16, v69
    v_and_b32 v147, 0xffff0000, v69
    v_lshlrev_b32 v148, 16, v70
    v_and_b32 v149, 0xffff0000, v70
    v_lshlrev_b32 v150, 16, v71
    v_and_b32 v151, 0xffff0000, v71
    v_lshlrev_b32 v152, 16, v72
    v_and_b32 v153, 0xffff0000, v72
    v_lshlrev_b32 v154, 16, v73
    v_and_b32 v155, 0xffff0000, v73
    v_lshlrev_b32 v156, 16, v74
    v_and_b32 v157, 0xffff0000, v74
    v_lshlrev_b32 v158, 16, v75
    v_and_b32 v159, 0xffff0000, v75
    v_mul_f32 v192, s5, v88
    v_mul_f32 v193, s5, v89
    v_mul_f32 v194, s5, v90
    v_mul_f32 v195, s5, v91
    v_mul_f32 v196, s5, v92
    v_mul_f32 v197, s5, v93
    v_mul_f32 v198, s5, v94
    v_mul_f32 v199, s5, v95
    v_mul_f32 v200, s5, v26
    v_mul_f32 v201, s5, v27
    v_mul_f32 v202, s5, v28
    v_mul_f32 v203, s5, v29
    v_mul_f32 v204, s5, v30
    v_mul_f32 v205, s5, v31
    v_mul_f32 v206, s5, v32
    v_mul_f32 v207, s5, v33
    v_mul_f32 v208, s5, v44
    v_mul_f32 v209, s5, v45
    v_mul_f32 v210, s5, v46
    v_mul_f32 v211, s5, v47
    v_mul_f32 v212, s5, v48
    v_mul_f32 v213, s5, v49
    v_mul_f32 v214, s5, v50
    v_mul_f32 v215, s5, v51
    v_exp_f32 v192, v192
    v_exp_f32 v193, v193
    v_exp_f32 v194, v194
    v_exp_f32 v195, v195
    v_exp_f32 v196, v196
    v_exp_f32 v197, v197
    v_exp_f32 v198, v198
    v_exp_f32 v199, v199
    v_exp_f32 v200, v200
    v_exp_f32 v201, v201
    v_exp_f32 v202, v202
    v_exp_f32 v203, v203
    v_exp_f32 v204, v204
    v_exp_f32 v205, v205
    v_exp_f32 v206, v206
    v_exp_f32 v207, v207
    v_exp_f32 v208, v208
    v_exp_f32 v209, v209
    v_exp_f32 v210, v210
    v_exp_f32 v211, v211
    v_exp_f32 v212, v212
    v_exp_f32 v213, v213
    v_exp_f32 v214, v214
    v_exp_f32 v215, v215
    buffer_load_dwordx2 v[114:115], v113, s[8:11], s47 offen sc1
    v_add_f32 v192, 1.0, v192
    v_add_f32 v193, 1.0, v193
    v_add_f32 v194, 1.0, v194
    v_add_f32 v195, 1.0, v195
    v_add_f32 v196, 1.0, v196
    v_add_f32 v197, 1.0, v197
    v_add_f32 v198, 1.0, v198
    v_add_f32 v199, 1.0, v199
    v_add_f32 v200, 1.0, v200
    v_add_f32 v201, 1.0, v201
    v_add_f32 v202, 1.0, v202
    v_add_f32 v203, 1.0, v203
    v_add_f32 v204, 1.0, v204
    v_add_f32 v205, 1.0, v205
    v_add_f32 v206, 1.0, v206
    v_add_f32 v207, 1.0, v207
    v_add_f32 v208, 1.0, v208
    v_add_f32 v209, 1.0, v209
    v_add_f32 v210, 1.0, v210
    v_add_f32 v211, 1.0, v211
    v_add_f32 v212, 1.0, v212
    v_add_f32 v213, 1.0, v213
    v_add_f32 v214, 1.0, v214
    v_add_f32 v215, 1.0, v215
    v_rcp_f32 v192, v192
    v_rcp_f32 v193, v193
    v_rcp_f32 v194, v194
    v_rcp_f32 v195, v195
    v_rcp_f32 v196, v196
    v_rcp_f32 v197, v197
    v_rcp_f32 v198, v198
    v_rcp_f32 v199, v199
    v_rcp_f32 v200, v200
    v_rcp_f32 v201, v201
    v_rcp_f32 v202, v202
    v_rcp_f32 v203, v203
    v_rcp_f32 v204, v204
    v_rcp_f32 v205, v205
    v_rcp_f32 v206, v206
    v_rcp_f32 v207, v207
    v_rcp_f32 v208, v208
    v_rcp_f32 v209, v209
    v_rcp_f32 v210, v210
    v_rcp_f32 v211, v211
    v_rcp_f32 v212, v212
    v_rcp_f32 v213, v213
    v_rcp_f32 v214, v214
    v_rcp_f32 v215, v215
    v_mul_f32 v192, v192, v88
    v_mul_f32 v193, v193, v89
    v_mul_f32 v194, v194, v90
    v_mul_f32 v195, v195, v91
    v_mul_f32 v196, v196, v92
    v_mul_f32 v197, v197, v93
    v_mul_f32 v198, v198, v94
    v_mul_f32 v199, v199, v95
    v_mul_f32 v200, v200, v26
    v_mul_f32 v201, v201, v27
    v_mul_f32 v202, v202, v28
    v_mul_f32 v203, v203, v29
    v_mul_f32 v204, v204, v30
    v_mul_f32 v205, v205, v31
    v_mul_f32 v206, v206, v32
    v_mul_f32 v207, v207, v33
    v_mul_f32 v208, v208, v44
    v_mul_f32 v209, v209, v45
    v_mul_f32 v210, v210, v46
    v_mul_f32 v211, v211, v47
    v_mul_f32 v212, v212, v48
    v_mul_f32 v213, v213, v49
    v_mul_f32 v214, v214, v50
    v_mul_f32 v215, v215, v51
    s_waitcnt vmcnt(0)
    v_cmp_ne_u64 vcc, s[38:39], v[114:115]
    s_mov_b32 s42, 0
    s_cbranch_vccz Lpok4
Lspin4:
    buffer_load_dwordx2 v[114:115], v113, s[8:11], s47 offen sc1
    s_add_u32 s42, s42, 1
    s_waitcnt vmcnt(0)
    v_cmp_ne_u64 vcc, s[38:39], v[114:115]
    s_cmp_ge_u32 s42, 0x100000
    s_cbranch_scc1 Lpok4
    s_cbranch_vccnz Lspin4
Lpok4:
    s_add_u32 s5, s80, 29360128
    buffer_load_dwordx4 a[52:55], v1, s[8:11], s5 offen offset:1024 sc1
    buffer_load_dwordx4 a[56:59], v1, s[8:11], s5 offen offset:2048 sc1
    buffer_load_dwordx4 a[60:63], v1, s[8:11], s5 offen offset:3072 sc1
    s_add_u32 s5, s80, 29376512
    buffer_load_dwordx4 a[68:71], v1, s[8:11], s5 offen offset:1024 sc1
    buffer_load_dwordx4 a[72:75], v1, s[8:11], s5 offen offset:2048 sc1
    buffer_load_dwordx4 a[76:79], v1, s[8:11], s5 offen offset:3072 sc1
    s_add_u32 s5, s80, 29392896
    buffer_load_dwordx4 a[84:87], v1, s[12:15], s5 offen offset:1024 sc1
    buffer_load_dwordx4 a[88:91], v1, s[12:15], s5 offen offset:2048 sc1
    buffer_load_dwordx4 a[92:95], v1, s[12:15], s5 offen offset:3072 sc1
    s_waitcnt vmcnt(6) lgkmcnt(0)
    v_mfma_f32_16x16x32_bf16 v[160:163], v[80:83], a[48:51], 0
    v_mfma_f32_16x16x32_bf16 v[160:163], v[80:83], a[52:55], v[160:163]
    v_mfma_f32_16x16x32_bf16 v[160:163], v[80:83], a[56:59], v[160:163]
    v_mfma_f32_16x16x32_bf16 v[160:163], v[80:83], a[60:63], v[160:163]
    v_mfma_f32_16x16x32_bf16 v[164:167], v[84:87], a[48:51], 0
    v_mfma_f32_16x16x32_bf16 v[164:167], v[84:87], a[52:55], v[164:167]
    v_mfma_f32_16x16x32_bf16 v[164:167], v[84:87], a[56:59], v[164:167]
    v_mfma_f32_16x16x32_bf16 v[164:167], v[84:87], a[60:63], v[164:167]
    s_nop 3
    v_fmac_f32 v136, v160, v192
    v_fmac_f32 v137, v161, v193
    v_fmac_f32 v138, v162, v194
    v_fmac_f32 v139, v163, v195
    v_fmac_f32 v140, v164, v196
    v_fmac_f32 v141, v165, v197
    v_fmac_f32 v142, v166, v198
    v_fmac_f32 v143, v167, v199
    v_cvt_pk_bf16_f32 v64, v136, v137
    v_cvt_pk_bf16_f32 v65, v138, v139
    v_cvt_pk_bf16_f32 v66, v140, v141
    v_cvt_pk_bf16_f32 v67, v142, v143
    buffer_store_dwordx4 v[64:67], v127, s[56:59], s44 offen
    s_waitcnt vmcnt(4) lgkmcnt(0)
    v_mfma_f32_16x16x32_bf16 v[168:171], v[80:83], a[64:67], 0
    v_mfma_f32_16x16x32_bf16 v[168:171], v[80:83], a[68:71], v[168:171]
    v_mfma_f32_16x16x32_bf16 v[168:171], v[80:83], a[72:75], v[168:171]
    v_mfma_f32_16x16x32_bf16 v[168:171], v[80:83], a[76:79], v[168:171]
    v_mfma_f32_16x16x32_bf16 v[172:175], v[84:87], a[64:67], 0
    v_mfma_f32_16x16x32_bf16 v[172:175], v[84:87], a[68:71], v[172:175]
    v_mfma_f32_16x16x32_bf16 v[172:175], v[84:87], a[72:75], v[172:175]
    v_mfma_f32_16x16x32_bf16 v[172:175], v[84:87], a[76:79], v[172:175]
    s_nop 3
    v_fmac_f32 v144, v168, v200
    v_fmac_f32 v145, v169, v201
    v_fmac_f32 v146, v170, v202
    v_fmac_f32 v147, v171, v203
    v_fmac_f32 v148, v172, v204
    v_fmac_f32 v149, v173, v205
    v_fmac_f32 v150, v174, v206
    v_fmac_f32 v151, v175, v207
    v_cvt_pk_bf16_f32 v68, v144, v145
    v_cvt_pk_bf16_f32 v69, v146, v147
    v_cvt_pk_bf16_f32 v70, v148, v149
    v_cvt_pk_bf16_f32 v71, v150, v151
    buffer_store_dwordx4 v[68:71], v127, s[56:59], s45 offen
    s_waitcnt vmcnt(2) lgkmcnt(0)
    v_mfma_f32_16x16x32_bf16 v[176:179], v[80:83], a[80:83], 0
    v_mfma_f32_16x16x32_bf16 v[176:179], v[80:83], a[84:87], v[176:179]
    v_mfma_f32_16x16x32_bf16 v[176:179], v[80:83], a[88:91], v[176:179]
    v_mfma_f32_16x16x32_bf16 v[176:179], v[80:83], a[92:95], v[176:179]
    v_mfma_f32_16x16x32_bf16 v[180:183], v[84:87], a[80:83], 0
    v_mfma_f32_16x16x32_bf16 v[180:183], v[84:87], a[84:87], v[180:183]
    v_mfma_f32_16x16x32_bf16 v[180:183], v[84:87], a[88:91], v[180:183]
    v_mfma_f32_16x16x32_bf16 v[180:183], v[84:87], a[92:95], v[180:183]
    s_nop 3
    v_fmac_f32 v152, v176, v208
    v_fmac_f32 v153, v177, v209
    v_fmac_f32 v154, v178, v210
    v_fmac_f32 v155, v179, v211
    v_fmac_f32 v156, v180, v212
    v_fmac_f32 v157, v181, v213
    v_fmac_f32 v158, v182, v214
    v_fmac_f32 v159, v183, v215
    v_cvt_pk_bf16_f32 v72, v152, v153
    v_cvt_pk_bf16_f32 v73, v154, v155
    v_cvt_pk_bf16_f32 v74, v156, v157
    v_cvt_pk_bf16_f32 v75, v158, v159
    s_cmp_lt_u32 s32, 2
    s_cselect_b32 s58, 2621440, 0
    buffer_store_dwordx4 v[72:75], v127, s[56:59], s46 offen
    s_or_b32 s3, s33, s32
    s_cmp_lg_u32 s3, 0
    s_cbranch_scc1 L_noep
    s_lshl_b32 s3, s34, 7
    s_add_u32 s3, s3, 72351744
    buffer_store_dwordx2 v[58:59], v57, s[8:11], s3 offen
L_noep:
L_end:
    s_endpgm
L_fallback:
    s_waitcnt vmcnt(0)
    s_mov_b32 s41, 1
    s_mov_b32 s36, s50
    s_mov_b32 s42, 0
    v_mov_b32 v36, 0xff800000
    v_mov_b32 v37, 0xff800000
    v_mov_b32 v38, 0xff800000
    v_mov_b32 v39, 0xff800000
L_fb_tile:
    s_barrier
    s_add_u32 m0, s50, 32768
    s_nop 0
    buffer_load_dwordx4 v2, s[24:27], s36 offen offset:0 lds
    buffer_load_dwordx4 v3, s[24:27], s36 offen offset:1024 lds
    buffer_load_dwordx4 v4, s[24:27], s36 offen offset:2048 lds
    buffer_load_dwordx4 v5, s[24:27], s36 offen offset:3072 lds
    s_add_u32 s36, s36, 4096
    s_add_u32 m0, s50, 36864
    s_nop 0
    buffer_load_dwordx4 v2, s[24:27], s36 offen offset:0 lds
    buffer_load_dwordx4 v3, s[24:27], s36 offen offset:1024 lds
    buffer_load_dwordx4 v4, s[24:27], s36 offen offset:2048 lds
    buffer_load_dwordx4 v5, s[24:27], s36 offen offset:3072 lds
    s_add_u32 s36, s36, 28672
    s_waitcnt vmcnt(0)
    s_barrier
    s_mov_b32 s3, 0
    v_mov_b32 v44, v8
    v_mov_b32 v45, v9
    v_mov_b32 v46, v10
    v_mov_b32 v47, v11
L_fb_kt:
    ds_read_b128 a[128:131], v44
    ds_read_b128 a[132:135], v45
    ds_read_b128 a[136:139], v46
    ds_read_b128 a[140:143], v47
    v_add_u32 v44, 4096, v44
    v_add_u32 v45, 4096, v45
    v_add_u32 v46, 4096, v46
    v_add_u32 v47, 4096, v47
    s_waitcnt lgkmcnt(0)
    v_mfma_f32_16x16x32_bf16 v[96:99], a[128:131], a[192:195], 0
    v_mfma_f32_16x16x32_bf16 v[96:99], a[132:135], a[196:199], v[96:99]
    v_mfma_f32_16x16x32_bf16 v[96:99], a[136:139], a[200:203], v[96:99]
    v_mfma_f32_16x16x32_bf16 v[96:99], a[140:143], a[204:207], v[96:99]
    v_mfma_f32_16x16x32_bf16 v[100:103], a[128:131], a[208:211], 0
    v_mfma_f32_16x16x32_bf16 v[100:103], a[132:135], a[212:215], v[100:103]
    v_mfma_f32_16x16x32_bf16 v[100:103], a[136:139], a[216:219], v[100:103]
    v_mfma_f32_16x16x32_bf16 v[100:103], a[140:143], a[220:223], v[100:103]
    v_mfma_f32_16x16x32_bf16 v[104:107], a[128:131], a[224:227], 0
    v_mfma_f32_16x16x32_bf16 v[104:107], a[132:135], a[228:231], v[104:107]
    v_mfma_f32_16x16x32_bf16 v[104:107], a[136:139], a[232:235], v[104:107]
    v_mfma_f32_16x16x32_bf16 v[104:107], a[140:143], a[236:239], v[104:107]
    v_mfma_f32_16x16x32_bf16 v[108:111], a[128:131], a[240:243], 0
    v_mfma_f32_16x16x32_bf16 v[108:111], a[132:135], a[244:247], v[108:111]
    v_mfma_f32_16x16x32_bf16 v[108:111], a[136:139], a[248:251], v[108:111]
    v_mfma_f32_16x16x32_bf16 v[108:111], a[140:143], a[252:255], v[108:111]
    s_nop 7
    v_max3_f32 v36, v36, v96, v97
    v_max3_f32 v36, v36, v98, v99
    v_max3_f32 v37, v37, v100, v101
    v_max3_f32 v37, v37, v102, v103
    v_max3_f32 v38, v38, v104, v105
    v_max3_f32 v38, v38, v106, v107
    v_max3_f32 v39, v39, v108, v109
    v_max3_f32 v39, v39, v110, v111
    s_add_u32 s3, s3, 1
    s_cmp_lt_u32 s3, 8
    s_cbranch_scc1 L_fb_kt
    s_add_u32 s42, s42, 1
    s_cmp_lt_u32 s42, 16
    s_cbranch_scc1 L_fb_tile
    s_barrier
    s_mov_b32 s36, s50
    s_mov_b32 s37, s50
    s_add_u32 m0, s50, 32768
    s_nop 0
    buffer_load_dwordx4 v2, s[24:27], s36 offen offset:0 lds
    buffer_load_dwordx4 v3, s[24:27], s36 offen offset:1024 lds
    buffer_load_dwordx4 v4, s[24:27], s36 offen offset:2048 lds
    buffer_load_dwordx4 v5, s[24:27], s36 offen offset:3072 lds
    s_add_u32 s36, s36, 4096
    s_add_u32 m0, s50, 36864
    s_nop 0
    buffer_load_dwordx4 v2, s[24:27], s36 offen offset:0 lds
    buffer_load_dwordx4 v3, s[24:27], s36 offen offset:1024 lds
    buffer_load_dwordx4 v4, s[24:27], s36 offen offset:2048 lds
    buffer_load_dwordx4 v5, s[24:27], s36 offen offset:3072 lds
    s_add_u32 s36, s36, 28672
    s_add_u32 m0, s50, 65536
    s_nop 0
    buffer_load_dwordx4 v2, s[24:27], s36 offen offset:0 lds
    buffer_load_dwordx4 v3, s[24:27], s36 offen offset:1024 lds
    buffer_load_dwordx4 v4, s[24:27], s36 offen offset:2048 lds
    buffer_load_dwordx4 v5, s[24:27], s36 offen offset:3072 lds
    s_add_u32 s36, s36, 4096
    s_add_u32 m0, s50, 69632
    s_nop 0
    buffer_load_dwordx4 v2, s[24:27], s36 offen offset:0 lds
    buffer_load_dwordx4 v3, s[24:27], s36 offen offset:1024 lds
    buffer_load_dwordx4 v4, s[24:27], s36 offen offset:2048 lds
    buffer_load_dwordx4 v5, s[24:27], s36 offen offset:3072 lds
    s_add_u32 s36, s36, 28672
    s_add_u32 m0, s50, 98304
    s_nop 0
    buffer_load_dwordx4 v6, s[28:31], s37 offen offset:0 lds
    buffer_load_dwordx4 v7, s[28:31], s37 offen offset:1024 lds
    buffer_load_dwordx4 v6, s[28:31], s37 offen offset:2048 lds
    buffer_load_dwordx4 v7, s[28:31], s37 offen offset:3072 lds
    s_add_u32 s37, s37, 4096
    s_add_u32 m0, s50, 102400
    s_nop 0
    buffer_load_dwordx4 v6, s[28:31], s37 offen offset:0 lds
    buffer_load_dwordx4 v7, s[28:31], s37 offen offset:1024 lds
    buffer_load_dwordx4 v6, s[28:31], s37 offen offset:2048 lds
    buffer_load_dwordx4 v7, s[28:31], s37 offen offset:3072 lds
    s_add_u32 s37, s37, 28672
    s_waitcnt vmcnt(0)
    s_barrier
    ds_read_b128 a[128:131], v8 offset:0
    ds_read_b128 a[132:135], v9 offset:0
    ds_read_b128 a[136:139], v10 offset:0
    ds_read_b128 a[140:143], v11 offset:0
    ds_read_b128 a[144:147], v8 offset:4096
    ds_read_b128 a[148:151], v9 offset:4096
    ds_read_b128 a[152:155], v10 offset:4096
    ds_read_b128 a[156:159], v11 offset:4096
    s_waitcnt lgkmcnt(0)
    v_mfma_f32_16x16x32_bf16 v[96:99], a[128:131], a[192:195], 0
    v_mfma_f32_16x16x32_bf16 v[96:99], a[132:135], a[196:199], v[96:99]
    v_mfma_f32_16x16x32_bf16 v[96:99], a[136:139], a[200:203], v[96:99]
    v_mfma_f32_16x16x32_bf16 v[96:99], a[140:143], a[204:207], v[96:99]
    v_mfma_f32_16x16x32_bf16 v[100:103], a[128:131], a[208:211], 0
    v_mfma_f32_16x16x32_bf16 v[100:103], a[132:135], a[212:215], v[100:103]
    v_mfma_f32_16x16x32_bf16 v[100:103], a[136:139], a[216:219], v[100:103]
    v_mfma_f32_16x16x32_bf16 v[100:103], a[140:143], a[220:223], v[100:103]
    v_mfma_f32_16x16x32_bf16 v[104:107], a[128:131], a[224:227], 0
    v_mfma_f32_16x16x32_bf16 v[104:107], a[132:135], a[228:231], v[104:107]
    v_mfma_f32_16x16x32_bf16 v[104:107], a[136:139], a[232:235], v[104:107]
    v_mfma_f32_16x16x32_bf16 v[104:107], a[140:143], a[236:239], v[104:107]
    v_mfma_f32_16x16x32_bf16 v[108:111], a[128:131], a[240:243], 0
    v_mfma_f32_16x16x32_bf16 v[108:111], a[132:135], a[244:247], v[108:111]
    v_mfma_f32_16x16x32_bf16 v[108:111], a[136:139], a[248:251], v[108:111]
    v_mfma_f32_16x16x32_bf16 v[108:111], a[140:143], a[252:255], v[108:111]
    v_mov_b32 v64, 0
    v_mov_b32 v65, 0
    v_mov_b32 v66, 0
    v_mov_b32 v67, 0
    v_mov_b32 v68, 0
    v_mov_b32 v69, 0
    v_mov_b32 v70, 0
    v_mov_b32 v71, 0
    v_mov_b32 v72, 0
    v_mov_b32 v73, 0
    v_mov_b32 v74, 0
    v_mov_b32 v75, 0
    v_mov_b32 v76, 0
    v_mov_b32 v77, 0
    v_mov_b32 v78, 0
    v_mov_b32 v79, 0
    s_mov_b32 s40, 7
    s_mov_b32 s49, 131072
    s_mov_b32 s75, s74
    s_and_b32 s76, s32, 1
    s_lshl_b32 s76, s76, 11
    s_branch L_setm
L_codeend:
.section .rodata,"a"
.p2align 6
.amdhsa_kernel recurrent_scan__gqa_block_cached__glu_gated_swiglu__prompt_kernel
  .amdhsa_next_free_vgpr 512
  .amdhsa_next_free_sgpr 102
  .amdhsa_accum_offset 256
  .amdhsa_group_segment_fixed_size 0
  .amdhsa_kernarg_size 96
  .amdhsa_user_sgpr_count 2
  .amdhsa_user_sgpr_kernarg_segment_ptr 1
  .amdhsa_system_sgpr_workgroup_id_x 1
.end_amdhsa_kernel
```
